```python
import torch

def _softmax(x, axis=-1):
    return torch.softmax(x, dim=axis)

def _gelu(x):
    return torch.nn.functional.gelu(x, approximate='tanh')

def _silu(x):
    return torch.nn.functional.silu(x)

def _sigmoid(x):
    return torch.sigmoid(x)

def _layernorm(x, axis=-1, eps=1e-05):
    m = x.mean(dim=axis, keepdim=True)
    v = x.var(dim=axis, keepdim=True, unbiased=False)
    return (x - m) / torch.sqrt(v + eps)

def _scatter_add(tgt, idx, src, axis=0):
    return tgt.clone().index_add_(axis, idx, src)

def _segment_sum(src, seg, n):
    out = torch.zeros((n,) + src.shape[1:], dtype=src.dtype)
    return out.index_add_(0, seg, src)

def _pad(x, pw):
    flat = tuple((v for pair in reversed(pw) for v in pair))
    return torch.nn.functional.pad(x, flat)
kernel_name = 'recurrent_scan__memory_aug_recurrent_mem_tr__glu_gated_glu__prompt'

def setup_inputs():

    _w = lambda a: (lambda t: t.to(torch.bfloat16) if t.is_floating_point() else t)(torch.as_tensor(a))

    def _A_setup():
        B, S, Dm = (1, 2048, 640)
        H, Dh = (32, 192)
        M, seg = (8, 32)
        seg = min(seg, S)
        S = S // seg * seg
        return {'x': _w((lambda *s: torch.randn(*s, dtype=torch.bfloat16) * 0.05)(B, S, Dm)), 'mem0': _w((lambda *s: torch.randn(*s, dtype=torch.bfloat16) * 0.2)(B, M, Dm)), 'Wq': _w((lambda *s: torch.randn(*s, dtype=torch.bfloat16) * 0.8)(Dm, H, Dh) * Dm ** (-0.5)), 'Wk': _w((lambda *s: torch.randn(*s, dtype=torch.bfloat16) * 0.8)(Dm, H, Dh) * Dm ** (-0.5)), 'Wv': _w((lambda *s: torch.randn(*s, dtype=torch.bfloat16) * 0.2)(Dm, H, Dh) * Dm ** (-0.5)), 'Wo': _w((lambda *s: torch.randn(*s, dtype=torch.bfloat16) * 0.2)(H, Dh, Dm) * (H * Dh) ** (-0.5)), 'seg_len': seg}
    _A_in = _A_setup()

    def _B_setup():
        B, S, D, F = (1, 2048, 640, 1536)
        return {'x': _w((lambda *s: torch.randn(*s, dtype=torch.bfloat16) * 0.05)(B, S, D)), 'w_gate': _w((lambda *s: torch.randn(*s, dtype=torch.bfloat16) * 0.2)(D, F)), 'w_up': _w((lambda *s: torch.randn(*s, dtype=torch.bfloat16) * 0.1)(D, F)), 'w_down': _w((lambda *s: torch.randn(*s, dtype=torch.bfloat16) * 0.1)(F, D))}
    _B_in = _B_setup()
    return {'A_x': _A_in['x'], 'A_mem0': _A_in['mem0'], 'A_Wq': _A_in['Wq'], 'A_Wk': _A_in['Wk'], 'A_Wv': _A_in['Wv'], 'A_Wo': _A_in['Wo'], 'A_seg_len': _A_in['seg_len'], 'B_x': _B_in['x'], 'B_w_gate': _B_in['w_gate'], 'B_w_up': _B_in['w_up'], 'B_w_down': _B_in['w_down']}

def reference(A_x, A_mem0, A_Wq, A_Wk, A_Wv, A_Wo, A_seg_len, B_x, B_w_gate, B_w_up, B_w_down):

    def _A_ref(x, mem0, Wq, Wk, Wv, Wo, seg_len):
        B, S, Dm = x.shape
        H, Dh = (Wq.shape[1], Wq.shape[2])
        M = mem0.shape[1]
        scale = Dh ** (-0.5)
        n_seg = S // seg_len
        L = M + seg_len
        idx = torch.arange(L)
        mask = (idx[:, None] < M) | (idx[:, None] >= idx[None, :])
        mem = mem0
        outs = []
        for s in range(n_seg):
            xs = x[:, s * seg_len:(s + 1) * seg_len, :].clone()
            h = torch.concatenate([mem, xs], axis=1)
            q = torch.einsum('btd,dhe->bhte', h, Wq)
            k = torch.einsum('btd,dhe->bhte', h, Wk)
            v = torch.einsum('btd,dhe->bhte', h, Wv)
            scores = torch.einsum('bhqe,bhke->bhqk', q, k) * scale
            scores = torch.where(mask[None, None], scores, -1000000000.0)
            p = _softmax(scores, axis=-1)
            o = torch.einsum('bhqk,bhke->bhqe', p, v)
            o = torch.einsum('bhte,hed->btd', o, Wo)
            mem = o[:, :M, :].clone()
            outs.append(o[:, M:, :])
        return torch.concatenate(outs, axis=1)

    def _B_ref(x, w_gate, w_up, w_down):
        g = torch.einsum('bsd,df->bsf', x, w_gate)
        u = torch.einsum('bsd,df->bsf', x, w_up)
        h = _sigmoid(g) * u
        return torch.einsum('bsf,fd->bsd', h, w_down)
    x = A_x
    xn = _layernorm(x, axis=-1)
    s = _A_ref(xn, A_mem0, A_Wq, A_Wk, A_Wv, A_Wo, A_seg_len)
    g = _silu(_B_ref(xn, B_w_gate, B_w_up, B_w_down))
    return x + s * g
```

```asm
; @launch kernel=recurrent_scan__memory_aug_recurrent_mem_tr__glu_gated_glu__prompt_kernel grid=(256,1,1) block=(256,1,1) lds=163840
.amdgcn_target "amdgcn-amd-amdhsa--gfx950"
.text
.globl recurrent_scan__memory_aug_recurrent_mem_tr__glu_gated_glu__prompt_kernel
.p2align 8
.type recurrent_scan__memory_aug_recurrent_mem_tr__glu_gated_glu__prompt_kernel,@function
recurrent_scan__memory_aug_recurrent_mem_tr__glu_gated_glu__prompt_kernel:
s_cmp_ge_u32 s2, 256
s_cbranch_scc1 done
s_load_dwordx2 s[84:85], s[0:1], 104
s_load_dwordx2 s[86:87], s[0:1], 96
s_load_dwordx2 s[88:89], s[0:1], 0
s_load_dwordx2 s[90:91], s[0:1], 88
s_load_dwordx4 s[92:95], s[0:1], 16
s_load_dwordx4 s[96:99], s[0:1], 32
s_getreg_b32 s3, hwreg(HW_REG_XCC_ID, 0, 4)
v_lshrrev_b32 v1, 6, v0
v_and_b32 v10, 63, v0
v_readfirstlane_b32 s24, v1
s_waitcnt lgkmcnt(0)
s_mov_b32 s4, s84
s_and_b32 s5, s85, 0xffff
s_mov_b32 s6, 268435456
s_mov_b32 s7, 0x20000
s_mov_b32 s16, s88
s_and_b32 s17, s89, 0xffff
s_mov_b32 s18, 2621440
s_mov_b32 s19, 0x20000
s_mov_b32 s20, s90
s_and_b32 s21, s91, 0xffff
s_mov_b32 s22, 2621440
s_mov_b32 s23, 0x20000
s_mov_b32 s50, -1
s_mov_b32 s51, 0
s_and_b32 s3, s3, 7
s_cmp_eq_u32 s24, 0
s_cbranch_scc0 pro_wait
s_lshl_b32 s40, s3, 2
v_mov_b32 v2, s40
v_mov_b32 v3, 1
v_mov_b32 v5, 32
s_mov_b64 exec, 1
global_atomic_add v4, v2, v3, s[86:87] sc0
s_waitcnt vmcnt(0)
global_atomic_add v5, v3, s[86:87]
v_readfirstlane_b32 s41, v4
s_lshl_b32 s42, s3, 5
s_add_u32 s42, s42, s41
s_cmp_lt_u32 s41, 32
s_cbranch_scc1 pro_have
v_mov_b32 v5, 36
global_atomic_add v6, v5, v3, s[86:87] sc0
s_waitcnt vmcnt(0)
v_readfirstlane_b32 s43, v6
s_mov_b32 s44, 0
pro_ovw:
v_mov_b32 v5, 32
global_load_dword v6, v5, s[86:87] sc1
s_waitcnt vmcnt(0)
v_readfirstlane_b32 s45, v6
s_cmp_ge_u32 s45, 256
s_cbranch_scc1 pro_ovs
s_add_u32 s44, s44, 1
s_cmp_lt_u32 s44, 0x400000
s_cbranch_scc1 pro_ovw
s_mov_b64 exec, -1
s_branch timeout
pro_ovs:
s_mov_b32 s44, 0
pro_ovl:
s_lshl_b32 s45, s44, 2
v_mov_b32 v5, s45
global_load_dword v6, v5, s[86:87] sc1
s_waitcnt vmcnt(0)
v_readfirstlane_b32 s45, v6
s_min_u32 s45, s45, 32
s_sub_u32 s46, 32, s45
s_cmp_lt_u32 s43, s46
s_cbranch_scc1 pro_ovf
s_sub_u32 s43, s43, s46
s_add_u32 s44, s44, 1
s_cmp_lt_u32 s44, 8
s_cbranch_scc1 pro_ovl
s_mov_b64 exec, -1
s_branch timeout
pro_ovf:
s_lshl_b32 s42, s44, 5
s_add_u32 s42, s42, s45
s_add_u32 s42, s42, s43
pro_have:
v_mov_b32 v4, s42
v_mov_b32 v2, 0
ds_write_b32 v2, v4
s_waitcnt lgkmcnt(0)
s_mov_b64 exec, -1
pro_wait:
s_barrier
v_mov_b32 v2, 0
ds_read_b32 v4, v2
s_waitcnt lgkmcnt(0)
v_readfirstlane_b32 s42, v4
s_barrier
s_cmp_eq_u32 s42, 94
s_cbranch_scc0 nocal
s_cmp_eq_u32 s24, 0
s_cbranch_scc0 cal_done
s_mov_b64 exec, 1
v_mov_b32 v2, 0
s_mov_b32 s44, 0
s_mov_b32 s45, 20480
s_mov_b32 s56, -1
s_memtime s[46:47]
s_waitcnt lgkmcnt(0)
buffer_store_dword v2, off, s[4:7], s45 sc1
s_waitcnt vmcnt(0)
s_memtime s[52:53]
s_waitcnt lgkmcnt(0)
s_memtime s[46:47]
s_waitcnt lgkmcnt(0)
buffer_store_dword v2, off, s[4:7], s45 sc1
s_waitcnt vmcnt(0)
s_memtime s[52:53]
s_waitcnt lgkmcnt(0)
s_sub_u32 s46, s52, s46
s_min_u32 s56, s56, s46
s_memtime s[46:47]
s_waitcnt lgkmcnt(0)
buffer_store_dword v2, off, s[4:7], s45 sc1
s_waitcnt vmcnt(0)
s_memtime s[52:53]
s_waitcnt lgkmcnt(0)
s_sub_u32 s46, s52, s46
s_min_u32 s56, s56, s46
s_memtime s[46:47]
s_waitcnt lgkmcnt(0)
buffer_store_dword v2, off, s[4:7], s45 sc1
s_waitcnt vmcnt(0)
s_memtime s[52:53]
s_waitcnt lgkmcnt(0)
s_sub_u32 s46, s52, s46
s_min_u32 s56, s56, s46
s_memtime s[46:47]
s_waitcnt lgkmcnt(0)
buffer_store_dword v2, off, s[4:7], s45 sc1
s_waitcnt vmcnt(0)
s_memtime s[52:53]
s_waitcnt lgkmcnt(0)
s_sub_u32 s46, s52, s46
s_min_u32 s56, s56, s46
s_mov_b32 s45, 28672
s_mov_b32 s57, -1
s_memtime s[46:47]
s_waitcnt lgkmcnt(0)
buffer_store_dword v2, off, s[4:7], s45 sc1
s_waitcnt vmcnt(0)
s_memtime s[52:53]
s_waitcnt lgkmcnt(0)
s_memtime s[46:47]
s_waitcnt lgkmcnt(0)
buffer_store_dword v2, off, s[4:7], s45 sc1
s_waitcnt vmcnt(0)
s_memtime s[52:53]
s_waitcnt lgkmcnt(0)
s_sub_u32 s46, s52, s46
s_min_u32 s57, s57, s46
s_memtime s[46:47]
s_waitcnt lgkmcnt(0)
buffer_store_dword v2, off, s[4:7], s45 sc1
s_waitcnt vmcnt(0)
s_memtime s[52:53]
s_waitcnt lgkmcnt(0)
s_sub_u32 s46, s52, s46
s_min_u32 s57, s57, s46
s_memtime s[46:47]
s_waitcnt lgkmcnt(0)
buffer_store_dword v2, off, s[4:7], s45 sc1
s_waitcnt vmcnt(0)
s_memtime s[52:53]
s_waitcnt lgkmcnt(0)
s_sub_u32 s46, s52, s46
s_min_u32 s57, s57, s46
s_memtime s[46:47]
s_waitcnt lgkmcnt(0)
buffer_store_dword v2, off, s[4:7], s45 sc1
s_waitcnt vmcnt(0)
s_memtime s[52:53]
s_waitcnt lgkmcnt(0)
s_sub_u32 s46, s52, s46
s_min_u32 s57, s57, s46
s_cmp_lt_u32 s57, s56
s_cselect_b32 s45, 1, 0
s_or_b32 s44, s44, s45
s_mov_b32 s45, 2117632
s_mov_b32 s56, -1
s_memtime s[46:47]
s_waitcnt lgkmcnt(0)
buffer_store_dword v2, off, s[4:7], s45 sc1
s_waitcnt vmcnt(0)
s_memtime s[52:53]
s_waitcnt lgkmcnt(0)
s_memtime s[46:47]
s_waitcnt lgkmcnt(0)
buffer_store_dword v2, off, s[4:7], s45 sc1
s_waitcnt vmcnt(0)
s_memtime s[52:53]
s_waitcnt lgkmcnt(0)
s_sub_u32 s46, s52, s46
s_min_u32 s56, s56, s46
s_memtime s[46:47]
s_waitcnt lgkmcnt(0)
buffer_store_dword v2, off, s[4:7], s45 sc1
s_waitcnt vmcnt(0)
s_memtime s[52:53]
s_waitcnt lgkmcnt(0)
s_sub_u32 s46, s52, s46
s_min_u32 s56, s56, s46
s_memtime s[46:47]
s_waitcnt lgkmcnt(0)
buffer_store_dword v2, off, s[4:7], s45 sc1
s_waitcnt vmcnt(0)
s_memtime s[52:53]
s_waitcnt lgkmcnt(0)
s_sub_u32 s46, s52, s46
s_min_u32 s56, s56, s46
s_memtime s[46:47]
s_waitcnt lgkmcnt(0)
buffer_store_dword v2, off, s[4:7], s45 sc1
s_waitcnt vmcnt(0)
s_memtime s[52:53]
s_waitcnt lgkmcnt(0)
s_sub_u32 s46, s52, s46
s_min_u32 s56, s56, s46
s_mov_b32 s45, 2125824
s_mov_b32 s57, -1
s_memtime s[46:47]
s_waitcnt lgkmcnt(0)
buffer_store_dword v2, off, s[4:7], s45 sc1
s_waitcnt vmcnt(0)
s_memtime s[52:53]
s_waitcnt lgkmcnt(0)
s_memtime s[46:47]
s_waitcnt lgkmcnt(0)
buffer_store_dword v2, off, s[4:7], s45 sc1
s_waitcnt vmcnt(0)
s_memtime s[52:53]
s_waitcnt lgkmcnt(0)
s_sub_u32 s46, s52, s46
s_min_u32 s57, s57, s46
s_memtime s[46:47]
s_waitcnt lgkmcnt(0)
buffer_store_dword v2, off, s[4:7], s45 sc1
s_waitcnt vmcnt(0)
s_memtime s[52:53]
s_waitcnt lgkmcnt(0)
s_sub_u32 s46, s52, s46
s_min_u32 s57, s57, s46
s_memtime s[46:47]
s_waitcnt lgkmcnt(0)
buffer_store_dword v2, off, s[4:7], s45 sc1
s_waitcnt vmcnt(0)
s_memtime s[52:53]
s_waitcnt lgkmcnt(0)
s_sub_u32 s46, s52, s46
s_min_u32 s57, s57, s46
s_memtime s[46:47]
s_waitcnt lgkmcnt(0)
buffer_store_dword v2, off, s[4:7], s45 sc1
s_waitcnt vmcnt(0)
s_memtime s[52:53]
s_waitcnt lgkmcnt(0)
s_sub_u32 s46, s52, s46
s_min_u32 s57, s57, s46
s_cmp_lt_u32 s57, s56
s_cselect_b32 s45, 2, 0
s_or_b32 s44, s44, s45
s_add_u32 s44, s44, 0x100
v_mov_b32 v3, s44
v_mov_b32 v2, 40
global_store_dword v2, v3, s[86:87] sc1
s_waitcnt vmcnt(0)
s_mov_b64 exec, -1
cal_done:
s_branch role_w
nocal:
s_cmp_ge_u32 s42, 128
s_cbranch_scc1 role_w
s_cmp_lt_u32 s42, 64
s_cbranch_scc1 placed
s_and_b32 s41, s42, 31
s_cmp_ge_u32 s41, 30
s_cbranch_scc1 role_w
s_lshr_b32 s43, s42, 5
s_sub_u32 s43, s43, 2
s_cmp_ge_u32 s41, 20
s_cbranch_scc1 role_w
s_mul_i32 s43, s43, 20
s_add_u32 s42, s43, s41
s_add_u32 s42, s42, 64
placed:
s_lshl_b32 s48, s42, 11
s_add_u32 s48, s48, 201392128
s_cmp_lt_u32 s42, 32
s_cbranch_scc1 role_qk
s_cmp_lt_u32 s42, 64
s_cbranch_scc1 role_vo
s_branch role_r
role_qk:
s_mov_b32 s25, s42
s_mov_b32 s8, s92
s_and_b32 s9, s93, 0xffff
s_mov_b32 s10, 7864320
s_mov_b32 s11, 0x20000
s_mov_b32 s12, s94
s_and_b32 s13, s95, 0xffff
s_mov_b32 s14, 7864320
s_mov_b32 s15, 0x20000
s_mul_i32 s49, s24, 6144
s_lshl_b32 s40, s24, 4
v_add_u32 v24, 0, v10
v_mul_u32_u24 v25, 2731, v24
v_lshrrev_b32 v25, 16, v25
v_mul_u32_u24 v26, 24, v25
v_sub_u32 v26, v24, v26
v_and_b32 v27, 2, v25
v_bfe_u32 v28, v25, 3, 1
v_lshl_add_u32 v27, v28, 2, v27
v_xor_b32 v26, v26, v27
v_lshlrev_b32 v26, 4, v26
v_add_u32 v25, s40, v25
v_mul_u32_u24 v25, 12288, v25
v_add_u32 v16, v25, v26
v_add_u32 v24, 64, v10
v_mul_u32_u24 v25, 2731, v24
v_lshrrev_b32 v25, 16, v25
v_mul_u32_u24 v26, 24, v25
v_sub_u32 v26, v24, v26
v_and_b32 v27, 2, v25
v_bfe_u32 v28, v25, 3, 1
v_lshl_add_u32 v27, v28, 2, v27
v_xor_b32 v26, v26, v27
v_lshlrev_b32 v26, 4, v26
v_add_u32 v25, s40, v25
v_mul_u32_u24 v25, 12288, v25
v_add_u32 v17, v25, v26
v_add_u32 v24, 128, v10
v_mul_u32_u24 v25, 2731, v24
v_lshrrev_b32 v25, 16, v25
v_mul_u32_u24 v26, 24, v25
v_sub_u32 v26, v24, v26
v_and_b32 v27, 2, v25
v_bfe_u32 v28, v25, 3, 1
v_lshl_add_u32 v27, v28, 2, v27
v_xor_b32 v26, v26, v27
v_lshlrev_b32 v26, 4, v26
v_add_u32 v25, s40, v25
v_mul_u32_u24 v25, 12288, v25
v_add_u32 v18, v25, v26
v_add_u32 v24, 192, v10
v_mul_u32_u24 v25, 2731, v24
v_lshrrev_b32 v25, 16, v25
v_mul_u32_u24 v26, 24, v25
v_sub_u32 v26, v24, v26
v_and_b32 v27, 2, v25
v_bfe_u32 v28, v25, 3, 1
v_lshl_add_u32 v27, v28, 2, v27
v_xor_b32 v26, v26, v27
v_lshlrev_b32 v26, 4, v26
v_add_u32 v25, s40, v25
v_mul_u32_u24 v25, 12288, v25
v_add_u32 v19, v25, v26
v_add_u32 v24, 256, v10
v_mul_u32_u24 v25, 2731, v24
v_lshrrev_b32 v25, 16, v25
v_mul_u32_u24 v26, 24, v25
v_sub_u32 v26, v24, v26
v_and_b32 v27, 2, v25
v_bfe_u32 v28, v25, 3, 1
v_lshl_add_u32 v27, v28, 2, v27
v_xor_b32 v26, v26, v27
v_lshlrev_b32 v26, 4, v26
v_add_u32 v25, s40, v25
v_mul_u32_u24 v25, 12288, v25
v_add_u32 v20, v25, v26
v_add_u32 v24, 320, v10
v_mul_u32_u24 v25, 2731, v24
v_lshrrev_b32 v25, 16, v25
v_mul_u32_u24 v26, 24, v25
v_sub_u32 v26, v24, v26
v_and_b32 v27, 2, v25
v_bfe_u32 v28, v25, 3, 1
v_lshl_add_u32 v27, v28, 2, v27
v_xor_b32 v26, v26, v27
v_lshlrev_b32 v26, 4, v26
v_add_u32 v25, s40, v25
v_mul_u32_u24 v25, 12288, v25
v_add_u32 v21, v25, v26
v_lshrrev_b32 v24, 4, v10
v_bfe_u32 v25, v10, 2, 2
v_lshl_add_u32 v26, v24, 3, v25
v_mul_u32_u24 v26, 384, v26
v_and_b32 v27, 3, v10
v_lshl_add_u32 v22, v27, 3, v26
v_lshrrev_b32 v25, 1, v25
v_and_b32 v24, 1, v24
v_lshl_add_u32 v24, v24, 1, v25
v_lshlrev_b32 v23, 5, v24
s_mul_i32 s40, s24, 96
s_add_u32 s40, s40, 0
v_xor_b32 v24, s40, v23
v_add_u32 v24, v24, v22
s_mul_i32 s40, s24, 96
s_add_u32 s40, s40, 32
v_xor_b32 v25, s40, v23
v_add_u32 v25, v25, v22
s_mul_i32 s40, s24, 96
s_add_u32 s40, s40, 64
v_xor_b32 v26, s40, v23
v_add_u32 v26, v26, v22
s_mul_i32 s43, s25, 384
s_add_u32 s43, s43, 0
s_add_u32 m0, s49, 0
s_nop 0
buffer_load_dwordx4 v16, s[8:11], s43 offen lds
s_add_u32 m0, s49, 1024
s_nop 0
buffer_load_dwordx4 v17, s[8:11], s43 offen lds
s_add_u32 m0, s49, 2048
s_nop 0
buffer_load_dwordx4 v18, s[8:11], s43 offen lds
s_add_u32 m0, s49, 3072
s_nop 0
buffer_load_dwordx4 v19, s[8:11], s43 offen lds
s_add_u32 m0, s49, 4096
s_nop 0
buffer_load_dwordx4 v20, s[8:11], s43 offen lds
s_add_u32 m0, s49, 5120
s_nop 0
buffer_load_dwordx4 v21, s[8:11], s43 offen lds
s_mul_i32 s43, s25, 384
s_add_u32 s43, s43, 0
s_add_u32 m0, s49, 24576
s_nop 0
buffer_load_dwordx4 v16, s[12:15], s43 offen lds
s_add_u32 m0, s49, 25600
s_nop 0
buffer_load_dwordx4 v17, s[12:15], s43 offen lds
s_add_u32 m0, s49, 26624
s_nop 0
buffer_load_dwordx4 v18, s[12:15], s43 offen lds
s_add_u32 m0, s49, 27648
s_nop 0
buffer_load_dwordx4 v19, s[12:15], s43 offen lds
s_add_u32 m0, s49, 28672
s_nop 0
buffer_load_dwordx4 v20, s[12:15], s43 offen lds
s_add_u32 m0, s49, 29696
s_nop 0
buffer_load_dwordx4 v21, s[12:15], s43 offen lds
s_mul_i32 s43, s25, 384
s_add_u32 s43, s43, 786432
s_add_u32 m0, s49, 49152
s_nop 0
buffer_load_dwordx4 v16, s[8:11], s43 offen lds
s_add_u32 m0, s49, 50176
s_nop 0
buffer_load_dwordx4 v17, s[8:11], s43 offen lds
s_add_u32 m0, s49, 51200
s_nop 0
buffer_load_dwordx4 v18, s[8:11], s43 offen lds
s_add_u32 m0, s49, 52224
s_nop 0
buffer_load_dwordx4 v19, s[8:11], s43 offen lds
s_add_u32 m0, s49, 53248
s_nop 0
buffer_load_dwordx4 v20, s[8:11], s43 offen lds
s_add_u32 m0, s49, 54272
s_nop 0
buffer_load_dwordx4 v21, s[8:11], s43 offen lds
s_mul_i32 s43, s25, 384
s_add_u32 s43, s43, 786432
s_add_u32 m0, s49, 73728
s_nop 0
buffer_load_dwordx4 v16, s[12:15], s43 offen lds
s_add_u32 m0, s49, 74752
s_nop 0
buffer_load_dwordx4 v17, s[12:15], s43 offen lds
s_add_u32 m0, s49, 75776
s_nop 0
buffer_load_dwordx4 v18, s[12:15], s43 offen lds
s_add_u32 m0, s49, 76800
s_nop 0
buffer_load_dwordx4 v19, s[12:15], s43 offen lds
s_add_u32 m0, s49, 77824
s_nop 0
buffer_load_dwordx4 v20, s[12:15], s43 offen lds
s_add_u32 m0, s49, 78848
s_nop 0
buffer_load_dwordx4 v21, s[12:15], s43 offen lds
s_mul_i32 s43, s25, 384
s_add_u32 s43, s43, 1572864
s_add_u32 m0, s49, 98304
s_nop 0
buffer_load_dwordx4 v16, s[8:11], s43 offen lds
s_add_u32 m0, s49, 99328
s_nop 0
buffer_load_dwordx4 v17, s[8:11], s43 offen lds
s_add_u32 m0, s49, 100352
s_nop 0
buffer_load_dwordx4 v18, s[8:11], s43 offen lds
s_add_u32 m0, s49, 101376
s_nop 0
buffer_load_dwordx4 v19, s[8:11], s43 offen lds
s_add_u32 m0, s49, 102400
s_nop 0
buffer_load_dwordx4 v20, s[8:11], s43 offen lds
s_add_u32 m0, s49, 103424
s_nop 0
buffer_load_dwordx4 v21, s[8:11], s43 offen lds
s_waitcnt vmcnt(24)
s_barrier
s_mul_i32 s43, s25, 384
s_add_u32 s43, s43, 1572864
s_add_u32 m0, s49, 122880
s_nop 0
buffer_load_dwordx4 v16, s[12:15], s43 offen lds
s_add_u32 m0, s49, 123904
s_nop 0
buffer_load_dwordx4 v17, s[12:15], s43 offen lds
s_add_u32 m0, s49, 124928
s_nop 0
buffer_load_dwordx4 v18, s[12:15], s43 offen lds
s_add_u32 m0, s49, 125952
s_nop 0
buffer_load_dwordx4 v19, s[12:15], s43 offen lds
s_add_u32 m0, s49, 126976
s_nop 0
buffer_load_dwordx4 v20, s[12:15], s43 offen lds
s_add_u32 m0, s49, 128000
s_nop 0
buffer_load_dwordx4 v21, s[12:15], s43 offen lds
v_add_u32 v27, 0, v24
v_add_u32 v28, 0, v25
v_add_u32 v29, 0, v26
ds_read_b64_tr_b16 a[0:1], v27 offset:0
ds_read_b64_tr_b16 a[2:3], v27 offset:1536
ds_read_b64_tr_b16 a[4:5], v27 offset:12288
ds_read_b64_tr_b16 a[6:7], v27 offset:13824
ds_read_b64_tr_b16 a[8:9], v28 offset:0
ds_read_b64_tr_b16 a[10:11], v28 offset:1536
ds_read_b64_tr_b16 a[12:13], v28 offset:12288
ds_read_b64_tr_b16 a[14:15], v28 offset:13824
ds_read_b64_tr_b16 a[96:97], v29 offset:0
ds_read_b64_tr_b16 a[98:99], v29 offset:1536
ds_read_b64_tr_b16 a[100:101], v29 offset:12288
ds_read_b64_tr_b16 a[102:103], v29 offset:13824
s_waitcnt vmcnt(24)
s_waitcnt lgkmcnt(0)
s_barrier
s_mul_i32 s43, s25, 384
s_add_u32 s43, s43, 2359296
s_add_u32 m0, s49, 0
s_nop 0
buffer_load_dwordx4 v16, s[8:11], s43 offen lds
s_add_u32 m0, s49, 1024
s_nop 0
buffer_load_dwordx4 v17, s[8:11], s43 offen lds
s_add_u32 m0, s49, 2048
s_nop 0
buffer_load_dwordx4 v18, s[8:11], s43 offen lds
s_add_u32 m0, s49, 3072
s_nop 0
buffer_load_dwordx4 v19, s[8:11], s43 offen lds
s_add_u32 m0, s49, 4096
s_nop 0
buffer_load_dwordx4 v20, s[8:11], s43 offen lds
s_add_u32 m0, s49, 5120
s_nop 0
buffer_load_dwordx4 v21, s[8:11], s43 offen lds
v_add_u32 v27, 0, v24
v_add_u32 v28, 0, v25
v_add_u32 v29, 0, v26
ds_read_b64_tr_b16 a[104:105], v27 offset:24576
ds_read_b64_tr_b16 a[106:107], v27 offset:26112
ds_read_b64_tr_b16 a[108:109], v27 offset:36864
ds_read_b64_tr_b16 a[110:111], v27 offset:38400
ds_read_b64_tr_b16 v[96:97], v28 offset:24576
ds_read_b64_tr_b16 v[98:99], v28 offset:26112
ds_read_b64_tr_b16 v[100:101], v28 offset:36864
ds_read_b64_tr_b16 v[102:103], v28 offset:38400
ds_read_b64_tr_b16 v[104:105], v29 offset:24576
ds_read_b64_tr_b16 v[106:107], v29 offset:26112
ds_read_b64_tr_b16 v[108:109], v29 offset:36864
ds_read_b64_tr_b16 v[110:111], v29 offset:38400
s_waitcnt vmcnt(24)
s_waitcnt lgkmcnt(0)
s_barrier
s_mul_i32 s43, s25, 384
s_add_u32 s43, s43, 2359296
s_add_u32 m0, s49, 24576
s_nop 0
buffer_load_dwordx4 v16, s[12:15], s43 offen lds
s_add_u32 m0, s49, 25600
s_nop 0
buffer_load_dwordx4 v17, s[12:15], s43 offen lds
s_add_u32 m0, s49, 26624
s_nop 0
buffer_load_dwordx4 v18, s[12:15], s43 offen lds
s_add_u32 m0, s49, 27648
s_nop 0
buffer_load_dwordx4 v19, s[12:15], s43 offen lds
s_add_u32 m0, s49, 28672
s_nop 0
buffer_load_dwordx4 v20, s[12:15], s43 offen lds
s_add_u32 m0, s49, 29696
s_nop 0
buffer_load_dwordx4 v21, s[12:15], s43 offen lds
v_add_u32 v27, 49152, v24
v_add_u32 v28, 49152, v25
v_add_u32 v29, 49152, v26
ds_read_b64_tr_b16 a[16:17], v27 offset:0
ds_read_b64_tr_b16 a[18:19], v27 offset:1536
ds_read_b64_tr_b16 a[20:21], v27 offset:12288
ds_read_b64_tr_b16 a[22:23], v27 offset:13824
ds_read_b64_tr_b16 a[24:25], v28 offset:0
ds_read_b64_tr_b16 a[26:27], v28 offset:1536
ds_read_b64_tr_b16 a[28:29], v28 offset:12288
ds_read_b64_tr_b16 a[30:31], v28 offset:13824
ds_read_b64_tr_b16 a[112:113], v29 offset:0
ds_read_b64_tr_b16 a[114:115], v29 offset:1536
ds_read_b64_tr_b16 a[116:117], v29 offset:12288
ds_read_b64_tr_b16 a[118:119], v29 offset:13824
s_waitcnt vmcnt(24)
s_waitcnt lgkmcnt(0)
s_barrier
s_mul_i32 s43, s25, 384
s_add_u32 s43, s43, 3145728
s_add_u32 m0, s49, 49152
s_nop 0
buffer_load_dwordx4 v16, s[8:11], s43 offen lds
s_add_u32 m0, s49, 50176
s_nop 0
buffer_load_dwordx4 v17, s[8:11], s43 offen lds
s_add_u32 m0, s49, 51200
s_nop 0
buffer_load_dwordx4 v18, s[8:11], s43 offen lds
s_add_u32 m0, s49, 52224
s_nop 0
buffer_load_dwordx4 v19, s[8:11], s43 offen lds
s_add_u32 m0, s49, 53248
s_nop 0
buffer_load_dwordx4 v20, s[8:11], s43 offen lds
s_add_u32 m0, s49, 54272
s_nop 0
buffer_load_dwordx4 v21, s[8:11], s43 offen lds
v_add_u32 v27, 49152, v24
v_add_u32 v28, 49152, v25
v_add_u32 v29, 49152, v26
ds_read_b64_tr_b16 a[120:121], v27 offset:24576
ds_read_b64_tr_b16 a[122:123], v27 offset:26112
ds_read_b64_tr_b16 a[124:125], v27 offset:36864
ds_read_b64_tr_b16 a[126:127], v27 offset:38400
ds_read_b64_tr_b16 v[112:113], v28 offset:24576
ds_read_b64_tr_b16 v[114:115], v28 offset:26112
ds_read_b64_tr_b16 v[116:117], v28 offset:36864
ds_read_b64_tr_b16 v[118:119], v28 offset:38400
ds_read_b64_tr_b16 v[120:121], v29 offset:24576
ds_read_b64_tr_b16 v[122:123], v29 offset:26112
ds_read_b64_tr_b16 v[124:125], v29 offset:36864
ds_read_b64_tr_b16 v[126:127], v29 offset:38400
s_waitcnt vmcnt(24)
s_waitcnt lgkmcnt(0)
s_barrier
s_mul_i32 s43, s25, 384
s_add_u32 s43, s43, 3145728
s_add_u32 m0, s49, 73728
s_nop 0
buffer_load_dwordx4 v16, s[12:15], s43 offen lds
s_add_u32 m0, s49, 74752
s_nop 0
buffer_load_dwordx4 v17, s[12:15], s43 offen lds
s_add_u32 m0, s49, 75776
s_nop 0
buffer_load_dwordx4 v18, s[12:15], s43 offen lds
s_add_u32 m0, s49, 76800
s_nop 0
buffer_load_dwordx4 v19, s[12:15], s43 offen lds
s_add_u32 m0, s49, 77824
s_nop 0
buffer_load_dwordx4 v20, s[12:15], s43 offen lds
s_add_u32 m0, s49, 78848
s_nop 0
buffer_load_dwordx4 v21, s[12:15], s43 offen lds
v_add_u32 v27, 98304, v24
v_add_u32 v28, 98304, v25
v_add_u32 v29, 98304, v26
ds_read_b64_tr_b16 a[32:33], v27 offset:0
ds_read_b64_tr_b16 a[34:35], v27 offset:1536
ds_read_b64_tr_b16 a[36:37], v27 offset:12288
ds_read_b64_tr_b16 a[38:39], v27 offset:13824
ds_read_b64_tr_b16 v[32:33], v28 offset:0
ds_read_b64_tr_b16 v[34:35], v28 offset:1536
ds_read_b64_tr_b16 v[36:37], v28 offset:12288
ds_read_b64_tr_b16 v[38:39], v28 offset:13824
ds_read_b64_tr_b16 a[128:129], v29 offset:0
ds_read_b64_tr_b16 a[130:131], v29 offset:1536
ds_read_b64_tr_b16 a[132:133], v29 offset:12288
ds_read_b64_tr_b16 a[134:135], v29 offset:13824
s_waitcnt vmcnt(24)
s_waitcnt lgkmcnt(0)
s_barrier
s_mul_i32 s43, s25, 384
s_add_u32 s43, s43, 3932160
s_add_u32 m0, s49, 98304
s_nop 0
buffer_load_dwordx4 v16, s[8:11], s43 offen lds
s_add_u32 m0, s49, 99328
s_nop 0
buffer_load_dwordx4 v17, s[8:11], s43 offen lds
s_add_u32 m0, s49, 100352
s_nop 0
buffer_load_dwordx4 v18, s[8:11], s43 offen lds
s_add_u32 m0, s49, 101376
s_nop 0
buffer_load_dwordx4 v19, s[8:11], s43 offen lds
s_add_u32 m0, s49, 102400
s_nop 0
buffer_load_dwordx4 v20, s[8:11], s43 offen lds
s_add_u32 m0, s49, 103424
s_nop 0
buffer_load_dwordx4 v21, s[8:11], s43 offen lds
v_add_u32 v27, 98304, v24
v_add_u32 v28, 98304, v25
v_add_u32 v29, 98304, v26
ds_read_b64_tr_b16 a[136:137], v27 offset:24576
ds_read_b64_tr_b16 a[138:139], v27 offset:26112
ds_read_b64_tr_b16 a[140:141], v27 offset:36864
ds_read_b64_tr_b16 a[142:143], v27 offset:38400
ds_read_b64_tr_b16 v[128:129], v28 offset:24576
ds_read_b64_tr_b16 v[130:131], v28 offset:26112
ds_read_b64_tr_b16 v[132:133], v28 offset:36864
ds_read_b64_tr_b16 v[134:135], v28 offset:38400
ds_read_b64_tr_b16 v[136:137], v29 offset:24576
ds_read_b64_tr_b16 v[138:139], v29 offset:26112
ds_read_b64_tr_b16 v[140:141], v29 offset:36864
ds_read_b64_tr_b16 v[142:143], v29 offset:38400
s_waitcnt vmcnt(24)
s_waitcnt lgkmcnt(0)
s_barrier
s_mul_i32 s43, s25, 384
s_add_u32 s43, s43, 3932160
s_add_u32 m0, s49, 122880
s_nop 0
buffer_load_dwordx4 v16, s[12:15], s43 offen lds
s_add_u32 m0, s49, 123904
s_nop 0
buffer_load_dwordx4 v17, s[12:15], s43 offen lds
s_add_u32 m0, s49, 124928
s_nop 0
buffer_load_dwordx4 v18, s[12:15], s43 offen lds
s_add_u32 m0, s49, 125952
s_nop 0
buffer_load_dwordx4 v19, s[12:15], s43 offen lds
s_add_u32 m0, s49, 126976
s_nop 0
buffer_load_dwordx4 v20, s[12:15], s43 offen lds
s_add_u32 m0, s49, 128000
s_nop 0
buffer_load_dwordx4 v21, s[12:15], s43 offen lds
v_add_u32 v27, 0, v24
v_add_u32 v28, 0, v25
v_add_u32 v29, 0, v26
ds_read_b64_tr_b16 a[40:41], v27 offset:0
ds_read_b64_tr_b16 a[42:43], v27 offset:1536
ds_read_b64_tr_b16 a[44:45], v27 offset:12288
ds_read_b64_tr_b16 a[46:47], v27 offset:13824
ds_read_b64_tr_b16 v[40:41], v28 offset:0
ds_read_b64_tr_b16 v[42:43], v28 offset:1536
ds_read_b64_tr_b16 v[44:45], v28 offset:12288
ds_read_b64_tr_b16 v[46:47], v28 offset:13824
ds_read_b64_tr_b16 a[144:145], v29 offset:0
ds_read_b64_tr_b16 a[146:147], v29 offset:1536
ds_read_b64_tr_b16 a[148:149], v29 offset:12288
ds_read_b64_tr_b16 a[150:151], v29 offset:13824
s_waitcnt vmcnt(24)
s_waitcnt lgkmcnt(0)
s_barrier
s_mul_i32 s43, s25, 384
s_add_u32 s43, s43, 4718592
s_add_u32 m0, s49, 0
s_nop 0
buffer_load_dwordx4 v16, s[8:11], s43 offen lds
s_add_u32 m0, s49, 1024
s_nop 0
buffer_load_dwordx4 v17, s[8:11], s43 offen lds
s_add_u32 m0, s49, 2048
s_nop 0
buffer_load_dwordx4 v18, s[8:11], s43 offen lds
s_add_u32 m0, s49, 3072
s_nop 0
buffer_load_dwordx4 v19, s[8:11], s43 offen lds
s_add_u32 m0, s49, 4096
s_nop 0
buffer_load_dwordx4 v20, s[8:11], s43 offen lds
s_add_u32 m0, s49, 5120
s_nop 0
buffer_load_dwordx4 v21, s[8:11], s43 offen lds
v_add_u32 v27, 0, v24
v_add_u32 v28, 0, v25
v_add_u32 v29, 0, v26
ds_read_b64_tr_b16 a[152:153], v27 offset:24576
ds_read_b64_tr_b16 a[154:155], v27 offset:26112
ds_read_b64_tr_b16 a[156:157], v27 offset:36864
ds_read_b64_tr_b16 a[158:159], v27 offset:38400
ds_read_b64_tr_b16 v[144:145], v28 offset:24576
ds_read_b64_tr_b16 v[146:147], v28 offset:26112
ds_read_b64_tr_b16 v[148:149], v28 offset:36864
ds_read_b64_tr_b16 v[150:151], v28 offset:38400
ds_read_b64_tr_b16 v[152:153], v29 offset:24576
ds_read_b64_tr_b16 v[154:155], v29 offset:26112
ds_read_b64_tr_b16 v[156:157], v29 offset:36864
ds_read_b64_tr_b16 v[158:159], v29 offset:38400
s_waitcnt vmcnt(24)
s_waitcnt lgkmcnt(0)
s_barrier
s_mul_i32 s43, s25, 384
s_add_u32 s43, s43, 4718592
s_add_u32 m0, s49, 24576
s_nop 0
buffer_load_dwordx4 v16, s[12:15], s43 offen lds
s_add_u32 m0, s49, 25600
s_nop 0
buffer_load_dwordx4 v17, s[12:15], s43 offen lds
s_add_u32 m0, s49, 26624
s_nop 0
buffer_load_dwordx4 v18, s[12:15], s43 offen lds
s_add_u32 m0, s49, 27648
s_nop 0
buffer_load_dwordx4 v19, s[12:15], s43 offen lds
s_add_u32 m0, s49, 28672
s_nop 0
buffer_load_dwordx4 v20, s[12:15], s43 offen lds
s_add_u32 m0, s49, 29696
s_nop 0
buffer_load_dwordx4 v21, s[12:15], s43 offen lds
v_add_u32 v27, 49152, v24
v_add_u32 v28, 49152, v25
v_add_u32 v29, 49152, v26
ds_read_b64_tr_b16 a[48:49], v27 offset:0
ds_read_b64_tr_b16 a[50:51], v27 offset:1536
ds_read_b64_tr_b16 a[52:53], v27 offset:12288
ds_read_b64_tr_b16 a[54:55], v27 offset:13824
ds_read_b64_tr_b16 v[48:49], v28 offset:0
ds_read_b64_tr_b16 v[50:51], v28 offset:1536
ds_read_b64_tr_b16 v[52:53], v28 offset:12288
ds_read_b64_tr_b16 v[54:55], v28 offset:13824
ds_read_b64_tr_b16 a[160:161], v29 offset:0
ds_read_b64_tr_b16 a[162:163], v29 offset:1536
ds_read_b64_tr_b16 a[164:165], v29 offset:12288
ds_read_b64_tr_b16 a[166:167], v29 offset:13824
s_waitcnt vmcnt(24)
s_waitcnt lgkmcnt(0)
s_barrier
s_mul_i32 s43, s25, 384
s_add_u32 s43, s43, 5505024
s_add_u32 m0, s49, 49152
s_nop 0
buffer_load_dwordx4 v16, s[8:11], s43 offen lds
s_add_u32 m0, s49, 50176
s_nop 0
buffer_load_dwordx4 v17, s[8:11], s43 offen lds
s_add_u32 m0, s49, 51200
s_nop 0
buffer_load_dwordx4 v18, s[8:11], s43 offen lds
s_add_u32 m0, s49, 52224
s_nop 0
buffer_load_dwordx4 v19, s[8:11], s43 offen lds
s_add_u32 m0, s49, 53248
s_nop 0
buffer_load_dwordx4 v20, s[8:11], s43 offen lds
s_add_u32 m0, s49, 54272
s_nop 0
buffer_load_dwordx4 v21, s[8:11], s43 offen lds
v_add_u32 v27, 49152, v24
v_add_u32 v28, 49152, v25
v_add_u32 v29, 49152, v26
ds_read_b64_tr_b16 a[168:169], v27 offset:24576
ds_read_b64_tr_b16 a[170:171], v27 offset:26112
ds_read_b64_tr_b16 a[172:173], v27 offset:36864
ds_read_b64_tr_b16 a[174:175], v27 offset:38400
ds_read_b64_tr_b16 v[160:161], v28 offset:24576
ds_read_b64_tr_b16 v[162:163], v28 offset:26112
ds_read_b64_tr_b16 v[164:165], v28 offset:36864
ds_read_b64_tr_b16 v[166:167], v28 offset:38400
ds_read_b64_tr_b16 v[168:169], v29 offset:24576
ds_read_b64_tr_b16 v[170:171], v29 offset:26112
ds_read_b64_tr_b16 v[172:173], v29 offset:36864
ds_read_b64_tr_b16 v[174:175], v29 offset:38400
s_waitcnt vmcnt(24)
s_waitcnt lgkmcnt(0)
s_barrier
s_mul_i32 s43, s25, 384
s_add_u32 s43, s43, 5505024
s_add_u32 m0, s49, 73728
s_nop 0
buffer_load_dwordx4 v16, s[12:15], s43 offen lds
s_add_u32 m0, s49, 74752
s_nop 0
buffer_load_dwordx4 v17, s[12:15], s43 offen lds
s_add_u32 m0, s49, 75776
s_nop 0
buffer_load_dwordx4 v18, s[12:15], s43 offen lds
s_add_u32 m0, s49, 76800
s_nop 0
buffer_load_dwordx4 v19, s[12:15], s43 offen lds
s_add_u32 m0, s49, 77824
s_nop 0
buffer_load_dwordx4 v20, s[12:15], s43 offen lds
s_add_u32 m0, s49, 78848
s_nop 0
buffer_load_dwordx4 v21, s[12:15], s43 offen lds
v_add_u32 v27, 98304, v24
v_add_u32 v28, 98304, v25
v_add_u32 v29, 98304, v26
ds_read_b64_tr_b16 a[56:57], v27 offset:0
ds_read_b64_tr_b16 a[58:59], v27 offset:1536
ds_read_b64_tr_b16 a[60:61], v27 offset:12288
ds_read_b64_tr_b16 a[62:63], v27 offset:13824
ds_read_b64_tr_b16 v[56:57], v28 offset:0
ds_read_b64_tr_b16 v[58:59], v28 offset:1536
ds_read_b64_tr_b16 v[60:61], v28 offset:12288
ds_read_b64_tr_b16 v[62:63], v28 offset:13824
ds_read_b64_tr_b16 a[176:177], v29 offset:0
ds_read_b64_tr_b16 a[178:179], v29 offset:1536
ds_read_b64_tr_b16 a[180:181], v29 offset:12288
ds_read_b64_tr_b16 a[182:183], v29 offset:13824
s_waitcnt vmcnt(24)
s_waitcnt lgkmcnt(0)
s_barrier
s_mul_i32 s43, s25, 384
s_add_u32 s43, s43, 6291456
s_add_u32 m0, s49, 98304
s_nop 0
buffer_load_dwordx4 v16, s[8:11], s43 offen lds
s_add_u32 m0, s49, 99328
s_nop 0
buffer_load_dwordx4 v17, s[8:11], s43 offen lds
s_add_u32 m0, s49, 100352
s_nop 0
buffer_load_dwordx4 v18, s[8:11], s43 offen lds
s_add_u32 m0, s49, 101376
s_nop 0
buffer_load_dwordx4 v19, s[8:11], s43 offen lds
s_add_u32 m0, s49, 102400
s_nop 0
buffer_load_dwordx4 v20, s[8:11], s43 offen lds
s_add_u32 m0, s49, 103424
s_nop 0
buffer_load_dwordx4 v21, s[8:11], s43 offen lds
v_add_u32 v27, 98304, v24
v_add_u32 v28, 98304, v25
v_add_u32 v29, 98304, v26
ds_read_b64_tr_b16 a[184:185], v27 offset:24576
ds_read_b64_tr_b16 a[186:187], v27 offset:26112
ds_read_b64_tr_b16 a[188:189], v27 offset:36864
ds_read_b64_tr_b16 a[190:191], v27 offset:38400
ds_read_b64_tr_b16 v[176:177], v28 offset:24576
ds_read_b64_tr_b16 v[178:179], v28 offset:26112
ds_read_b64_tr_b16 v[180:181], v28 offset:36864
ds_read_b64_tr_b16 v[182:183], v28 offset:38400
ds_read_b64_tr_b16 v[184:185], v29 offset:24576
ds_read_b64_tr_b16 v[186:187], v29 offset:26112
ds_read_b64_tr_b16 v[188:189], v29 offset:36864
ds_read_b64_tr_b16 v[190:191], v29 offset:38400
s_waitcnt vmcnt(24)
s_waitcnt lgkmcnt(0)
s_barrier
s_mul_i32 s43, s25, 384
s_add_u32 s43, s43, 6291456
s_add_u32 m0, s49, 122880
s_nop 0
buffer_load_dwordx4 v16, s[12:15], s43 offen lds
s_add_u32 m0, s49, 123904
s_nop 0
buffer_load_dwordx4 v17, s[12:15], s43 offen lds
s_add_u32 m0, s49, 124928
s_nop 0
buffer_load_dwordx4 v18, s[12:15], s43 offen lds
s_add_u32 m0, s49, 125952
s_nop 0
buffer_load_dwordx4 v19, s[12:15], s43 offen lds
s_add_u32 m0, s49, 126976
s_nop 0
buffer_load_dwordx4 v20, s[12:15], s43 offen lds
s_add_u32 m0, s49, 128000
s_nop 0
buffer_load_dwordx4 v21, s[12:15], s43 offen lds
v_add_u32 v27, 0, v24
v_add_u32 v28, 0, v25
v_add_u32 v29, 0, v26
ds_read_b64_tr_b16 a[64:65], v27 offset:0
ds_read_b64_tr_b16 a[66:67], v27 offset:1536
ds_read_b64_tr_b16 a[68:69], v27 offset:12288
ds_read_b64_tr_b16 a[70:71], v27 offset:13824
ds_read_b64_tr_b16 v[64:65], v28 offset:0
ds_read_b64_tr_b16 v[66:67], v28 offset:1536
ds_read_b64_tr_b16 v[68:69], v28 offset:12288
ds_read_b64_tr_b16 v[70:71], v28 offset:13824
ds_read_b64_tr_b16 a[192:193], v29 offset:0
ds_read_b64_tr_b16 a[194:195], v29 offset:1536
ds_read_b64_tr_b16 a[196:197], v29 offset:12288
ds_read_b64_tr_b16 a[198:199], v29 offset:13824
s_waitcnt vmcnt(24)
s_waitcnt lgkmcnt(0)
s_barrier
s_mul_i32 s43, s25, 384
s_add_u32 s43, s43, 7077888
s_add_u32 m0, s49, 0
s_nop 0
buffer_load_dwordx4 v16, s[8:11], s43 offen lds
s_add_u32 m0, s49, 1024
s_nop 0
buffer_load_dwordx4 v17, s[8:11], s43 offen lds
s_add_u32 m0, s49, 2048
s_nop 0
buffer_load_dwordx4 v18, s[8:11], s43 offen lds
s_add_u32 m0, s49, 3072
s_nop 0
buffer_load_dwordx4 v19, s[8:11], s43 offen lds
s_add_u32 m0, s49, 4096
s_nop 0
buffer_load_dwordx4 v20, s[8:11], s43 offen lds
s_add_u32 m0, s49, 5120
s_nop 0
buffer_load_dwordx4 v21, s[8:11], s43 offen lds
v_add_u32 v27, 0, v24
v_add_u32 v28, 0, v25
v_add_u32 v29, 0, v26
ds_read_b64_tr_b16 a[200:201], v27 offset:24576
ds_read_b64_tr_b16 a[202:203], v27 offset:26112
ds_read_b64_tr_b16 a[204:205], v27 offset:36864
ds_read_b64_tr_b16 a[206:207], v27 offset:38400
ds_read_b64_tr_b16 v[192:193], v28 offset:24576
ds_read_b64_tr_b16 v[194:195], v28 offset:26112
ds_read_b64_tr_b16 v[196:197], v28 offset:36864
ds_read_b64_tr_b16 v[198:199], v28 offset:38400
ds_read_b64_tr_b16 v[200:201], v29 offset:24576
ds_read_b64_tr_b16 v[202:203], v29 offset:26112
ds_read_b64_tr_b16 v[204:205], v29 offset:36864
ds_read_b64_tr_b16 v[206:207], v29 offset:38400
s_waitcnt vmcnt(24)
s_waitcnt lgkmcnt(0)
s_barrier
s_mul_i32 s43, s25, 384
s_add_u32 s43, s43, 7077888
s_add_u32 m0, s49, 24576
s_nop 0
buffer_load_dwordx4 v16, s[12:15], s43 offen lds
s_add_u32 m0, s49, 25600
s_nop 0
buffer_load_dwordx4 v17, s[12:15], s43 offen lds
s_add_u32 m0, s49, 26624
s_nop 0
buffer_load_dwordx4 v18, s[12:15], s43 offen lds
s_add_u32 m0, s49, 27648
s_nop 0
buffer_load_dwordx4 v19, s[12:15], s43 offen lds
s_add_u32 m0, s49, 28672
s_nop 0
buffer_load_dwordx4 v20, s[12:15], s43 offen lds
s_add_u32 m0, s49, 29696
s_nop 0
buffer_load_dwordx4 v21, s[12:15], s43 offen lds
v_add_u32 v27, 49152, v24
v_add_u32 v28, 49152, v25
v_add_u32 v29, 49152, v26
ds_read_b64_tr_b16 a[72:73], v27 offset:0
ds_read_b64_tr_b16 a[74:75], v27 offset:1536
ds_read_b64_tr_b16 a[76:77], v27 offset:12288
ds_read_b64_tr_b16 a[78:79], v27 offset:13824
ds_read_b64_tr_b16 v[72:73], v28 offset:0
ds_read_b64_tr_b16 v[74:75], v28 offset:1536
ds_read_b64_tr_b16 v[76:77], v28 offset:12288
ds_read_b64_tr_b16 v[78:79], v28 offset:13824
ds_read_b64_tr_b16 a[208:209], v29 offset:0
ds_read_b64_tr_b16 a[210:211], v29 offset:1536
ds_read_b64_tr_b16 a[212:213], v29 offset:12288
ds_read_b64_tr_b16 a[214:215], v29 offset:13824
s_waitcnt vmcnt(24)
s_waitcnt lgkmcnt(0)
s_barrier
v_add_u32 v27, 49152, v24
v_add_u32 v28, 49152, v25
v_add_u32 v29, 49152, v26
ds_read_b64_tr_b16 a[216:217], v27 offset:24576
ds_read_b64_tr_b16 a[218:219], v27 offset:26112
ds_read_b64_tr_b16 a[220:221], v27 offset:36864
ds_read_b64_tr_b16 a[222:223], v27 offset:38400
ds_read_b64_tr_b16 v[208:209], v28 offset:24576
ds_read_b64_tr_b16 v[210:211], v28 offset:26112
ds_read_b64_tr_b16 v[212:213], v28 offset:36864
ds_read_b64_tr_b16 v[214:215], v28 offset:38400
ds_read_b64_tr_b16 v[216:217], v29 offset:24576
ds_read_b64_tr_b16 v[218:219], v29 offset:26112
ds_read_b64_tr_b16 v[220:221], v29 offset:36864
ds_read_b64_tr_b16 v[222:223], v29 offset:38400
s_waitcnt vmcnt(18)
s_waitcnt lgkmcnt(0)
s_barrier
v_add_u32 v27, 98304, v24
v_add_u32 v28, 98304, v25
v_add_u32 v29, 98304, v26
ds_read_b64_tr_b16 a[80:81], v27 offset:0
ds_read_b64_tr_b16 a[82:83], v27 offset:1536
ds_read_b64_tr_b16 a[84:85], v27 offset:12288
ds_read_b64_tr_b16 a[86:87], v27 offset:13824
ds_read_b64_tr_b16 v[80:81], v28 offset:0
ds_read_b64_tr_b16 v[82:83], v28 offset:1536
ds_read_b64_tr_b16 v[84:85], v28 offset:12288
ds_read_b64_tr_b16 v[86:87], v28 offset:13824
ds_read_b64_tr_b16 a[224:225], v29 offset:0
ds_read_b64_tr_b16 a[226:227], v29 offset:1536
ds_read_b64_tr_b16 a[228:229], v29 offset:12288
ds_read_b64_tr_b16 a[230:231], v29 offset:13824
s_waitcnt vmcnt(12)
s_waitcnt lgkmcnt(0)
s_barrier
v_add_u32 v27, 98304, v24
v_add_u32 v28, 98304, v25
v_add_u32 v29, 98304, v26
ds_read_b64_tr_b16 a[232:233], v27 offset:24576
ds_read_b64_tr_b16 a[234:235], v27 offset:26112
ds_read_b64_tr_b16 a[236:237], v27 offset:36864
ds_read_b64_tr_b16 a[238:239], v27 offset:38400
ds_read_b64_tr_b16 v[224:225], v28 offset:24576
ds_read_b64_tr_b16 v[226:227], v28 offset:26112
ds_read_b64_tr_b16 v[228:229], v28 offset:36864
ds_read_b64_tr_b16 v[230:231], v28 offset:38400
ds_read_b64_tr_b16 v[232:233], v29 offset:24576
ds_read_b64_tr_b16 v[234:235], v29 offset:26112
ds_read_b64_tr_b16 v[236:237], v29 offset:36864
ds_read_b64_tr_b16 v[238:239], v29 offset:38400
s_waitcnt vmcnt(6)
s_waitcnt lgkmcnt(0)
s_barrier
v_add_u32 v27, 0, v24
v_add_u32 v28, 0, v25
v_add_u32 v29, 0, v26
ds_read_b64_tr_b16 a[88:89], v27 offset:0
ds_read_b64_tr_b16 a[90:91], v27 offset:1536
ds_read_b64_tr_b16 a[92:93], v27 offset:12288
ds_read_b64_tr_b16 a[94:95], v27 offset:13824
ds_read_b64_tr_b16 v[88:89], v28 offset:0
ds_read_b64_tr_b16 v[90:91], v28 offset:1536
ds_read_b64_tr_b16 v[92:93], v28 offset:12288
ds_read_b64_tr_b16 v[94:95], v28 offset:13824
ds_read_b64_tr_b16 a[240:241], v29 offset:0
ds_read_b64_tr_b16 a[242:243], v29 offset:1536
ds_read_b64_tr_b16 a[244:245], v29 offset:12288
ds_read_b64_tr_b16 a[246:247], v29 offset:13824
s_waitcnt vmcnt(0)
s_waitcnt lgkmcnt(0)
s_barrier
v_add_u32 v27, 0, v24
v_add_u32 v28, 0, v25
v_add_u32 v29, 0, v26
ds_read_b64_tr_b16 a[248:249], v27 offset:24576
ds_read_b64_tr_b16 a[250:251], v27 offset:26112
ds_read_b64_tr_b16 a[252:253], v27 offset:36864
ds_read_b64_tr_b16 a[254:255], v27 offset:38400
ds_read_b64_tr_b16 v[240:241], v28 offset:24576
ds_read_b64_tr_b16 v[242:243], v28 offset:26112
ds_read_b64_tr_b16 v[244:245], v28 offset:36864
ds_read_b64_tr_b16 v[246:247], v28 offset:38400
ds_read_b64_tr_b16 v[248:249], v29 offset:24576
ds_read_b64_tr_b16 v[250:251], v29 offset:26112
ds_read_b64_tr_b16 v[252:253], v29 offset:36864
ds_read_b64_tr_b16 v[254:255], v29 offset:38400
s_waitcnt lgkmcnt(0)
s_lshl_b32 s40, s24, 14
s_add_u32 s40, s40, 65536
v_lshlrev_b32 v11, 4, v10
v_add_u32 v11, s40, v11
s_barrier
ds_write_b128 v11, v[32:35] offset:0
ds_write_b128 v11, v[36:39] offset:1024
ds_write_b128 v11, v[40:43] offset:2048
ds_write_b128 v11, v[44:47] offset:3072
ds_write_b128 v11, v[48:51] offset:4096
ds_write_b128 v11, v[52:55] offset:5120
ds_write_b128 v11, v[56:59] offset:6144
ds_write_b128 v11, v[60:63] offset:7168
ds_write_b128 v11, v[64:67] offset:8192
ds_write_b128 v11, v[68:71] offset:9216
ds_write_b128 v11, v[72:75] offset:10240
ds_write_b128 v11, v[76:79] offset:11264
ds_write_b128 v11, v[80:83] offset:12288
ds_write_b128 v11, v[84:87] offset:13312
ds_write_b128 v11, v[88:91] offset:14336
ds_write_b128 v11, v[92:95] offset:15360
s_waitcnt lgkmcnt(0)
s_mov_b32 s44, 0
qk_gp:
v_mov_b32 v16, 40
global_load_dword v17, v16, s[86:87] sc1
s_waitcnt vmcnt(0)
v_readfirstlane_b32 s45, v17
s_cmp_lg_u32 s45, 0
s_cbranch_scc1 qk_gpd
s_sleep 8
s_add_u32 s44, s44, 1
s_cmp_lt_u32 s44, 0x100000
s_cbranch_scc1 qk_gp
s_branch timeout
qk_gpd:
s_and_b32 s27, s45, 1
s_lshl_b32 s27, s27, 13
s_and_b32 s83, s45, 2
s_lshl_b32 s83, s83, 12
s_add_u32 s28, s27, 0
s_add_u32 s31, s27, 98304
s_add_u32 s34, s27, 294912
s_mov_b32 s37, 4194304
s_add_u32 s29, s27, 32768
s_add_u32 s32, s27, 163840
s_add_u32 s35, s27, 950272
s_mov_b32 s38, 4276224
s_add_u32 s30, s27, 65536
s_add_u32 s33, s27, 229376
s_add_u32 s36, s83, 2162688
s_mov_b32 s39, 4358144
v_lshlrev_b32 v1, 4, v10
s_lshl_b32 s40, s24, 10
v_add_u32 v2, s40, v1
s_lshl_b32 s41, s24, 9
s_add_u32 s41, s41, 16384
v_add_u32 v4, s41, v1
v_and_b32 v5, 8, v10
v_cmp_eq_u32 vcc, 0, v5
v_mov_b32 v5, 0xeeeeeeee
v_mov_b32 v9, 0x44444444
v_cndmask_b32 v5, v5, v9, vcc
v_and_b32 v16, 15, v10
v_lshrrev_b32 v17, 4, v10
v_lshrrev_b32 v18, 2, v16
v_and_b32 v19, 1, v17
v_xor_b32 v18, v18, v19
v_lshlrev_b32 v18, 3, v18
v_lshl_add_u32 v18, v16, 5, v18
v_lshrrev_b32 v19, 5, v10
v_lshl_add_u32 v18, v19, 2, v18
s_mul_i32 s40, s24, 1536
s_add_u32 s40, s40, 8192
v_add_u32 v3, s40, v18
v_xor_b32 v12, 16, v3
v_bfe_u32 v18, v10, 2, 2
v_lshl_add_u32 v18, v17, 2, v18
v_lshlrev_b32 v18, 5, v18
v_and_b32 v19, 3, v10
v_xor_b32 v19, v19, v17
v_lshlrev_b32 v19, 3, v19
v_add_u32 v13, v18, v19
v_add_u32 v13, 8192, v13
v_lshrrev_b32 v18, 2, v16
v_and_b32 v19, 3, v16
v_lshrrev_b32 v20, 1, v18
v_lshlrev_b32 v20, 4, v20
v_lshrrev_b32 v21, 1, v19
v_lshl_add_u32 v20, v21, 2, v20
v_and_b32 v21, 1, v18
v_lshl_add_u32 v20, v21, 1, v20
v_and_b32 v21, 1, v19
v_add_u32 v20, v20, v21
v_lshl_add_u32 v21, v18, 3, v19
s_cmp_eq_u32 s24, 0
s_cselect_b64 vcc, -1, 0
v_cndmask_b32 v20, v21, v20, vcc
v_and_b32 v21, 16, v20
v_lshrrev_b32 v22, 2, v21
v_lshrrev_b32 v21, 1, v21
v_xor_b32 v20, v20, v21
v_xor_b32 v20, v20, v22
v_lshlrev_b32 v20, 4, v20
v_lshl_add_u32 v6, v17, 9, v20
v_add_u32 v6, 18432, v6
s_cmp_eq_u32 s24, 0
s_cselect_b32 s52, 128, 64
v_xor_b32 v7, s52, v6
s_sub_u32 s40, s24, 1
s_lshl_b32 s40, s40, 4
v_add_u32 v18, s40, v16
v_lshrrev_b32 v19, 1, v17
v_lshlrev_b32 v19, 4, v19
v_and_b32 v20, 1, v17
v_lshl_add_u32 v19, v20, 2, v19
v_add_u32 v19, 0, v19
v_cmp_le_u32 s[54:55], v19, v18
v_lshrrev_b32 v19, 1, v17
v_lshlrev_b32 v19, 4, v19
v_and_b32 v20, 1, v17
v_lshl_add_u32 v19, v20, 2, v19
v_add_u32 v19, 1, v19
v_cmp_le_u32 s[56:57], v19, v18
v_lshrrev_b32 v19, 1, v17
v_lshlrev_b32 v19, 4, v19
v_and_b32 v20, 1, v17
v_lshl_add_u32 v19, v20, 2, v19
v_add_u32 v19, 2, v19
v_cmp_le_u32 s[58:59], v19, v18
v_lshrrev_b32 v19, 1, v17
v_lshlrev_b32 v19, 4, v19
v_and_b32 v20, 1, v17
v_lshl_add_u32 v19, v20, 2, v19
v_add_u32 v19, 3, v19
v_cmp_le_u32 s[60:61], v19, v18
v_lshrrev_b32 v19, 1, v17
v_lshlrev_b32 v19, 4, v19
v_and_b32 v20, 1, v17
v_lshl_add_u32 v19, v20, 2, v19
v_add_u32 v19, 8, v19
v_cmp_le_u32 s[62:63], v19, v18
v_lshrrev_b32 v19, 1, v17
v_lshlrev_b32 v19, 4, v19
v_and_b32 v20, 1, v17
v_lshl_add_u32 v19, v20, 2, v19
v_add_u32 v19, 9, v19
v_cmp_le_u32 s[64:65], v19, v18
v_lshrrev_b32 v19, 1, v17
v_lshlrev_b32 v19, 4, v19
v_and_b32 v20, 1, v17
v_lshl_add_u32 v19, v20, 2, v19
v_add_u32 v19, 10, v19
v_cmp_le_u32 s[66:67], v19, v18
v_lshrrev_b32 v19, 1, v17
v_lshlrev_b32 v19, 4, v19
v_and_b32 v20, 1, v17
v_lshl_add_u32 v19, v20, 2, v19
v_add_u32 v19, 11, v19
v_cmp_le_u32 s[68:69], v19, v18
s_cmp_eq_u32 s24, 0
s_cbranch_scc0 qk_mk
s_mov_b32 s54, -1
s_mov_b32 s55, -1
s_mov_b32 s56, -1
s_mov_b32 s57, -1
s_mov_b32 s58, -1
s_mov_b32 s59, -1
s_mov_b32 s60, -1
s_mov_b32 s61, -1
s_mov_b32 s62, -1
s_mov_b32 s63, -1
s_mov_b32 s64, -1
s_mov_b32 s65, -1
s_mov_b32 s66, -1
s_mov_b32 s67, -1
s_mov_b32 s68, -1
s_mov_b32 s69, -1
qk_mk:
v_mov_b32 v14, 0xff800000
s_lshr_b32 s40, s25, 3
s_lshl_b32 s40, s40, 14
s_and_b32 s41, s25, 7
s_lshl_b32 s41, s41, 10
s_add_u32 s53, s40, s41
s_cmp_eq_u32 s24, 0
s_cbranch_scc0 qk_su1
v_lshlrev_b32 v18, 7, v17
v_lshl_add_u32 v18, v16, 4, v18
v_add_u32 v0, s53, v18
v_and_b32 v18, 1, v17
v_lshlrev_b32 v18, 6, v18
v_lshl_add_u32 v18, v16, 3, v18
v_add_u32 v18, 512, v18
v_add_u32 v8, s53, v18
s_branch qk_su3
qk_su1:
s_mul_i32 s40, s25, 2560
s_cmp_eq_u32 s24, 3
s_cbranch_scc1 qk_su2
s_sub_u32 s41, s24, 1
s_lshl_b32 s42, s41, 10
s_add_u32 s42, s42, s40
v_add_u32 v0, s42, v1
s_lshl_b32 s42, s41, 8
s_add_u32 s42, s42, s40
s_add_u32 s42, s42, 2048
v_lshlrev_b32 v18, 4, v16
v_add_u32 v8, s42, v18
s_branch qk_su3
qk_su2:
v_add_u32 v0, s53, v1
v_add_u32 v8, s40, v1
qk_su3:
s_mov_b32 s70, 0x00ff00ff
s_mov_b32 s71, 0x00ff00ff
s_mov_b32 s72, 0
s_mov_b32 s73, 0x00ff00ff
s_mov_b32 s74, 0
s_mov_b32 s75, -1
s_mov_b32 s76, 0
s_mov_b32 s77, 0x0000ffff
s_mov_b32 s78, -1
s_mov_b32 s79, 0xff
s_mov_b32 s80, 0x3dd53b95
s_mov_b32 s81, 0x3dd53b95
s_mul_i32 s85, s25, 12288
s_mov_b32 s82, 0
s_cmp_lg_u32 s24, 3
s_cbranch_scc1 qk_noarm
v_mov_b32 v32, -1
v_mov_b32 v33, -1
v_mov_b32 v34, -1
v_mov_b32 v35, -1
s_mov_b64 exec, s[78:79]
buffer_store_dwordx4 v[32:35], v0, s[4:7], s31 offen sc1
s_mov_b64 exec, -1
buffer_store_dwordx4 v[32:35], v8, s[4:7], s37 offen sc1
buffer_store_dwordx4 v[32:35], v8, s[4:7], s37 offen offset:1024 sc1
s_mov_b64 exec, s[50:51]
buffer_store_dwordx4 v[32:35], v8, s[4:7], s37 offen offset:2048 sc1
s_mov_b64 exec, -1
s_mov_b64 exec, s[78:79]
buffer_store_dwordx4 v[32:35], v0, s[4:7], s32 offen sc1
s_mov_b64 exec, -1
buffer_store_dwordx4 v[32:35], v8, s[4:7], s38 offen sc1
buffer_store_dwordx4 v[32:35], v8, s[4:7], s38 offen offset:1024 sc1
s_mov_b64 exec, s[50:51]
buffer_store_dwordx4 v[32:35], v8, s[4:7], s38 offen offset:2048 sc1
s_mov_b64 exec, -1
s_mov_b64 exec, s[78:79]
buffer_store_dwordx4 v[32:35], v0, s[4:7], s33 offen sc1
s_mov_b64 exec, -1
buffer_store_dwordx4 v[32:35], v8, s[4:7], s39 offen sc1
buffer_store_dwordx4 v[32:35], v8, s[4:7], s39 offen offset:1024 sc1
s_mov_b64 exec, s[50:51]
buffer_store_dwordx4 v[32:35], v8, s[4:7], s39 offen offset:2048 sc1
s_mov_b64 exec, -1
qk_noarm:
s_waitcnt vmcnt(0)
s_barrier
s_cmp_eq_u32 s24, 0
s_cbranch_scc0 qk_as
v_mov_b32 v16, 68
v_mov_b32 v17, 1
s_mov_b64 exec, 1
global_atomic_add v16, v17, s[86:87] sc1
s_mov_b64 exec, -1
qk_as:
s_cmp_eq_u32 s24, 0
s_cbranch_scc0 qka1_wd
s_mov_b32 s46, 0
v_mov_b32 v17, 68
qka1_wf:
global_load_dword v16, v17, s[86:87] sc1
s_waitcnt vmcnt(0)
v_readfirstlane_b32 s45, v16
s_cmp_ge_u32 s45, 104
s_cbranch_scc1 qka1_wd
s_sleep 6
s_add_u32 s46, s46, 1
s_cmp_lt_u32 s46, 0x100000
s_cbranch_scc1 qka1_wf
s_branch timeout
qka1_wd:
s_barrier
s_cmp_eq_u32 s24, 0
s_cbranch_scc0 qka2_wd
s_mov_b32 s46, 0
v_mov_b32 v17, 64
qka2_wf:
global_load_dword v16, v17, s[86:87] sc1
s_waitcnt vmcnt(0)
v_readfirstlane_b32 s45, v16
s_cmp_ge_u32 s45, 128
s_cbranch_scc1 qka2_wd
s_sleep 6
s_add_u32 s46, s46, 1
s_cmp_lt_u32 s46, 0x100000
s_cbranch_scc1 qka2_wf
s_branch timeout
qka2_wd:
s_barrier
s_cmp_lg_u32 s24, 3
s_cbranch_scc1 qk_nodma0
s_mov_b32 s84, 0
s_lshl_b32 s47, s84, 7
s_add_u32 s47, s47, 201326592
s_mov_b32 s46, 0
v_mov_b32 v17, 0
qk0k_wf:
buffer_load_dword v16, off, s[4:7], s47 sc1
s_waitcnt vmcnt(0)
v_readfirstlane_b32 s45, v16
s_cmp_ge_u32 s45, 32
s_cbranch_scc1 qk0k_wd
s_add_u32 s46, s46, 1
s_cmp_lt_u32 s46, 0x200000
s_cbranch_scc1 qk0k_wf
s_branch timeout
qk0k_wd:
s_lshl_b32 s47, s84, 7
s_add_u32 s47, s47, 201328640
s_mov_b32 s46, 0
v_mov_b32 v17, 0
qk0q_wf:
buffer_load_dword v16, off, s[4:7], s47 sc1
s_waitcnt vmcnt(0)
v_readfirstlane_b32 s45, v16
s_cmp_ge_u32 s45, 32
s_cbranch_scc1 qk0q_wd
s_add_u32 s46, s46, 1
s_cmp_lt_u32 s46, 0x200000
s_cbranch_scc1 qk0q_wf
s_branch timeout
qk0q_wd:
s_add_u32 s43, s85, 16777216
s_mov_b32 m0, 18432
s_nop 0
buffer_load_dwordx4 v1, s[4:7], s43 offen sc1 lds
s_add_u32 m0, m0, 1024
s_add_u32 s43, s43, 1024
buffer_load_dwordx4 v1, s[4:7], s43 offen sc1 lds
s_add_u32 m0, m0, 1024
s_add_u32 s43, s43, 1024
buffer_load_dwordx4 v1, s[4:7], s43 offen sc1 lds
s_add_u32 m0, m0, 1024
s_add_u32 s43, s43, 1024
buffer_load_dwordx4 v1, s[4:7], s43 offen sc1 lds
s_add_u32 m0, m0, 1024
s_add_u32 s43, s43, 1024
buffer_load_dwordx4 v1, s[4:7], s43 offen sc1 lds
s_add_u32 m0, m0, 1024
s_add_u32 s43, s43, 1024
buffer_load_dwordx4 v1, s[4:7], s43 offen sc1 lds
s_add_u32 m0, m0, 1024
s_add_u32 s43, s43, 1024
buffer_load_dwordx4 v1, s[4:7], s43 offen sc1 lds
s_add_u32 m0, m0, 1024
s_add_u32 s43, s43, 1024
buffer_load_dwordx4 v1, s[4:7], s43 offen sc1 lds
s_add_u32 m0, m0, 1024
s_add_u32 s43, s43, 1024
buffer_load_dwordx4 v1, s[4:7], s43 offen sc1 lds
s_add_u32 m0, m0, 1024
s_add_u32 s43, s43, 1024
buffer_load_dwordx4 v1, s[4:7], s43 offen sc1 lds
s_add_u32 m0, m0, 1024
s_add_u32 s43, s43, 1024
buffer_load_dwordx4 v1, s[4:7], s43 offen sc1 lds
s_add_u32 m0, m0, 1024
s_add_u32 s43, s43, 1024
buffer_load_dwordx4 v1, s[4:7], s43 offen sc1 lds
s_add_u32 s43, s85, 50331648
s_add_u32 m0, s82, 30720
s_nop 0
buffer_load_dwordx4 v1, s[4:7], s43 offen sc1 lds
s_add_u32 m0, m0, 1024
s_add_u32 s43, s43, 1024
buffer_load_dwordx4 v1, s[4:7], s43 offen sc1 lds
s_add_u32 m0, m0, 1024
s_add_u32 s43, s43, 1024
buffer_load_dwordx4 v1, s[4:7], s43 offen sc1 lds
s_add_u32 m0, m0, 1024
s_add_u32 s43, s43, 1024
buffer_load_dwordx4 v1, s[4:7], s43 offen sc1 lds
s_add_u32 m0, m0, 1024
s_add_u32 s43, s43, 1024
buffer_load_dwordx4 v1, s[4:7], s43 offen sc1 lds
s_add_u32 m0, m0, 1024
s_add_u32 s43, s43, 1024
buffer_load_dwordx4 v1, s[4:7], s43 offen sc1 lds
s_add_u32 m0, m0, 1024
s_add_u32 s43, s43, 1024
buffer_load_dwordx4 v1, s[4:7], s43 offen sc1 lds
s_add_u32 m0, m0, 1024
s_add_u32 s43, s43, 1024
buffer_load_dwordx4 v1, s[4:7], s43 offen sc1 lds
s_add_u32 m0, m0, 1024
s_add_u32 s43, s43, 1024
buffer_load_dwordx4 v1, s[4:7], s43 offen sc1 lds
s_add_u32 m0, m0, 1024
s_add_u32 s43, s43, 1024
buffer_load_dwordx4 v1, s[4:7], s43 offen sc1 lds
s_add_u32 m0, m0, 1024
s_add_u32 s43, s43, 1024
buffer_load_dwordx4 v1, s[4:7], s43 offen sc1 lds
s_add_u32 m0, m0, 1024
s_add_u32 s43, s43, 1024
buffer_load_dwordx4 v1, s[4:7], s43 offen sc1 lds
qk_nodma0:
s_mov_b32 s26, 0
qk_step:
v_mov_b32 v16, 0
v_mov_b32 v17, 0
v_mov_b32 v18, 0
v_mov_b32 v19, 0
v_mov_b32 v20, 0
v_mov_b32 v21, 0
v_mov_b32 v22, 0
v_mov_b32 v23, 0
v_mov_b32 v24, 0
v_mov_b32 v25, 0
v_mov_b32 v26, 0
v_mov_b32 v27, 0
v_mov_b32 v28, 0
v_mov_b32 v29, 0
v_mov_b32 v30, 0
v_mov_b32 v31, 0
v_mov_b32 v32, 0
v_mov_b32 v33, 0
v_mov_b32 v34, 0
v_mov_b32 v35, 0
v_mov_b32 v36, 0
v_mov_b32 v37, 0
v_mov_b32 v38, 0
v_mov_b32 v39, 0
s_add_u32 s84, s28, 4096
buffer_load_dwordx4 v[40:43], v2, s[4:7], s28 offen sc1
buffer_load_dwordx4 v[44:47], v2, s[4:7], s84 offen sc1
s_mov_b64 exec, s[50:51]
buffer_load_dwordx4 v[48:51], v4, s[4:7], s28 offen sc1
s_mov_b64 exec, -1
s_mov_b32 s42, 0
qk_poll_loop:
s_mov_b64 s[44:45], 0
s_waitcnt vmcnt(2)
v_max3_u32 v9, v40, v41, v42
v_max_u32 v9, v9, v43
v_cmp_eq_u32 vcc, -1, v9
s_or_b64 s[44:45], s[44:45], vcc
s_mov_b64 exec, vcc
buffer_load_dwordx4 v[40:43], v2, s[4:7], s28 offen sc1
s_mov_b64 exec, -1
s_waitcnt vmcnt(2)
v_max3_u32 v9, v44, v45, v46
v_max_u32 v9, v9, v47
v_cmp_eq_u32 vcc, -1, v9
s_or_b64 s[44:45], s[44:45], vcc
s_mov_b64 exec, vcc
buffer_load_dwordx4 v[44:47], v2, s[4:7], s84 offen sc1
s_mov_b64 exec, -1
s_waitcnt vmcnt(2)
v_max3_u32 v9, v48, v49, v50
v_max_u32 v9, v9, v51
s_mov_b64 exec, s[50:51]
v_cmp_eq_u32 vcc, -1, v9
s_or_b64 s[44:45], s[44:45], vcc
s_mov_b64 exec, vcc
buffer_load_dwordx4 v[48:51], v4, s[4:7], s28 offen sc1
s_mov_b64 exec, -1
s_cmp_eq_u64 s[44:45], 0
s_cbranch_scc1 qk_poll_done
s_add_u32 s42, s42, 1
s_cmp_lt_u32 s42, 0x100000
s_cbranch_scc1 qk_poll_loop
s_branch timeout
qk_poll_done:
s_waitcnt vmcnt(0)
ds_write_b128 v2, v[40:43]
ds_write_b128 v2, v[44:47] offset:4096
s_mov_b64 exec, s[50:51]
ds_write_b128 v4, v[48:51]
s_mov_b64 exec, -1
s_waitcnt lgkmcnt(0)
s_barrier
ds_read_b128 v[40:43], v1 offset:0
ds_read_b128 v[44:47], v1 offset:1024
ds_read_b128 v[48:51], v1 offset:2048
ds_read_b128 v[52:55], v1 offset:3072
ds_read_b128 v[56:59], v1 offset:4096
ds_read_b128 v[60:63], v1 offset:5120
ds_read_b128 v[64:67], v1 offset:6144
ds_read_b128 v[68:71], v1 offset:7168
ds_read_b128 v[72:75], v1 offset:16384
ds_read_b128 v[76:79], v1 offset:17408
s_waitcnt lgkmcnt(9)
v_smfmac_f32_16x16x64_bf16 v[16:19], v[40:43], a[0:7], v5
ds_read_b128 v[80:83], v11 offset:0
v_smfmac_f32_16x16x64_bf16 v[20:23], v[40:43], a[8:15], v5
ds_read_b128 v[84:87], v11 offset:1024
s_waitcnt lgkmcnt(10)
v_smfmac_f32_16x16x64_bf16 v[16:19], v[44:47], a[16:23], v5
ds_read_b128 v[88:91], v11 offset:2048
v_smfmac_f32_16x16x64_bf16 v[20:23], v[44:47], a[24:31], v5
ds_read_b128 v[92:95], v11 offset:3072
s_waitcnt lgkmcnt(11)
v_smfmac_f32_16x16x64_bf16 v[16:19], v[48:51], a[32:39], v5
s_waitcnt lgkmcnt(2)
v_smfmac_f32_16x16x64_bf16 v[20:23], v[48:51], v[80:87], v5
ds_read_b128 v[80:83], v11 offset:4096
v_smfmac_f32_16x16x64_bf16 v[16:19], v[52:55], a[40:47], v5
ds_read_b128 v[84:87], v11 offset:5120
s_waitcnt lgkmcnt(2)
v_smfmac_f32_16x16x64_bf16 v[20:23], v[52:55], v[88:95], v5
ds_read_b128 v[88:91], v11 offset:6144
v_smfmac_f32_16x16x64_bf16 v[16:19], v[56:59], a[48:55], v5
ds_read_b128 v[92:95], v11 offset:7168
s_waitcnt lgkmcnt(2)
v_smfmac_f32_16x16x64_bf16 v[20:23], v[56:59], v[80:87], v5
ds_read_b128 v[80:83], v11 offset:8192
v_smfmac_f32_16x16x64_bf16 v[16:19], v[60:63], a[56:63], v5
ds_read_b128 v[84:87], v11 offset:9216
s_waitcnt lgkmcnt(2)
v_smfmac_f32_16x16x64_bf16 v[20:23], v[60:63], v[88:95], v5
ds_read_b128 v[88:91], v11 offset:10240
v_smfmac_f32_16x16x64_bf16 v[16:19], v[64:67], a[64:71], v5
ds_read_b128 v[92:95], v11 offset:11264
s_waitcnt lgkmcnt(2)
v_smfmac_f32_16x16x64_bf16 v[20:23], v[64:67], v[80:87], v5
ds_read_b128 v[80:83], v11 offset:12288
v_smfmac_f32_16x16x64_bf16 v[16:19], v[68:71], a[72:79], v5
ds_read_b128 v[84:87], v11 offset:13312
s_waitcnt lgkmcnt(2)
v_smfmac_f32_16x16x64_bf16 v[20:23], v[68:71], v[88:95], v5
ds_read_b128 v[88:91], v11 offset:14336
v_smfmac_f32_16x16x64_bf16 v[16:19], v[72:75], a[80:87], v5
ds_read_b128 v[92:95], v11 offset:15360
s_waitcnt lgkmcnt(2)
v_smfmac_f32_16x16x64_bf16 v[20:23], v[72:75], v[80:87], v5
v_smfmac_f32_16x16x64_bf16 v[16:19], v[76:79], a[88:95], v5
s_waitcnt lgkmcnt(0)
v_smfmac_f32_16x16x64_bf16 v[20:23], v[76:79], v[88:95], v5
v_smfmac_f32_16x16x64_bf16 v[24:27], v[40:43], a[96:103], v5
v_smfmac_f32_16x16x64_bf16 v[28:31], v[40:43], a[104:111], v5
v_smfmac_f32_16x16x64_bf16 v[24:27], v[44:47], a[112:119], v5
s_nop 2
v_permlane32_swap_b32 v16, v18
v_smfmac_f32_16x16x64_bf16 v[28:31], v[44:47], a[120:127], v5
v_permlane32_swap_b32 v17, v19
v_smfmac_f32_16x16x64_bf16 v[24:27], v[48:51], a[128:135], v5
v_add_f32 v16, v16, v18
v_smfmac_f32_16x16x64_bf16 v[28:31], v[48:51], a[136:143], v5
v_add_f32 v17, v17, v19
v_smfmac_f32_16x16x64_bf16 v[24:27], v[52:55], a[144:151], v5
v_cvt_pk_bf16_f32 v18, v16, v17
v_smfmac_f32_16x16x64_bf16 v[28:31], v[52:55], a[152:159], v5
ds_write_b32 v3, v18 offset:0
v_smfmac_f32_16x16x64_bf16 v[24:27], v[56:59], a[160:167], v5
v_permlane32_swap_b32 v20, v22
v_smfmac_f32_16x16x64_bf16 v[28:31], v[56:59], a[168:175], v5
v_permlane32_swap_b32 v21, v23
v_smfmac_f32_16x16x64_bf16 v[24:27], v[60:63], a[176:183], v5
v_add_f32 v20, v20, v22
v_smfmac_f32_16x16x64_bf16 v[28:31], v[60:63], a[184:191], v5
v_add_f32 v21, v21, v23
v_smfmac_f32_16x16x64_bf16 v[24:27], v[64:67], a[192:199], v5
v_cvt_pk_bf16_f32 v22, v20, v21
v_smfmac_f32_16x16x64_bf16 v[28:31], v[64:67], a[200:207], v5
ds_write_b32 v3, v22 offset:512
v_smfmac_f32_16x16x64_bf16 v[24:27], v[68:71], a[208:215], v5
ds_read_b128 v[80:83], v6 offset:0
v_smfmac_f32_16x16x64_bf16 v[28:31], v[68:71], a[216:223], v5
ds_read_b128 v[84:87], v7 offset:0
v_smfmac_f32_16x16x64_bf16 v[24:27], v[72:75], a[224:231], v5
v_cndmask_b32_e64 v88, v14, 0, s[74:75]
v_smfmac_f32_16x16x64_bf16 v[28:31], v[72:75], a[232:239], v5
v_cndmask_b32_e64 v89, v14, 0, s[74:75]
v_smfmac_f32_16x16x64_bf16 v[24:27], v[76:79], a[240:247], v5
v_cndmask_b32_e64 v90, v14, 0, s[74:75]
v_smfmac_f32_16x16x64_bf16 v[28:31], v[76:79], a[248:255], v5
v_cndmask_b32_e64 v91, v14, 0, s[74:75]
v_cndmask_b32_e64 v92, v14, 0, s[54:55]
v_cndmask_b32_e64 v93, v14, 0, s[56:57]
v_cndmask_b32_e64 v94, v14, 0, s[58:59]
v_cndmask_b32_e64 v95, v14, 0, s[60:61]
v_smfmac_f32_16x16x64_bf16 v[32:35], v[40:43], v[96:103], v5
v_smfmac_f32_16x16x64_bf16 v[36:39], v[40:43], v[104:111], v5
v_smfmac_f32_16x16x64_bf16 v[32:35], v[44:47], v[112:119], v5
v_permlane32_swap_b32 v24, v26
v_smfmac_f32_16x16x64_bf16 v[36:39], v[44:47], v[120:127], v5
v_permlane32_swap_b32 v25, v27
ds_read_b128 v[40:43], v6 offset:2048
v_smfmac_f32_16x16x64_bf16 v[32:35], v[48:51], v[128:135], v5
v_add_f32 v24, v24, v26
v_smfmac_f32_16x16x64_bf16 v[36:39], v[48:51], v[136:143], v5
v_add_f32 v25, v25, v27
ds_read_b128 v[44:47], v7 offset:2048
v_smfmac_f32_16x16x64_bf16 v[32:35], v[52:55], v[144:151], v5
v_cvt_pk_bf16_f32 v26, v24, v25
v_smfmac_f32_16x16x64_bf16 v[36:39], v[52:55], v[152:159], v5
ds_write_b32 v3, v26 offset:1024
ds_read_b128 v[48:51], v6 offset:4096
v_smfmac_f32_16x16x64_bf16 v[32:35], v[56:59], v[160:167], v5
v_permlane32_swap_b32 v28, v30
v_smfmac_f32_16x16x64_bf16 v[36:39], v[56:59], v[168:175], v5
v_permlane32_swap_b32 v29, v31
ds_read_b128 v[52:55], v7 offset:4096
v_smfmac_f32_16x16x64_bf16 v[32:35], v[60:63], v[176:183], v5
v_add_f32 v28, v28, v30
v_smfmac_f32_16x16x64_bf16 v[36:39], v[60:63], v[184:191], v5
v_add_f32 v29, v29, v31
ds_read_b128 v[56:59], v6 offset:6144
v_smfmac_f32_16x16x64_bf16 v[32:35], v[64:67], v[192:199], v5
v_cvt_pk_bf16_f32 v30, v28, v29
v_smfmac_f32_16x16x64_bf16 v[36:39], v[64:67], v[200:207], v5
ds_write_b32 v12, v30 offset:0
ds_read_b128 v[60:63], v7 offset:6144
v_smfmac_f32_16x16x64_bf16 v[32:35], v[68:71], v[208:215], v5
v_cndmask_b32_e64 v16, v14, 0, s[62:63]
v_smfmac_f32_16x16x64_bf16 v[36:39], v[68:71], v[216:223], v5
v_cndmask_b32_e64 v17, v14, 0, s[64:65]
ds_read_b128 v[64:67], v6 offset:8192
v_smfmac_f32_16x16x64_bf16 v[32:35], v[72:75], v[224:231], v5
v_cndmask_b32_e64 v18, v14, 0, s[66:67]
v_smfmac_f32_16x16x64_bf16 v[36:39], v[72:75], v[232:239], v5
v_cndmask_b32_e64 v19, v14, 0, s[68:69]
ds_read_b128 v[68:71], v7 offset:8192
v_smfmac_f32_16x16x64_bf16 v[32:35], v[76:79], v[240:247], v5
v_smfmac_f32_16x16x64_bf16 v[36:39], v[76:79], v[248:255], v5
ds_read_b128 v[72:75], v6 offset:10240
s_nop 5
v_permlane32_swap_b32 v32, v34
v_permlane32_swap_b32 v36, v38
v_permlane32_swap_b32 v33, v35
v_permlane32_swap_b32 v37, v39
v_pk_add_f32 v[32:33], v[32:33], v[34:35]
v_pk_add_f32 v[36:37], v[36:37], v[38:39]
v_cvt_pk_bf16_f32 v34, v32, v33
v_cvt_pk_bf16_f32 v38, v36, v37
s_waitcnt lgkmcnt(10)
ds_write_b32 v12, v34 offset:512
ds_write_b32 v12, v38 offset:1024
ds_read_b128 v[76:79], v7 offset:10240
s_waitcnt lgkmcnt(0)
s_barrier
s_cmp_eq_u32 s24, 3
s_cbranch_scc1 qk_w3
s_cmp_eq_u32 s24, 0
s_cbranch_scc0 qk_tok
ds_read_b64_tr_b16 v[20:21], v13 offset:0
ds_read_b64_tr_b16 v[22:23], v13 offset:512
ds_read_b64_tr_b16 v[24:25], v13 offset:1024
ds_read_b64_tr_b16 v[26:27], v13 offset:1536
ds_read_b64_tr_b16 v[28:29], v13 offset:2048
ds_read_b64_tr_b16 v[30:31], v13 offset:2560
ds_read_b64_tr_b16 v[32:33], v13 offset:3072
ds_read_b64_tr_b16 v[34:35], v13 offset:3584
ds_read_b64_tr_b16 v[36:37], v13 offset:4096
ds_read_b64_tr_b16 v[38:39], v13 offset:4608
s_waitcnt lgkmcnt(8)
v_mfma_f32_16x16x32_bf16 v[92:95], v[80:83], v[20:23], v[92:95]
v_mfma_f32_16x16x32_bf16 v[16:19], v[84:87], v[20:23], v[16:19]
v_mfma_f32_16x16x32_bf16 v[88:91], v[20:23], v[20:23], v[88:91]
ds_read_b64_tr_b16 v[20:21], v13 offset:5120
ds_read_b64_tr_b16 v[22:23], v13 offset:5632
s_waitcnt lgkmcnt(8)
v_mfma_f32_16x16x32_bf16 v[92:95], v[40:43], v[24:27], v[92:95]
v_mfma_f32_16x16x32_bf16 v[16:19], v[44:47], v[24:27], v[16:19]
v_mfma_f32_16x16x32_bf16 v[88:91], v[24:27], v[24:27], v[88:91]
s_waitcnt lgkmcnt(6)
v_mfma_f32_16x16x32_bf16 v[92:95], v[48:51], v[28:31], v[92:95]
v_mfma_f32_16x16x32_bf16 v[16:19], v[52:55], v[28:31], v[16:19]
v_mfma_f32_16x16x32_bf16 v[88:91], v[28:31], v[28:31], v[88:91]
s_waitcnt lgkmcnt(4)
v_mfma_f32_16x16x32_bf16 v[92:95], v[56:59], v[32:35], v[92:95]
v_mfma_f32_16x16x32_bf16 v[16:19], v[60:63], v[32:35], v[16:19]
v_mfma_f32_16x16x32_bf16 v[88:91], v[32:35], v[32:35], v[88:91]
s_waitcnt lgkmcnt(2)
v_mfma_f32_16x16x32_bf16 v[92:95], v[64:67], v[36:39], v[92:95]
v_mfma_f32_16x16x32_bf16 v[16:19], v[68:71], v[36:39], v[16:19]
v_mfma_f32_16x16x32_bf16 v[88:91], v[36:39], v[36:39], v[88:91]
s_waitcnt lgkmcnt(0)
v_mfma_f32_16x16x32_bf16 v[92:95], v[72:75], v[20:23], v[92:95]
v_mfma_f32_16x16x32_bf16 v[16:19], v[76:79], v[20:23], v[16:19]
v_mfma_f32_16x16x32_bf16 v[88:91], v[20:23], v[20:23], v[88:91]
s_nop 7
v_max3_f32 v20, v88, v89, v90
v_max3_f32 v22, v91, v92, v93
v_max3_f32 v20, v20, v94, v95
v_max3_f32 v22, v22, v16, v17
v_max3_f32 v20, v20, v18, v19
v_max_f32 v20, v20, v22
v_mov_b32 v22, v20
s_nop 1
v_permlane16_swap_b32 v22, v20
v_max_f32 v20, v20, v22
v_mov_b32 v22, v20
s_nop 1
v_permlane32_swap_b32 v22, v20
v_max_f32 v20, v20, v22
v_mul_f32 v20, s80, v20
v_pk_fma_f32 v[88:89], v[88:89], s[80:81], v[20:21] op_sel_hi:[1,1,0] neg_lo:[0,0,1] neg_hi:[0,0,1]
v_pk_fma_f32 v[90:91], v[90:91], s[80:81], v[20:21] op_sel_hi:[1,1,0] neg_lo:[0,0,1] neg_hi:[0,0,1]
v_pk_fma_f32 v[92:93], v[92:93], s[80:81], v[20:21] op_sel_hi:[1,1,0] neg_lo:[0,0,1] neg_hi:[0,0,1]
v_pk_fma_f32 v[94:95], v[94:95], s[80:81], v[20:21] op_sel_hi:[1,1,0] neg_lo:[0,0,1] neg_hi:[0,0,1]
v_pk_fma_f32 v[16:17], v[16:17], s[80:81], v[20:21] op_sel_hi:[1,1,0] neg_lo:[0,0,1] neg_hi:[0,0,1]
v_pk_fma_f32 v[18:19], v[18:19], s[80:81], v[20:21] op_sel_hi:[1,1,0] neg_lo:[0,0,1] neg_hi:[0,0,1]
v_exp_f32 v88, v88
v_exp_f32 v89, v89
v_exp_f32 v90, v90
v_exp_f32 v91, v91
v_exp_f32 v92, v92
v_exp_f32 v93, v93
v_exp_f32 v94, v94
v_exp_f32 v95, v95
v_exp_f32 v16, v16
v_exp_f32 v17, v17
v_exp_f32 v18, v18
v_exp_f32 v19, v19
v_pk_add_f32 v[24:25], v[88:89], v[90:91]
v_pk_add_f32 v[26:27], v[92:93], v[94:95]
v_pk_add_f32 v[28:29], v[16:17], v[18:19]
v_pk_add_f32 v[24:25], v[24:25], v[26:27]
v_pk_add_f32 v[24:25], v[24:25], v[28:29]
v_add_f32 v20, v24, v25
v_mov_b32 v22, v20
s_nop 1
v_permlane16_swap_b32 v22, v20
v_add_f32 v20, v20, v22
v_mov_b32 v22, v20
s_nop 1
v_permlane32_swap_b32 v22, v20
v_add_f32 v20, v20, v22
v_rcp_f32 v20, v20
s_nop 0
v_pk_mul_f32 v[88:89], v[88:89], v[20:21] op_sel_hi:[1,0] clamp
v_pk_mul_f32 v[90:91], v[90:91], v[20:21] op_sel_hi:[1,0] clamp
v_pk_mul_f32 v[92:93], v[92:93], v[20:21] op_sel_hi:[1,0] clamp
v_pk_mul_f32 v[94:95], v[94:95], v[20:21] op_sel_hi:[1,0] clamp
v_pk_mul_f32 v[16:17], v[16:17], v[20:21] op_sel_hi:[1,0] clamp
v_pk_mul_f32 v[18:19], v[18:19], v[20:21] op_sel_hi:[1,0] clamp
v_cvt_pk_bf16_f32 v32, v92, v93
v_cvt_pk_bf16_f32 v33, v94, v95
v_cvt_pk_bf16_f32 v34, v16, v17
v_cvt_pk_bf16_f32 v35, v18, v19
s_mov_b64 exec, s[70:71]
buffer_store_dwordx4 v[32:35], v0, s[4:7], s31 offen sc1
v_cvt_pk_bf16_f32 v36, v88, v89
v_cvt_pk_bf16_f32 v37, v90, v91
s_mov_b64 exec, s[72:73]
buffer_store_dwordx2 v[36:37], v8, s[4:7], s31 offen sc1
s_mov_b64 exec, -1
s_barrier
s_branch qk_end
qk_tok:
s_sub_u32 s40, s24, 1
s_lshl_b32 s40, s40, 10
s_add_u32 s40, s40, s82
s_add_u32 s40, s40, 30720
v_add_u32 v10, s40, v1
ds_read_b128 v[28:31], v10 offset:0
ds_read_b64_tr_b16 v[20:21], v13 offset:0
ds_read_b64_tr_b16 v[22:23], v13 offset:512
ds_read_b128 v[32:35], v10 offset:2048
ds_read_b64_tr_b16 v[24:25], v13 offset:1024
ds_read_b64_tr_b16 v[26:27], v13 offset:1536
ds_read_b128 v[36:39], v10 offset:4096
s_waitcnt lgkmcnt(6)
s_waitcnt lgkmcnt(4)
v_mfma_f32_16x16x32_bf16 v[92:95], v[80:83], v[28:31], v[92:95]
v_mfma_f32_16x16x32_bf16 v[16:19], v[84:87], v[28:31], v[16:19]
v_mfma_f32_16x16x32_bf16 v[88:91], v[20:23], v[28:31], v[88:91]
ds_read_b64_tr_b16 v[20:21], v13 offset:2048
ds_read_b64_tr_b16 v[22:23], v13 offset:2560
ds_read_b128 v[28:31], v10 offset:6144
s_waitcnt lgkmcnt(6)
s_waitcnt lgkmcnt(4)
v_mfma_f32_16x16x32_bf16 v[92:95], v[40:43], v[32:35], v[92:95]
v_mfma_f32_16x16x32_bf16 v[16:19], v[44:47], v[32:35], v[16:19]
v_mfma_f32_16x16x32_bf16 v[88:91], v[24:27], v[32:35], v[88:91]
ds_read_b64_tr_b16 v[24:25], v13 offset:3072
ds_read_b64_tr_b16 v[26:27], v13 offset:3584
ds_read_b128 v[32:35], v10 offset:8192
s_waitcnt lgkmcnt(6)
s_waitcnt lgkmcnt(4)
v_mfma_f32_16x16x32_bf16 v[92:95], v[48:51], v[36:39], v[92:95]
v_mfma_f32_16x16x32_bf16 v[16:19], v[52:55], v[36:39], v[16:19]
v_mfma_f32_16x16x32_bf16 v[88:91], v[20:23], v[36:39], v[88:91]
ds_read_b64_tr_b16 v[20:21], v13 offset:4096
ds_read_b64_tr_b16 v[22:23], v13 offset:4608
ds_read_b128 v[36:39], v10 offset:10240
s_waitcnt lgkmcnt(6)
s_waitcnt lgkmcnt(4)
v_mfma_f32_16x16x32_bf16 v[92:95], v[56:59], v[28:31], v[92:95]
v_mfma_f32_16x16x32_bf16 v[16:19], v[60:63], v[28:31], v[16:19]
v_mfma_f32_16x16x32_bf16 v[88:91], v[24:27], v[28:31], v[88:91]
ds_read_b64_tr_b16 v[24:25], v13 offset:5120
ds_read_b64_tr_b16 v[26:27], v13 offset:5632
s_waitcnt lgkmcnt(5)
s_waitcnt lgkmcnt(3)
v_mfma_f32_16x16x32_bf16 v[92:95], v[64:67], v[32:35], v[92:95]
v_mfma_f32_16x16x32_bf16 v[16:19], v[68:71], v[32:35], v[16:19]
v_mfma_f32_16x16x32_bf16 v[88:91], v[20:23], v[32:35], v[88:91]
s_waitcnt lgkmcnt(2)
s_waitcnt lgkmcnt(0)
v_mfma_f32_16x16x32_bf16 v[92:95], v[72:75], v[36:39], v[92:95]
v_mfma_f32_16x16x32_bf16 v[16:19], v[76:79], v[36:39], v[16:19]
v_mfma_f32_16x16x32_bf16 v[88:91], v[24:27], v[36:39], v[88:91]
s_nop 7
v_max3_f32 v20, v88, v89, v90
v_max3_f32 v22, v91, v92, v93
v_max3_f32 v20, v20, v94, v95
v_max3_f32 v22, v22, v16, v17
v_max3_f32 v20, v20, v18, v19
v_max_f32 v20, v20, v22
v_mov_b32 v22, v20
s_nop 1
v_permlane16_swap_b32 v22, v20
v_max_f32 v20, v20, v22
v_mov_b32 v22, v20
s_nop 1
v_permlane32_swap_b32 v22, v20
v_max_f32 v20, v20, v22
v_mul_f32 v20, s80, v20
v_pk_fma_f32 v[88:89], v[88:89], s[80:81], v[20:21] op_sel_hi:[1,1,0] neg_lo:[0,0,1] neg_hi:[0,0,1]
v_pk_fma_f32 v[90:91], v[90:91], s[80:81], v[20:21] op_sel_hi:[1,1,0] neg_lo:[0,0,1] neg_hi:[0,0,1]
v_pk_fma_f32 v[92:93], v[92:93], s[80:81], v[20:21] op_sel_hi:[1,1,0] neg_lo:[0,0,1] neg_hi:[0,0,1]
v_pk_fma_f32 v[94:95], v[94:95], s[80:81], v[20:21] op_sel_hi:[1,1,0] neg_lo:[0,0,1] neg_hi:[0,0,1]
v_pk_fma_f32 v[16:17], v[16:17], s[80:81], v[20:21] op_sel_hi:[1,1,0] neg_lo:[0,0,1] neg_hi:[0,0,1]
v_pk_fma_f32 v[18:19], v[18:19], s[80:81], v[20:21] op_sel_hi:[1,1,0] neg_lo:[0,0,1] neg_hi:[0,0,1]
v_exp_f32 v88, v88
v_exp_f32 v89, v89
v_exp_f32 v90, v90
v_exp_f32 v91, v91
v_exp_f32 v92, v92
v_exp_f32 v93, v93
v_exp_f32 v94, v94
v_exp_f32 v95, v95
v_exp_f32 v16, v16
v_exp_f32 v17, v17
v_exp_f32 v18, v18
v_exp_f32 v19, v19
v_pk_add_f32 v[24:25], v[88:89], v[90:91]
v_pk_add_f32 v[26:27], v[92:93], v[94:95]
v_pk_add_f32 v[28:29], v[16:17], v[18:19]
v_pk_add_f32 v[24:25], v[24:25], v[26:27]
v_pk_add_f32 v[24:25], v[24:25], v[28:29]
v_add_f32 v20, v24, v25
v_mov_b32 v22, v20
s_nop 1
v_permlane16_swap_b32 v22, v20
v_add_f32 v20, v20, v22
v_mov_b32 v22, v20
s_nop 1
v_permlane32_swap_b32 v22, v20
v_add_f32 v20, v20, v22
v_rcp_f32 v20, v20
s_nop 0
v_pk_mul_f32 v[88:89], v[88:89], v[20:21] op_sel_hi:[1,0] clamp
v_pk_mul_f32 v[90:91], v[90:91], v[20:21] op_sel_hi:[1,0] clamp
v_pk_mul_f32 v[92:93], v[92:93], v[20:21] op_sel_hi:[1,0] clamp
v_pk_mul_f32 v[94:95], v[94:95], v[20:21] op_sel_hi:[1,0] clamp
v_pk_mul_f32 v[16:17], v[16:17], v[20:21] op_sel_hi:[1,0] clamp
v_pk_mul_f32 v[18:19], v[18:19], v[20:21] op_sel_hi:[1,0] clamp
v_cvt_pk_bf16_f32 v32, v92, v93
v_cvt_pk_bf16_f32 v33, v94, v95
v_cvt_pk_bf16_f32 v34, v16, v17
v_cvt_pk_bf16_f32 v35, v18, v19
buffer_store_dwordx4 v[32:35], v0, s[4:7], s37 offen sc1
v_cvt_pk_bf16_f32 v36, v88, v89
v_cvt_pk_bf16_f32 v38, v90, v91
s_nop 0
v_permlane16_swap_b32 v36, v37
v_permlane16_swap_b32 v38, v39
s_mov_b64 exec, s[76:77]
buffer_store_dwordx4 v[36:39], v8, s[4:7], s37 offen sc1
s_mov_b64 exec, -1
s_barrier
s_branch qk_end
qk_w3:
v_mov_b32 v32, -1
v_mov_b32 v33, -1
v_mov_b32 v34, -1
v_mov_b32 v35, -1
s_mov_b64 exec, s[78:79]
buffer_store_dwordx4 v[32:35], v0, s[4:7], s33 offen sc1
s_mov_b64 exec, -1
buffer_store_dwordx4 v[32:35], v8, s[4:7], s38 offen sc1
buffer_store_dwordx4 v[32:35], v8, s[4:7], s38 offen offset:1024 sc1
s_mov_b64 exec, s[50:51]
buffer_store_dwordx4 v[32:35], v8, s[4:7], s38 offen offset:2048 sc1
s_mov_b64 exec, -1
s_barrier
s_cmp_ge_u32 s26, 63
s_cbranch_scc1 qk_w3d
s_add_u32 s85, s85, 393216
s_add_u32 s84, s26, 1
s_and_b32 s83, s84, 3
s_cmp_eq_u32 s83, 0
s_cbranch_scc0 qk1_nw
s_lshr_b32 s84, s84, 2
s_lshl_b32 s47, s84, 7
s_add_u32 s47, s47, 201326592
s_mov_b32 s46, 0
v_mov_b32 v17, 0
qk1k_wf:
buffer_load_dword v16, off, s[4:7], s47 sc1
s_waitcnt vmcnt(0)
v_readfirstlane_b32 s45, v16
s_cmp_ge_u32 s45, 32
s_cbranch_scc1 qk1k_wd
s_add_u32 s46, s46, 1
s_cmp_lt_u32 s46, 0x200000
s_cbranch_scc1 qk1k_wf
s_branch timeout
qk1k_wd:
s_lshl_b32 s47, s84, 7
s_add_u32 s47, s47, 201328640
s_mov_b32 s46, 0
v_mov_b32 v17, 0
qk1q_wf:
buffer_load_dword v16, off, s[4:7], s47 sc1
s_waitcnt vmcnt(0)
v_readfirstlane_b32 s45, v16
s_cmp_ge_u32 s45, 32
s_cbranch_scc1 qk1q_wd
s_add_u32 s46, s46, 1
s_cmp_lt_u32 s46, 0x200000
s_cbranch_scc1 qk1q_wf
s_branch timeout
qk1q_wd:
qk1_nw:
s_xor_b32 s41, s82, 12288
s_add_u32 s43, s85, 16777216
s_mov_b32 m0, 18432
s_nop 0
buffer_load_dwordx4 v1, s[4:7], s43 offen sc1 lds
s_add_u32 m0, m0, 1024
s_add_u32 s43, s43, 1024
buffer_load_dwordx4 v1, s[4:7], s43 offen sc1 lds
s_add_u32 m0, m0, 1024
s_add_u32 s43, s43, 1024
buffer_load_dwordx4 v1, s[4:7], s43 offen sc1 lds
s_add_u32 m0, m0, 1024
s_add_u32 s43, s43, 1024
buffer_load_dwordx4 v1, s[4:7], s43 offen sc1 lds
s_add_u32 m0, m0, 1024
s_add_u32 s43, s43, 1024
buffer_load_dwordx4 v1, s[4:7], s43 offen sc1 lds
s_add_u32 m0, m0, 1024
s_add_u32 s43, s43, 1024
buffer_load_dwordx4 v1, s[4:7], s43 offen sc1 lds
s_add_u32 m0, m0, 1024
s_add_u32 s43, s43, 1024
buffer_load_dwordx4 v1, s[4:7], s43 offen sc1 lds
s_add_u32 m0, m0, 1024
s_add_u32 s43, s43, 1024
buffer_load_dwordx4 v1, s[4:7], s43 offen sc1 lds
s_add_u32 m0, m0, 1024
s_add_u32 s43, s43, 1024
buffer_load_dwordx4 v1, s[4:7], s43 offen sc1 lds
s_add_u32 m0, m0, 1024
s_add_u32 s43, s43, 1024
buffer_load_dwordx4 v1, s[4:7], s43 offen sc1 lds
s_add_u32 m0, m0, 1024
s_add_u32 s43, s43, 1024
buffer_load_dwordx4 v1, s[4:7], s43 offen sc1 lds
s_add_u32 m0, m0, 1024
s_add_u32 s43, s43, 1024
buffer_load_dwordx4 v1, s[4:7], s43 offen sc1 lds
s_add_u32 s43, s85, 50331648
s_add_u32 m0, s41, 30720
s_nop 0
buffer_load_dwordx4 v1, s[4:7], s43 offen sc1 lds
s_add_u32 m0, m0, 1024
s_add_u32 s43, s43, 1024
buffer_load_dwordx4 v1, s[4:7], s43 offen sc1 lds
s_add_u32 m0, m0, 1024
s_add_u32 s43, s43, 1024
buffer_load_dwordx4 v1, s[4:7], s43 offen sc1 lds
s_add_u32 m0, m0, 1024
s_add_u32 s43, s43, 1024
buffer_load_dwordx4 v1, s[4:7], s43 offen sc1 lds
s_add_u32 m0, m0, 1024
s_add_u32 s43, s43, 1024
buffer_load_dwordx4 v1, s[4:7], s43 offen sc1 lds
s_add_u32 m0, m0, 1024
s_add_u32 s43, s43, 1024
buffer_load_dwordx4 v1, s[4:7], s43 offen sc1 lds
s_add_u32 m0, m0, 1024
s_add_u32 s43, s43, 1024
buffer_load_dwordx4 v1, s[4:7], s43 offen sc1 lds
s_add_u32 m0, m0, 1024
s_add_u32 s43, s43, 1024
buffer_load_dwordx4 v1, s[4:7], s43 offen sc1 lds
s_add_u32 m0, m0, 1024
s_add_u32 s43, s43, 1024
buffer_load_dwordx4 v1, s[4:7], s43 offen sc1 lds
s_add_u32 m0, m0, 1024
s_add_u32 s43, s43, 1024
buffer_load_dwordx4 v1, s[4:7], s43 offen sc1 lds
s_add_u32 m0, m0, 1024
s_add_u32 s43, s43, 1024
buffer_load_dwordx4 v1, s[4:7], s43 offen sc1 lds
s_add_u32 m0, m0, 1024
s_add_u32 s43, s43, 1024
buffer_load_dwordx4 v1, s[4:7], s43 offen sc1 lds
qk_w3d:
qk_end:
s_xor_b32 s82, s82, 12288
s_mov_b32 s40, s28
s_mov_b32 s28, s29
s_mov_b32 s29, s30
s_mov_b32 s30, s40
s_mov_b32 s40, s31
s_mov_b32 s31, s32
s_mov_b32 s32, s33
s_mov_b32 s33, s40
s_mov_b32 s40, s37
s_mov_b32 s37, s38
s_mov_b32 s38, s39
s_mov_b32 s39, s40
s_add_u32 s26, s26, 1
s_cmp_lt_u32 s26, 64
s_cbranch_scc1 qk_step
s_branch done
role_vo:
s_sub_u32 s25, s42, 32
s_mov_b32 s8, s96
s_and_b32 s9, s97, 0xffff
s_mov_b32 s10, 7864320
s_mov_b32 s11, 0x20000
s_mov_b32 s12, s98
s_and_b32 s13, s99, 0xffff
s_mov_b32 s14, 7864320
s_mov_b32 s15, 0x20000
s_mul_i32 s49, s24, 6144
s_lshl_b32 s40, s24, 4
v_add_u32 v24, 0, v10
v_mul_u32_u24 v25, 2731, v24
v_lshrrev_b32 v25, 16, v25
v_mul_u32_u24 v26, 24, v25
v_sub_u32 v26, v24, v26
v_and_b32 v27, 2, v25
v_bfe_u32 v28, v25, 3, 1
v_lshl_add_u32 v27, v28, 2, v27
v_xor_b32 v26, v26, v27
v_lshlrev_b32 v26, 4, v26
v_add_u32 v25, s40, v25
v_mul_u32_u24 v25, 12288, v25
v_add_u32 v12, v25, v26
v_add_u32 v24, 64, v10
v_mul_u32_u24 v25, 2731, v24
v_lshrrev_b32 v25, 16, v25
v_mul_u32_u24 v26, 24, v25
v_sub_u32 v26, v24, v26
v_and_b32 v27, 2, v25
v_bfe_u32 v28, v25, 3, 1
v_lshl_add_u32 v27, v28, 2, v27
v_xor_b32 v26, v26, v27
v_lshlrev_b32 v26, 4, v26
v_add_u32 v25, s40, v25
v_mul_u32_u24 v25, 12288, v25
v_add_u32 v13, v25, v26
v_add_u32 v24, 128, v10
v_mul_u32_u24 v25, 2731, v24
v_lshrrev_b32 v25, 16, v25
v_mul_u32_u24 v26, 24, v25
v_sub_u32 v26, v24, v26
v_and_b32 v27, 2, v25
v_bfe_u32 v28, v25, 3, 1
v_lshl_add_u32 v27, v28, 2, v27
v_xor_b32 v26, v26, v27
v_lshlrev_b32 v26, 4, v26
v_add_u32 v25, s40, v25
v_mul_u32_u24 v25, 12288, v25
v_add_u32 v14, v25, v26
v_add_u32 v24, 192, v10
v_mul_u32_u24 v25, 2731, v24
v_lshrrev_b32 v25, 16, v25
v_mul_u32_u24 v26, 24, v25
v_sub_u32 v26, v24, v26
v_and_b32 v27, 2, v25
v_bfe_u32 v28, v25, 3, 1
v_lshl_add_u32 v27, v28, 2, v27
v_xor_b32 v26, v26, v27
v_lshlrev_b32 v26, 4, v26
v_add_u32 v25, s40, v25
v_mul_u32_u24 v25, 12288, v25
v_add_u32 v15, v25, v26
v_add_u32 v24, 256, v10
v_mul_u32_u24 v25, 2731, v24
v_lshrrev_b32 v25, 16, v25
v_mul_u32_u24 v26, 24, v25
v_sub_u32 v26, v24, v26
v_and_b32 v27, 2, v25
v_bfe_u32 v28, v25, 3, 1
v_lshl_add_u32 v27, v28, 2, v27
v_xor_b32 v26, v26, v27
v_lshlrev_b32 v26, 4, v26
v_add_u32 v25, s40, v25
v_mul_u32_u24 v25, 12288, v25
v_add_u32 v16, v25, v26
v_add_u32 v24, 320, v10
v_mul_u32_u24 v25, 2731, v24
v_lshrrev_b32 v25, 16, v25
v_mul_u32_u24 v26, 24, v25
v_sub_u32 v26, v24, v26
v_and_b32 v27, 2, v25
v_bfe_u32 v28, v25, 3, 1
v_lshl_add_u32 v27, v28, 2, v27
v_xor_b32 v26, v26, v27
v_lshlrev_b32 v26, 4, v26
v_add_u32 v25, s40, v25
v_mul_u32_u24 v25, 12288, v25
v_add_u32 v17, v25, v26
v_lshrrev_b32 v24, 4, v10
v_bfe_u32 v25, v10, 2, 2
v_lshl_add_u32 v26, v24, 3, v25
v_mul_u32_u24 v26, 384, v26
v_and_b32 v27, 3, v10
v_lshl_add_u32 v8, v27, 3, v26
v_lshrrev_b32 v25, 1, v25
v_and_b32 v24, 1, v24
v_lshl_add_u32 v24, v24, 1, v25
v_lshlrev_b32 v9, 5, v24
s_mul_i32 s40, s24, 96
s_add_u32 s40, s40, 0
v_xor_b32 v18, s40, v9
v_add_u32 v18, v18, v8
s_mul_i32 s40, s24, 96
s_add_u32 s40, s40, 32
v_xor_b32 v19, s40, v9
v_add_u32 v19, v19, v8
s_mul_i32 s40, s24, 96
s_add_u32 s40, s40, 64
v_xor_b32 v20, s40, v9
v_add_u32 v20, v20, v8
s_mul_i32 s43, s25, 384
s_add_u32 s43, s43, 0
s_add_u32 m0, s49, 0
s_nop 0
buffer_load_dwordx4 v12, s[8:11], s43 offen lds
s_add_u32 m0, s49, 1024
s_nop 0
buffer_load_dwordx4 v13, s[8:11], s43 offen lds
s_add_u32 m0, s49, 2048
s_nop 0
buffer_load_dwordx4 v14, s[8:11], s43 offen lds
s_add_u32 m0, s49, 3072
s_nop 0
buffer_load_dwordx4 v15, s[8:11], s43 offen lds
s_add_u32 m0, s49, 4096
s_nop 0
buffer_load_dwordx4 v16, s[8:11], s43 offen lds
s_add_u32 m0, s49, 5120
s_nop 0
buffer_load_dwordx4 v17, s[8:11], s43 offen lds
s_mul_i32 s43, s25, 384
s_add_u32 s43, s43, 786432
s_add_u32 m0, s49, 24576
s_nop 0
buffer_load_dwordx4 v12, s[8:11], s43 offen lds
s_add_u32 m0, s49, 25600
s_nop 0
buffer_load_dwordx4 v13, s[8:11], s43 offen lds
s_add_u32 m0, s49, 26624
s_nop 0
buffer_load_dwordx4 v14, s[8:11], s43 offen lds
s_add_u32 m0, s49, 27648
s_nop 0
buffer_load_dwordx4 v15, s[8:11], s43 offen lds
s_add_u32 m0, s49, 28672
s_nop 0
buffer_load_dwordx4 v16, s[8:11], s43 offen lds
s_add_u32 m0, s49, 29696
s_nop 0
buffer_load_dwordx4 v17, s[8:11], s43 offen lds
s_mul_i32 s43, s25, 384
s_add_u32 s43, s43, 1572864
s_add_u32 m0, s49, 49152
s_nop 0
buffer_load_dwordx4 v12, s[8:11], s43 offen lds
s_add_u32 m0, s49, 50176
s_nop 0
buffer_load_dwordx4 v13, s[8:11], s43 offen lds
s_add_u32 m0, s49, 51200
s_nop 0
buffer_load_dwordx4 v14, s[8:11], s43 offen lds
s_add_u32 m0, s49, 52224
s_nop 0
buffer_load_dwordx4 v15, s[8:11], s43 offen lds
s_add_u32 m0, s49, 53248
s_nop 0
buffer_load_dwordx4 v16, s[8:11], s43 offen lds
s_add_u32 m0, s49, 54272
s_nop 0
buffer_load_dwordx4 v17, s[8:11], s43 offen lds
s_mul_i32 s43, s25, 384
s_add_u32 s43, s43, 2359296
s_add_u32 m0, s49, 73728
s_nop 0
buffer_load_dwordx4 v12, s[8:11], s43 offen lds
s_add_u32 m0, s49, 74752
s_nop 0
buffer_load_dwordx4 v13, s[8:11], s43 offen lds
s_add_u32 m0, s49, 75776
s_nop 0
buffer_load_dwordx4 v14, s[8:11], s43 offen lds
s_add_u32 m0, s49, 76800
s_nop 0
buffer_load_dwordx4 v15, s[8:11], s43 offen lds
s_add_u32 m0, s49, 77824
s_nop 0
buffer_load_dwordx4 v16, s[8:11], s43 offen lds
s_add_u32 m0, s49, 78848
s_nop 0
buffer_load_dwordx4 v17, s[8:11], s43 offen lds
s_mul_i32 s43, s25, 384
s_add_u32 s43, s43, 3145728
s_add_u32 m0, s49, 98304
s_nop 0
buffer_load_dwordx4 v12, s[8:11], s43 offen lds
s_add_u32 m0, s49, 99328
s_nop 0
buffer_load_dwordx4 v13, s[8:11], s43 offen lds
s_add_u32 m0, s49, 100352
s_nop 0
buffer_load_dwordx4 v14, s[8:11], s43 offen lds
s_add_u32 m0, s49, 101376
s_nop 0
buffer_load_dwordx4 v15, s[8:11], s43 offen lds
s_add_u32 m0, s49, 102400
s_nop 0
buffer_load_dwordx4 v16, s[8:11], s43 offen lds
s_add_u32 m0, s49, 103424
s_nop 0
buffer_load_dwordx4 v17, s[8:11], s43 offen lds
s_waitcnt vmcnt(24)
s_barrier
s_mul_i32 s43, s25, 384
s_add_u32 s43, s43, 3932160
s_add_u32 m0, s49, 122880
s_nop 0
buffer_load_dwordx4 v12, s[8:11], s43 offen lds
s_add_u32 m0, s49, 123904
s_nop 0
buffer_load_dwordx4 v13, s[8:11], s43 offen lds
s_add_u32 m0, s49, 124928
s_nop 0
buffer_load_dwordx4 v14, s[8:11], s43 offen lds
s_add_u32 m0, s49, 125952
s_nop 0
buffer_load_dwordx4 v15, s[8:11], s43 offen lds
s_add_u32 m0, s49, 126976
s_nop 0
buffer_load_dwordx4 v16, s[8:11], s43 offen lds
s_add_u32 m0, s49, 128000
s_nop 0
buffer_load_dwordx4 v17, s[8:11], s43 offen lds
v_add_u32 v21, 0, v18
v_add_u32 v22, 0, v19
v_add_u32 v23, 0, v20
ds_read_b64_tr_b16 a[0:1], v21 offset:0
ds_read_b64_tr_b16 a[2:3], v21 offset:1536
ds_read_b64_tr_b16 a[4:5], v21 offset:12288
ds_read_b64_tr_b16 a[6:7], v21 offset:13824
ds_read_b64_tr_b16 a[8:9], v22 offset:0
ds_read_b64_tr_b16 a[10:11], v22 offset:1536
ds_read_b64_tr_b16 a[12:13], v22 offset:12288
ds_read_b64_tr_b16 a[14:15], v22 offset:13824
ds_read_b64_tr_b16 a[16:17], v23 offset:0
ds_read_b64_tr_b16 a[18:19], v23 offset:1536
ds_read_b64_tr_b16 a[20:21], v23 offset:12288
ds_read_b64_tr_b16 a[22:23], v23 offset:13824
s_waitcnt vmcnt(24)
s_waitcnt lgkmcnt(0)
s_barrier
s_mul_i32 s43, s25, 384
s_add_u32 s43, s43, 4718592
s_add_u32 m0, s49, 0
s_nop 0
buffer_load_dwordx4 v12, s[8:11], s43 offen lds
s_add_u32 m0, s49, 1024
s_nop 0
buffer_load_dwordx4 v13, s[8:11], s43 offen lds
s_add_u32 m0, s49, 2048
s_nop 0
buffer_load_dwordx4 v14, s[8:11], s43 offen lds
s_add_u32 m0, s49, 3072
s_nop 0
buffer_load_dwordx4 v15, s[8:11], s43 offen lds
s_add_u32 m0, s49, 4096
s_nop 0
buffer_load_dwordx4 v16, s[8:11], s43 offen lds
s_add_u32 m0, s49, 5120
s_nop 0
buffer_load_dwordx4 v17, s[8:11], s43 offen lds
v_add_u32 v21, 0, v18
v_add_u32 v22, 0, v19
v_add_u32 v23, 0, v20
ds_read_b64_tr_b16 a[24:25], v21 offset:24576
ds_read_b64_tr_b16 a[26:27], v21 offset:26112
ds_read_b64_tr_b16 a[28:29], v21 offset:36864
ds_read_b64_tr_b16 a[30:31], v21 offset:38400
ds_read_b64_tr_b16 a[32:33], v22 offset:24576
ds_read_b64_tr_b16 a[34:35], v22 offset:26112
ds_read_b64_tr_b16 a[36:37], v22 offset:36864
ds_read_b64_tr_b16 a[38:39], v22 offset:38400
ds_read_b64_tr_b16 a[40:41], v23 offset:24576
ds_read_b64_tr_b16 a[42:43], v23 offset:26112
ds_read_b64_tr_b16 a[44:45], v23 offset:36864
ds_read_b64_tr_b16 a[46:47], v23 offset:38400
s_waitcnt vmcnt(24)
s_waitcnt lgkmcnt(0)
s_barrier
s_mul_i32 s43, s25, 384
s_add_u32 s43, s43, 5505024
s_add_u32 m0, s49, 24576
s_nop 0
buffer_load_dwordx4 v12, s[8:11], s43 offen lds
s_add_u32 m0, s49, 25600
s_nop 0
buffer_load_dwordx4 v13, s[8:11], s43 offen lds
s_add_u32 m0, s49, 26624
s_nop 0
buffer_load_dwordx4 v14, s[8:11], s43 offen lds
s_add_u32 m0, s49, 27648
s_nop 0
buffer_load_dwordx4 v15, s[8:11], s43 offen lds
s_add_u32 m0, s49, 28672
s_nop 0
buffer_load_dwordx4 v16, s[8:11], s43 offen lds
s_add_u32 m0, s49, 29696
s_nop 0
buffer_load_dwordx4 v17, s[8:11], s43 offen lds
v_add_u32 v21, 49152, v18
v_add_u32 v22, 49152, v19
v_add_u32 v23, 49152, v20
ds_read_b64_tr_b16 a[48:49], v21 offset:0
ds_read_b64_tr_b16 a[50:51], v21 offset:1536
ds_read_b64_tr_b16 a[52:53], v21 offset:12288
ds_read_b64_tr_b16 a[54:55], v21 offset:13824
ds_read_b64_tr_b16 a[56:57], v22 offset:0
ds_read_b64_tr_b16 a[58:59], v22 offset:1536
ds_read_b64_tr_b16 a[60:61], v22 offset:12288
ds_read_b64_tr_b16 a[62:63], v22 offset:13824
ds_read_b64_tr_b16 a[64:65], v23 offset:0
ds_read_b64_tr_b16 a[66:67], v23 offset:1536
ds_read_b64_tr_b16 a[68:69], v23 offset:12288
ds_read_b64_tr_b16 a[70:71], v23 offset:13824
s_waitcnt vmcnt(24)
s_waitcnt lgkmcnt(0)
s_barrier
s_mul_i32 s43, s25, 384
s_add_u32 s43, s43, 6291456
s_add_u32 m0, s49, 49152
s_nop 0
buffer_load_dwordx4 v12, s[8:11], s43 offen lds
s_add_u32 m0, s49, 50176
s_nop 0
buffer_load_dwordx4 v13, s[8:11], s43 offen lds
s_add_u32 m0, s49, 51200
s_nop 0
buffer_load_dwordx4 v14, s[8:11], s43 offen lds
s_add_u32 m0, s49, 52224
s_nop 0
buffer_load_dwordx4 v15, s[8:11], s43 offen lds
s_add_u32 m0, s49, 53248
s_nop 0
buffer_load_dwordx4 v16, s[8:11], s43 offen lds
s_add_u32 m0, s49, 54272
s_nop 0
buffer_load_dwordx4 v17, s[8:11], s43 offen lds
v_add_u32 v21, 49152, v18
v_add_u32 v22, 49152, v19
v_add_u32 v23, 49152, v20
ds_read_b64_tr_b16 a[72:73], v21 offset:24576
ds_read_b64_tr_b16 a[74:75], v21 offset:26112
ds_read_b64_tr_b16 a[76:77], v21 offset:36864
ds_read_b64_tr_b16 a[78:79], v21 offset:38400
ds_read_b64_tr_b16 v[32:33], v22 offset:24576
ds_read_b64_tr_b16 v[34:35], v22 offset:26112
ds_read_b64_tr_b16 v[36:37], v22 offset:36864
ds_read_b64_tr_b16 v[38:39], v22 offset:38400
ds_read_b64_tr_b16 a[80:81], v23 offset:24576
ds_read_b64_tr_b16 a[82:83], v23 offset:26112
ds_read_b64_tr_b16 a[84:85], v23 offset:36864
ds_read_b64_tr_b16 a[86:87], v23 offset:38400
s_waitcnt vmcnt(24)
s_waitcnt lgkmcnt(0)
s_barrier
s_mul_i32 s43, s25, 384
s_add_u32 s43, s43, 7077888
s_add_u32 m0, s49, 73728
s_nop 0
buffer_load_dwordx4 v12, s[8:11], s43 offen lds
s_add_u32 m0, s49, 74752
s_nop 0
buffer_load_dwordx4 v13, s[8:11], s43 offen lds
s_add_u32 m0, s49, 75776
s_nop 0
buffer_load_dwordx4 v14, s[8:11], s43 offen lds
s_add_u32 m0, s49, 76800
s_nop 0
buffer_load_dwordx4 v15, s[8:11], s43 offen lds
s_add_u32 m0, s49, 77824
s_nop 0
buffer_load_dwordx4 v16, s[8:11], s43 offen lds
s_add_u32 m0, s49, 78848
s_nop 0
buffer_load_dwordx4 v17, s[8:11], s43 offen lds
v_add_u32 v21, 98304, v18
v_add_u32 v22, 98304, v19
v_add_u32 v23, 98304, v20
ds_read_b64_tr_b16 a[88:89], v21 offset:0
ds_read_b64_tr_b16 a[90:91], v21 offset:1536
ds_read_b64_tr_b16 a[92:93], v21 offset:12288
ds_read_b64_tr_b16 a[94:95], v21 offset:13824
ds_read_b64_tr_b16 a[96:97], v22 offset:0
ds_read_b64_tr_b16 a[98:99], v22 offset:1536
ds_read_b64_tr_b16 a[100:101], v22 offset:12288
ds_read_b64_tr_b16 a[102:103], v22 offset:13824
ds_read_b64_tr_b16 a[104:105], v23 offset:0
ds_read_b64_tr_b16 a[106:107], v23 offset:1536
ds_read_b64_tr_b16 a[108:109], v23 offset:12288
ds_read_b64_tr_b16 a[110:111], v23 offset:13824
s_waitcnt vmcnt(24)
s_waitcnt lgkmcnt(0)
s_barrier
v_add_u32 v21, 98304, v18
v_add_u32 v22, 98304, v19
v_add_u32 v23, 98304, v20
ds_read_b64_tr_b16 a[112:113], v21 offset:24576
ds_read_b64_tr_b16 a[114:115], v21 offset:26112
ds_read_b64_tr_b16 a[116:117], v21 offset:36864
ds_read_b64_tr_b16 a[118:119], v21 offset:38400
ds_read_b64_tr_b16 v[40:41], v22 offset:24576
ds_read_b64_tr_b16 v[42:43], v22 offset:26112
ds_read_b64_tr_b16 v[44:45], v22 offset:36864
ds_read_b64_tr_b16 v[46:47], v22 offset:38400
ds_read_b64_tr_b16 a[120:121], v23 offset:24576
ds_read_b64_tr_b16 a[122:123], v23 offset:26112
ds_read_b64_tr_b16 a[124:125], v23 offset:36864
ds_read_b64_tr_b16 a[126:127], v23 offset:38400
s_waitcnt vmcnt(18)
s_waitcnt lgkmcnt(0)
s_barrier
v_add_u32 v21, 0, v18
v_add_u32 v22, 0, v19
v_add_u32 v23, 0, v20
ds_read_b64_tr_b16 a[128:129], v21 offset:0
ds_read_b64_tr_b16 a[130:131], v21 offset:1536
ds_read_b64_tr_b16 a[132:133], v21 offset:12288
ds_read_b64_tr_b16 a[134:135], v21 offset:13824
ds_read_b64_tr_b16 a[136:137], v22 offset:0
ds_read_b64_tr_b16 a[138:139], v22 offset:1536
ds_read_b64_tr_b16 a[140:141], v22 offset:12288
ds_read_b64_tr_b16 a[142:143], v22 offset:13824
ds_read_b64_tr_b16 a[144:145], v23 offset:0
ds_read_b64_tr_b16 a[146:147], v23 offset:1536
ds_read_b64_tr_b16 a[148:149], v23 offset:12288
ds_read_b64_tr_b16 a[150:151], v23 offset:13824
s_waitcnt vmcnt(12)
s_waitcnt lgkmcnt(0)
s_barrier
v_add_u32 v21, 0, v18
v_add_u32 v22, 0, v19
v_add_u32 v23, 0, v20
ds_read_b64_tr_b16 a[152:153], v21 offset:24576
ds_read_b64_tr_b16 a[154:155], v21 offset:26112
ds_read_b64_tr_b16 a[156:157], v21 offset:36864
ds_read_b64_tr_b16 a[158:159], v21 offset:38400
ds_read_b64_tr_b16 v[48:49], v22 offset:24576
ds_read_b64_tr_b16 v[50:51], v22 offset:26112
ds_read_b64_tr_b16 v[52:53], v22 offset:36864
ds_read_b64_tr_b16 v[54:55], v22 offset:38400
ds_read_b64_tr_b16 a[160:161], v23 offset:24576
ds_read_b64_tr_b16 a[162:163], v23 offset:26112
ds_read_b64_tr_b16 a[164:165], v23 offset:36864
ds_read_b64_tr_b16 a[166:167], v23 offset:38400
s_waitcnt vmcnt(6)
s_waitcnt lgkmcnt(0)
s_barrier
v_add_u32 v21, 49152, v18
v_add_u32 v22, 49152, v19
v_add_u32 v23, 49152, v20
ds_read_b64_tr_b16 a[168:169], v21 offset:0
ds_read_b64_tr_b16 a[170:171], v21 offset:1536
ds_read_b64_tr_b16 a[172:173], v21 offset:12288
ds_read_b64_tr_b16 a[174:175], v21 offset:13824
ds_read_b64_tr_b16 a[176:177], v22 offset:0
ds_read_b64_tr_b16 a[178:179], v22 offset:1536
ds_read_b64_tr_b16 a[180:181], v22 offset:12288
ds_read_b64_tr_b16 a[182:183], v22 offset:13824
ds_read_b64_tr_b16 a[184:185], v23 offset:0
ds_read_b64_tr_b16 a[186:187], v23 offset:1536
ds_read_b64_tr_b16 a[188:189], v23 offset:12288
ds_read_b64_tr_b16 a[190:191], v23 offset:13824
s_waitcnt vmcnt(0)
s_waitcnt lgkmcnt(0)
s_barrier
v_add_u32 v21, 49152, v18
v_add_u32 v22, 49152, v19
v_add_u32 v23, 49152, v20
ds_read_b64_tr_b16 a[192:193], v21 offset:24576
ds_read_b64_tr_b16 a[194:195], v21 offset:26112
ds_read_b64_tr_b16 a[196:197], v21 offset:36864
ds_read_b64_tr_b16 a[198:199], v21 offset:38400
ds_read_b64_tr_b16 v[56:57], v22 offset:24576
ds_read_b64_tr_b16 v[58:59], v22 offset:26112
ds_read_b64_tr_b16 v[60:61], v22 offset:36864
ds_read_b64_tr_b16 v[62:63], v22 offset:38400
ds_read_b64_tr_b16 a[200:201], v23 offset:24576
ds_read_b64_tr_b16 a[202:203], v23 offset:26112
ds_read_b64_tr_b16 a[204:205], v23 offset:36864
ds_read_b64_tr_b16 a[206:207], v23 offset:38400
s_waitcnt lgkmcnt(0)
s_barrier
v_add_u32 v28, 0, v10
v_mul_u32_u24 v29, 3277, v28
v_lshrrev_b32 v29, 18, v29
v_mul_u32_u24 v30, 80, v29
v_sub_u32 v30, v28, v30
s_lshl_b32 s40, s24, 3
v_add_u32 v29, s40, v29
v_and_b32 v31, 3, v29
v_bfe_u32 v12, v29, 3, 1
v_lshl_add_u32 v31, v12, 2, v31
v_lshlrev_b32 v31, 1, v31
v_xor_b32 v30, v30, v31
v_lshlrev_b32 v30, 4, v30
v_mul_u32_u24 v29, 1280, v29
v_add_u32 v18, v29, v30
v_add_u32 v28, 64, v10
v_mul_u32_u24 v29, 3277, v28
v_lshrrev_b32 v29, 18, v29
v_mul_u32_u24 v30, 80, v29
v_sub_u32 v30, v28, v30
s_lshl_b32 s40, s24, 3
v_add_u32 v29, s40, v29
v_and_b32 v31, 3, v29
v_bfe_u32 v12, v29, 3, 1
v_lshl_add_u32 v31, v12, 2, v31
v_lshlrev_b32 v31, 1, v31
v_xor_b32 v30, v30, v31
v_lshlrev_b32 v30, 4, v30
v_mul_u32_u24 v29, 1280, v29
v_add_u32 v19, v29, v30
v_add_u32 v28, 128, v10
v_mul_u32_u24 v29, 3277, v28
v_lshrrev_b32 v29, 18, v29
v_mul_u32_u24 v30, 80, v29
v_sub_u32 v30, v28, v30
s_lshl_b32 s40, s24, 3
v_add_u32 v29, s40, v29
v_and_b32 v31, 3, v29
v_bfe_u32 v12, v29, 3, 1
v_lshl_add_u32 v31, v12, 2, v31
v_lshlrev_b32 v31, 1, v31
v_xor_b32 v30, v30, v31
v_lshlrev_b32 v30, 4, v30
v_mul_u32_u24 v29, 1280, v29
v_add_u32 v20, v29, v30
v_add_u32 v28, 192, v10
v_mul_u32_u24 v29, 3277, v28
v_lshrrev_b32 v29, 18, v29
v_mul_u32_u24 v30, 80, v29
v_sub_u32 v30, v28, v30
s_lshl_b32 s40, s24, 3
v_add_u32 v29, s40, v29
v_and_b32 v31, 3, v29
v_bfe_u32 v12, v29, 3, 1
v_lshl_add_u32 v31, v12, 2, v31
v_lshlrev_b32 v31, 1, v31
v_xor_b32 v30, v30, v31
v_lshlrev_b32 v30, 4, v30
v_mul_u32_u24 v29, 1280, v29
v_add_u32 v21, v29, v30
v_add_u32 v28, 256, v10
v_mul_u32_u24 v29, 3277, v28
v_lshrrev_b32 v29, 18, v29
v_mul_u32_u24 v30, 80, v29
v_sub_u32 v30, v28, v30
s_lshl_b32 s40, s24, 3
v_add_u32 v29, s40, v29
v_and_b32 v31, 3, v29
v_bfe_u32 v12, v29, 3, 1
v_lshl_add_u32 v31, v12, 2, v31
v_lshlrev_b32 v31, 1, v31
v_xor_b32 v30, v30, v31
v_lshlrev_b32 v30, 4, v30
v_mul_u32_u24 v29, 1280, v29
v_add_u32 v22, v29, v30
v_add_u32 v28, 320, v10
v_mul_u32_u24 v29, 3277, v28
v_lshrrev_b32 v29, 18, v29
v_mul_u32_u24 v30, 80, v29
v_sub_u32 v30, v28, v30
s_lshl_b32 s40, s24, 3
v_add_u32 v29, s40, v29
v_and_b32 v31, 3, v29
v_bfe_u32 v12, v29, 3, 1
v_lshl_add_u32 v31, v12, 2, v31
v_lshlrev_b32 v31, 1, v31
v_xor_b32 v30, v30, v31
v_lshlrev_b32 v30, 4, v30
v_mul_u32_u24 v29, 1280, v29
v_add_u32 v23, v29, v30
v_add_u32 v28, 384, v10
v_mul_u32_u24 v29, 3277, v28
v_lshrrev_b32 v29, 18, v29
v_mul_u32_u24 v30, 80, v29
v_sub_u32 v30, v28, v30
s_lshl_b32 s40, s24, 3
v_add_u32 v29, s40, v29
v_and_b32 v31, 3, v29
v_bfe_u32 v12, v29, 3, 1
v_lshl_add_u32 v31, v12, 2, v31
v_lshlrev_b32 v31, 1, v31
v_xor_b32 v30, v30, v31
v_lshlrev_b32 v30, 4, v30
v_mul_u32_u24 v29, 1280, v29
v_add_u32 v24, v29, v30
v_add_u32 v28, 448, v10
v_mul_u32_u24 v29, 3277, v28
v_lshrrev_b32 v29, 18, v29
v_mul_u32_u24 v30, 80, v29
v_sub_u32 v30, v28, v30
s_lshl_b32 s40, s24, 3
v_add_u32 v29, s40, v29
v_and_b32 v31, 3, v29
v_bfe_u32 v12, v29, 3, 1
v_lshl_add_u32 v31, v12, 2, v31
v_lshlrev_b32 v31, 1, v31
v_xor_b32 v30, v30, v31
v_lshlrev_b32 v30, 4, v30
v_mul_u32_u24 v29, 1280, v29
v_add_u32 v25, v29, v30
v_add_u32 v28, 512, v10
v_mul_u32_u24 v29, 3277, v28
v_lshrrev_b32 v29, 18, v29
v_mul_u32_u24 v30, 80, v29
v_sub_u32 v30, v28, v30
s_lshl_b32 s40, s24, 3
v_add_u32 v29, s40, v29
v_and_b32 v31, 3, v29
v_bfe_u32 v12, v29, 3, 1
v_lshl_add_u32 v31, v12, 2, v31
v_lshlrev_b32 v31, 1, v31
v_xor_b32 v30, v30, v31
v_lshlrev_b32 v30, 4, v30
v_mul_u32_u24 v29, 1280, v29
v_add_u32 v26, v29, v30
v_add_u32 v28, 576, v10
v_mul_u32_u24 v29, 3277, v28
v_lshrrev_b32 v29, 18, v29
v_mul_u32_u24 v30, 80, v29
v_sub_u32 v30, v28, v30
s_lshl_b32 s40, s24, 3
v_add_u32 v29, s40, v29
v_and_b32 v31, 3, v29
v_bfe_u32 v12, v29, 3, 1
v_lshl_add_u32 v31, v12, 2, v31
v_lshlrev_b32 v31, 1, v31
v_xor_b32 v30, v30, v31
v_lshlrev_b32 v30, 4, v30
v_mul_u32_u24 v29, 1280, v29
v_add_u32 v27, v29, v30
s_mul_i32 s49, s24, 10240
v_lshrrev_b32 v28, 4, v10
v_bfe_u32 v29, v10, 2, 2
v_lshl_add_u32 v30, v28, 3, v29
v_mul_u32_u24 v30, 1280, v30
v_and_b32 v31, 3, v10
v_lshl_add_u32 v8, v31, 3, v30
v_and_b32 v28, 1, v28
v_lshl_add_u32 v28, v28, 2, v29
v_lshlrev_b32 v9, 5, v28
s_mul_i32 s43, s25, 245760
s_add_u32 s43, s43, 0
s_add_u32 m0, s49, 0
s_nop 0
buffer_load_dwordx4 v18, s[12:15], s43 offen lds
s_add_u32 m0, s49, 1024
s_nop 0
buffer_load_dwordx4 v19, s[12:15], s43 offen lds
s_add_u32 m0, s49, 2048
s_nop 0
buffer_load_dwordx4 v20, s[12:15], s43 offen lds
s_add_u32 m0, s49, 3072
s_nop 0
buffer_load_dwordx4 v21, s[12:15], s43 offen lds
s_add_u32 m0, s49, 4096
s_nop 0
buffer_load_dwordx4 v22, s[12:15], s43 offen lds
s_add_u32 m0, s49, 5120
s_nop 0
buffer_load_dwordx4 v23, s[12:15], s43 offen lds
s_add_u32 m0, s49, 6144
s_nop 0
buffer_load_dwordx4 v24, s[12:15], s43 offen lds
s_add_u32 m0, s49, 7168
s_nop 0
buffer_load_dwordx4 v25, s[12:15], s43 offen lds
s_add_u32 m0, s49, 8192
s_nop 0
buffer_load_dwordx4 v26, s[12:15], s43 offen lds
s_add_u32 m0, s49, 9216
s_nop 0
buffer_load_dwordx4 v27, s[12:15], s43 offen lds
s_mul_i32 s43, s25, 245760
s_add_u32 s43, s43, 40960
s_add_u32 m0, s49, 40960
s_nop 0
buffer_load_dwordx4 v18, s[12:15], s43 offen lds
s_add_u32 m0, s49, 41984
s_nop 0
buffer_load_dwordx4 v19, s[12:15], s43 offen lds
s_add_u32 m0, s49, 43008
s_nop 0
buffer_load_dwordx4 v20, s[12:15], s43 offen lds
s_add_u32 m0, s49, 44032
s_nop 0
buffer_load_dwordx4 v21, s[12:15], s43 offen lds
s_add_u32 m0, s49, 45056
s_nop 0
buffer_load_dwordx4 v22, s[12:15], s43 offen lds
s_add_u32 m0, s49, 46080
s_nop 0
buffer_load_dwordx4 v23, s[12:15], s43 offen lds
s_add_u32 m0, s49, 47104
s_nop 0
buffer_load_dwordx4 v24, s[12:15], s43 offen lds
s_add_u32 m0, s49, 48128
s_nop 0
buffer_load_dwordx4 v25, s[12:15], s43 offen lds
s_add_u32 m0, s49, 49152
s_nop 0
buffer_load_dwordx4 v26, s[12:15], s43 offen lds
s_add_u32 m0, s49, 50176
s_nop 0
buffer_load_dwordx4 v27, s[12:15], s43 offen lds
s_mul_i32 s43, s25, 245760
s_add_u32 s43, s43, 81920
s_add_u32 m0, s49, 81920
s_nop 0
buffer_load_dwordx4 v18, s[12:15], s43 offen lds
s_add_u32 m0, s49, 82944
s_nop 0
buffer_load_dwordx4 v19, s[12:15], s43 offen lds
s_add_u32 m0, s49, 83968
s_nop 0
buffer_load_dwordx4 v20, s[12:15], s43 offen lds
s_add_u32 m0, s49, 84992
s_nop 0
buffer_load_dwordx4 v21, s[12:15], s43 offen lds
s_add_u32 m0, s49, 86016
s_nop 0
buffer_load_dwordx4 v22, s[12:15], s43 offen lds
s_add_u32 m0, s49, 87040
s_nop 0
buffer_load_dwordx4 v23, s[12:15], s43 offen lds
s_add_u32 m0, s49, 88064
s_nop 0
buffer_load_dwordx4 v24, s[12:15], s43 offen lds
s_add_u32 m0, s49, 89088
s_nop 0
buffer_load_dwordx4 v25, s[12:15], s43 offen lds
s_add_u32 m0, s49, 90112
s_nop 0
buffer_load_dwordx4 v26, s[12:15], s43 offen lds
s_add_u32 m0, s49, 91136
s_nop 0
buffer_load_dwordx4 v27, s[12:15], s43 offen lds
s_waitcnt vmcnt(20)
s_barrier
s_mul_i32 s40, s24, 320
s_add_u32 s40, s40, 0
v_xor_b32 v28, s40, v9
v_add_u32 v28, v28, v8
v_add_u32 v28, 0, v28
ds_read_b64_tr_b16 a[208:209], v28 offset:0
ds_read_b64_tr_b16 a[210:211], v28 offset:5120
s_mul_i32 s40, s24, 320
s_add_u32 s40, s40, 32
v_xor_b32 v29, s40, v9
v_add_u32 v29, v29, v8
v_add_u32 v29, 0, v29
ds_read_b64_tr_b16 a[232:233], v29 offset:0
ds_read_b64_tr_b16 a[234:235], v29 offset:5120
s_mul_i32 s40, s24, 320
s_add_u32 s40, s40, 64
v_xor_b32 v28, s40, v9
v_add_u32 v28, v28, v8
v_add_u32 v28, 0, v28
ds_read_b64_tr_b16 v[96:97], v28 offset:0
ds_read_b64_tr_b16 v[98:99], v28 offset:5120
s_mul_i32 s40, s24, 320
s_add_u32 s40, s40, 96
v_xor_b32 v29, s40, v9
v_add_u32 v29, v29, v8
v_add_u32 v29, 0, v29
ds_read_b64_tr_b16 v[112:113], v29 offset:0
ds_read_b64_tr_b16 v[114:115], v29 offset:5120
s_mul_i32 s40, s24, 320
s_add_u32 s40, s40, 128
v_xor_b32 v28, s40, v9
v_add_u32 v28, v28, v8
v_add_u32 v28, 0, v28
ds_read_b64_tr_b16 v[136:137], v28 offset:0
ds_read_b64_tr_b16 v[138:139], v28 offset:5120
s_mul_i32 s40, s24, 320
s_add_u32 s40, s40, 160
v_xor_b32 v29, s40, v9
v_add_u32 v29, v29, v8
v_add_u32 v29, 0, v29
ds_read_b64_tr_b16 v[152:153], v29 offset:0
ds_read_b64_tr_b16 v[154:155], v29 offset:5120
s_mul_i32 s40, s24, 320
s_add_u32 s40, s40, 192
v_xor_b32 v28, s40, v9
v_add_u32 v28, v28, v8
v_add_u32 v28, 0, v28
ds_read_b64_tr_b16 v[176:177], v28 offset:0
ds_read_b64_tr_b16 v[178:179], v28 offset:5120
s_mul_i32 s40, s24, 320
s_add_u32 s40, s40, 224
v_xor_b32 v29, s40, v9
v_add_u32 v29, v29, v8
v_add_u32 v29, 0, v29
ds_read_b64_tr_b16 v[192:193], v29 offset:0
s_waitcnt lgkmcnt(10)
ds_read_b64_tr_b16 v[194:195], v29 offset:5120
s_mul_i32 s40, s24, 320
s_add_u32 s40, s40, 256
v_xor_b32 v28, s40, v9
v_add_u32 v28, v28, v8
v_add_u32 v28, 0, v28
ds_read_b64_tr_b16 v[216:217], v28 offset:0
ds_read_b64_tr_b16 v[218:219], v28 offset:5120
s_mul_i32 s40, s24, 320
s_add_u32 s40, s40, 288
v_xor_b32 v29, s40, v9
v_add_u32 v29, v29, v8
v_add_u32 v29, 0, v29
ds_read_b64_tr_b16 v[232:233], v29 offset:0
ds_read_b64_tr_b16 v[234:235], v29 offset:5120
s_waitcnt lgkmcnt(0)
s_barrier
s_mul_i32 s43, s25, 245760
s_add_u32 s43, s43, 122880
s_add_u32 m0, s49, 0
s_nop 0
buffer_load_dwordx4 v18, s[12:15], s43 offen lds
s_add_u32 m0, s49, 1024
s_nop 0
buffer_load_dwordx4 v19, s[12:15], s43 offen lds
s_add_u32 m0, s49, 2048
s_nop 0
buffer_load_dwordx4 v20, s[12:15], s43 offen lds
s_add_u32 m0, s49, 3072
s_nop 0
buffer_load_dwordx4 v21, s[12:15], s43 offen lds
s_add_u32 m0, s49, 4096
s_nop 0
buffer_load_dwordx4 v22, s[12:15], s43 offen lds
s_add_u32 m0, s49, 5120
s_nop 0
buffer_load_dwordx4 v23, s[12:15], s43 offen lds
s_add_u32 m0, s49, 6144
s_nop 0
buffer_load_dwordx4 v24, s[12:15], s43 offen lds
s_add_u32 m0, s49, 7168
s_nop 0
buffer_load_dwordx4 v25, s[12:15], s43 offen lds
s_add_u32 m0, s49, 8192
s_nop 0
buffer_load_dwordx4 v26, s[12:15], s43 offen lds
s_add_u32 m0, s49, 9216
s_nop 0
buffer_load_dwordx4 v27, s[12:15], s43 offen lds
s_waitcnt vmcnt(20)
s_barrier
s_mul_i32 s40, s24, 320
s_add_u32 s40, s40, 0
v_xor_b32 v28, s40, v9
v_add_u32 v28, v28, v8
v_add_u32 v28, 40960, v28
ds_read_b64_tr_b16 a[212:213], v28 offset:0
ds_read_b64_tr_b16 a[214:215], v28 offset:5120
s_mul_i32 s40, s24, 320
s_add_u32 s40, s40, 32
v_xor_b32 v29, s40, v9
v_add_u32 v29, v29, v8
v_add_u32 v29, 40960, v29
ds_read_b64_tr_b16 a[236:237], v29 offset:0
ds_read_b64_tr_b16 a[238:239], v29 offset:5120
s_mul_i32 s40, s24, 320
s_add_u32 s40, s40, 64
v_xor_b32 v28, s40, v9
v_add_u32 v28, v28, v8
v_add_u32 v28, 40960, v28
ds_read_b64_tr_b16 v[100:101], v28 offset:0
ds_read_b64_tr_b16 v[102:103], v28 offset:5120
s_mul_i32 s40, s24, 320
s_add_u32 s40, s40, 96
v_xor_b32 v29, s40, v9
v_add_u32 v29, v29, v8
v_add_u32 v29, 40960, v29
ds_read_b64_tr_b16 v[116:117], v29 offset:0
ds_read_b64_tr_b16 v[118:119], v29 offset:5120
s_mul_i32 s40, s24, 320
s_add_u32 s40, s40, 128
v_xor_b32 v28, s40, v9
v_add_u32 v28, v28, v8
v_add_u32 v28, 40960, v28
ds_read_b64_tr_b16 v[140:141], v28 offset:0
ds_read_b64_tr_b16 v[142:143], v28 offset:5120
s_mul_i32 s40, s24, 320
s_add_u32 s40, s40, 160
v_xor_b32 v29, s40, v9
v_add_u32 v29, v29, v8
v_add_u32 v29, 40960, v29
ds_read_b64_tr_b16 v[156:157], v29 offset:0
ds_read_b64_tr_b16 v[158:159], v29 offset:5120
s_mul_i32 s40, s24, 320
s_add_u32 s40, s40, 192
v_xor_b32 v28, s40, v9
v_add_u32 v28, v28, v8
v_add_u32 v28, 40960, v28
ds_read_b64_tr_b16 v[180:181], v28 offset:0
ds_read_b64_tr_b16 v[182:183], v28 offset:5120
s_mul_i32 s40, s24, 320
s_add_u32 s40, s40, 224
v_xor_b32 v29, s40, v9
v_add_u32 v29, v29, v8
v_add_u32 v29, 40960, v29
ds_read_b64_tr_b16 v[196:197], v29 offset:0
s_waitcnt lgkmcnt(10)
ds_read_b64_tr_b16 v[198:199], v29 offset:5120
s_mul_i32 s40, s24, 320
s_add_u32 s40, s40, 256
v_xor_b32 v28, s40, v9
v_add_u32 v28, v28, v8
v_add_u32 v28, 40960, v28
ds_read_b64_tr_b16 v[220:221], v28 offset:0
ds_read_b64_tr_b16 v[222:223], v28 offset:5120
s_mul_i32 s40, s24, 320
s_add_u32 s40, s40, 288
v_xor_b32 v29, s40, v9
v_add_u32 v29, v29, v8
v_add_u32 v29, 40960, v29
ds_read_b64_tr_b16 v[236:237], v29 offset:0
ds_read_b64_tr_b16 v[238:239], v29 offset:5120
s_waitcnt lgkmcnt(0)
s_barrier
s_mul_i32 s43, s25, 245760
s_add_u32 s43, s43, 163840
s_add_u32 m0, s49, 40960
s_nop 0
buffer_load_dwordx4 v18, s[12:15], s43 offen lds
s_add_u32 m0, s49, 41984
s_nop 0
buffer_load_dwordx4 v19, s[12:15], s43 offen lds
s_add_u32 m0, s49, 43008
s_nop 0
buffer_load_dwordx4 v20, s[12:15], s43 offen lds
s_add_u32 m0, s49, 44032
s_nop 0
buffer_load_dwordx4 v21, s[12:15], s43 offen lds
s_add_u32 m0, s49, 45056
s_nop 0
buffer_load_dwordx4 v22, s[12:15], s43 offen lds
s_add_u32 m0, s49, 46080
s_nop 0
buffer_load_dwordx4 v23, s[12:15], s43 offen lds
s_add_u32 m0, s49, 47104
s_nop 0
buffer_load_dwordx4 v24, s[12:15], s43 offen lds
s_add_u32 m0, s49, 48128
s_nop 0
buffer_load_dwordx4 v25, s[12:15], s43 offen lds
s_add_u32 m0, s49, 49152
s_nop 0
buffer_load_dwordx4 v26, s[12:15], s43 offen lds
s_add_u32 m0, s49, 50176
s_nop 0
buffer_load_dwordx4 v27, s[12:15], s43 offen lds
s_waitcnt vmcnt(20)
s_barrier
s_mul_i32 s40, s24, 320
s_add_u32 s40, s40, 0
v_xor_b32 v28, s40, v9
v_add_u32 v28, v28, v8
v_add_u32 v28, 81920, v28
ds_read_b64_tr_b16 a[216:217], v28 offset:0
ds_read_b64_tr_b16 a[218:219], v28 offset:5120
s_mul_i32 s40, s24, 320
s_add_u32 s40, s40, 32
v_xor_b32 v29, s40, v9
v_add_u32 v29, v29, v8
v_add_u32 v29, 81920, v29
ds_read_b64_tr_b16 a[240:241], v29 offset:0
ds_read_b64_tr_b16 a[242:243], v29 offset:5120
s_mul_i32 s40, s24, 320
s_add_u32 s40, s40, 64
v_xor_b32 v28, s40, v9
v_add_u32 v28, v28, v8
v_add_u32 v28, 81920, v28
ds_read_b64_tr_b16 v[64:65], v28 offset:0
ds_read_b64_tr_b16 v[66:67], v28 offset:5120
s_mul_i32 s40, s24, 320
s_add_u32 s40, s40, 96
v_xor_b32 v29, s40, v9
v_add_u32 v29, v29, v8
v_add_u32 v29, 81920, v29
ds_read_b64_tr_b16 v[120:121], v29 offset:0
ds_read_b64_tr_b16 v[122:123], v29 offset:5120
s_mul_i32 s40, s24, 320
s_add_u32 s40, s40, 128
v_xor_b32 v28, s40, v9
v_add_u32 v28, v28, v8
v_add_u32 v28, 81920, v28
ds_read_b64_tr_b16 v[72:73], v28 offset:0
ds_read_b64_tr_b16 v[74:75], v28 offset:5120
s_mul_i32 s40, s24, 320
s_add_u32 s40, s40, 160
v_xor_b32 v29, s40, v9
v_add_u32 v29, v29, v8
v_add_u32 v29, 81920, v29
ds_read_b64_tr_b16 v[160:161], v29 offset:0
ds_read_b64_tr_b16 v[162:163], v29 offset:5120
s_mul_i32 s40, s24, 320
s_add_u32 s40, s40, 192
v_xor_b32 v28, s40, v9
v_add_u32 v28, v28, v8
v_add_u32 v28, 81920, v28
ds_read_b64_tr_b16 v[80:81], v28 offset:0
ds_read_b64_tr_b16 v[82:83], v28 offset:5120
s_mul_i32 s40, s24, 320
s_add_u32 s40, s40, 224
v_xor_b32 v29, s40, v9
v_add_u32 v29, v29, v8
v_add_u32 v29, 81920, v29
ds_read_b64_tr_b16 v[200:201], v29 offset:0
s_waitcnt lgkmcnt(10)
ds_read_b64_tr_b16 v[202:203], v29 offset:5120
s_mul_i32 s40, s24, 320
s_add_u32 s40, s40, 256
v_xor_b32 v28, s40, v9
v_add_u32 v28, v28, v8
v_add_u32 v28, 81920, v28
ds_read_b64_tr_b16 v[88:89], v28 offset:0
ds_read_b64_tr_b16 v[90:91], v28 offset:5120
s_mul_i32 s40, s24, 320
s_add_u32 s40, s40, 288
v_xor_b32 v29, s40, v9
v_add_u32 v29, v29, v8
v_add_u32 v29, 81920, v29
ds_read_b64_tr_b16 v[240:241], v29 offset:0
ds_read_b64_tr_b16 v[242:243], v29 offset:5120
s_waitcnt lgkmcnt(0)
s_barrier
s_mul_i32 s43, s25, 245760
s_add_u32 s43, s43, 204800
s_add_u32 m0, s49, 81920
s_nop 0
buffer_load_dwordx4 v18, s[12:15], s43 offen lds
s_add_u32 m0, s49, 82944
s_nop 0
buffer_load_dwordx4 v19, s[12:15], s43 offen lds
s_add_u32 m0, s49, 83968
s_nop 0
buffer_load_dwordx4 v20, s[12:15], s43 offen lds
s_add_u32 m0, s49, 84992
s_nop 0
buffer_load_dwordx4 v21, s[12:15], s43 offen lds
s_add_u32 m0, s49, 86016
s_nop 0
buffer_load_dwordx4 v22, s[12:15], s43 offen lds
s_add_u32 m0, s49, 87040
s_nop 0
buffer_load_dwordx4 v23, s[12:15], s43 offen lds
s_add_u32 m0, s49, 88064
s_nop 0
buffer_load_dwordx4 v24, s[12:15], s43 offen lds
s_add_u32 m0, s49, 89088
s_nop 0
buffer_load_dwordx4 v25, s[12:15], s43 offen lds
s_add_u32 m0, s49, 90112
s_nop 0
buffer_load_dwordx4 v26, s[12:15], s43 offen lds
s_add_u32 m0, s49, 91136
s_nop 0
buffer_load_dwordx4 v27, s[12:15], s43 offen lds
s_waitcnt vmcnt(20)
s_barrier
s_mul_i32 s40, s24, 320
s_add_u32 s40, s40, 0
v_xor_b32 v28, s40, v9
v_add_u32 v28, v28, v8
v_add_u32 v28, 0, v28
ds_read_b64_tr_b16 a[220:221], v28 offset:0
ds_read_b64_tr_b16 a[222:223], v28 offset:5120
s_mul_i32 s40, s24, 320
s_add_u32 s40, s40, 32
v_xor_b32 v29, s40, v9
v_add_u32 v29, v29, v8
v_add_u32 v29, 0, v29
ds_read_b64_tr_b16 a[244:245], v29 offset:0
ds_read_b64_tr_b16 a[246:247], v29 offset:5120
s_mul_i32 s40, s24, 320
s_add_u32 s40, s40, 64
v_xor_b32 v28, s40, v9
v_add_u32 v28, v28, v8
v_add_u32 v28, 0, v28
ds_read_b64_tr_b16 v[68:69], v28 offset:0
ds_read_b64_tr_b16 v[70:71], v28 offset:5120
s_mul_i32 s40, s24, 320
s_add_u32 s40, s40, 96
v_xor_b32 v29, s40, v9
v_add_u32 v29, v29, v8
v_add_u32 v29, 0, v29
ds_read_b64_tr_b16 v[124:125], v29 offset:0
ds_read_b64_tr_b16 v[126:127], v29 offset:5120
s_mul_i32 s40, s24, 320
s_add_u32 s40, s40, 128
v_xor_b32 v28, s40, v9
v_add_u32 v28, v28, v8
v_add_u32 v28, 0, v28
ds_read_b64_tr_b16 v[76:77], v28 offset:0
ds_read_b64_tr_b16 v[78:79], v28 offset:5120
s_mul_i32 s40, s24, 320
s_add_u32 s40, s40, 160
v_xor_b32 v29, s40, v9
v_add_u32 v29, v29, v8
v_add_u32 v29, 0, v29
ds_read_b64_tr_b16 v[164:165], v29 offset:0
ds_read_b64_tr_b16 v[166:167], v29 offset:5120
s_mul_i32 s40, s24, 320
s_add_u32 s40, s40, 192
v_xor_b32 v28, s40, v9
v_add_u32 v28, v28, v8
v_add_u32 v28, 0, v28
ds_read_b64_tr_b16 v[84:85], v28 offset:0
ds_read_b64_tr_b16 v[86:87], v28 offset:5120
s_mul_i32 s40, s24, 320
s_add_u32 s40, s40, 224
v_xor_b32 v29, s40, v9
v_add_u32 v29, v29, v8
v_add_u32 v29, 0, v29
ds_read_b64_tr_b16 v[204:205], v29 offset:0
s_waitcnt lgkmcnt(10)
ds_read_b64_tr_b16 v[206:207], v29 offset:5120
s_mul_i32 s40, s24, 320
s_add_u32 s40, s40, 256
v_xor_b32 v28, s40, v9
v_add_u32 v28, v28, v8
v_add_u32 v28, 0, v28
ds_read_b64_tr_b16 v[92:93], v28 offset:0
ds_read_b64_tr_b16 v[94:95], v28 offset:5120
s_mul_i32 s40, s24, 320
s_add_u32 s40, s40, 288
v_xor_b32 v29, s40, v9
v_add_u32 v29, v29, v8
v_add_u32 v29, 0, v29
ds_read_b64_tr_b16 v[244:245], v29 offset:0
ds_read_b64_tr_b16 v[246:247], v29 offset:5120
s_waitcnt vmcnt(10)
s_waitcnt lgkmcnt(0)
s_barrier
s_mul_i32 s40, s24, 320
s_add_u32 s40, s40, 0
v_xor_b32 v28, s40, v9
v_add_u32 v28, v28, v8
v_add_u32 v28, 40960, v28
ds_read_b64_tr_b16 a[224:225], v28 offset:0
ds_read_b64_tr_b16 a[226:227], v28 offset:5120
s_mul_i32 s40, s24, 320
s_add_u32 s40, s40, 32
v_xor_b32 v29, s40, v9
v_add_u32 v29, v29, v8
v_add_u32 v29, 40960, v29
ds_read_b64_tr_b16 a[248:249], v29 offset:0
ds_read_b64_tr_b16 a[250:251], v29 offset:5120
s_mul_i32 s40, s24, 320
s_add_u32 s40, s40, 64
v_xor_b32 v28, s40, v9
v_add_u32 v28, v28, v8
v_add_u32 v28, 40960, v28
ds_read_b64_tr_b16 v[104:105], v28 offset:0
ds_read_b64_tr_b16 v[106:107], v28 offset:5120
s_mul_i32 s40, s24, 320
s_add_u32 s40, s40, 96
v_xor_b32 v29, s40, v9
v_add_u32 v29, v29, v8
v_add_u32 v29, 40960, v29
ds_read_b64_tr_b16 v[128:129], v29 offset:0
ds_read_b64_tr_b16 v[130:131], v29 offset:5120
s_mul_i32 s40, s24, 320
s_add_u32 s40, s40, 128
v_xor_b32 v28, s40, v9
v_add_u32 v28, v28, v8
v_add_u32 v28, 40960, v28
ds_read_b64_tr_b16 v[144:145], v28 offset:0
ds_read_b64_tr_b16 v[146:147], v28 offset:5120
s_mul_i32 s40, s24, 320
s_add_u32 s40, s40, 160
v_xor_b32 v29, s40, v9
v_add_u32 v29, v29, v8
v_add_u32 v29, 40960, v29
ds_read_b64_tr_b16 v[168:169], v29 offset:0
ds_read_b64_tr_b16 v[170:171], v29 offset:5120
s_mul_i32 s40, s24, 320
s_add_u32 s40, s40, 192
v_xor_b32 v28, s40, v9
v_add_u32 v28, v28, v8
v_add_u32 v28, 40960, v28
ds_read_b64_tr_b16 v[184:185], v28 offset:0
ds_read_b64_tr_b16 v[186:187], v28 offset:5120
s_mul_i32 s40, s24, 320
s_add_u32 s40, s40, 224
v_xor_b32 v29, s40, v9
v_add_u32 v29, v29, v8
v_add_u32 v29, 40960, v29
ds_read_b64_tr_b16 v[208:209], v29 offset:0
s_waitcnt lgkmcnt(10)
ds_read_b64_tr_b16 v[210:211], v29 offset:5120
s_mul_i32 s40, s24, 320
s_add_u32 s40, s40, 256
v_xor_b32 v28, s40, v9
v_add_u32 v28, v28, v8
v_add_u32 v28, 40960, v28
ds_read_b64_tr_b16 v[224:225], v28 offset:0
ds_read_b64_tr_b16 v[226:227], v28 offset:5120
s_mul_i32 s40, s24, 320
s_add_u32 s40, s40, 288
v_xor_b32 v29, s40, v9
v_add_u32 v29, v29, v8
v_add_u32 v29, 40960, v29
ds_read_b64_tr_b16 v[248:249], v29 offset:0
ds_read_b64_tr_b16 v[250:251], v29 offset:5120
s_waitcnt vmcnt(0)
s_waitcnt lgkmcnt(0)
s_barrier
s_mul_i32 s40, s24, 320
s_add_u32 s40, s40, 0
v_xor_b32 v28, s40, v9
v_add_u32 v28, v28, v8
v_add_u32 v28, 81920, v28
ds_read_b64_tr_b16 a[228:229], v28 offset:0
ds_read_b64_tr_b16 a[230:231], v28 offset:5120
s_mul_i32 s40, s24, 320
s_add_u32 s40, s40, 32
v_xor_b32 v29, s40, v9
v_add_u32 v29, v29, v8
v_add_u32 v29, 81920, v29
ds_read_b64_tr_b16 a[252:253], v29 offset:0
ds_read_b64_tr_b16 a[254:255], v29 offset:5120
s_mul_i32 s40, s24, 320
s_add_u32 s40, s40, 64
v_xor_b32 v28, s40, v9
v_add_u32 v28, v28, v8
v_add_u32 v28, 81920, v28
ds_read_b64_tr_b16 v[108:109], v28 offset:0
ds_read_b64_tr_b16 v[110:111], v28 offset:5120
s_mul_i32 s40, s24, 320
s_add_u32 s40, s40, 96
v_xor_b32 v29, s40, v9
v_add_u32 v29, v29, v8
v_add_u32 v29, 81920, v29
ds_read_b64_tr_b16 v[132:133], v29 offset:0
ds_read_b64_tr_b16 v[134:135], v29 offset:5120
s_mul_i32 s40, s24, 320
s_add_u32 s40, s40, 128
v_xor_b32 v28, s40, v9
v_add_u32 v28, v28, v8
v_add_u32 v28, 81920, v28
ds_read_b64_tr_b16 v[148:149], v28 offset:0
ds_read_b64_tr_b16 v[150:151], v28 offset:5120
s_mul_i32 s40, s24, 320
s_add_u32 s40, s40, 160
v_xor_b32 v29, s40, v9
v_add_u32 v29, v29, v8
v_add_u32 v29, 81920, v29
ds_read_b64_tr_b16 v[172:173], v29 offset:0
ds_read_b64_tr_b16 v[174:175], v29 offset:5120
s_mul_i32 s40, s24, 320
s_add_u32 s40, s40, 192
v_xor_b32 v28, s40, v9
v_add_u32 v28, v28, v8
v_add_u32 v28, 81920, v28
ds_read_b64_tr_b16 v[188:189], v28 offset:0
ds_read_b64_tr_b16 v[190:191], v28 offset:5120
s_mul_i32 s40, s24, 320
s_add_u32 s40, s40, 224
v_xor_b32 v29, s40, v9
v_add_u32 v29, v29, v8
v_add_u32 v29, 81920, v29
ds_read_b64_tr_b16 v[212:213], v29 offset:0
s_waitcnt lgkmcnt(10)
ds_read_b64_tr_b16 v[214:215], v29 offset:5120
s_mul_i32 s40, s24, 320
s_add_u32 s40, s40, 256
v_xor_b32 v28, s40, v9
v_add_u32 v28, v28, v8
v_add_u32 v28, 81920, v28
ds_read_b64_tr_b16 v[228:229], v28 offset:0
ds_read_b64_tr_b16 v[230:231], v28 offset:5120
s_mul_i32 s40, s24, 320
s_add_u32 s40, s40, 288
v_xor_b32 v29, s40, v9
v_add_u32 v29, v29, v8
v_add_u32 v29, 81920, v29
ds_read_b64_tr_b16 v[252:253], v29 offset:0
ds_read_b64_tr_b16 v[254:255], v29 offset:5120
s_waitcnt lgkmcnt(0)
s_lshl_b32 s40, s24, 14
s_add_u32 s40, s40, 65536
v_lshlrev_b32 v11, 4, v10
v_add_u32 v11, s40, v11
s_barrier
ds_write_b128 v11, v[32:35] offset:0
ds_write_b128 v11, v[36:39] offset:1024
ds_write_b128 v11, v[40:43] offset:2048
ds_write_b128 v11, v[44:47] offset:3072
ds_write_b128 v11, v[48:51] offset:4096
ds_write_b128 v11, v[52:55] offset:5120
ds_write_b128 v11, v[56:59] offset:6144
ds_write_b128 v11, v[60:63] offset:7168
ds_write_b128 v11, v[64:67] offset:8192
ds_write_b128 v11, v[68:71] offset:9216
ds_write_b128 v11, v[72:75] offset:10240
ds_write_b128 v11, v[76:79] offset:11264
ds_write_b128 v11, v[80:83] offset:12288
ds_write_b128 v11, v[84:87] offset:13312
ds_write_b128 v11, v[88:91] offset:14336
ds_write_b128 v11, v[92:95] offset:15360
s_waitcnt lgkmcnt(0)
s_mov_b32 s44, 0
vo_gp:
v_mov_b32 v16, 40
global_load_dword v17, v16, s[86:87] sc1
s_waitcnt vmcnt(0)
v_readfirstlane_b32 s45, v17
s_cmp_lg_u32 s45, 0
s_cbranch_scc1 vo_gpd
s_sleep 8
s_add_u32 s44, s44, 1
s_cmp_lt_u32 s44, 0x100000
s_cbranch_scc1 vo_gp
s_branch timeout
vo_gpd:
s_and_b32 s27, s45, 1
s_lshl_b32 s27, s27, 13
s_and_b32 s83, s45, 2
s_lshl_b32 s83, s83, 12
s_add_u32 s28, s27, 0
s_add_u32 s31, s27, 98304
s_add_u32 s34, s27, 294912
s_mov_b32 s37, 4194304
s_add_u32 s29, s27, 32768
s_add_u32 s32, s27, 163840
s_add_u32 s35, s27, 950272
s_mov_b32 s38, 4276224
s_add_u32 s30, s27, 65536
s_add_u32 s33, s27, 229376
s_add_u32 s36, s83, 2162688
s_mov_b32 s39, 4358144
v_lshlrev_b32 v1, 4, v10
s_lshl_b32 s40, s24, 10
v_add_u32 v2, s40, v1
s_lshl_b32 s41, s24, 9
s_add_u32 s41, s41, 16384
v_add_u32 v4, s41, v1
v_and_b32 v5, 8, v10
v_cmp_eq_u32 vcc, 0, v5
v_mov_b32 v5, 0xeeeeeeee
v_mov_b32 v9, 0x44444444
v_cndmask_b32 v5, v5, v9, vcc
v_and_b32 v16, 15, v10
v_lshrrev_b32 v17, 4, v10
v_and_b32 v18, 1, v17
v_lshlrev_b32 v18, 1, v18
v_lshrrev_b32 v19, 5, v10
v_add_u32 v18, v18, v19
v_lshlrev_b32 v18, 2, v18
v_lshl_add_u32 v18, v16, 4, v18
s_mul_i32 s40, s24, 768
s_add_u32 s40, s40, 8192
v_add_u32 v12, s40, v18
v_bfe_u32 v18, v10, 2, 2
v_and_b32 v19, 3, v10
v_lshlrev_b32 v20, 4, v17
v_lshrrev_b32 v21, 1, v18
v_lshl_add_u32 v20, v21, 2, v20
v_lshrrev_b32 v21, 1, v19
v_lshl_add_u32 v20, v21, 1, v20
v_and_b32 v21, 1, v18
v_add_u32 v20, v20, v21
v_lshlrev_b32 v20, 4, v20
v_and_b32 v21, 1, v19
v_lshl_add_u32 v20, v21, 3, v20
v_add_u32 v13, 8192, v20
s_mul_i32 s40, s24, 163840
s_lshl_b32 s41, s25, 8
s_add_u32 s40, s40, s41
v_lshlrev_b32 v18, 14, v17
v_lshl_add_u32 v18, v16, 4, v18
v_add_u32 v14, s40, v18
v_lshrrev_b32 v18, 5, v10
v_add_u32 v18, 8, v18
v_lshlrev_b32 v18, 14, v18
v_lshl_add_u32 v18, v16, 4, v18
v_add_u32 v15, s40, v18
s_mov_b32 s70, 0x0000ffff
s_mov_b32 s71, 0x0000ffff
v_mov_b32 v32, -1
v_mov_b32 v33, -1
v_mov_b32 v34, -1
v_mov_b32 v35, -1
buffer_store_dwordx4 v[32:35], v14, s[4:7], s34 offen sc1
s_add_u32 s41, s34, 65536
buffer_store_dwordx4 v[32:35], v14, s[4:7], s41 offen sc1
s_mov_b64 exec, s[70:71]
buffer_store_dwordx4 v[32:35], v15, s[4:7], s34 offen sc1
s_mov_b64 exec, -1
buffer_store_dwordx4 v[32:35], v14, s[4:7], s35 offen sc1
s_add_u32 s41, s35, 65536
buffer_store_dwordx4 v[32:35], v14, s[4:7], s41 offen sc1
s_mov_b64 exec, s[70:71]
buffer_store_dwordx4 v[32:35], v15, s[4:7], s35 offen sc1
s_mov_b64 exec, -1
buffer_store_dwordx4 v[32:35], v14, s[4:7], s36 offen sc1
s_add_u32 s41, s36, 65536
buffer_store_dwordx4 v[32:35], v14, s[4:7], s41 offen sc1
s_mov_b64 exec, s[70:71]
buffer_store_dwordx4 v[32:35], v15, s[4:7], s36 offen sc1
s_mov_b64 exec, -1
s_waitcnt vmcnt(0)
s_barrier
s_cmp_eq_u32 s24, 0
s_cbranch_scc0 vo_as
v_mov_b32 v16, 68
v_mov_b32 v17, 1
s_mov_b64 exec, 1
global_atomic_add v16, v17, s[86:87] sc1
s_mov_b64 exec, -1
vo_as:
s_cmp_eq_u32 s24, 0
s_cbranch_scc0 voa1_wd
s_mov_b32 s46, 0
v_mov_b32 v17, 68
voa1_wf:
global_load_dword v16, v17, s[86:87] sc1
s_waitcnt vmcnt(0)
v_readfirstlane_b32 s45, v16
s_cmp_ge_u32 s45, 104
s_cbranch_scc1 voa1_wd
s_sleep 6
s_add_u32 s46, s46, 1
s_cmp_lt_u32 s46, 0x100000
s_cbranch_scc1 voa1_wf
s_branch timeout
voa1_wd:
s_barrier
s_cmp_eq_u32 s24, 0
s_cbranch_scc0 voa2_wd
s_mov_b32 s46, 0
v_mov_b32 v17, 64
voa2_wf:
global_load_dword v16, v17, s[86:87] sc1
s_waitcnt vmcnt(0)
v_readfirstlane_b32 s45, v16
s_cmp_ge_u32 s45, 128
s_cbranch_scc1 voa2_wd
s_sleep 6
s_add_u32 s46, s46, 1
s_cmp_lt_u32 s46, 0x100000
s_cbranch_scc1 voa2_wf
s_branch timeout
voa2_wd:
s_barrier
s_mov_b32 s26, 0
vo_step:
v_mov_b32 v16, 0
v_mov_b32 v17, 0
v_mov_b32 v18, 0
v_mov_b32 v19, 0
v_mov_b32 v20, 0
v_mov_b32 v21, 0
v_mov_b32 v22, 0
v_mov_b32 v23, 0
v_mov_b32 v24, 0
v_mov_b32 v25, 0
v_mov_b32 v26, 0
v_mov_b32 v27, 0
v_mov_b32 v28, 0
v_mov_b32 v29, 0
v_mov_b32 v30, 0
v_mov_b32 v31, 0
v_mov_b32 v32, 0
v_mov_b32 v33, 0
v_mov_b32 v34, 0
v_mov_b32 v35, 0
v_mov_b32 v36, 0
v_mov_b32 v37, 0
v_mov_b32 v38, 0
v_mov_b32 v39, 0
v_mov_b32 v40, 0
v_mov_b32 v41, 0
v_mov_b32 v42, 0
v_mov_b32 v43, 0
v_mov_b32 v44, 0
v_mov_b32 v45, 0
v_mov_b32 v46, 0
v_mov_b32 v47, 0
v_mov_b32 v48, 0
v_mov_b32 v49, 0
v_mov_b32 v50, 0
v_mov_b32 v51, 0
v_mov_b32 v52, 0
v_mov_b32 v53, 0
v_mov_b32 v54, 0
v_mov_b32 v55, 0
v_mov_b32 v56, 0
v_mov_b32 v57, 0
v_mov_b32 v58, 0
v_mov_b32 v59, 0
v_mov_b32 v60, 0
v_mov_b32 v61, 0
v_mov_b32 v62, 0
v_mov_b32 v63, 0
v_mov_b32 v64, 0
v_mov_b32 v65, 0
v_mov_b32 v66, 0
v_mov_b32 v67, 0
s_add_u32 s84, s28, 4096
buffer_load_dwordx4 v[68:71], v2, s[4:7], s28 offen sc1
buffer_load_dwordx4 v[72:75], v2, s[4:7], s84 offen sc1
s_mov_b64 exec, s[50:51]
buffer_load_dwordx4 v[76:79], v4, s[4:7], s28 offen sc1
s_mov_b64 exec, -1
s_mov_b32 s42, 0
vo_poll_loop:
s_mov_b64 s[44:45], 0
s_waitcnt vmcnt(2)
v_max3_u32 v9, v68, v69, v70
v_max_u32 v9, v9, v71
v_cmp_eq_u32 vcc, -1, v9
s_or_b64 s[44:45], s[44:45], vcc
s_mov_b64 exec, vcc
buffer_load_dwordx4 v[68:71], v2, s[4:7], s28 offen sc1
s_mov_b64 exec, -1
s_waitcnt vmcnt(2)
v_max3_u32 v9, v72, v73, v74
v_max_u32 v9, v9, v75
v_cmp_eq_u32 vcc, -1, v9
s_or_b64 s[44:45], s[44:45], vcc
s_mov_b64 exec, vcc
buffer_load_dwordx4 v[72:75], v2, s[4:7], s84 offen sc1
s_mov_b64 exec, -1
s_waitcnt vmcnt(2)
v_max3_u32 v9, v76, v77, v78
v_max_u32 v9, v9, v79
s_mov_b64 exec, s[50:51]
v_cmp_eq_u32 vcc, -1, v9
s_or_b64 s[44:45], s[44:45], vcc
s_mov_b64 exec, vcc
buffer_load_dwordx4 v[76:79], v4, s[4:7], s28 offen sc1
s_mov_b64 exec, -1
s_cmp_eq_u64 s[44:45], 0
s_cbranch_scc1 vo_poll_done
s_add_u32 s42, s42, 1
s_cmp_lt_u32 s42, 0x100000
s_cbranch_scc1 vo_poll_loop
s_branch timeout
vo_poll_done:
s_waitcnt vmcnt(0)
ds_write_b128 v2, v[68:71]
ds_write_b128 v2, v[72:75] offset:4096
s_mov_b64 exec, s[50:51]
ds_write_b128 v4, v[76:79]
s_mov_b64 exec, -1
s_waitcnt lgkmcnt(0)
s_barrier
ds_read_b128 v[68:71], v1 offset:0
ds_read_b128 v[72:75], v1 offset:1024
ds_read_b128 v[76:79], v1 offset:2048
ds_read_b128 v[80:83], v1 offset:3072
ds_read_b128 v[84:87], v1 offset:4096
s_waitcnt lgkmcnt(4)
v_smfmac_f32_16x16x64_bf16 v[56:59], v[68:71], a[0:7], v5
v_smfmac_f32_16x16x64_bf16 v[60:63], v[68:71], a[8:15], v5
v_smfmac_f32_16x16x64_bf16 v[64:67], v[68:71], a[16:23], v5
ds_read_b128 v[68:71], v1 offset:5120
s_waitcnt lgkmcnt(4)
v_smfmac_f32_16x16x64_bf16 v[56:59], v[72:75], a[24:31], v5
ds_read_b128 v[88:91], v11 offset:0
v_smfmac_f32_16x16x64_bf16 v[60:63], v[72:75], a[32:39], v5
ds_read_b128 v[92:95], v11 offset:1024
v_smfmac_f32_16x16x64_bf16 v[64:67], v[72:75], a[40:47], v5
ds_read_b128 v[72:75], v1 offset:6144
s_waitcnt lgkmcnt(6)
v_smfmac_f32_16x16x64_bf16 v[56:59], v[76:79], a[48:55], v5
v_smfmac_f32_16x16x64_bf16 v[60:63], v[76:79], a[56:63], v5
v_smfmac_f32_16x16x64_bf16 v[64:67], v[76:79], a[64:71], v5
ds_read_b128 v[76:79], v1 offset:7168
s_waitcnt lgkmcnt(6)
v_smfmac_f32_16x16x64_bf16 v[56:59], v[80:83], a[72:79], v5
s_waitcnt lgkmcnt(2)
v_smfmac_f32_16x16x64_bf16 v[60:63], v[80:83], v[88:95], v5
ds_read_b128 v[88:91], v11 offset:2048
v_smfmac_f32_16x16x64_bf16 v[64:67], v[80:83], a[80:87], v5
ds_read_b128 v[92:95], v11 offset:3072
ds_read_b128 v[80:83], v1 offset:16384
v_smfmac_f32_16x16x64_bf16 v[56:59], v[84:87], a[88:95], v5
v_smfmac_f32_16x16x64_bf16 v[60:63], v[84:87], a[96:103], v5
v_smfmac_f32_16x16x64_bf16 v[64:67], v[84:87], a[104:111], v5
ds_read_b128 v[84:87], v1 offset:17408
v_smfmac_f32_16x16x64_bf16 v[56:59], v[68:71], a[112:119], v5
s_waitcnt lgkmcnt(2)
v_smfmac_f32_16x16x64_bf16 v[60:63], v[68:71], v[88:95], v5
ds_read_b128 v[88:91], v11 offset:4096
v_smfmac_f32_16x16x64_bf16 v[64:67], v[68:71], a[120:127], v5
ds_read_b128 v[92:95], v11 offset:5120
v_smfmac_f32_16x16x64_bf16 v[56:59], v[72:75], a[128:135], v5
v_mov_b32 v6, -1
v_smfmac_f32_16x16x64_bf16 v[60:63], v[72:75], a[136:143], v5
v_mov_b32 v7, -1
v_smfmac_f32_16x16x64_bf16 v[64:67], v[72:75], a[144:151], v5
v_mov_b32 v8, -1
v_smfmac_f32_16x16x64_bf16 v[56:59], v[76:79], a[152:159], v5
s_waitcnt lgkmcnt(0)
v_smfmac_f32_16x16x64_bf16 v[60:63], v[76:79], v[88:95], v5
ds_read_b128 v[88:91], v11 offset:6144
v_smfmac_f32_16x16x64_bf16 v[64:67], v[76:79], a[160:167], v5
ds_read_b128 v[92:95], v11 offset:7168
v_smfmac_f32_16x16x64_bf16 v[56:59], v[80:83], a[168:175], v5
v_mov_b32 v9, -1
v_smfmac_f32_16x16x64_bf16 v[60:63], v[80:83], a[176:183], v5
s_add_u32 s41, s36, 0
v_smfmac_f32_16x16x64_bf16 v[64:67], v[80:83], a[184:191], v5
buffer_store_dwordx4 v[6:9], v14, s[4:7], s41 offen sc1
v_smfmac_f32_16x16x64_bf16 v[56:59], v[84:87], a[192:199], v5
s_waitcnt lgkmcnt(0)
v_smfmac_f32_16x16x64_bf16 v[60:63], v[84:87], v[88:95], v5
s_add_u32 s41, s36, 65536
v_smfmac_f32_16x16x64_bf16 v[64:67], v[84:87], a[200:207], v5
buffer_store_dwordx4 v[6:9], v14, s[4:7], s41 offen sc1
s_mov_b64 exec, s[70:71]
buffer_store_dwordx4 v[6:9], v15, s[4:7], s36 offen sc1
s_mov_b64 exec, -1
v_permlane32_swap_b32 v56, v58
s_nop 0
v_permlane32_swap_b32 v60, v62
s_nop 0
v_permlane32_swap_b32 v64, v66
v_permlane32_swap_b32 v57, v59
v_permlane32_swap_b32 v61, v63
v_permlane32_swap_b32 v65, v67
v_pk_add_f32 v[56:57], v[56:57], v[58:59]
v_pk_add_f32 v[60:61], v[60:61], v[62:63]
v_pk_add_f32 v[64:65], v[64:65], v[66:67]
v_cvt_pk_bf16_f32 v58, v56, v57
v_cvt_pk_bf16_f32 v62, v60, v61
v_cvt_pk_bf16_f32 v66, v64, v65
ds_write_b32 v12, v58 offset:0
ds_write_b32 v12, v62 offset:256
ds_write_b32 v12, v66 offset:512
s_waitcnt lgkmcnt(0)
s_barrier
ds_read_b64_tr_b16 v[68:69], v13 offset:0
ds_read_b64_tr_b16 v[70:71], v13 offset:128
ds_read_b64_tr_b16 v[72:73], v13 offset:1024
ds_read_b64_tr_b16 v[74:75], v13 offset:1152
ds_read_b64_tr_b16 v[76:77], v13 offset:2048
ds_read_b64_tr_b16 v[78:79], v13 offset:2176
ds_read_b128 v[88:91], v11 offset:8192
ds_read_b128 v[92:95], v11 offset:9216
s_waitcnt lgkmcnt(6)
v_smfmac_f32_16x16x64_bf16 v[16:19], v[68:71], a[208:215], v5
s_waitcnt lgkmcnt(4)
v_smfmac_f32_16x16x64_bf16 v[16:19], v[72:75], a[216:223], v5
s_waitcnt lgkmcnt(2)
v_smfmac_f32_16x16x64_bf16 v[16:19], v[76:79], a[224:231], v5
v_smfmac_f32_16x16x64_bf16 v[20:23], v[68:71], a[232:239], v5
v_smfmac_f32_16x16x64_bf16 v[20:23], v[72:75], a[240:247], v5
v_smfmac_f32_16x16x64_bf16 v[20:23], v[76:79], a[248:255], v5
s_nop 4
v_permlane32_swap_b32 v16, v18
v_smfmac_f32_16x16x64_bf16 v[24:27], v[68:71], v[96:103], v5
v_permlane32_swap_b32 v17, v19
s_waitcnt lgkmcnt(0)
v_smfmac_f32_16x16x64_bf16 v[24:27], v[72:75], v[88:95], v5
ds_read_b128 v[88:91], v11 offset:10240
ds_read_b128 v[92:95], v11 offset:11264
v_smfmac_f32_16x16x64_bf16 v[24:27], v[76:79], v[104:111], v5
v_add_f32 v16, v16, v18
v_add_f32 v17, v17, v19
v_smfmac_f32_16x16x64_bf16 v[28:31], v[68:71], v[112:119], v5
v_cvt_pk_bf16_f32 v56, v16, v17
v_smfmac_f32_16x16x64_bf16 v[28:31], v[72:75], v[120:127], v5
v_permlane32_swap_b32 v20, v22
v_smfmac_f32_16x16x64_bf16 v[28:31], v[76:79], v[128:135], v5
v_permlane32_swap_b32 v21, v23
v_smfmac_f32_16x16x64_bf16 v[32:35], v[68:71], v[136:143], v5
v_add_f32 v20, v20, v22
v_add_f32 v21, v21, v23
s_waitcnt lgkmcnt(0)
v_smfmac_f32_16x16x64_bf16 v[32:35], v[72:75], v[88:95], v5
ds_read_b128 v[88:91], v11 offset:12288
ds_read_b128 v[92:95], v11 offset:13312
v_smfmac_f32_16x16x64_bf16 v[32:35], v[76:79], v[144:151], v5
v_cvt_pk_bf16_f32 v57, v20, v21
v_smfmac_f32_16x16x64_bf16 v[36:39], v[68:71], v[152:159], v5
v_permlane32_swap_b32 v24, v26
v_smfmac_f32_16x16x64_bf16 v[36:39], v[72:75], v[160:167], v5
v_permlane32_swap_b32 v25, v27
v_smfmac_f32_16x16x64_bf16 v[36:39], v[76:79], v[168:175], v5
v_add_f32 v24, v24, v26
v_add_f32 v25, v25, v27
v_smfmac_f32_16x16x64_bf16 v[40:43], v[68:71], v[176:183], v5
v_cvt_pk_bf16_f32 v58, v24, v25
s_waitcnt lgkmcnt(0)
v_smfmac_f32_16x16x64_bf16 v[40:43], v[72:75], v[88:95], v5
ds_read_b128 v[88:91], v11 offset:14336
ds_read_b128 v[92:95], v11 offset:15360
v_smfmac_f32_16x16x64_bf16 v[40:43], v[76:79], v[184:191], v5
v_permlane32_swap_b32 v28, v30
v_smfmac_f32_16x16x64_bf16 v[44:47], v[68:71], v[192:199], v5
v_permlane32_swap_b32 v29, v31
v_smfmac_f32_16x16x64_bf16 v[44:47], v[72:75], v[200:207], v5
v_add_f32 v28, v28, v30
v_add_f32 v29, v29, v31
v_smfmac_f32_16x16x64_bf16 v[44:47], v[76:79], v[208:215], v5
v_cvt_pk_bf16_f32 v59, v28, v29
v_smfmac_f32_16x16x64_bf16 v[48:51], v[68:71], v[216:223], v5
v_permlane32_swap_b32 v56, v58
s_waitcnt lgkmcnt(0)
v_smfmac_f32_16x16x64_bf16 v[48:51], v[72:75], v[88:95], v5
v_permlane32_swap_b32 v57, v59
v_smfmac_f32_16x16x64_bf16 v[48:51], v[76:79], v[224:231], v5
s_nop 0
v_permlane16_swap_b32 v56, v57
v_smfmac_f32_16x16x64_bf16 v[52:55], v[68:71], v[232:239], v5
v_permlane16_swap_b32 v58, v59
s_add_u32 s41, s34, 0
v_smfmac_f32_16x16x64_bf16 v[52:55], v[72:75], v[240:247], v5
buffer_store_dwordx4 v[56:59], v14, s[4:7], s41 offen sc1
v_smfmac_f32_16x16x64_bf16 v[52:55], v[76:79], v[248:255], v5
v_permlane32_swap_b32 v32, v34
v_permlane32_swap_b32 v33, v35
v_add_f32 v32, v32, v34
v_add_f32 v33, v33, v35
v_cvt_pk_bf16_f32 v60, v32, v33
v_permlane32_swap_b32 v36, v38
v_permlane32_swap_b32 v37, v39
v_add_f32 v36, v36, v38
v_add_f32 v37, v37, v39
v_cvt_pk_bf16_f32 v61, v36, v37
v_permlane32_swap_b32 v40, v42
v_permlane32_swap_b32 v41, v43
v_add_f32 v40, v40, v42
v_add_f32 v41, v41, v43
v_cvt_pk_bf16_f32 v62, v40, v41
v_permlane32_swap_b32 v44, v46
v_permlane32_swap_b32 v45, v47
v_add_f32 v44, v44, v46
v_add_f32 v45, v45, v47
v_cvt_pk_bf16_f32 v63, v44, v45
v_permlane32_swap_b32 v60, v62
s_nop 0
v_permlane32_swap_b32 v61, v63
s_nop 1
v_permlane16_swap_b32 v60, v61
v_permlane16_swap_b32 v62, v63
s_add_u32 s41, s34, 65536
buffer_store_dwordx4 v[60:63], v14, s[4:7], s41 offen sc1
v_permlane32_swap_b32 v48, v50
v_permlane32_swap_b32 v49, v51
v_add_f32 v48, v48, v50
v_add_f32 v49, v49, v51
v_cvt_pk_bf16_f32 v64, v48, v49
v_permlane32_swap_b32 v52, v54
v_permlane32_swap_b32 v53, v55
v_add_f32 v52, v52, v54
v_add_f32 v53, v53, v55
v_cvt_pk_bf16_f32 v66, v52, v53
s_nop 1
v_permlane32_swap_b32 v64, v66
s_nop 1
v_permlane16_swap_b32 v64, v65
v_permlane16_swap_b32 v66, v67
s_mov_b64 exec, s[70:71]
buffer_store_dwordx4 v[64:67], v15, s[4:7], s34 offen sc1
s_mov_b64 exec, -1
s_mov_b32 s40, s28
s_mov_b32 s28, s29
s_mov_b32 s29, s30
s_mov_b32 s30, s40
s_mov_b32 s40, s34
s_mov_b32 s34, s35
s_mov_b32 s35, s36
s_mov_b32 s36, s40
s_add_u32 s26, s26, 1
s_cmp_lt_u32 s26, 64
s_cbranch_scc1 vo_step
s_branch done
role_r:
s_sub_u32 s25, s42, 64
s_mov_b32 s44, 0
r_gp:
v_mov_b32 v16, 40
global_load_dword v17, v16, s[86:87] sc1
s_waitcnt vmcnt(0)
v_readfirstlane_b32 s45, v17
s_cmp_lg_u32 s45, 0
s_cbranch_scc1 r_gpd
s_sleep 8
s_add_u32 s44, s44, 1
s_cmp_lt_u32 s44, 0x100000
s_cbranch_scc1 r_gp
s_branch timeout
r_gpd:
s_and_b32 s27, s45, 1
s_lshl_b32 s27, s27, 13
s_and_b32 s83, s45, 2
s_lshl_b32 s83, s83, 12
s_add_u32 s28, s27, 0
s_add_u32 s31, s27, 98304
s_add_u32 s34, s27, 294912
s_mov_b32 s37, 4194304
s_add_u32 s29, s27, 32768
s_add_u32 s32, s27, 163840
s_add_u32 s35, s27, 950272
s_mov_b32 s38, 4276224
s_add_u32 s30, s27, 65536
s_add_u32 s33, s27, 229376
s_add_u32 s36, s83, 2162688
s_mov_b32 s39, 4358144
v_lshlrev_b32 v1, 4, v10
v_and_b32 v16, 15, v10
v_lshrrev_b32 v17, 4, v10
v_and_b32 v18, 7, v10
v_bfe_u32 v19, v10, 3, 1
v_cmp_eq_u32 vcc, 0, v19
v_mov_b32 v5, 0xeeeeeeee
v_mov_b32 v8, 0x44444444
v_cndmask_b32 v5, v5, v8, vcc
s_lshl_b32 s40, s24, 14
v_lshrrev_b32 v20, 1, v17
v_lshlrev_b32 v20, 10, v20
v_and_b32 v21, 1, v17
v_lshl_add_u32 v21, v21, 1, v19
v_lshl_add_u32 v20, v21, 7, v20
v_lshl_add_u32 v20, v18, 4, v20
v_add_u32 v2, s40, v20
v_add_u32 v3, 4096, v2
v_lshlrev_b32 v20, 11, v17
v_lshl_add_u32 v20, v19, 6, v20
v_lshl_add_u32 v20, v18, 3, v20
v_add_u32 v20, 512, v20
v_add_u32 v4, s40, v20
s_lshl_b32 s40, s25, 14
s_lshl_b32 s41, s24, 11
s_add_u32 s40, s40, s41
v_lshlrev_b32 v20, 8, v17
v_lshl_add_u32 v20, v16, 4, v20
v_add_u32 v6, s40, v20
s_lshl_b32 s40, s24, 13
v_add_u32 v7, s40, v1
v_add_u32 v11, 4096, v7
v_and_b32 v20, 1, v17
v_lshlrev_b32 v20, 2, v20
v_lshrrev_b32 v21, 5, v10
v_add_u32 v20, v20, v21
v_lshlrev_b32 v20, 6, v20
v_lshl_add_u32 v20, v16, 2, v20
s_lshl_b32 s40, s24, 9
v_add_u32 v12, s40, v20
v_and_b32 v20, 3, v10
v_bfe_u32 v21, v10, 2, 3
v_lshrrev_b32 v22, 5, v10
v_lshlrev_b32 v23, 6, v21
v_lshl_add_u32 v23, v20, 4, v23
v_lshl_add_u32 v13, v22, 3, v23
s_lshr_b32 s40, s25, 2
s_lshr_b32 s41, s40, 3
s_lshl_b32 s41, s41, 14
s_and_b32 s40, s40, 7
s_lshl_b32 s40, s40, 10
s_add_u32 s40, s40, s41
s_and_b32 s41, s25, 3
s_lshl_b32 s41, s41, 8
s_add_u32 s40, s40, s41
v_lshlrev_b32 v23, 4, v21
v_lshl_add_u32 v23, v22, 7, v23
v_add_u32 v14, s40, v23
s_mov_b32 s70, 0x11111111
s_mov_b32 s71, 0x11111111
v_mul_u32_u24 v20, 2560, v17
v_lshl_add_u32 v20, v16, 4, v20
v_add_u32 v24, 2048, v20
v_lshlrev_b32 v20, 8, v17
v_lshl_add_u32 v20, v16, 2, v20
s_lshl_b32 s40, s24, 11
s_add_u32 s40, s40, 4096
v_add_u32 v25, s40, v20
v_lshrrev_b32 v20, 3, v0
v_and_b32 v21, 7, v0
v_lshrrev_b32 v22, 4, v20
v_lshlrev_b32 v22, 10, v22
v_and_b32 v23, 15, v20
v_lshl_add_u32 v22, v23, 6, v22
v_lshl_add_u32 v22, v21, 3, v22
v_add_u32 v26, 4096, v22
v_mul_u32_u24 v22, 1280, v20
v_lshl_add_u32 v22, v21, 2, v22
s_lshl_b32 s40, s25, 5
v_add_u32 v27, s40, v22
s_mul_i32 s81, s25, 32768
s_add_u32 s81, s81, 83886080
s_mov_b32 s82, 0
s_cmp_eq_u32 s24, 0
s_cbranch_scc0 r_noarm
s_load_dwordx2 s[44:45], s[0:1], 8
s_waitcnt lgkmcnt(0)
s_mov_b32 s8, s44
s_and_b32 s9, s45, 0xffff
s_mov_b32 s10, 10240
s_mov_b32 s11, 0x20000
v_and_b32 v20, 3, v10
v_bfe_u32 v21, v10, 2, 3
v_lshrrev_b32 v22, 5, v10
v_mul_u32_u24 v23, 1280, v21
v_lshl_add_u32 v23, v20, 3, v23
v_lshl_add_u32 v23, v22, 2, v23
s_lshl_b32 s40, s25, 5
buffer_load_dword v40, v23, s[8:11], s40 offen
s_waitcnt vmcnt(0)
v_mov_b32_dpp v41, v40 quad_perm:[1,1,1,1] row_mask:0xf bank_mask:0xf
v_mov_b32_dpp v42, v40 quad_perm:[2,2,2,2] row_mask:0xf bank_mask:0xf
v_mov_b32_dpp v43, v40 quad_perm:[3,3,3,3] row_mask:0xf bank_mask:0xf
v_mov_b32 v44, -1
v_mov_b32 v45, -1
v_mov_b32 v46, -1
v_mov_b32 v47, -1
s_mov_b64 exec, s[70:71]
buffer_store_dwordx4 v[40:43], v14, s[4:7], s28 offen sc1
buffer_store_dwordx4 v[44:47], v14, s[4:7], s29 offen sc1
buffer_store_dwordx4 v[44:47], v14, s[4:7], s30 offen sc1
s_mov_b64 exec, -1
r_noarm:
s_waitcnt vmcnt(0)
s_barrier
s_cmp_eq_u32 s24, 0
s_cbranch_scc0 r_as
v_mov_b32 v16, 68
v_mov_b32 v17, 1
s_mov_b64 exec, 1
global_atomic_add v16, v17, s[86:87] sc1
s_mov_b64 exec, -1
r_as:
s_cmp_eq_u32 s24, 0
s_cbranch_scc0 ra1_wd
s_mov_b32 s46, 0
v_mov_b32 v17, 68
ra1_wf:
global_load_dword v16, v17, s[86:87] sc1
s_waitcnt vmcnt(0)
v_readfirstlane_b32 s45, v16
s_cmp_ge_u32 s45, 104
s_cbranch_scc1 ra1_wd
s_sleep 6
s_add_u32 s46, s46, 1
s_cmp_lt_u32 s46, 0x100000
s_cbranch_scc1 ra1_wf
s_branch timeout
ra1_wd:
s_barrier
s_cmp_eq_u32 s24, 0
s_cbranch_scc0 ra2_wd
s_mov_b32 s46, 0
v_mov_b32 v17, 64
ra2_wf:
global_load_dword v16, v17, s[86:87] sc1
s_waitcnt vmcnt(0)
v_readfirstlane_b32 s45, v16
s_cmp_ge_u32 s45, 128
s_cbranch_scc1 ra2_wd
s_sleep 6
s_add_u32 s46, s46, 1
s_cmp_lt_u32 s46, 0x100000
s_cbranch_scc1 ra2_wf
s_branch timeout
ra2_wd:
s_barrier
s_mov_b32 s84, 0
s_lshl_b32 s47, s84, 7
s_add_u32 s47, s47, 201330688
s_mov_b32 s46, 0
v_mov_b32 v10, 0
rvo0_wf:
buffer_load_dword v9, off, s[4:7], s47 sc1
s_waitcnt vmcnt(0)
v_readfirstlane_b32 s45, v9
s_cmp_ge_u32 s45, 64
s_cbranch_scc1 rvo0_wd
s_add_u32 s46, s46, 1
s_cmp_lt_u32 s46, 0x200000
s_cbranch_scc1 rvo0_wf
s_branch timeout
rvo0_wd:
buffer_load_dwordx4 v[128:131], v7, s[4:7], s81 offen offset:0 sc1
buffer_load_dwordx4 v[132:135], v7, s[4:7], s81 offen offset:1024 sc1
buffer_load_dwordx4 v[136:139], v7, s[4:7], s81 offen offset:2048 sc1
buffer_load_dwordx4 v[140:143], v7, s[4:7], s81 offen offset:3072 sc1
buffer_load_dwordx4 v[144:147], v11, s[4:7], s81 offen offset:0 sc1
buffer_load_dwordx4 v[148:151], v11, s[4:7], s81 offen offset:1024 sc1
buffer_load_dwordx4 v[152:155], v11, s[4:7], s81 offen offset:2048 sc1
buffer_load_dwordx4 v[156:159], v11, s[4:7], s81 offen offset:3072 sc1
v_mov_b32 v64, 0
v_mov_b32 v65, 0
v_mov_b32 v66, 0
v_mov_b32 v67, 0
v_mov_b32 v72, 0
v_mov_b32 v73, 0
v_mov_b32 v74, 0
v_mov_b32 v75, 0
v_mov_b32 v80, 0
v_mov_b32 v81, 0
v_mov_b32 v82, 0
v_mov_b32 v83, 0
v_mov_b32 v88, 0
v_mov_b32 v89, 0
v_mov_b32 v90, 0
v_mov_b32 v91, 0
v_mov_b32 v96, 0
v_mov_b32 v97, 0
v_mov_b32 v98, 0
v_mov_b32 v99, 0
v_mov_b32 v104, 0
v_mov_b32 v105, 0
v_mov_b32 v106, 0
v_mov_b32 v107, 0
v_mov_b32 v112, 0
v_mov_b32 v113, 0
v_mov_b32 v114, 0
v_mov_b32 v115, 0
v_mov_b32 v120, 0
v_mov_b32 v121, 0
v_mov_b32 v122, 0
v_mov_b32 v123, 0
s_mov_b32 s26, 0
r_step:
v_mov_b32 v28, 0
v_mov_b32 v29, 0
v_mov_b32 v30, 0
v_mov_b32 v31, 0
buffer_load_dwordx4 v[32:35], v2, s[4:7], s31 offen offset:0 sc1
buffer_load_dwordx4 v[36:39], v2, s[4:7], s31 offen offset:2048 sc1
buffer_load_dwordx4 v[40:43], v3, s[4:7], s31 offen offset:0 sc1
buffer_load_dwordx4 v[44:47], v3, s[4:7], s31 offen offset:2048 sc1
buffer_load_dwordx2 v[48:49], v4, s[4:7], s31 offen sc1
buffer_load_dwordx2 v[50:51], v4, s[4:7], s31 offen offset:1024 sc1
buffer_load_dwordx4 v[56:59], v6, s[4:7], s34 offen sc1
buffer_load_dwordx4 v[60:63], v6, s[4:7], s34 offen offset:1024 sc1
s_mov_b32 s42, 0
r0_poll_loop:
s_mov_b64 s[44:45], 0
s_waitcnt vmcnt(7)
v_max3_u32 v9, v32, v33, v34
v_max_u32 v9, v9, v35
v_cmp_eq_u32 vcc, -1, v9
s_or_b64 s[44:45], s[44:45], vcc
s_mov_b64 exec, vcc
buffer_load_dwordx4 v[32:35], v2, s[4:7], s31 offen offset:0 sc1
s_mov_b64 exec, -1
s_waitcnt vmcnt(7)
v_max3_u32 v9, v36, v37, v38
v_max_u32 v9, v9, v39
v_cmp_eq_u32 vcc, -1, v9
s_or_b64 s[44:45], s[44:45], vcc
s_mov_b64 exec, vcc
buffer_load_dwordx4 v[36:39], v2, s[4:7], s31 offen offset:2048 sc1
s_mov_b64 exec, -1
s_waitcnt vmcnt(7)
v_max3_u32 v9, v40, v41, v42
v_max_u32 v9, v9, v43
v_cmp_eq_u32 vcc, -1, v9
s_or_b64 s[44:45], s[44:45], vcc
s_mov_b64 exec, vcc
buffer_load_dwordx4 v[40:43], v3, s[4:7], s31 offen offset:0 sc1
s_mov_b64 exec, -1
s_waitcnt vmcnt(7)
v_max3_u32 v9, v44, v45, v46
v_max_u32 v9, v9, v47
v_cmp_eq_u32 vcc, -1, v9
s_or_b64 s[44:45], s[44:45], vcc
s_mov_b64 exec, vcc
buffer_load_dwordx4 v[44:47], v3, s[4:7], s31 offen offset:2048 sc1
s_mov_b64 exec, -1
s_waitcnt vmcnt(7)
v_max_u32 v9, v48, v49
v_cmp_eq_u32 vcc, -1, v9
s_or_b64 s[44:45], s[44:45], vcc
s_mov_b64 exec, vcc
buffer_load_dwordx2 v[48:49], v4, s[4:7], s31 offen sc1
s_mov_b64 exec, -1
s_waitcnt vmcnt(7)
v_max_u32 v9, v50, v51
v_cmp_eq_u32 vcc, -1, v9
s_or_b64 s[44:45], s[44:45], vcc
s_mov_b64 exec, vcc
buffer_load_dwordx2 v[50:51], v4, s[4:7], s31 offen offset:1024 sc1
s_mov_b64 exec, -1
s_waitcnt vmcnt(7)
v_max3_u32 v9, v56, v57, v58
v_max_u32 v9, v9, v59
v_cmp_eq_u32 vcc, -1, v9
s_or_b64 s[44:45], s[44:45], vcc
s_mov_b64 exec, vcc
buffer_load_dwordx4 v[56:59], v6, s[4:7], s34 offen sc1
s_mov_b64 exec, -1
s_waitcnt vmcnt(7)
v_max3_u32 v9, v60, v61, v62
v_max_u32 v9, v9, v63
v_cmp_eq_u32 vcc, -1, v9
s_or_b64 s[44:45], s[44:45], vcc
s_mov_b64 exec, vcc
buffer_load_dwordx4 v[60:63], v6, s[4:7], s34 offen offset:1024 sc1
s_mov_b64 exec, -1
s_cmp_eq_u64 s[44:45], 0
s_cbranch_scc1 r0_poll_done
s_add_u32 s42, s42, 1
s_cmp_lt_u32 s42, 0x100000
s_cbranch_scc1 r0_poll_loop
s_branch timeout
r0_poll_done:
s_waitcnt vmcnt(0)
v_smfmac_f32_16x16x64_bf16 v[28:31], v[32:35], v[128:135], v5
v_smfmac_f32_16x16x64_bf16 v[28:31], v[36:39], v[136:143], v5
v_smfmac_f32_16x16x64_bf16 v[28:31], v[40:43], v[144:151], v5
v_smfmac_f32_16x16x64_bf16 v[28:31], v[44:47], v[152:159], v5
v_smfmac_f32_16x16x64_bf16 v[28:31], v[48:51], v[56:63], v5
s_nop 7
v_permlane32_swap_b32 v28, v29
v_permlane32_swap_b32 v30, v31
v_add_f32 v28, v28, v29
v_add_f32 v30, v30, v31
ds_write2_b32 v12, v28, v30 offset0:0 offset1:32
s_waitcnt lgkmcnt(0)
s_barrier
s_cmp_eq_u32 s24, 0
s_cbranch_scc0 r0_nopub
ds_read_b64 v[40:41], v13 offset:0
ds_read_b64 v[42:43], v13 offset:512
ds_read_b64 v[44:45], v13 offset:1024
ds_read_b64 v[46:47], v13 offset:1536
s_waitcnt lgkmcnt(0)
v_add_f32 v40, v40, v42
v_add_f32 v41, v41, v43
v_add_f32 v44, v44, v46
v_add_f32 v45, v45, v47
v_add_f32 v40, v40, v44
v_add_f32 v41, v41, v45
v_cvt_pk_bf16_f32 v40, v40, v41
v_min_u32 v40, -2, v40
s_nop 1
v_mov_b32_dpp v41, v40 quad_perm:[1,1,1,1] row_mask:0xf bank_mask:0xf
v_mov_b32_dpp v42, v40 quad_perm:[2,2,2,2] row_mask:0xf bank_mask:0xf
v_mov_b32_dpp v43, v40 quad_perm:[3,3,3,3] row_mask:0xf bank_mask:0xf
s_mov_b64 exec, s[70:71]
buffer_store_dwordx4 v[40:43], v14, s[4:7], s29 offen sc1
s_mov_b64 exec, -1
s_mov_b64 exec, s[70:71]
v_mov_b32 v44, -1
v_mov_b32 v45, -1
v_mov_b32 v46, -1
v_mov_b32 v47, -1
buffer_store_dwordx4 v[44:47], v14, s[4:7], s28 offen sc1
s_mov_b64 exec, -1
r0_nopub:
s_barrier
s_cmp_eq_u32 s24, 0
s_cbranch_scc0 r0_nsig
s_cmp_lt_u32 s26, 2
s_cbranch_scc1 r0_nsig
s_cmp_ge_u32 s26, 34
s_cbranch_scc1 r0_nsig
s_sub_u32 s41, s26, 2
s_lshl_b32 s41, s41, 7
s_add_u32 s41, s41, 201335808
v_mov_b32 v41, 1
s_mov_b64 exec, 1
buffer_atomic_add v41, off, s[4:7], s41 sc1
s_mov_b64 exec, -1
r0_nsig:
s_cmp_lt_u32 s26, 32
s_cbranch_scc1 r0_nog
s_and_b32 s84, s26, 3
s_cmp_eq_u32 s84, 0
s_cbranch_scc0 r0_nog
s_lshr_b32 s84, s26, 2
s_lshl_b32 s47, s84, 7
s_add_u32 s47, s47, 201333760
s_mov_b32 s46, 0
v_mov_b32 v10, 0
r0g_wf:
buffer_load_dword v9, off, s[4:7], s47 sc1
s_waitcnt vmcnt(0)
v_readfirstlane_b32 s45, v9
s_cmp_ge_u32 s45, 4
s_cbranch_scc1 r0g_wd
s_add_u32 s46, s46, 1
s_cmp_lt_u32 s46, 0x200000
s_cbranch_scc1 r0g_wf
s_branch timeout
r0g_wd:
r0_nog:
s_add_u32 s84, s26, 1
s_and_b32 s85, s84, 3
s_cmp_eq_u32 s85, 0
s_cbranch_scc0 r0_novw
s_cmp_ge_u32 s26, 63
s_cbranch_scc1 r0_novw
s_lshr_b32 s84, s84, 2
s_cmp_lt_u32 s84, 2
s_cselect_b32 s85, 64, 32
s_lshl_b32 s47, s84, 7
s_add_u32 s47, s47, 201330688
s_mov_b32 s46, 0
v_mov_b32 v10, 0
r0v_wf:
buffer_load_dword v9, off, s[4:7], s47 sc1
s_waitcnt vmcnt(0)
v_readfirstlane_b32 s45, v9
s_cmp_ge_u32 s45, s85
s_cbranch_scc1 r0v_wd
s_add_u32 s46, s46, 1
s_cmp_lt_u32 s46, 0x200000
s_cbranch_scc1 r0v_wf
s_branch timeout
r0v_wd:
r0_novw:
s_mul_i32 s40, s24, 20480
s_add_u32 s40, s40, s37
s_mov_b32 s41, s40
s_mov_b64 exec, s[50:51]
buffer_load_dwordx4 v[64:67], v1, s[4:7], s41 offen offset:0 sc1
s_mov_b64 exec, -1
buffer_load_dwordx4 v[68:71], v1, s[4:7], s41 offen offset:1024 sc1
s_add_u32 s41, s41, 2560
s_mov_b64 exec, s[50:51]
buffer_load_dwordx4 v[72:75], v1, s[4:7], s41 offen offset:0 sc1
s_mov_b64 exec, -1
buffer_load_dwordx4 v[76:79], v1, s[4:7], s41 offen offset:1024 sc1
s_add_u32 s41, s41, 2560
s_mov_b64 exec, s[50:51]
buffer_load_dwordx4 v[80:83], v1, s[4:7], s41 offen offset:0 sc1
s_mov_b64 exec, -1
buffer_load_dwordx4 v[84:87], v1, s[4:7], s41 offen offset:1024 sc1
s_add_u32 s41, s41, 2560
s_mov_b64 exec, s[50:51]
buffer_load_dwordx4 v[88:91], v1, s[4:7], s41 offen offset:0 sc1
s_mov_b64 exec, -1
buffer_load_dwordx4 v[92:95], v1, s[4:7], s41 offen offset:1024 sc1
s_add_u32 s41, s41, 2560
s_mov_b64 exec, s[50:51]
buffer_load_dwordx4 v[96:99], v1, s[4:7], s41 offen offset:0 sc1
s_mov_b64 exec, -1
buffer_load_dwordx4 v[100:103], v1, s[4:7], s41 offen offset:1024 sc1
s_add_u32 s41, s41, 2560
s_mov_b64 exec, s[50:51]
buffer_load_dwordx4 v[104:107], v1, s[4:7], s41 offen offset:0 sc1
s_mov_b64 exec, -1
buffer_load_dwordx4 v[108:111], v1, s[4:7], s41 offen offset:1024 sc1
s_add_u32 s41, s41, 2560
s_mov_b64 exec, s[50:51]
buffer_load_dwordx4 v[112:115], v1, s[4:7], s41 offen offset:0 sc1
s_mov_b64 exec, -1
buffer_load_dwordx4 v[116:119], v1, s[4:7], s41 offen offset:1024 sc1
s_add_u32 s41, s41, 2560
s_mov_b64 exec, s[50:51]
buffer_load_dwordx4 v[120:123], v1, s[4:7], s41 offen offset:0 sc1
s_mov_b64 exec, -1
buffer_load_dwordx4 v[124:127], v1, s[4:7], s41 offen offset:1024 sc1
buffer_load_dwordx4 v[192:195], v24, s[4:7], s40 offen offset:0 sc1
buffer_load_dwordx4 v[196:199], v24, s[4:7], s40 offen offset:256 sc1
s_add_u32 s40, s40, 10240
buffer_load_dwordx4 v[200:203], v24, s[4:7], s40 offen offset:0 sc1
buffer_load_dwordx4 v[204:207], v24, s[4:7], s40 offen offset:256 sc1
buffer_load_dword v52, v27, s[16:19], s82 offen
s_add_u32 s41, s82, 176160768
buffer_load_dword v53, v27, s[4:7], s41 offen sc1
s_add_u32 s81, s81, 1310720
buffer_load_dwordx4 v[160:163], v7, s[4:7], s81 offen offset:0 sc1
buffer_load_dwordx4 v[164:167], v7, s[4:7], s81 offen offset:1024 sc1
buffer_load_dwordx4 v[168:171], v7, s[4:7], s81 offen offset:2048 sc1
buffer_load_dwordx4 v[172:175], v7, s[4:7], s81 offen offset:3072 sc1
buffer_load_dwordx4 v[176:179], v11, s[4:7], s81 offen offset:0 sc1
buffer_load_dwordx4 v[180:183], v11, s[4:7], s81 offen offset:1024 sc1
buffer_load_dwordx4 v[184:187], v11, s[4:7], s81 offen offset:2048 sc1
buffer_load_dwordx4 v[188:191], v11, s[4:7], s81 offen offset:3072 sc1
s_cmp_eq_u32 s26, 0
s_cbranch_scc1 r0_noepi
s_sub_u32 s85, s26, 1
s_sub_u32 s84, s82, 40960
ds_read_b64 v[40:41], v26 offset:8192
ds_read_b64 v[42:43], v26 offset:10240
ds_read_b64 v[44:45], v26 offset:12288
ds_read_b64 v[46:47], v26 offset:14336
s_waitcnt lgkmcnt(0)
v_add_f32 v40, v40, v42
v_add_f32 v41, v41, v43
v_add_f32 v44, v44, v46
v_add_f32 v45, v45, v47
v_add_f32 v40, v40, v44
v_add_f32 v41, v41, v45
v_cvt_pk_bf16_f32 v40, v40, v41
s_cmp_lt_u32 s85, 32
s_cbranch_scc0 r0_direct
s_add_u32 s41, s84, 192937984
buffer_store_dword v40, v27, s[4:7], s41 offen sc1
s_branch r0_edone
r0_direct:
v_lshlrev_b32 v41, 16, v40
v_and_b32 v42, 0xffff0000, v40
v_lshlrev_b32 v43, 16, v55
v_and_b32 v44, 0xffff0000, v55
v_mul_f32 v41, v41, v43
v_mul_f32 v42, v42, v44
v_cvt_pk_bf16_f32 v40, v41, v42
v_lshlrev_b32 v41, 16, v40
v_and_b32 v42, 0xffff0000, v40
v_lshlrev_b32 v43, 16, v54
v_and_b32 v44, 0xffff0000, v54
v_add_f32 v41, v41, v43
v_add_f32 v42, v42, v44
v_cvt_pk_bf16_f32 v40, v41, v42
buffer_store_dword v40, v27, s[20:23], s84 offen
r0_edone:
r0_noepi:
s_cmp_eq_u32 s26, 0
s_cbranch_scc0 r0_hasepi
buffer_load_dword v15, off, s[4:7], 0
r0_hasepi:
s_mov_b32 s42, 0
r0_pt:
v_mov_b32 v9, 0
s_waitcnt vmcnt(29)
v_mfma_f32_16x16x32_bf16 v[40:43], v[64:67], v[128:131], 0
v_max3_u32 v9, v9, v64, v65
v_max3_u32 v9, v9, v66, v67
v_mfma_f32_16x16x32_bf16 v[44:47], v[68:71], v[128:131], 0
v_max3_u32 v9, v9, v68, v69
v_max3_u32 v9, v9, v70, v71
s_waitcnt vmcnt(27)
v_mfma_f32_16x16x32_bf16 v[40:43], v[72:75], v[132:135], v[40:43]
v_max3_u32 v9, v9, v72, v73
v_max3_u32 v9, v9, v74, v75
v_mfma_f32_16x16x32_bf16 v[44:47], v[76:79], v[132:135], v[44:47]
v_max3_u32 v9, v9, v76, v77
v_max3_u32 v9, v9, v78, v79
s_waitcnt vmcnt(25)
v_mfma_f32_16x16x32_bf16 v[40:43], v[80:83], v[136:139], v[40:43]
v_max3_u32 v9, v9, v80, v81
v_max3_u32 v9, v9, v82, v83
v_mfma_f32_16x16x32_bf16 v[44:47], v[84:87], v[136:139], v[44:47]
v_max3_u32 v9, v9, v84, v85
v_max3_u32 v9, v9, v86, v87
s_waitcnt vmcnt(23)
v_mfma_f32_16x16x32_bf16 v[40:43], v[88:91], v[140:143], v[40:43]
v_max3_u32 v9, v9, v88, v89
v_max3_u32 v9, v9, v90, v91
v_mfma_f32_16x16x32_bf16 v[44:47], v[92:95], v[140:143], v[44:47]
v_max3_u32 v9, v9, v92, v93
v_max3_u32 v9, v9, v94, v95
s_waitcnt vmcnt(21)
v_mfma_f32_16x16x32_bf16 v[40:43], v[96:99], v[144:147], v[40:43]
v_max3_u32 v9, v9, v96, v97
v_max3_u32 v9, v9, v98, v99
v_mfma_f32_16x16x32_bf16 v[44:47], v[100:103], v[144:147], v[44:47]
v_max3_u32 v9, v9, v100, v101
v_max3_u32 v9, v9, v102, v103
s_waitcnt vmcnt(19)
v_mfma_f32_16x16x32_bf16 v[40:43], v[104:107], v[148:151], v[40:43]
v_max3_u32 v9, v9, v104, v105
v_max3_u32 v9, v9, v106, v107
v_mfma_f32_16x16x32_bf16 v[44:47], v[108:111], v[148:151], v[44:47]
v_max3_u32 v9, v9, v108, v109
v_max3_u32 v9, v9, v110, v111
s_waitcnt vmcnt(17)
v_mfma_f32_16x16x32_bf16 v[40:43], v[112:115], v[152:155], v[40:43]
v_max3_u32 v9, v9, v112, v113
v_max3_u32 v9, v9, v114, v115
v_mfma_f32_16x16x32_bf16 v[44:47], v[116:119], v[152:155], v[44:47]
v_max3_u32 v9, v9, v116, v117
v_max3_u32 v9, v9, v118, v119
s_waitcnt vmcnt(15)
v_mfma_f32_16x16x32_bf16 v[40:43], v[120:123], v[156:159], v[40:43]
v_max3_u32 v9, v9, v120, v121
v_max3_u32 v9, v9, v122, v123
v_mfma_f32_16x16x32_bf16 v[44:47], v[124:127], v[156:159], v[44:47]
v_max3_u32 v9, v9, v124, v125
v_max3_u32 v9, v9, v126, v127
s_waitcnt vmcnt(11)
v_mfma_f32_16x16x32_bf16 v[40:43], v[192:195], v[56:59], v[40:43]
v_max3_u32 v9, v9, v192, v193
v_max3_u32 v9, v9, v194, v195
v_mfma_f32_16x16x32_bf16 v[44:47], v[196:199], v[56:59], v[44:47]
v_max3_u32 v9, v9, v196, v197
v_max3_u32 v9, v9, v198, v199
v_mfma_f32_16x16x32_bf16 v[40:43], v[200:203], v[60:63], v[40:43]
v_max3_u32 v9, v9, v200, v201
v_max3_u32 v9, v9, v202, v203
v_mfma_f32_16x16x32_bf16 v[44:47], v[204:207], v[60:63], v[44:47]
v_max3_u32 v9, v9, v204, v205
v_max3_u32 v9, v9, v206, v207
v_cmp_eq_u32 vcc, -1, v9
s_cbranch_vccz r0_ptok
s_add_u32 s42, s42, 1
s_cmp_lt_u32 s42, 0x100000
s_cbranch_scc0 timeout
s_nop 7
s_mul_i32 s40, s24, 20480
s_add_u32 s40, s40, s37
s_mov_b32 s41, s40
s_mov_b64 exec, s[50:51]
buffer_load_dwordx4 v[64:67], v1, s[4:7], s41 offen offset:0 sc1
s_mov_b64 exec, -1
buffer_load_dwordx4 v[68:71], v1, s[4:7], s41 offen offset:1024 sc1
s_add_u32 s41, s41, 2560
s_mov_b64 exec, s[50:51]
buffer_load_dwordx4 v[72:75], v1, s[4:7], s41 offen offset:0 sc1
s_mov_b64 exec, -1
buffer_load_dwordx4 v[76:79], v1, s[4:7], s41 offen offset:1024 sc1
s_add_u32 s41, s41, 2560
s_mov_b64 exec, s[50:51]
buffer_load_dwordx4 v[80:83], v1, s[4:7], s41 offen offset:0 sc1
s_mov_b64 exec, -1
buffer_load_dwordx4 v[84:87], v1, s[4:7], s41 offen offset:1024 sc1
s_add_u32 s41, s41, 2560
s_mov_b64 exec, s[50:51]
buffer_load_dwordx4 v[88:91], v1, s[4:7], s41 offen offset:0 sc1
s_mov_b64 exec, -1
buffer_load_dwordx4 v[92:95], v1, s[4:7], s41 offen offset:1024 sc1
s_add_u32 s41, s41, 2560
s_mov_b64 exec, s[50:51]
buffer_load_dwordx4 v[96:99], v1, s[4:7], s41 offen offset:0 sc1
s_mov_b64 exec, -1
buffer_load_dwordx4 v[100:103], v1, s[4:7], s41 offen offset:1024 sc1
s_add_u32 s41, s41, 2560
s_mov_b64 exec, s[50:51]
buffer_load_dwordx4 v[104:107], v1, s[4:7], s41 offen offset:0 sc1
s_mov_b64 exec, -1
buffer_load_dwordx4 v[108:111], v1, s[4:7], s41 offen offset:1024 sc1
s_add_u32 s41, s41, 2560
s_mov_b64 exec, s[50:51]
buffer_load_dwordx4 v[112:115], v1, s[4:7], s41 offen offset:0 sc1
s_mov_b64 exec, -1
buffer_load_dwordx4 v[116:119], v1, s[4:7], s41 offen offset:1024 sc1
s_add_u32 s41, s41, 2560
s_mov_b64 exec, s[50:51]
buffer_load_dwordx4 v[120:123], v1, s[4:7], s41 offen offset:0 sc1
s_mov_b64 exec, -1
buffer_load_dwordx4 v[124:127], v1, s[4:7], s41 offen offset:1024 sc1
buffer_load_dwordx4 v[192:195], v24, s[4:7], s40 offen offset:0 sc1
buffer_load_dwordx4 v[196:199], v24, s[4:7], s40 offen offset:256 sc1
s_add_u32 s40, s40, 10240
buffer_load_dwordx4 v[200:203], v24, s[4:7], s40 offen offset:0 sc1
buffer_load_dwordx4 v[204:207], v24, s[4:7], s40 offen offset:256 sc1
s_waitcnt vmcnt(0)
s_branch r0_pt
r0_ptok:
v_add_u32 v9, 0, v25
ds_write2_b32 v9, v40, v41 offset0:0 offset1:16
ds_write2_b32 v9, v42, v43 offset0:32 offset1:48
v_add_u32 v9, 1024, v25
ds_write2_b32 v9, v44, v45 offset0:0 offset1:16
ds_write2_b32 v9, v46, v47 offset0:32 offset1:48
s_waitcnt lgkmcnt(0)
r0_skiptok:
s_add_u32 s82, s82, 40960
s_mov_b32 s40, s28
s_mov_b32 s28, s29
s_mov_b32 s29, s30
s_mov_b32 s30, s40
s_mov_b32 s40, s31
s_mov_b32 s31, s32
s_mov_b32 s32, s33
s_mov_b32 s33, s40
s_mov_b32 s40, s34
s_mov_b32 s34, s35
s_mov_b32 s35, s36
s_mov_b32 s36, s40
s_mov_b32 s40, s37
s_mov_b32 s37, s38
s_mov_b32 s38, s39
s_mov_b32 s39, s40
s_add_u32 s26, s26, 1
s_cmp_ge_u32 s26, 64
s_cbranch_scc1 r_fin0
v_mov_b32 v28, 0
v_mov_b32 v29, 0
v_mov_b32 v30, 0
v_mov_b32 v31, 0
buffer_load_dwordx4 v[32:35], v2, s[4:7], s31 offen offset:0 sc1
buffer_load_dwordx4 v[36:39], v2, s[4:7], s31 offen offset:2048 sc1
buffer_load_dwordx4 v[40:43], v3, s[4:7], s31 offen offset:0 sc1
buffer_load_dwordx4 v[44:47], v3, s[4:7], s31 offen offset:2048 sc1
buffer_load_dwordx2 v[48:49], v4, s[4:7], s31 offen sc1
buffer_load_dwordx2 v[50:51], v4, s[4:7], s31 offen offset:1024 sc1
buffer_load_dwordx4 v[56:59], v6, s[4:7], s34 offen sc1
buffer_load_dwordx4 v[60:63], v6, s[4:7], s34 offen offset:1024 sc1
s_mov_b32 s42, 0
r1_poll_loop:
s_mov_b64 s[44:45], 0
s_waitcnt vmcnt(7)
v_max3_u32 v9, v32, v33, v34
v_max_u32 v9, v9, v35
v_cmp_eq_u32 vcc, -1, v9
s_or_b64 s[44:45], s[44:45], vcc
s_mov_b64 exec, vcc
buffer_load_dwordx4 v[32:35], v2, s[4:7], s31 offen offset:0 sc1
s_mov_b64 exec, -1
s_waitcnt vmcnt(7)
v_max3_u32 v9, v36, v37, v38
v_max_u32 v9, v9, v39
v_cmp_eq_u32 vcc, -1, v9
s_or_b64 s[44:45], s[44:45], vcc
s_mov_b64 exec, vcc
buffer_load_dwordx4 v[36:39], v2, s[4:7], s31 offen offset:2048 sc1
s_mov_b64 exec, -1
s_waitcnt vmcnt(7)
v_max3_u32 v9, v40, v41, v42
v_max_u32 v9, v9, v43
v_cmp_eq_u32 vcc, -1, v9
s_or_b64 s[44:45], s[44:45], vcc
s_mov_b64 exec, vcc
buffer_load_dwordx4 v[40:43], v3, s[4:7], s31 offen offset:0 sc1
s_mov_b64 exec, -1
s_waitcnt vmcnt(7)
v_max3_u32 v9, v44, v45, v46
v_max_u32 v9, v9, v47
v_cmp_eq_u32 vcc, -1, v9
s_or_b64 s[44:45], s[44:45], vcc
s_mov_b64 exec, vcc
buffer_load_dwordx4 v[44:47], v3, s[4:7], s31 offen offset:2048 sc1
s_mov_b64 exec, -1
s_waitcnt vmcnt(7)
v_max_u32 v9, v48, v49
v_cmp_eq_u32 vcc, -1, v9
s_or_b64 s[44:45], s[44:45], vcc
s_mov_b64 exec, vcc
buffer_load_dwordx2 v[48:49], v4, s[4:7], s31 offen sc1
s_mov_b64 exec, -1
s_waitcnt vmcnt(7)
v_max_u32 v9, v50, v51
v_cmp_eq_u32 vcc, -1, v9
s_or_b64 s[44:45], s[44:45], vcc
s_mov_b64 exec, vcc
buffer_load_dwordx2 v[50:51], v4, s[4:7], s31 offen offset:1024 sc1
s_mov_b64 exec, -1
s_waitcnt vmcnt(7)
v_max3_u32 v9, v56, v57, v58
v_max_u32 v9, v9, v59
v_cmp_eq_u32 vcc, -1, v9
s_or_b64 s[44:45], s[44:45], vcc
s_mov_b64 exec, vcc
buffer_load_dwordx4 v[56:59], v6, s[4:7], s34 offen sc1
s_mov_b64 exec, -1
s_waitcnt vmcnt(7)
v_max3_u32 v9, v60, v61, v62
v_max_u32 v9, v9, v63
v_cmp_eq_u32 vcc, -1, v9
s_or_b64 s[44:45], s[44:45], vcc
s_mov_b64 exec, vcc
buffer_load_dwordx4 v[60:63], v6, s[4:7], s34 offen offset:1024 sc1
s_mov_b64 exec, -1
s_cmp_eq_u64 s[44:45], 0
s_cbranch_scc1 r1_poll_done
s_add_u32 s42, s42, 1
s_cmp_lt_u32 s42, 0x100000
s_cbranch_scc1 r1_poll_loop
s_branch timeout
r1_poll_done:
s_waitcnt vmcnt(0)
v_smfmac_f32_16x16x64_bf16 v[28:31], v[32:35], v[160:167], v5
v_smfmac_f32_16x16x64_bf16 v[28:31], v[36:39], v[168:175], v5
v_smfmac_f32_16x16x64_bf16 v[28:31], v[40:43], v[176:183], v5
v_smfmac_f32_16x16x64_bf16 v[28:31], v[44:47], v[184:191], v5
v_smfmac_f32_16x16x64_bf16 v[28:31], v[48:51], v[56:63], v5
s_nop 7
v_permlane32_swap_b32 v28, v29
v_permlane32_swap_b32 v30, v31
v_add_f32 v28, v28, v29
v_add_f32 v30, v30, v31
ds_write2_b32 v12, v28, v30 offset0:0 offset1:32
s_waitcnt lgkmcnt(0)
s_barrier
s_cmp_eq_u32 s24, 0
s_cbranch_scc0 r1_nopub
ds_read_b64 v[40:41], v13 offset:0
ds_read_b64 v[42:43], v13 offset:512
ds_read_b64 v[44:45], v13 offset:1024
ds_read_b64 v[46:47], v13 offset:1536
s_waitcnt lgkmcnt(0)
v_add_f32 v40, v40, v42
v_add_f32 v41, v41, v43
v_add_f32 v44, v44, v46
v_add_f32 v45, v45, v47
v_add_f32 v40, v40, v44
v_add_f32 v41, v41, v45
v_cvt_pk_bf16_f32 v40, v40, v41
v_min_u32 v40, -2, v40
s_nop 1
v_mov_b32_dpp v41, v40 quad_perm:[1,1,1,1] row_mask:0xf bank_mask:0xf
v_mov_b32_dpp v42, v40 quad_perm:[2,2,2,2] row_mask:0xf bank_mask:0xf
v_mov_b32_dpp v43, v40 quad_perm:[3,3,3,3] row_mask:0xf bank_mask:0xf
s_mov_b64 exec, s[70:71]
buffer_store_dwordx4 v[40:43], v14, s[4:7], s29 offen sc1
s_mov_b64 exec, -1
s_mov_b64 exec, s[70:71]
v_mov_b32 v44, -1
v_mov_b32 v45, -1
v_mov_b32 v46, -1
v_mov_b32 v47, -1
buffer_store_dwordx4 v[44:47], v14, s[4:7], s28 offen sc1
s_mov_b64 exec, -1
r1_nopub:
s_barrier
s_cmp_eq_u32 s24, 0
s_cbranch_scc0 r1_nsig
s_cmp_lt_u32 s26, 2
s_cbranch_scc1 r1_nsig
s_cmp_ge_u32 s26, 34
s_cbranch_scc1 r1_nsig
s_sub_u32 s41, s26, 2
s_lshl_b32 s41, s41, 7
s_add_u32 s41, s41, 201335808
v_mov_b32 v41, 1
s_mov_b64 exec, 1
buffer_atomic_add v41, off, s[4:7], s41 sc1
s_mov_b64 exec, -1
r1_nsig:
s_cmp_lt_u32 s26, 32
s_cbranch_scc1 r1_nog
s_and_b32 s84, s26, 3
s_cmp_eq_u32 s84, 0
s_cbranch_scc0 r1_nog
s_lshr_b32 s84, s26, 2
s_lshl_b32 s47, s84, 7
s_add_u32 s47, s47, 201333760
s_mov_b32 s46, 0
v_mov_b32 v10, 0
r1g_wf:
buffer_load_dword v9, off, s[4:7], s47 sc1
s_waitcnt vmcnt(0)
v_readfirstlane_b32 s45, v9
s_cmp_ge_u32 s45, 4
s_cbranch_scc1 r1g_wd
s_add_u32 s46, s46, 1
s_cmp_lt_u32 s46, 0x200000
s_cbranch_scc1 r1g_wf
s_branch timeout
r1g_wd:
r1_nog:
s_add_u32 s84, s26, 1
s_and_b32 s85, s84, 3
s_cmp_eq_u32 s85, 0
s_cbranch_scc0 r1_novw
s_cmp_ge_u32 s26, 63
s_cbranch_scc1 r1_novw
s_lshr_b32 s84, s84, 2
s_cmp_lt_u32 s84, 2
s_cselect_b32 s85, 64, 32
s_lshl_b32 s47, s84, 7
s_add_u32 s47, s47, 201330688
s_mov_b32 s46, 0
v_mov_b32 v10, 0
r1v_wf:
buffer_load_dword v9, off, s[4:7], s47 sc1
s_waitcnt vmcnt(0)
v_readfirstlane_b32 s45, v9
s_cmp_ge_u32 s45, s85
s_cbranch_scc1 r1v_wd
s_add_u32 s46, s46, 1
s_cmp_lt_u32 s46, 0x200000
s_cbranch_scc1 r1v_wf
s_branch timeout
r1v_wd:
r1_novw:
s_mul_i32 s40, s24, 20480
s_add_u32 s40, s40, s37
s_mov_b32 s41, s40
s_mov_b64 exec, s[50:51]
buffer_load_dwordx4 v[64:67], v1, s[4:7], s41 offen offset:0 sc1
s_mov_b64 exec, -1
buffer_load_dwordx4 v[68:71], v1, s[4:7], s41 offen offset:1024 sc1
s_add_u32 s41, s41, 2560
s_mov_b64 exec, s[50:51]
buffer_load_dwordx4 v[72:75], v1, s[4:7], s41 offen offset:0 sc1
s_mov_b64 exec, -1
buffer_load_dwordx4 v[76:79], v1, s[4:7], s41 offen offset:1024 sc1
s_add_u32 s41, s41, 2560
s_mov_b64 exec, s[50:51]
buffer_load_dwordx4 v[80:83], v1, s[4:7], s41 offen offset:0 sc1
s_mov_b64 exec, -1
buffer_load_dwordx4 v[84:87], v1, s[4:7], s41 offen offset:1024 sc1
s_add_u32 s41, s41, 2560
s_mov_b64 exec, s[50:51]
buffer_load_dwordx4 v[88:91], v1, s[4:7], s41 offen offset:0 sc1
s_mov_b64 exec, -1
buffer_load_dwordx4 v[92:95], v1, s[4:7], s41 offen offset:1024 sc1
s_add_u32 s41, s41, 2560
s_mov_b64 exec, s[50:51]
buffer_load_dwordx4 v[96:99], v1, s[4:7], s41 offen offset:0 sc1
s_mov_b64 exec, -1
buffer_load_dwordx4 v[100:103], v1, s[4:7], s41 offen offset:1024 sc1
s_add_u32 s41, s41, 2560
s_mov_b64 exec, s[50:51]
buffer_load_dwordx4 v[104:107], v1, s[4:7], s41 offen offset:0 sc1
s_mov_b64 exec, -1
buffer_load_dwordx4 v[108:111], v1, s[4:7], s41 offen offset:1024 sc1
s_add_u32 s41, s41, 2560
s_mov_b64 exec, s[50:51]
buffer_load_dwordx4 v[112:115], v1, s[4:7], s41 offen offset:0 sc1
s_mov_b64 exec, -1
buffer_load_dwordx4 v[116:119], v1, s[4:7], s41 offen offset:1024 sc1
s_add_u32 s41, s41, 2560
s_mov_b64 exec, s[50:51]
buffer_load_dwordx4 v[120:123], v1, s[4:7], s41 offen offset:0 sc1
s_mov_b64 exec, -1
buffer_load_dwordx4 v[124:127], v1, s[4:7], s41 offen offset:1024 sc1
buffer_load_dwordx4 v[192:195], v24, s[4:7], s40 offen offset:0 sc1
buffer_load_dwordx4 v[196:199], v24, s[4:7], s40 offen offset:256 sc1
s_add_u32 s40, s40, 10240
buffer_load_dwordx4 v[200:203], v24, s[4:7], s40 offen offset:0 sc1
buffer_load_dwordx4 v[204:207], v24, s[4:7], s40 offen offset:256 sc1
buffer_load_dword v54, v27, s[16:19], s82 offen
s_add_u32 s41, s82, 176160768
buffer_load_dword v55, v27, s[4:7], s41 offen sc1
s_add_u32 s81, s81, 1310720
buffer_load_dwordx4 v[128:131], v7, s[4:7], s81 offen offset:0 sc1
buffer_load_dwordx4 v[132:135], v7, s[4:7], s81 offen offset:1024 sc1
buffer_load_dwordx4 v[136:139], v7, s[4:7], s81 offen offset:2048 sc1
buffer_load_dwordx4 v[140:143], v7, s[4:7], s81 offen offset:3072 sc1
buffer_load_dwordx4 v[144:147], v11, s[4:7], s81 offen offset:0 sc1
buffer_load_dwordx4 v[148:151], v11, s[4:7], s81 offen offset:1024 sc1
buffer_load_dwordx4 v[152:155], v11, s[4:7], s81 offen offset:2048 sc1
buffer_load_dwordx4 v[156:159], v11, s[4:7], s81 offen offset:3072 sc1
s_cmp_eq_u32 s26, 0
s_cbranch_scc1 r1_noepi
s_sub_u32 s85, s26, 1
s_sub_u32 s84, s82, 40960
ds_read_b64 v[40:41], v26 offset:0
ds_read_b64 v[42:43], v26 offset:2048
ds_read_b64 v[44:45], v26 offset:4096
ds_read_b64 v[46:47], v26 offset:6144
s_waitcnt lgkmcnt(0)
v_add_f32 v40, v40, v42
v_add_f32 v41, v41, v43
v_add_f32 v44, v44, v46
v_add_f32 v45, v45, v47
v_add_f32 v40, v40, v44
v_add_f32 v41, v41, v45
v_cvt_pk_bf16_f32 v40, v40, v41
s_cmp_lt_u32 s85, 32
s_cbranch_scc0 r1_direct
s_add_u32 s41, s84, 192937984
buffer_store_dword v40, v27, s[4:7], s41 offen sc1
s_branch r1_edone
r1_direct:
v_lshlrev_b32 v41, 16, v40
v_and_b32 v42, 0xffff0000, v40
v_lshlrev_b32 v43, 16, v53
v_and_b32 v44, 0xffff0000, v53
v_mul_f32 v41, v41, v43
v_mul_f32 v42, v42, v44
v_cvt_pk_bf16_f32 v40, v41, v42
v_lshlrev_b32 v41, 16, v40
v_and_b32 v42, 0xffff0000, v40
v_lshlrev_b32 v43, 16, v52
v_and_b32 v44, 0xffff0000, v52
v_add_f32 v41, v41, v43
v_add_f32 v42, v42, v44
v_cvt_pk_bf16_f32 v40, v41, v42
buffer_store_dword v40, v27, s[20:23], s84 offen
r1_edone:
r1_noepi:
s_cmp_eq_u32 s26, 0
s_cbranch_scc0 r1_hasepi
buffer_load_dword v15, off, s[4:7], 0
r1_hasepi:
s_mov_b32 s42, 0
r1_pt:
v_mov_b32 v9, 0
s_waitcnt vmcnt(29)
v_mfma_f32_16x16x32_bf16 v[40:43], v[64:67], v[160:163], 0
v_max3_u32 v9, v9, v64, v65
v_max3_u32 v9, v9, v66, v67
v_mfma_f32_16x16x32_bf16 v[44:47], v[68:71], v[160:163], 0
v_max3_u32 v9, v9, v68, v69
v_max3_u32 v9, v9, v70, v71
s_waitcnt vmcnt(27)
v_mfma_f32_16x16x32_bf16 v[40:43], v[72:75], v[164:167], v[40:43]
v_max3_u32 v9, v9, v72, v73
v_max3_u32 v9, v9, v74, v75
v_mfma_f32_16x16x32_bf16 v[44:47], v[76:79], v[164:167], v[44:47]
v_max3_u32 v9, v9, v76, v77
v_max3_u32 v9, v9, v78, v79
s_waitcnt vmcnt(25)
v_mfma_f32_16x16x32_bf16 v[40:43], v[80:83], v[168:171], v[40:43]
v_max3_u32 v9, v9, v80, v81
v_max3_u32 v9, v9, v82, v83
v_mfma_f32_16x16x32_bf16 v[44:47], v[84:87], v[168:171], v[44:47]
v_max3_u32 v9, v9, v84, v85
v_max3_u32 v9, v9, v86, v87
s_waitcnt vmcnt(23)
v_mfma_f32_16x16x32_bf16 v[40:43], v[88:91], v[172:175], v[40:43]
v_max3_u32 v9, v9, v88, v89
v_max3_u32 v9, v9, v90, v91
v_mfma_f32_16x16x32_bf16 v[44:47], v[92:95], v[172:175], v[44:47]
v_max3_u32 v9, v9, v92, v93
v_max3_u32 v9, v9, v94, v95
s_waitcnt vmcnt(21)
v_mfma_f32_16x16x32_bf16 v[40:43], v[96:99], v[176:179], v[40:43]
v_max3_u32 v9, v9, v96, v97
v_max3_u32 v9, v9, v98, v99
v_mfma_f32_16x16x32_bf16 v[44:47], v[100:103], v[176:179], v[44:47]
v_max3_u32 v9, v9, v100, v101
v_max3_u32 v9, v9, v102, v103
s_waitcnt vmcnt(19)
v_mfma_f32_16x16x32_bf16 v[40:43], v[104:107], v[180:183], v[40:43]
v_max3_u32 v9, v9, v104, v105
v_max3_u32 v9, v9, v106, v107
v_mfma_f32_16x16x32_bf16 v[44:47], v[108:111], v[180:183], v[44:47]
v_max3_u32 v9, v9, v108, v109
v_max3_u32 v9, v9, v110, v111
s_waitcnt vmcnt(17)
v_mfma_f32_16x16x32_bf16 v[40:43], v[112:115], v[184:187], v[40:43]
v_max3_u32 v9, v9, v112, v113
v_max3_u32 v9, v9, v114, v115
v_mfma_f32_16x16x32_bf16 v[44:47], v[116:119], v[184:187], v[44:47]
v_max3_u32 v9, v9, v116, v117
v_max3_u32 v9, v9, v118, v119
s_waitcnt vmcnt(15)
v_mfma_f32_16x16x32_bf16 v[40:43], v[120:123], v[188:191], v[40:43]
v_max3_u32 v9, v9, v120, v121
v_max3_u32 v9, v9, v122, v123
v_mfma_f32_16x16x32_bf16 v[44:47], v[124:127], v[188:191], v[44:47]
v_max3_u32 v9, v9, v124, v125
v_max3_u32 v9, v9, v126, v127
s_waitcnt vmcnt(11)
v_mfma_f32_16x16x32_bf16 v[40:43], v[192:195], v[56:59], v[40:43]
v_max3_u32 v9, v9, v192, v193
v_max3_u32 v9, v9, v194, v195
v_mfma_f32_16x16x32_bf16 v[44:47], v[196:199], v[56:59], v[44:47]
v_max3_u32 v9, v9, v196, v197
v_max3_u32 v9, v9, v198, v199
v_mfma_f32_16x16x32_bf16 v[40:43], v[200:203], v[60:63], v[40:43]
v_max3_u32 v9, v9, v200, v201
v_max3_u32 v9, v9, v202, v203
v_mfma_f32_16x16x32_bf16 v[44:47], v[204:207], v[60:63], v[44:47]
v_max3_u32 v9, v9, v204, v205
v_max3_u32 v9, v9, v206, v207
v_cmp_eq_u32 vcc, -1, v9
s_cbranch_vccz r1_ptok
s_add_u32 s42, s42, 1
s_cmp_lt_u32 s42, 0x100000
s_cbranch_scc0 timeout
s_nop 7
s_mul_i32 s40, s24, 20480
s_add_u32 s40, s40, s37
s_mov_b32 s41, s40
s_mov_b64 exec, s[50:51]
buffer_load_dwordx4 v[64:67], v1, s[4:7], s41 offen offset:0 sc1
s_mov_b64 exec, -1
buffer_load_dwordx4 v[68:71], v1, s[4:7], s41 offen offset:1024 sc1
s_add_u32 s41, s41, 2560
s_mov_b64 exec, s[50:51]
buffer_load_dwordx4 v[72:75], v1, s[4:7], s41 offen offset:0 sc1
s_mov_b64 exec, -1
buffer_load_dwordx4 v[76:79], v1, s[4:7], s41 offen offset:1024 sc1
s_add_u32 s41, s41, 2560
s_mov_b64 exec, s[50:51]
buffer_load_dwordx4 v[80:83], v1, s[4:7], s41 offen offset:0 sc1
s_mov_b64 exec, -1
buffer_load_dwordx4 v[84:87], v1, s[4:7], s41 offen offset:1024 sc1
s_add_u32 s41, s41, 2560
s_mov_b64 exec, s[50:51]
buffer_load_dwordx4 v[88:91], v1, s[4:7], s41 offen offset:0 sc1
s_mov_b64 exec, -1
buffer_load_dwordx4 v[92:95], v1, s[4:7], s41 offen offset:1024 sc1
s_add_u32 s41, s41, 2560
s_mov_b64 exec, s[50:51]
buffer_load_dwordx4 v[96:99], v1, s[4:7], s41 offen offset:0 sc1
s_mov_b64 exec, -1
buffer_load_dwordx4 v[100:103], v1, s[4:7], s41 offen offset:1024 sc1
s_add_u32 s41, s41, 2560
s_mov_b64 exec, s[50:51]
buffer_load_dwordx4 v[104:107], v1, s[4:7], s41 offen offset:0 sc1
s_mov_b64 exec, -1
buffer_load_dwordx4 v[108:111], v1, s[4:7], s41 offen offset:1024 sc1
s_add_u32 s41, s41, 2560
s_mov_b64 exec, s[50:51]
buffer_load_dwordx4 v[112:115], v1, s[4:7], s41 offen offset:0 sc1
s_mov_b64 exec, -1
buffer_load_dwordx4 v[116:119], v1, s[4:7], s41 offen offset:1024 sc1
s_add_u32 s41, s41, 2560
s_mov_b64 exec, s[50:51]
buffer_load_dwordx4 v[120:123], v1, s[4:7], s41 offen offset:0 sc1
s_mov_b64 exec, -1
buffer_load_dwordx4 v[124:127], v1, s[4:7], s41 offen offset:1024 sc1
buffer_load_dwordx4 v[192:195], v24, s[4:7], s40 offen offset:0 sc1
buffer_load_dwordx4 v[196:199], v24, s[4:7], s40 offen offset:256 sc1
s_add_u32 s40, s40, 10240
buffer_load_dwordx4 v[200:203], v24, s[4:7], s40 offen offset:0 sc1
buffer_load_dwordx4 v[204:207], v24, s[4:7], s40 offen offset:256 sc1
s_waitcnt vmcnt(0)
s_branch r1_pt
r1_ptok:
v_add_u32 v9, 8192, v25
ds_write2_b32 v9, v40, v41 offset0:0 offset1:16
ds_write2_b32 v9, v42, v43 offset0:32 offset1:48
v_add_u32 v9, 9216, v25
ds_write2_b32 v9, v44, v45 offset0:0 offset1:16
ds_write2_b32 v9, v46, v47 offset0:32 offset1:48
s_waitcnt lgkmcnt(0)
r1_skiptok:
s_add_u32 s82, s82, 40960
s_mov_b32 s40, s28
s_mov_b32 s28, s29
s_mov_b32 s29, s30
s_mov_b32 s30, s40
s_mov_b32 s40, s31
s_mov_b32 s31, s32
s_mov_b32 s32, s33
s_mov_b32 s33, s40
s_mov_b32 s40, s34
s_mov_b32 s34, s35
s_mov_b32 s35, s36
s_mov_b32 s36, s40
s_mov_b32 s40, s37
s_mov_b32 s37, s38
s_mov_b32 s38, s39
s_mov_b32 s39, s40
s_add_u32 s26, s26, 1
s_cmp_lt_u32 s26, 64
s_cbranch_scc1 r_step
s_barrier
s_waitcnt vmcnt(0)
s_sub_u32 s84, s82, 40960
ds_read_b64 v[40:41], v26 offset:8192
ds_read_b64 v[42:43], v26 offset:10240
ds_read_b64 v[44:45], v26 offset:12288
ds_read_b64 v[46:47], v26 offset:14336
s_waitcnt lgkmcnt(0)
v_add_f32 v40, v40, v42
v_add_f32 v41, v41, v43
v_add_f32 v44, v44, v46
v_add_f32 v45, v45, v47
v_add_f32 v40, v40, v44
v_add_f32 v41, v41, v45
v_cvt_pk_bf16_f32 v40, v40, v41
v_lshlrev_b32 v41, 16, v40
v_and_b32 v42, 0xffff0000, v40
v_lshlrev_b32 v43, 16, v55
v_and_b32 v44, 0xffff0000, v55
v_mul_f32 v41, v41, v43
v_mul_f32 v42, v42, v44
v_cvt_pk_bf16_f32 v40, v41, v42
v_lshlrev_b32 v41, 16, v40
v_and_b32 v42, 0xffff0000, v40
v_lshlrev_b32 v43, 16, v54
v_and_b32 v44, 0xffff0000, v54
v_add_f32 v41, v41, v43
v_add_f32 v42, v42, v44
v_cvt_pk_bf16_f32 v40, v41, v42
buffer_store_dword v40, v27, s[20:23], s84 offen
s_branch done
r_fin0:
s_barrier
s_waitcnt vmcnt(0)
s_sub_u32 s84, s82, 40960
ds_read_b64 v[40:41], v26 offset:0
ds_read_b64 v[42:43], v26 offset:2048
ds_read_b64 v[44:45], v26 offset:4096
ds_read_b64 v[46:47], v26 offset:6144
s_waitcnt lgkmcnt(0)
v_add_f32 v40, v40, v42
v_add_f32 v41, v41, v43
v_add_f32 v44, v44, v46
v_add_f32 v45, v45, v47
v_add_f32 v40, v40, v44
v_add_f32 v41, v41, v45
v_cvt_pk_bf16_f32 v40, v40, v41
v_lshlrev_b32 v41, 16, v40
v_and_b32 v42, 0xffff0000, v40
v_lshlrev_b32 v43, 16, v53
v_and_b32 v44, 0xffff0000, v53
v_mul_f32 v41, v41, v43
v_mul_f32 v42, v42, v44
v_cvt_pk_bf16_f32 v40, v41, v42
v_lshlrev_b32 v41, 16, v40
v_and_b32 v42, 0xffff0000, v40
v_lshlrev_b32 v43, 16, v52
v_and_b32 v44, 0xffff0000, v52
v_add_f32 v41, v41, v43
v_add_f32 v42, v42, v44
v_cvt_pk_bf16_f32 v40, v41, v42
buffer_store_dword v40, v27, s[20:23], s84 offen
s_branch done
role_t:
s_mul_i32 s43, s43, 10
s_sub_u32 s41, s41, 20
s_add_u32 s25, s41, s43
s_add_u32 s48, s25, 104
s_lshl_b32 s48, s48, 11
s_add_u32 s48, s48, 201392128
s_branch done
role_w:
s_cmp_lt_u32 s42, 128
s_cbranch_scc1 wk_noini
s_sub_u32 s90, s42, 128
v_lshrrev_b32 v1, 6, v0
v_lshrrev_b32 v2, 4, v10
v_lshl_add_u32 v2, v1, 2, v2
s_lshl_b32 s40, s90, 4
v_add_u32 v2, s40, v2
v_and_b32 v3, 15, v10
v_mul_u32_u24 v4, 1280, v2
v_lshl_add_u32 v4, v3, 4, v4
buffer_load_dwordx4 v[16:19], v4, s[16:19], 0 offen offset:0
buffer_load_dwordx4 v[20:23], v4, s[16:19], 0 offen offset:256
buffer_load_dwordx4 v[24:27], v4, s[16:19], 0 offen offset:512
buffer_load_dwordx4 v[28:31], v4, s[16:19], 0 offen offset:768
buffer_load_dwordx4 v[32:35], v4, s[16:19], 0 offen offset:1024
s_lshl_b32 s40, s90, 12
v_lshlrev_b32 v5, 4, v0
v_add_u32 v5, s40, v5
v_mov_b32 v44, 0
v_mov_b32 v45, 0
v_mov_b32 v46, 0
v_mov_b32 v47, 0
s_mov_b32 s41, 201326592
v_cmp_gt_u32 vcc, 0x10000, v5
s_and_saveexec_b64 s[46:47], vcc
buffer_store_dwordx4 v[44:47], v5, s[4:7], s41 offen sc1
s_mov_b64 exec, s[46:47]
s_waitcnt vmcnt(1)
v_lshlrev_b32 v64, 16, v16
v_and_b32 v65, 0xffff0000, v16
v_lshlrev_b32 v66, 16, v17
v_and_b32 v67, 0xffff0000, v17
v_lshlrev_b32 v68, 16, v18
v_and_b32 v69, 0xffff0000, v18
v_lshlrev_b32 v70, 16, v19
v_and_b32 v71, 0xffff0000, v19
v_lshlrev_b32 v72, 16, v20
v_and_b32 v73, 0xffff0000, v20
v_lshlrev_b32 v74, 16, v21
v_and_b32 v75, 0xffff0000, v21
v_lshlrev_b32 v76, 16, v22
v_and_b32 v77, 0xffff0000, v22
v_lshlrev_b32 v78, 16, v23
v_and_b32 v79, 0xffff0000, v23
v_lshlrev_b32 v80, 16, v24
v_and_b32 v81, 0xffff0000, v24
v_lshlrev_b32 v82, 16, v25
v_and_b32 v83, 0xffff0000, v25
v_lshlrev_b32 v84, 16, v26
v_and_b32 v85, 0xffff0000, v26
v_lshlrev_b32 v86, 16, v27
v_and_b32 v87, 0xffff0000, v27
v_lshlrev_b32 v88, 16, v28
v_and_b32 v89, 0xffff0000, v28
v_lshlrev_b32 v90, 16, v29
v_and_b32 v91, 0xffff0000, v29
v_lshlrev_b32 v92, 16, v30
v_and_b32 v93, 0xffff0000, v30
v_lshlrev_b32 v94, 16, v31
v_and_b32 v95, 0xffff0000, v31
v_lshlrev_b32 v96, 16, v32
v_and_b32 v97, 0xffff0000, v32
v_lshlrev_b32 v98, 16, v33
v_and_b32 v99, 0xffff0000, v33
v_lshlrev_b32 v100, 16, v34
v_and_b32 v101, 0xffff0000, v34
v_lshlrev_b32 v102, 16, v35
v_and_b32 v103, 0xffff0000, v35
v_add_f32 v48, v64, v65
v_add_f32 v49, v66, v67
v_add_f32 v48, v48, v68
v_add_f32 v49, v49, v69
v_add_f32 v48, v48, v70
v_add_f32 v49, v49, v71
v_add_f32 v48, v48, v72
v_add_f32 v49, v49, v73
v_add_f32 v48, v48, v74
v_add_f32 v49, v49, v75
v_add_f32 v48, v48, v76
v_add_f32 v49, v49, v77
v_add_f32 v48, v48, v78
v_add_f32 v49, v49, v79
v_add_f32 v48, v48, v80
v_add_f32 v49, v49, v81
v_add_f32 v48, v48, v82
v_add_f32 v49, v49, v83
v_add_f32 v48, v48, v84
v_add_f32 v49, v49, v85
v_add_f32 v48, v48, v86
v_add_f32 v49, v49, v87
v_add_f32 v48, v48, v88
v_add_f32 v49, v49, v89
v_add_f32 v48, v48, v90
v_add_f32 v49, v49, v91
v_add_f32 v48, v48, v92
v_add_f32 v49, v49, v93
v_add_f32 v48, v48, v94
v_add_f32 v49, v49, v95
v_add_f32 v48, v48, v96
v_add_f32 v49, v49, v97
v_add_f32 v48, v48, v98
v_add_f32 v49, v49, v99
v_add_f32 v48, v48, v100
v_add_f32 v49, v49, v101
v_add_f32 v48, v48, v102
v_add_f32 v49, v49, v103
v_add_f32 v48, v48, v49
s_nop 1
v_add_f32_dpp v48, v48, v48 row_ror:8 row_mask:0xf bank_mask:0xf
s_nop 1
v_add_f32_dpp v48, v48, v48 row_ror:4 row_mask:0xf bank_mask:0xf
s_nop 1
v_add_f32_dpp v48, v48, v48 row_ror:2 row_mask:0xf bank_mask:0xf
s_nop 1
v_add_f32_dpp v48, v48, v48 row_ror:1 row_mask:0xf bank_mask:0xf
v_mul_f32 v48, 0x3acccccd, v48
v_sub_f32 v49, v64, v48
v_mul_f32 v50, v49, v49
v_sub_f32 v54, v65, v48
v_mul_f32 v55, v54, v54
v_sub_f32 v49, v66, v48
v_sub_f32 v54, v67, v48
v_fmac_f32 v50, v49, v49
v_fmac_f32 v55, v54, v54
v_sub_f32 v49, v68, v48
v_sub_f32 v54, v69, v48
v_fmac_f32 v50, v49, v49
v_fmac_f32 v55, v54, v54
v_sub_f32 v49, v70, v48
v_sub_f32 v54, v71, v48
v_fmac_f32 v50, v49, v49
v_fmac_f32 v55, v54, v54
v_sub_f32 v49, v72, v48
v_sub_f32 v54, v73, v48
v_fmac_f32 v50, v49, v49
v_fmac_f32 v55, v54, v54
v_sub_f32 v49, v74, v48
v_sub_f32 v54, v75, v48
v_fmac_f32 v50, v49, v49
v_fmac_f32 v55, v54, v54
v_sub_f32 v49, v76, v48
v_sub_f32 v54, v77, v48
v_fmac_f32 v50, v49, v49
v_fmac_f32 v55, v54, v54
v_sub_f32 v49, v78, v48
v_sub_f32 v54, v79, v48
v_fmac_f32 v50, v49, v49
v_fmac_f32 v55, v54, v54
v_sub_f32 v49, v80, v48
v_sub_f32 v54, v81, v48
v_fmac_f32 v50, v49, v49
v_fmac_f32 v55, v54, v54
v_sub_f32 v49, v82, v48
v_sub_f32 v54, v83, v48
v_fmac_f32 v50, v49, v49
v_fmac_f32 v55, v54, v54
v_sub_f32 v49, v84, v48
v_sub_f32 v54, v85, v48
v_fmac_f32 v50, v49, v49
v_fmac_f32 v55, v54, v54
v_sub_f32 v49, v86, v48
v_sub_f32 v54, v87, v48
v_fmac_f32 v50, v49, v49
v_fmac_f32 v55, v54, v54
v_sub_f32 v49, v88, v48
v_sub_f32 v54, v89, v48
v_fmac_f32 v50, v49, v49
v_fmac_f32 v55, v54, v54
v_sub_f32 v49, v90, v48
v_sub_f32 v54, v91, v48
v_fmac_f32 v50, v49, v49
v_fmac_f32 v55, v54, v54
v_sub_f32 v49, v92, v48
v_sub_f32 v54, v93, v48
v_fmac_f32 v50, v49, v49
v_fmac_f32 v55, v54, v54
v_sub_f32 v49, v94, v48
v_sub_f32 v54, v95, v48
v_fmac_f32 v50, v49, v49
v_fmac_f32 v55, v54, v54
v_sub_f32 v49, v96, v48
v_sub_f32 v54, v97, v48
v_fmac_f32 v50, v49, v49
v_fmac_f32 v55, v54, v54
v_sub_f32 v49, v98, v48
v_sub_f32 v54, v99, v48
v_fmac_f32 v50, v49, v49
v_fmac_f32 v55, v54, v54
v_sub_f32 v49, v100, v48
v_sub_f32 v54, v101, v48
v_fmac_f32 v50, v49, v49
v_fmac_f32 v55, v54, v54
v_sub_f32 v49, v102, v48
v_sub_f32 v54, v103, v48
v_fmac_f32 v50, v49, v49
v_fmac_f32 v55, v54, v54
v_add_f32 v50, v50, v55
s_nop 1
v_add_f32_dpp v50, v50, v50 row_ror:8 row_mask:0xf bank_mask:0xf
s_nop 1
v_add_f32_dpp v50, v50, v50 row_ror:4 row_mask:0xf bank_mask:0xf
s_nop 1
v_add_f32_dpp v50, v50, v50 row_ror:2 row_mask:0xf bank_mask:0xf
s_nop 1
v_add_f32_dpp v50, v50, v50 row_ror:1 row_mask:0xf bank_mask:0xf
v_mul_f32 v50, 0x3acccccd, v50
v_cvt_pk_bf16_f32 v48, v48, v48
v_lshlrev_b32 v48, 16, v48
v_cvt_pk_bf16_f32 v50, v50, v50
v_lshlrev_b32 v50, 16, v50
v_add_f32 v50, 0x3727c5ac, v50
v_cvt_pk_bf16_f32 v50, v50, v50
v_lshlrev_b32 v50, 16, v50
v_sqrt_f32 v50, v50
s_nop 0
v_cvt_pk_bf16_f32 v50, v50, v50
v_lshlrev_b32 v50, 16, v50
v_rcp_f32 v51, v50
s_nop 0
v_fma_f32 v52, -v50, v51, 2.0
v_mul_f32 v51, v51, v52
v_sub_f32 v64, v64, v48
v_sub_f32 v65, v65, v48
v_cvt_pk_bf16_f32 v53, v64, v65
v_lshlrev_b32 v64, 16, v53
v_and_b32 v65, 0xffff0000, v53
v_mul_f32 v64, v64, v51
v_mul_f32 v65, v65, v51
v_cvt_pk_bf16_f32 v16, v64, v65
v_sub_f32 v66, v66, v48
v_sub_f32 v67, v67, v48
v_cvt_pk_bf16_f32 v53, v66, v67
v_lshlrev_b32 v66, 16, v53
v_and_b32 v67, 0xffff0000, v53
v_mul_f32 v66, v66, v51
v_mul_f32 v67, v67, v51
v_cvt_pk_bf16_f32 v17, v66, v67
v_sub_f32 v68, v68, v48
v_sub_f32 v69, v69, v48
v_cvt_pk_bf16_f32 v53, v68, v69
v_lshlrev_b32 v68, 16, v53
v_and_b32 v69, 0xffff0000, v53
v_mul_f32 v68, v68, v51
v_mul_f32 v69, v69, v51
v_cvt_pk_bf16_f32 v18, v68, v69
v_sub_f32 v70, v70, v48
v_sub_f32 v71, v71, v48
v_cvt_pk_bf16_f32 v53, v70, v71
v_lshlrev_b32 v70, 16, v53
v_and_b32 v71, 0xffff0000, v53
v_mul_f32 v70, v70, v51
v_mul_f32 v71, v71, v51
v_cvt_pk_bf16_f32 v19, v70, v71
v_sub_f32 v72, v72, v48
v_sub_f32 v73, v73, v48
v_cvt_pk_bf16_f32 v53, v72, v73
v_lshlrev_b32 v72, 16, v53
v_and_b32 v73, 0xffff0000, v53
v_mul_f32 v72, v72, v51
v_mul_f32 v73, v73, v51
v_cvt_pk_bf16_f32 v20, v72, v73
v_sub_f32 v74, v74, v48
v_sub_f32 v75, v75, v48
v_cvt_pk_bf16_f32 v53, v74, v75
v_lshlrev_b32 v74, 16, v53
v_and_b32 v75, 0xffff0000, v53
v_mul_f32 v74, v74, v51
v_mul_f32 v75, v75, v51
v_cvt_pk_bf16_f32 v21, v74, v75
v_sub_f32 v76, v76, v48
v_sub_f32 v77, v77, v48
v_cvt_pk_bf16_f32 v53, v76, v77
v_lshlrev_b32 v76, 16, v53
v_and_b32 v77, 0xffff0000, v53
v_mul_f32 v76, v76, v51
v_mul_f32 v77, v77, v51
v_cvt_pk_bf16_f32 v22, v76, v77
v_sub_f32 v78, v78, v48
v_sub_f32 v79, v79, v48
v_cvt_pk_bf16_f32 v53, v78, v79
v_lshlrev_b32 v78, 16, v53
v_and_b32 v79, 0xffff0000, v53
v_mul_f32 v78, v78, v51
v_mul_f32 v79, v79, v51
v_cvt_pk_bf16_f32 v23, v78, v79
v_sub_f32 v80, v80, v48
v_sub_f32 v81, v81, v48
v_cvt_pk_bf16_f32 v53, v80, v81
v_lshlrev_b32 v80, 16, v53
v_and_b32 v81, 0xffff0000, v53
v_mul_f32 v80, v80, v51
v_mul_f32 v81, v81, v51
v_cvt_pk_bf16_f32 v24, v80, v81
v_sub_f32 v82, v82, v48
v_sub_f32 v83, v83, v48
v_cvt_pk_bf16_f32 v53, v82, v83
v_lshlrev_b32 v82, 16, v53
v_and_b32 v83, 0xffff0000, v53
v_mul_f32 v82, v82, v51
v_mul_f32 v83, v83, v51
v_cvt_pk_bf16_f32 v25, v82, v83
v_sub_f32 v84, v84, v48
v_sub_f32 v85, v85, v48
v_cvt_pk_bf16_f32 v53, v84, v85
v_lshlrev_b32 v84, 16, v53
v_and_b32 v85, 0xffff0000, v53
v_mul_f32 v84, v84, v51
v_mul_f32 v85, v85, v51
v_cvt_pk_bf16_f32 v26, v84, v85
v_sub_f32 v86, v86, v48
v_sub_f32 v87, v87, v48
v_cvt_pk_bf16_f32 v53, v86, v87
v_lshlrev_b32 v86, 16, v53
v_and_b32 v87, 0xffff0000, v53
v_mul_f32 v86, v86, v51
v_mul_f32 v87, v87, v51
v_cvt_pk_bf16_f32 v27, v86, v87
v_sub_f32 v88, v88, v48
v_sub_f32 v89, v89, v48
v_cvt_pk_bf16_f32 v53, v88, v89
v_lshlrev_b32 v88, 16, v53
v_and_b32 v89, 0xffff0000, v53
v_mul_f32 v88, v88, v51
v_mul_f32 v89, v89, v51
v_cvt_pk_bf16_f32 v28, v88, v89
v_sub_f32 v90, v90, v48
v_sub_f32 v91, v91, v48
v_cvt_pk_bf16_f32 v53, v90, v91
v_lshlrev_b32 v90, 16, v53
v_and_b32 v91, 0xffff0000, v53
v_mul_f32 v90, v90, v51
v_mul_f32 v91, v91, v51
v_cvt_pk_bf16_f32 v29, v90, v91
v_sub_f32 v92, v92, v48
v_sub_f32 v93, v93, v48
v_cvt_pk_bf16_f32 v53, v92, v93
v_lshlrev_b32 v92, 16, v53
v_and_b32 v93, 0xffff0000, v53
v_mul_f32 v92, v92, v51
v_mul_f32 v93, v93, v51
v_cvt_pk_bf16_f32 v30, v92, v93
v_sub_f32 v94, v94, v48
v_sub_f32 v95, v95, v48
v_cvt_pk_bf16_f32 v53, v94, v95
v_lshlrev_b32 v94, 16, v53
v_and_b32 v95, 0xffff0000, v53
v_mul_f32 v94, v94, v51
v_mul_f32 v95, v95, v51
v_cvt_pk_bf16_f32 v31, v94, v95
v_sub_f32 v96, v96, v48
v_sub_f32 v97, v97, v48
v_cvt_pk_bf16_f32 v53, v96, v97
v_lshlrev_b32 v96, 16, v53
v_and_b32 v97, 0xffff0000, v53
v_mul_f32 v96, v96, v51
v_mul_f32 v97, v97, v51
v_cvt_pk_bf16_f32 v32, v96, v97
v_sub_f32 v98, v98, v48
v_sub_f32 v99, v99, v48
v_cvt_pk_bf16_f32 v53, v98, v99
v_lshlrev_b32 v98, 16, v53
v_and_b32 v99, 0xffff0000, v53
v_mul_f32 v98, v98, v51
v_mul_f32 v99, v99, v51
v_cvt_pk_bf16_f32 v33, v98, v99
v_sub_f32 v100, v100, v48
v_sub_f32 v101, v101, v48
v_cvt_pk_bf16_f32 v53, v100, v101
v_lshlrev_b32 v100, 16, v53
v_and_b32 v101, 0xffff0000, v53
v_mul_f32 v100, v100, v51
v_mul_f32 v101, v101, v51
v_cvt_pk_bf16_f32 v34, v100, v101
v_sub_f32 v102, v102, v48
v_sub_f32 v103, v103, v48
v_cvt_pk_bf16_f32 v53, v102, v103
v_lshlrev_b32 v102, 16, v53
v_and_b32 v103, 0xffff0000, v53
v_mul_f32 v102, v102, v51
v_mul_f32 v103, v103, v51
v_cvt_pk_bf16_f32 v35, v102, v103
v_lshrrev_b32 v5, 5, v2
v_mul_u32_u24 v5, 40960, v5
v_and_b32 v6, 31, v2
v_lshl_add_u32 v5, v6, 4, v5
v_lshrrev_b32 v6, 1, v3
v_lshl_add_u32 v5, v6, 10, v5
v_and_b32 v6, 1, v3
v_lshl_add_u32 v5, v6, 9, v5
s_mov_b32 s41, 8388608
buffer_store_dwordx4 v[16:19], v5, s[4:7], s41 offen sc1
s_mov_b32 s41, 8396800
buffer_store_dwordx4 v[20:23], v5, s[4:7], s41 offen sc1
s_mov_b32 s41, 8404992
buffer_store_dwordx4 v[24:27], v5, s[4:7], s41 offen sc1
s_mov_b32 s41, 8413184
buffer_store_dwordx4 v[28:31], v5, s[4:7], s41 offen sc1
s_mov_b32 s41, 8421376
buffer_store_dwordx4 v[32:35], v5, s[4:7], s41 offen sc1
s_waitcnt vmcnt(0)
s_barrier
s_cmp_eq_u32 s24, 0
s_cbranch_scc0 wk_noini
v_mov_b32 v2, 64
v_mov_b32 v3, 1
s_mov_b64 exec, 1
global_atomic_add v2, v3, s[86:87] sc1
s_mov_b64 exec, -1
wk_noini:
s_load_dwordx2 s[84:85], s[0:1], 104
s_load_dwordx4 s[68:71], s[0:1], 16
s_load_dwordx4 s[72:75], s[0:1], 32
s_load_dwordx4 s[76:79], s[0:1], 64
s_load_dwordx2 s[80:81], s[0:1], 80
v_lshrrev_b32 v1, 6, v0
s_nop 0
v_readfirstlane_b32 s24, v1
s_waitcnt lgkmcnt(0)
s_mov_b32 s4, s84
s_and_b32 s5, s85, 0xffff
s_mov_b32 s6, 268435456
s_mov_b32 s7, 0x20000
v_and_b32 v10, 63, v0
v_lshlrev_b32 v1, 4, v10
s_mul_i32 s62, s24, 6144
s_lshl_b32 s63, s24, 4
s_lshr_b32 s90, s42, 5
s_sub_u32 s91, s90, 4
s_mul_i32 s89, s90, 6
s_and_b32 s88, s42, 31
s_add_u32 s89, s89, s88
s_add_u32 s89, s89, 2
s_and_b32 s89, s89, 3
s_cmp_ge_u32 s90, 4
s_cselect_b32 s93, s91, s89
v_add_u32 v16, 0, v10
v_mul_u32_u24 v17, 2731, v16
v_lshrrev_b32 v17, 16, v17
v_mul_u32_u24 v18, 24, v17
v_sub_u32 v18, v16, v18
v_lshlrev_b32 v19, 1, v17
v_and_b32 v19, 4, v19
v_xor_b32 v18, v18, v19
v_lshlrev_b32 v18, 4, v18
v_add_u32 v17, s63, v17
v_mul_u32_u24 v17, 12288, v17
v_add_u32 v4, v17, v18
v_add_u32 v16, 64, v10
v_mul_u32_u24 v17, 2731, v16
v_lshrrev_b32 v17, 16, v17
v_mul_u32_u24 v18, 24, v17
v_sub_u32 v18, v16, v18
v_lshlrev_b32 v19, 1, v17
v_and_b32 v19, 4, v19
v_xor_b32 v18, v18, v19
v_lshlrev_b32 v18, 4, v18
v_add_u32 v17, s63, v17
v_mul_u32_u24 v17, 12288, v17
v_add_u32 v5, v17, v18
v_add_u32 v16, 128, v10
v_mul_u32_u24 v17, 2731, v16
v_lshrrev_b32 v17, 16, v17
v_mul_u32_u24 v18, 24, v17
v_sub_u32 v18, v16, v18
v_lshlrev_b32 v19, 1, v17
v_and_b32 v19, 4, v19
v_xor_b32 v18, v18, v19
v_lshlrev_b32 v18, 4, v18
v_add_u32 v17, s63, v17
v_mul_u32_u24 v17, 12288, v17
v_add_u32 v6, v17, v18
v_add_u32 v16, 192, v10
v_mul_u32_u24 v17, 2731, v16
v_lshrrev_b32 v17, 16, v17
v_mul_u32_u24 v18, 24, v17
v_sub_u32 v18, v16, v18
v_lshlrev_b32 v19, 1, v17
v_and_b32 v19, 4, v19
v_xor_b32 v18, v18, v19
v_lshlrev_b32 v18, 4, v18
v_add_u32 v17, s63, v17
v_mul_u32_u24 v17, 12288, v17
v_add_u32 v7, v17, v18
v_add_u32 v16, 256, v10
v_mul_u32_u24 v17, 2731, v16
v_lshrrev_b32 v17, 16, v17
v_mul_u32_u24 v18, 24, v17
v_sub_u32 v18, v16, v18
v_lshlrev_b32 v19, 1, v17
v_and_b32 v19, 4, v19
v_xor_b32 v18, v18, v19
v_lshlrev_b32 v18, 4, v18
v_add_u32 v17, s63, v17
v_mul_u32_u24 v17, 12288, v17
v_add_u32 v8, v17, v18
v_add_u32 v16, 320, v10
v_mul_u32_u24 v17, 2731, v16
v_lshrrev_b32 v17, 16, v17
v_mul_u32_u24 v18, 24, v17
v_sub_u32 v18, v16, v18
v_lshlrev_b32 v19, 1, v17
v_and_b32 v19, 4, v19
v_xor_b32 v18, v18, v19
v_lshlrev_b32 v18, 4, v18
v_add_u32 v17, s63, v17
v_mul_u32_u24 v17, 12288, v17
v_add_u32 v9, v17, v18
v_lshrrev_b32 v16, 5, v10
v_lshlrev_b32 v16, 3, v16
v_bfe_u32 v17, v10, 2, 2
v_add_u32 v16, v16, v17
v_mul_u32_u24 v16, 384, v16
v_bfe_u32 v18, v10, 4, 1
v_lshl_add_u32 v16, v18, 5, v16
v_and_b32 v18, 3, v10
v_lshl_add_u32 v13, v18, 3, v16
v_lshrrev_b32 v16, 1, v17
v_lshlrev_b32 v17, 6, v16
v_add_u32 v2, v13, v17
v_sub_u32 v3, 64, v17
v_add_u32 v3, v13, v3
v_add_u32 v13, 49152, v2
v_add_u32 v15, 49152, v3
v_accvgpr_write_b32 a96, v4
v_accvgpr_write_b32 a97, v5
v_accvgpr_write_b32 a98, v6
v_accvgpr_write_b32 a99, v7
v_accvgpr_write_b32 a100, v8
v_accvgpr_write_b32 a101, v9
v_accvgpr_write_b32 a102, v2
v_accvgpr_write_b32 a103, v3
v_accvgpr_write_b32 a104, v13
v_accvgpr_write_b32 a105, v15
v_and_b32 v16, 31, v10
v_lshrrev_b32 v17, 5, v10
v_lshrrev_b32 v18, 4, v16
v_lshlrev_b32 v18, 1, v18
v_bfe_u32 v19, v16, 2, 1
v_add_u32 v18, v18, v19
v_lshlrev_b32 v18, 3, v18
v_and_b32 v19, 3, v16
v_add_u32 v18, v18, v19
v_bfe_u32 v19, v16, 3, 1
v_lshl_add_u32 v18, v19, 2, v18
v_and_b32 v19, 16, v18
v_lshrrev_b32 v20, 1, v19
v_lshrrev_b32 v19, 2, v19
v_xor_b32 v18, v18, v19
v_xor_b32 v18, v18, v20
v_lshlrev_b32 v18, 4, v18
v_lshl_add_u32 v14, v17, 9, v18
v_add_u32 v15, 1024, v14
v_accvgpr_write_b32 a106, v14
v_accvgpr_write_b32 a107, v15
v_and_b32 v16, 31, v10
v_lshrrev_b32 v17, 5, v10
v_lshrrev_b32 v18, 4, v16
v_lshlrev_b32 v18, 10, v18
v_lshl_add_u32 v18, v17, 8, v18
v_and_b32 v19, 15, v16
v_lshl_add_u32 v14, v19, 4, v18
v_add_u32 v15, 512, v14
v_accvgpr_write_b32 a108, v14
v_accvgpr_write_b32 a109, v15
v_lshrrev_b32 v16, 3, v10
v_and_b32 v17, 7, v10
v_lshlrev_b32 v18, 1, v16
v_and_b32 v18, 4, v18
v_xor_b32 v17, v17, v18
v_lshlrev_b32 v17, 4, v17
s_mul_i32 s40, s24, 48
v_add_u32 v16, s40, v16
v_mul_u32_u24 v16, 1280, v16
v_add_u32 v4, v16, v17
v_lshrrev_b32 v16, 5, v10
v_lshlrev_b32 v16, 2, v16
v_bfe_u32 v17, v10, 2, 2
v_add_u32 v16, v16, v17
v_mul_u32_u24 v16, 128, v16
v_bfe_u32 v18, v10, 4, 1
v_lshl_add_u32 v16, v18, 5, v16
v_and_b32 v18, 3, v10
v_lshl_add_u32 v13, v18, 3, v16
v_lshrrev_b32 v16, 1, v17
v_lshlrev_b32 v17, 6, v16
v_add_u32 v2, v13, v17
v_sub_u32 v3, 64, v17
v_add_u32 v3, v13, v3
v_add_u32 v13, 49152, v2
v_add_u32 v15, 49152, v3
v_bfe_u32 v16, v10, 4, 1
v_lshlrev_b32 v16, 15, v16
v_lshrrev_b32 v17, 5, v10
v_lshl_add_u32 v16, v17, 8, v16
v_and_b32 v17, 15, v10
v_lshl_add_u32 v14, v17, 4, v16
v_accvgpr_write_b32 a110, v4
v_accvgpr_write_b32 a111, v2
v_accvgpr_write_b32 a112, v3
v_accvgpr_write_b32 a113, v13
v_accvgpr_write_b32 a114, v15
v_accvgpr_write_b32 a115, v14
v_add_u32 v16, 0, v10
v_mul_u32_u24 v17, 5462, v16
v_lshrrev_b32 v17, 16, v17
v_mul_u32_u24 v18, 12, v17
v_sub_u32 v18, v16, v18
v_lshlrev_b32 v18, 4, v18
v_add_u32 v17, s63, v17
v_mul_u32_u24 v17, 3072, v17
v_add_u32 v4, v17, v18
v_add_u32 v16, 64, v10
v_mul_u32_u24 v17, 5462, v16
v_lshrrev_b32 v17, 16, v17
v_mul_u32_u24 v18, 12, v17
v_sub_u32 v18, v16, v18
v_lshlrev_b32 v18, 4, v18
v_add_u32 v17, s63, v17
v_mul_u32_u24 v17, 3072, v17
v_add_u32 v5, v17, v18
v_add_u32 v16, 128, v10
v_mul_u32_u24 v17, 5462, v16
v_lshrrev_b32 v17, 16, v17
v_mul_u32_u24 v18, 12, v17
v_sub_u32 v18, v16, v18
v_lshlrev_b32 v18, 4, v18
v_add_u32 v17, s63, v17
v_mul_u32_u24 v17, 3072, v17
v_add_u32 v6, v17, v18
v_lshrrev_b32 v16, 5, v10
v_lshlrev_b32 v16, 3, v16
v_bfe_u32 v17, v10, 2, 2
v_add_u32 v16, v16, v17
v_mul_u32_u24 v16, 192, v16
v_bfe_u32 v18, v10, 4, 1
v_lshl_add_u32 v16, v18, 5, v16
v_and_b32 v18, 3, v10
v_lshl_add_u32 v2, v18, 3, v16
v_lshrrev_b32 v16, 1, v17
v_add_u32 v13, 49152, v2
v_accvgpr_write_b32 a116, v4
v_accvgpr_write_b32 a117, v5
v_accvgpr_write_b32 a118, v6
v_accvgpr_write_b32 a119, v2
v_accvgpr_write_b32 a120, v13
v_add_u32 v16, 0, v10
v_mul_u32_u24 v17, 3277, v16
v_lshrrev_b32 v17, 16, v17
v_mul_u32_u24 v18, 20, v17
v_sub_u32 v18, v16, v18
v_lshlrev_b32 v18, 4, v18
v_add_u32 v17, s63, v17
v_mul_u32_u24 v17, 1280, v17
v_add_u32 v4, v17, v18
v_add_u32 v16, 64, v10
v_mul_u32_u24 v17, 3277, v16
v_lshrrev_b32 v17, 16, v17
v_mul_u32_u24 v18, 20, v17
v_sub_u32 v18, v16, v18
v_lshlrev_b32 v18, 4, v18
v_add_u32 v17, s63, v17
v_mul_u32_u24 v17, 1280, v17
v_add_u32 v5, v17, v18
v_add_u32 v16, 128, v10
v_mul_u32_u24 v17, 3277, v16
v_lshrrev_b32 v17, 16, v17
v_mul_u32_u24 v18, 20, v17
v_sub_u32 v18, v16, v18
v_lshlrev_b32 v18, 4, v18
v_add_u32 v17, s63, v17
v_mul_u32_u24 v17, 1280, v17
v_add_u32 v6, v17, v18
v_add_u32 v16, 192, v10
v_mul_u32_u24 v17, 3277, v16
v_lshrrev_b32 v17, 16, v17
v_mul_u32_u24 v18, 20, v17
v_sub_u32 v18, v16, v18
v_lshlrev_b32 v18, 4, v18
v_add_u32 v17, s63, v17
v_mul_u32_u24 v17, 1280, v17
v_add_u32 v7, v17, v18
v_add_u32 v16, 256, v10
v_mul_u32_u24 v17, 3277, v16
v_lshrrev_b32 v17, 16, v17
v_mul_u32_u24 v18, 20, v17
v_sub_u32 v18, v16, v18
v_lshlrev_b32 v18, 4, v18
v_add_u32 v17, s63, v17
v_mul_u32_u24 v17, 1280, v17
v_add_u32 v8, v17, v18
v_lshrrev_b32 v16, 5, v10
v_lshlrev_b32 v16, 2, v16
v_bfe_u32 v17, v10, 2, 2
v_add_u32 v16, v16, v17
v_mul_u32_u24 v16, 320, v16
v_bfe_u32 v18, v10, 4, 1
v_lshl_add_u32 v16, v18, 5, v16
v_and_b32 v18, 3, v10
v_lshl_add_u32 v2, v18, 3, v16
v_lshrrev_b32 v16, 1, v17
v_add_u32 v13, 49152, v2
v_and_b32 v16, 31, v10
v_mul_u32_u24 v16, 1280, v16
v_lshrrev_b32 v17, 5, v10
v_lshl_add_u32 v14, v17, 3, v16
v_accvgpr_write_b32 a121, v4
v_accvgpr_write_b32 a122, v5
v_accvgpr_write_b32 a123, v6
v_accvgpr_write_b32 a124, v7
v_accvgpr_write_b32 a125, v8
v_accvgpr_write_b32 a126, v2
v_accvgpr_write_b32 a127, v13
v_accvgpr_write_b32 a128, v14
s_mov_b32 s28, s86
s_and_b32 s29, s87, 0xffff
s_mov_b32 s30, 256
s_mov_b32 s31, 0x20000
s_lshl_b32 s32, s93, 2
s_add_u32 s32, s32, 128
s_cmp_eq_u32 s24, 0
s_cbranch_scc0 tk5635
v_accvgpr_write_b32 a200, 1
s_mov_b64 exec, 1
buffer_atomic_add a200, off, s[28:31], s32 sc0
s_mov_b64 exec, -1
tk5635:
s_cmp_eq_u32 s24, 0
s_cbranch_scc0 wkini_wd
s_mov_b32 s46, 0
v_mov_b32 v17, 64
wkini_wf:
global_load_dword v16, v17, s[86:87] sc1
s_waitcnt vmcnt(0)
v_readfirstlane_b32 s45, v16
s_cmp_ge_u32 s45, 128
s_cbranch_scc1 wkini_wd
s_sleep 3
s_add_u32 s46, s46, 1
s_cmp_lt_u32 s46, 0x100000
s_cbranch_scc1 wkini_wf
s_branch timeout
wkini_wd:
s_barrier
s_waitcnt vmcnt(0)
s_mov_b32 s66, 0
wk_sig:
s_cmp_eq_u32 s24, 0
s_cbranch_scc0 wk_tw
v_accvgpr_read_b32 v4, a200
v_mov_b32 v2, 98304
s_mov_b64 exec, 1
ds_write_b32 v2, v4
s_mov_b64 exec, -1
s_waitcnt lgkmcnt(0)
wk_tw:
s_barrier
s_cmp_eq_u32 s24, 0
s_cbranch_scc0 wk_nosig
s_cmp_eq_u32 s66, 0
s_cbranch_scc1 wk_nosig
s_lshl_b32 s65, s65, 7
s_add_u32 s65, s65, 201326592
v_mov_b32 v3, 1
s_mov_b64 exec, 1
buffer_atomic_add v3, off, s[4:7], s65 sc1
s_cmp_eq_u32 s66, 2
s_cbranch_scc0 wk_sig1
buffer_atomic_add v3, off, s[4:7], s65 offset:128 sc1
wk_sig1:
s_mov_b64 exec, -1
wk_nosig:
v_mov_b32 v2, 98304
ds_read_b32 v4, v2
s_waitcnt lgkmcnt(0)
v_readfirstlane_b32 s67, v4
s_cmp_ge_u32 s67, 288
s_cbranch_scc1 done
s_mov_b32 s66, 5376
s_mov_b32 s65, 280
s_cmp_lt_u32 s67, 280
s_cselect_b32 s66, 21518, s66
s_cselect_b32 s65, 278, s65
s_cmp_lt_u32 s67, 278
s_cselect_b32 s66, 21516, s66
s_cselect_b32 s65, 276, s65
s_cmp_lt_u32 s67, 276
s_cselect_b32 s66, 24838, s66
s_cselect_b32 s65, 260, s65
s_cmp_lt_u32 s67, 260
s_cselect_b32 s66, 24582, s66
s_cselect_b32 s65, 244, s65
s_cmp_lt_u32 s67, 244
s_cselect_b32 s66, 25094, s66
s_cselect_b32 s65, 228, s65
s_cmp_lt_u32 s67, 228
s_cselect_b32 s66, 21514, s66
s_cselect_b32 s65, 226, s65
s_cmp_lt_u32 s67, 226
s_cselect_b32 s66, 21512, s66
s_cselect_b32 s65, 224, s65
s_cmp_lt_u32 s67, 224
s_cselect_b32 s66, 8967, s66
s_cselect_b32 s65, 220, s65
s_cmp_lt_u32 s67, 220
s_cselect_b32 s66, 8966, s66
s_cselect_b32 s65, 216, s65
s_cmp_lt_u32 s67, 216
s_cselect_b32 s66, 21510, s66
s_cselect_b32 s65, 214, s65
s_cmp_lt_u32 s67, 214
s_cselect_b32 s66, 21508, s66
s_cselect_b32 s65, 212, s65
s_cmp_lt_u32 s67, 212
s_cselect_b32 s66, 21506, s66
s_cselect_b32 s65, 210, s65
s_cmp_lt_u32 s67, 210
s_cselect_b32 s66, 21504, s66
s_cselect_b32 s65, 208, s65
s_cmp_lt_u32 s67, 208
s_cselect_b32 s66, 8965, s66
s_cselect_b32 s65, 204, s65
s_cmp_lt_u32 s67, 204
s_cselect_b32 s66, 8964, s66
s_cselect_b32 s65, 200, s65
s_cmp_lt_u32 s67, 200
s_cselect_b32 s66, 24836, s66
s_cselect_b32 s65, 184, s65
s_cmp_lt_u32 s67, 184
s_cselect_b32 s66, 24580, s66
s_cselect_b32 s65, 168, s65
s_cmp_lt_u32 s67, 168
s_cselect_b32 s66, 25092, s66
s_cselect_b32 s65, 152, s65
s_cmp_lt_u32 s67, 152
s_cselect_b32 s66, 8963, s66
s_cselect_b32 s65, 148, s65
s_cmp_lt_u32 s67, 148
s_cselect_b32 s66, 8962, s66
s_cselect_b32 s65, 144, s65
s_cmp_lt_u32 s67, 144
s_cselect_b32 s66, 8961, s66
s_cselect_b32 s65, 140, s65
s_cmp_lt_u32 s67, 140
s_cselect_b32 s66, 8960, s66
s_cselect_b32 s65, 136, s65
s_cmp_lt_u32 s67, 136
s_cselect_b32 s66, 24834, s66
s_cselect_b32 s65, 120, s65
s_cmp_lt_u32 s67, 120
s_cselect_b32 s66, 24578, s66
s_cselect_b32 s65, 104, s65
s_cmp_lt_u32 s67, 104
s_cselect_b32 s66, 25090, s66
s_cselect_b32 s65, 88, s65
s_cmp_lt_u32 s67, 88
s_cselect_b32 s66, 8449, s66
s_cselect_b32 s65, 80, s65
s_cmp_lt_u32 s67, 80
s_cselect_b32 s66, 8193, s66
s_cselect_b32 s65, 72, s65
s_cmp_lt_u32 s67, 72
s_cselect_b32 s66, 4353, s66
s_cselect_b32 s65, 64, s65
s_cmp_lt_u32 s67, 64
s_cselect_b32 s66, 5633, s66
s_cselect_b32 s65, 48, s65
s_cmp_lt_u32 s67, 48
s_cselect_b32 s66, 4097, s66
s_cselect_b32 s65, 40, s65
s_cmp_lt_u32 s67, 40
s_cselect_b32 s66, 8705, s66
s_cselect_b32 s65, 32, s65
s_cmp_lt_u32 s67, 32
s_cselect_b32 s66, 4352, s66
s_cselect_b32 s65, 24, s65
s_cmp_lt_u32 s67, 24
s_cselect_b32 s66, 4096, s66
s_cselect_b32 s65, 16, s65
s_cmp_lt_u32 s67, 16
s_cselect_b32 s66, 5632, s66
s_cselect_b32 s65, 0, s65
s_bfe_u32 s64, s66, 0x40008
s_and_b32 s55, s66, 0xff
s_sub_u32 s65, s67, s65
s_bfe_u32 s94, s66, 0x2000c
s_bitcmp1_b32 s66, 14
s_cbranch_scc0 wk_np
s_and_b32 s66, s65, 1
s_add_u32 s55, s55, s66
s_lshr_b32 s65, s65, 1
wk_np:
s_cmp_eq_u32 s64, 5
s_cbranch_scc1 wk_f0
s_cmp_eq_u32 s64, 4
s_cbranch_scc1 wk_dn
s_cmp_eq_u32 s64, 3
s_cbranch_scc1 wk_gu
s_mov_b32 s95, 0
s_cmp_eq_u32 s64, 6
s_cbranch_scc0 wk_n6
s_and_b32 s95, s65, 1
s_lshr_b32 s65, s65, 1
s_mov_b32 s64, 2
wk_n6:
s_lshl_b32 s54, s93, 3
s_add_u32 s54, s54, s65
s_cmp_eq_u32 s94, 1
s_cbranch_scc1 wk_p1
s_cmp_eq_u32 s64, 0
s_cselect_b32 s8, s70, s68
s_cselect_b32 s9, s71, s69
s_cmp_eq_u32 s64, 2
s_cselect_b32 s8, s72, s8
s_cselect_b32 s9, s73, s9
s_and_b32 s9, s9, 0xffff
s_mov_b32 s10, 7864320
s_mov_b32 s11, 0x20000
s_mov_b32 s12, s74
s_and_b32 s13, s75, 0xffff
s_mov_b32 s14, 7864320
s_mov_b32 s15, 0x20000
v_accvgpr_read_b32 v4, a96
v_accvgpr_read_b32 v5, a97
v_accvgpr_read_b32 v6, a98
v_accvgpr_read_b32 v7, a99
v_accvgpr_read_b32 v8, a100
v_accvgpr_read_b32 v9, a101
v_accvgpr_read_b32 v2, a102
v_accvgpr_read_b32 v3, a103
v_accvgpr_read_b32 v13, a104
v_accvgpr_read_b32 v15, a105
s_mul_i32 s40, s24, 81920
v_add_u32 v11, s40, v1
v_add_u32 v12, 40960, v11
s_mul_i32 s57, s55, 327680
s_add_u32 s57, s57, 8388608
s_mul_i32 s56, s54, 384
s_add_u32 s43, s56, 0
s_add_u32 m0, s62, 0
s_nop 0
buffer_load_dwordx4 v4, s[8:11], s43 offen lds
s_add_u32 m0, s62, 1024
s_nop 0
buffer_load_dwordx4 v5, s[8:11], s43 offen lds
s_add_u32 m0, s62, 2048
s_nop 0
buffer_load_dwordx4 v6, s[8:11], s43 offen lds
s_add_u32 m0, s62, 3072
s_nop 0
buffer_load_dwordx4 v7, s[8:11], s43 offen lds
s_add_u32 m0, s62, 4096
s_nop 0
buffer_load_dwordx4 v8, s[8:11], s43 offen lds
s_add_u32 m0, s62, 5120
s_nop 0
buffer_load_dwordx4 v9, s[8:11], s43 offen lds
s_add_u32 s43, s56, 786432
s_add_u32 m0, s62, 24576
s_nop 0
buffer_load_dwordx4 v4, s[8:11], s43 offen lds
s_add_u32 m0, s62, 25600
s_nop 0
buffer_load_dwordx4 v5, s[8:11], s43 offen lds
s_add_u32 m0, s62, 26624
s_nop 0
buffer_load_dwordx4 v6, s[8:11], s43 offen lds
s_add_u32 m0, s62, 27648
s_nop 0
buffer_load_dwordx4 v7, s[8:11], s43 offen lds
s_add_u32 m0, s62, 28672
s_nop 0
buffer_load_dwordx4 v8, s[8:11], s43 offen lds
s_add_u32 m0, s62, 29696
s_nop 0
buffer_load_dwordx4 v9, s[8:11], s43 offen lds
s_add_u32 s43, s56, 1572864
s_add_u32 m0, s62, 49152
s_nop 0
buffer_load_dwordx4 v4, s[8:11], s43 offen lds
s_add_u32 m0, s62, 50176
s_nop 0
buffer_load_dwordx4 v5, s[8:11], s43 offen lds
s_add_u32 m0, s62, 51200
s_nop 0
buffer_load_dwordx4 v6, s[8:11], s43 offen lds
s_add_u32 m0, s62, 52224
s_nop 0
buffer_load_dwordx4 v7, s[8:11], s43 offen lds
s_add_u32 m0, s62, 53248
s_nop 0
buffer_load_dwordx4 v8, s[8:11], s43 offen lds
s_add_u32 m0, s62, 54272
s_nop 0
buffer_load_dwordx4 v9, s[8:11], s43 offen lds
s_add_u32 s59, s57, 0
s_add_u32 s60, s57, 4096
s_add_u32 s61, s57, 8192
buffer_load_dwordx4 a[0:3], v11, s[4:7], s59 offen offset:0 sc1
buffer_load_dwordx4 a[4:7], v12, s[4:7], s59 offen offset:0 sc1
buffer_load_dwordx4 a[8:11], v11, s[4:7], s59 offen offset:1024 sc1
buffer_load_dwordx4 a[12:15], v12, s[4:7], s59 offen offset:1024 sc1
buffer_load_dwordx4 a[16:19], v11, s[4:7], s59 offen offset:2048 sc1
buffer_load_dwordx4 a[20:23], v12, s[4:7], s59 offen offset:2048 sc1
buffer_load_dwordx4 a[24:27], v11, s[4:7], s59 offen offset:3072 sc1
buffer_load_dwordx4 a[28:31], v12, s[4:7], s59 offen offset:3072 sc1
buffer_load_dwordx4 a[32:35], v11, s[4:7], s60 offen offset:0 sc1
buffer_load_dwordx4 a[36:39], v12, s[4:7], s60 offen offset:0 sc1
buffer_load_dwordx4 a[40:43], v11, s[4:7], s60 offen offset:1024 sc1
buffer_load_dwordx4 a[44:47], v12, s[4:7], s60 offen offset:1024 sc1
buffer_load_dwordx4 a[48:51], v11, s[4:7], s60 offen offset:2048 sc1
buffer_load_dwordx4 a[52:55], v12, s[4:7], s60 offen offset:2048 sc1
buffer_load_dwordx4 a[56:59], v11, s[4:7], s60 offen offset:3072 sc1
buffer_load_dwordx4 a[60:63], v12, s[4:7], s60 offen offset:3072 sc1
s_waitcnt vmcnt(28)
s_barrier
ds_read_b64_tr_b16 v[16:17], v2 offset:0
ds_read_b64_tr_b16 v[18:19], v2 offset:1536
ds_read_b64_tr_b16 v[20:21], v3 offset:0
ds_read_b64_tr_b16 v[22:23], v3 offset:1536
ds_read_b64_tr_b16 v[24:25], v2 offset:128
ds_read_b64_tr_b16 v[26:27], v2 offset:1664
ds_read_b64_tr_b16 v[28:29], v3 offset:128
ds_read_b64_tr_b16 v[30:31], v3 offset:1664
ds_read_b64_tr_b16 v[32:33], v2 offset:256
ds_read_b64_tr_b16 v[34:35], v2 offset:1792
ds_read_b64_tr_b16 v[36:37], v3 offset:256
ds_read_b64_tr_b16 v[38:39], v3 offset:1792
s_waitcnt lgkmcnt(0)
s_waitcnt vmcnt(14)
v_mfma_f32_32x32x16_bf16 v[64:79], v[16:19], a[0:3], 0
s_add_u32 s61, s57, 8192
ds_read_b64_tr_b16 v[40:41], v2 offset:6144
v_mfma_f32_32x32x16_bf16 v[80:95], v[16:19], a[4:7], 0
ds_read_b64_tr_b16 v[42:43], v2 offset:7680
ds_read_b64_tr_b16 v[44:45], v3 offset:6144
v_mfma_f32_32x32x16_bf16 v[96:111], v[20:23], a[0:3], 0
ds_read_b64_tr_b16 v[46:47], v3 offset:7680
ds_read_b64_tr_b16 v[48:49], v2 offset:6272
v_mfma_f32_32x32x16_bf16 v[112:127], v[20:23], a[4:7], 0
ds_read_b64_tr_b16 v[50:51], v2 offset:7808
ds_read_b64_tr_b16 v[52:53], v3 offset:6272
v_mfma_f32_32x32x16_bf16 v[128:143], v[24:27], a[0:3], 0
ds_read_b64_tr_b16 v[54:55], v3 offset:7808
ds_read_b64_tr_b16 v[56:57], v2 offset:6400
v_mfma_f32_32x32x16_bf16 v[144:159], v[24:27], a[4:7], 0
ds_read_b64_tr_b16 v[58:59], v2 offset:7936
ds_read_b64_tr_b16 v[60:61], v3 offset:6400
v_mfma_f32_32x32x16_bf16 v[160:175], v[28:31], a[0:3], 0
ds_read_b64_tr_b16 v[62:63], v3 offset:7936
buffer_load_dwordx4 a[64:67], v11, s[4:7], s61 offen offset:0 sc1
buffer_load_dwordx4 a[68:71], v12, s[4:7], s61 offen offset:0 sc1
v_mfma_f32_32x32x16_bf16 v[176:191], v[28:31], a[4:7], 0
v_mfma_f32_32x32x16_bf16 v[192:207], v[32:35], a[0:3], 0
v_mfma_f32_32x32x16_bf16 v[208:223], v[32:35], a[4:7], 0
v_mfma_f32_32x32x16_bf16 v[224:239], v[36:39], a[0:3], 0
v_mfma_f32_32x32x16_bf16 v[240:255], v[36:39], a[4:7], 0
s_waitcnt lgkmcnt(0)
s_waitcnt vmcnt(14)
v_mfma_f32_32x32x16_bf16 v[64:79], v[40:43], a[8:11], v[64:79]
ds_read_b64_tr_b16 v[16:17], v2 offset:12288
ds_read_b64_tr_b16 v[18:19], v2 offset:13824
v_mfma_f32_32x32x16_bf16 v[80:95], v[40:43], a[12:15], v[80:95]
ds_read_b64_tr_b16 v[20:21], v3 offset:12288
ds_read_b64_tr_b16 v[22:23], v3 offset:13824
v_mfma_f32_32x32x16_bf16 v[96:111], v[44:47], a[8:11], v[96:111]
ds_read_b64_tr_b16 v[24:25], v2 offset:12416
ds_read_b64_tr_b16 v[26:27], v2 offset:13952
v_mfma_f32_32x32x16_bf16 v[112:127], v[44:47], a[12:15], v[112:127]
ds_read_b64_tr_b16 v[28:29], v3 offset:12416
ds_read_b64_tr_b16 v[30:31], v3 offset:13952
v_mfma_f32_32x32x16_bf16 v[128:143], v[48:51], a[8:11], v[128:143]
ds_read_b64_tr_b16 v[32:33], v2 offset:12544
ds_read_b64_tr_b16 v[34:35], v2 offset:14080
v_mfma_f32_32x32x16_bf16 v[144:159], v[48:51], a[12:15], v[144:159]
ds_read_b64_tr_b16 v[36:37], v3 offset:12544
ds_read_b64_tr_b16 v[38:39], v3 offset:14080
v_mfma_f32_32x32x16_bf16 v[160:175], v[52:55], a[8:11], v[160:175]
buffer_load_dwordx4 a[72:75], v11, s[4:7], s61 offen offset:1024 sc1
buffer_load_dwordx4 a[76:79], v12, s[4:7], s61 offen offset:1024 sc1
v_mfma_f32_32x32x16_bf16 v[176:191], v[52:55], a[12:15], v[176:191]
v_mfma_f32_32x32x16_bf16 v[192:207], v[56:59], a[8:11], v[192:207]
v_mfma_f32_32x32x16_bf16 v[208:223], v[56:59], a[12:15], v[208:223]
v_mfma_f32_32x32x16_bf16 v[224:239], v[60:63], a[8:11], v[224:239]
v_mfma_f32_32x32x16_bf16 v[240:255], v[60:63], a[12:15], v[240:255]
s_waitcnt lgkmcnt(0)
s_waitcnt vmcnt(14)
v_mfma_f32_32x32x16_bf16 v[64:79], v[16:19], a[16:19], v[64:79]
ds_read_b64_tr_b16 v[40:41], v2 offset:18432
ds_read_b64_tr_b16 v[42:43], v2 offset:19968
v_mfma_f32_32x32x16_bf16 v[80:95], v[16:19], a[20:23], v[80:95]
ds_read_b64_tr_b16 v[44:45], v3 offset:18432
ds_read_b64_tr_b16 v[46:47], v3 offset:19968
v_mfma_f32_32x32x16_bf16 v[96:111], v[20:23], a[16:19], v[96:111]
ds_read_b64_tr_b16 v[48:49], v2 offset:18560
ds_read_b64_tr_b16 v[50:51], v2 offset:20096
v_mfma_f32_32x32x16_bf16 v[112:127], v[20:23], a[20:23], v[112:127]
ds_read_b64_tr_b16 v[52:53], v3 offset:18560
ds_read_b64_tr_b16 v[54:55], v3 offset:20096
v_mfma_f32_32x32x16_bf16 v[128:143], v[24:27], a[16:19], v[128:143]
ds_read_b64_tr_b16 v[56:57], v2 offset:18688
ds_read_b64_tr_b16 v[58:59], v2 offset:20224
v_mfma_f32_32x32x16_bf16 v[144:159], v[24:27], a[20:23], v[144:159]
ds_read_b64_tr_b16 v[60:61], v3 offset:18688
ds_read_b64_tr_b16 v[62:63], v3 offset:20224
v_mfma_f32_32x32x16_bf16 v[160:175], v[28:31], a[16:19], v[160:175]
buffer_load_dwordx4 a[0:3], v11, s[4:7], s61 offen offset:2048 sc1
buffer_load_dwordx4 a[4:7], v12, s[4:7], s61 offen offset:2048 sc1
v_mfma_f32_32x32x16_bf16 v[176:191], v[28:31], a[20:23], v[176:191]
v_mfma_f32_32x32x16_bf16 v[192:207], v[32:35], a[16:19], v[192:207]
v_mfma_f32_32x32x16_bf16 v[208:223], v[32:35], a[20:23], v[208:223]
v_mfma_f32_32x32x16_bf16 v[224:239], v[36:39], a[16:19], v[224:239]
v_mfma_f32_32x32x16_bf16 v[240:255], v[36:39], a[20:23], v[240:255]
s_waitcnt lgkmcnt(0)
s_barrier
s_waitcnt vmcnt(14)
v_mfma_f32_32x32x16_bf16 v[64:79], v[40:43], a[24:27], v[64:79]
ds_read_b64_tr_b16 v[16:17], v2 offset:24576
ds_read_b64_tr_b16 v[18:19], v2 offset:26112
v_mfma_f32_32x32x16_bf16 v[80:95], v[40:43], a[28:31], v[80:95]
ds_read_b64_tr_b16 v[20:21], v3 offset:24576
ds_read_b64_tr_b16 v[22:23], v3 offset:26112
v_mfma_f32_32x32x16_bf16 v[96:111], v[44:47], a[24:27], v[96:111]
ds_read_b64_tr_b16 v[24:25], v2 offset:24704
ds_read_b64_tr_b16 v[26:27], v2 offset:26240
v_mfma_f32_32x32x16_bf16 v[112:127], v[44:47], a[28:31], v[112:127]
ds_read_b64_tr_b16 v[28:29], v3 offset:24704
ds_read_b64_tr_b16 v[30:31], v3 offset:26240
v_mfma_f32_32x32x16_bf16 v[128:143], v[48:51], a[24:27], v[128:143]
ds_read_b64_tr_b16 v[32:33], v2 offset:24832
ds_read_b64_tr_b16 v[34:35], v2 offset:26368
v_mfma_f32_32x32x16_bf16 v[144:159], v[48:51], a[28:31], v[144:159]
ds_read_b64_tr_b16 v[36:37], v3 offset:24832
ds_read_b64_tr_b16 v[38:39], v3 offset:26368
v_mfma_f32_32x32x16_bf16 v[160:175], v[52:55], a[24:27], v[160:175]
s_add_u32 s43, s56, 2359296
s_add_u32 m0, s62, 73728
s_nop 0
buffer_load_dwordx4 v4, s[8:11], s43 offen lds
s_add_u32 m0, s62, 74752
s_nop 0
buffer_load_dwordx4 v5, s[8:11], s43 offen lds
s_add_u32 m0, s62, 75776
s_nop 0
buffer_load_dwordx4 v6, s[8:11], s43 offen lds
s_add_u32 m0, s62, 76800
s_nop 0
buffer_load_dwordx4 v7, s[8:11], s43 offen lds
s_add_u32 m0, s62, 77824
s_nop 0
buffer_load_dwordx4 v8, s[8:11], s43 offen lds
s_add_u32 m0, s62, 78848
s_nop 0
buffer_load_dwordx4 v9, s[8:11], s43 offen lds
buffer_load_dwordx4 a[8:11], v11, s[4:7], s61 offen offset:3072 sc1
buffer_load_dwordx4 a[12:15], v12, s[4:7], s61 offen offset:3072 sc1
v_mfma_f32_32x32x16_bf16 v[176:191], v[52:55], a[28:31], v[176:191]
v_mfma_f32_32x32x16_bf16 v[192:207], v[56:59], a[24:27], v[192:207]
v_mfma_f32_32x32x16_bf16 v[208:223], v[56:59], a[28:31], v[208:223]
v_mfma_f32_32x32x16_bf16 v[224:239], v[60:63], a[24:27], v[224:239]
v_mfma_f32_32x32x16_bf16 v[240:255], v[60:63], a[28:31], v[240:255]
s_waitcnt lgkmcnt(0)
s_waitcnt vmcnt(20)
v_mfma_f32_32x32x16_bf16 v[64:79], v[16:19], a[32:35], v[64:79]
s_add_u32 s59, s57, 12288
ds_read_b64_tr_b16 v[40:41], v2 offset:30720
v_mfma_f32_32x32x16_bf16 v[80:95], v[16:19], a[36:39], v[80:95]
ds_read_b64_tr_b16 v[42:43], v2 offset:32256
ds_read_b64_tr_b16 v[44:45], v3 offset:30720
v_mfma_f32_32x32x16_bf16 v[96:111], v[20:23], a[32:35], v[96:111]
ds_read_b64_tr_b16 v[46:47], v3 offset:32256
ds_read_b64_tr_b16 v[48:49], v2 offset:30848
v_mfma_f32_32x32x16_bf16 v[112:127], v[20:23], a[36:39], v[112:127]
ds_read_b64_tr_b16 v[50:51], v2 offset:32384
ds_read_b64_tr_b16 v[52:53], v3 offset:30848
v_mfma_f32_32x32x16_bf16 v[128:143], v[24:27], a[32:35], v[128:143]
ds_read_b64_tr_b16 v[54:55], v3 offset:32384
ds_read_b64_tr_b16 v[56:57], v2 offset:30976
v_mfma_f32_32x32x16_bf16 v[144:159], v[24:27], a[36:39], v[144:159]
ds_read_b64_tr_b16 v[58:59], v2 offset:32512
ds_read_b64_tr_b16 v[60:61], v3 offset:30976
v_mfma_f32_32x32x16_bf16 v[160:175], v[28:31], a[32:35], v[160:175]
ds_read_b64_tr_b16 v[62:63], v3 offset:32512
buffer_load_dwordx4 a[16:19], v11, s[4:7], s59 offen offset:0 sc1
buffer_load_dwordx4 a[20:23], v12, s[4:7], s59 offen offset:0 sc1
v_mfma_f32_32x32x16_bf16 v[176:191], v[28:31], a[36:39], v[176:191]
v_mfma_f32_32x32x16_bf16 v[192:207], v[32:35], a[32:35], v[192:207]
v_mfma_f32_32x32x16_bf16 v[208:223], v[32:35], a[36:39], v[208:223]
v_mfma_f32_32x32x16_bf16 v[224:239], v[36:39], a[32:35], v[224:239]
v_mfma_f32_32x32x16_bf16 v[240:255], v[36:39], a[36:39], v[240:255]
s_waitcnt lgkmcnt(0)
s_waitcnt vmcnt(20)
v_mfma_f32_32x32x16_bf16 v[64:79], v[40:43], a[40:43], v[64:79]
ds_read_b64_tr_b16 v[16:17], v2 offset:36864
ds_read_b64_tr_b16 v[18:19], v2 offset:38400
v_mfma_f32_32x32x16_bf16 v[80:95], v[40:43], a[44:47], v[80:95]
ds_read_b64_tr_b16 v[20:21], v3 offset:36864
ds_read_b64_tr_b16 v[22:23], v3 offset:38400
v_mfma_f32_32x32x16_bf16 v[96:111], v[44:47], a[40:43], v[96:111]
ds_read_b64_tr_b16 v[24:25], v2 offset:36992
ds_read_b64_tr_b16 v[26:27], v2 offset:38528
v_mfma_f32_32x32x16_bf16 v[112:127], v[44:47], a[44:47], v[112:127]
ds_read_b64_tr_b16 v[28:29], v3 offset:36992
ds_read_b64_tr_b16 v[30:31], v3 offset:38528
v_mfma_f32_32x32x16_bf16 v[128:143], v[48:51], a[40:43], v[128:143]
ds_read_b64_tr_b16 v[32:33], v2 offset:37120
ds_read_b64_tr_b16 v[34:35], v2 offset:38656
v_mfma_f32_32x32x16_bf16 v[144:159], v[48:51], a[44:47], v[144:159]
ds_read_b64_tr_b16 v[36:37], v3 offset:37120
ds_read_b64_tr_b16 v[38:39], v3 offset:38656
v_mfma_f32_32x32x16_bf16 v[160:175], v[52:55], a[40:43], v[160:175]
buffer_load_dwordx4 a[24:27], v11, s[4:7], s59 offen offset:1024 sc1
buffer_load_dwordx4 a[28:31], v12, s[4:7], s59 offen offset:1024 sc1
v_mfma_f32_32x32x16_bf16 v[176:191], v[52:55], a[44:47], v[176:191]
v_mfma_f32_32x32x16_bf16 v[192:207], v[56:59], a[40:43], v[192:207]
v_mfma_f32_32x32x16_bf16 v[208:223], v[56:59], a[44:47], v[208:223]
v_mfma_f32_32x32x16_bf16 v[224:239], v[60:63], a[40:43], v[224:239]
v_mfma_f32_32x32x16_bf16 v[240:255], v[60:63], a[44:47], v[240:255]
s_waitcnt lgkmcnt(0)
s_waitcnt vmcnt(20)
v_mfma_f32_32x32x16_bf16 v[64:79], v[16:19], a[48:51], v[64:79]
ds_read_b64_tr_b16 v[40:41], v2 offset:43008
ds_read_b64_tr_b16 v[42:43], v2 offset:44544
v_mfma_f32_32x32x16_bf16 v[80:95], v[16:19], a[52:55], v[80:95]
ds_read_b64_tr_b16 v[44:45], v3 offset:43008
ds_read_b64_tr_b16 v[46:47], v3 offset:44544
v_mfma_f32_32x32x16_bf16 v[96:111], v[20:23], a[48:51], v[96:111]
ds_read_b64_tr_b16 v[48:49], v2 offset:43136
ds_read_b64_tr_b16 v[50:51], v2 offset:44672
v_mfma_f32_32x32x16_bf16 v[112:127], v[20:23], a[52:55], v[112:127]
ds_read_b64_tr_b16 v[52:53], v3 offset:43136
ds_read_b64_tr_b16 v[54:55], v3 offset:44672
v_mfma_f32_32x32x16_bf16 v[128:143], v[24:27], a[48:51], v[128:143]
ds_read_b64_tr_b16 v[56:57], v2 offset:43264
ds_read_b64_tr_b16 v[58:59], v2 offset:44800
v_mfma_f32_32x32x16_bf16 v[144:159], v[24:27], a[52:55], v[144:159]
ds_read_b64_tr_b16 v[60:61], v3 offset:43264
ds_read_b64_tr_b16 v[62:63], v3 offset:44800
v_mfma_f32_32x32x16_bf16 v[160:175], v[28:31], a[48:51], v[160:175]
buffer_load_dwordx4 a[32:35], v11, s[4:7], s59 offen offset:2048 sc1
buffer_load_dwordx4 a[36:39], v12, s[4:7], s59 offen offset:2048 sc1
v_mfma_f32_32x32x16_bf16 v[176:191], v[28:31], a[52:55], v[176:191]
v_mfma_f32_32x32x16_bf16 v[192:207], v[32:35], a[48:51], v[192:207]
v_mfma_f32_32x32x16_bf16 v[208:223], v[32:35], a[52:55], v[208:223]
v_mfma_f32_32x32x16_bf16 v[224:239], v[36:39], a[48:51], v[224:239]
v_mfma_f32_32x32x16_bf16 v[240:255], v[36:39], a[52:55], v[240:255]
s_waitcnt lgkmcnt(0)
s_barrier
s_waitcnt vmcnt(20)
v_mfma_f32_32x32x16_bf16 v[64:79], v[40:43], a[56:59], v[64:79]
ds_read_b64_tr_b16 v[16:17], v13 offset:0
ds_read_b64_tr_b16 v[18:19], v13 offset:1536
v_mfma_f32_32x32x16_bf16 v[80:95], v[40:43], a[60:63], v[80:95]
ds_read_b64_tr_b16 v[20:21], v15 offset:0
ds_read_b64_tr_b16 v[22:23], v15 offset:1536
v_mfma_f32_32x32x16_bf16 v[96:111], v[44:47], a[56:59], v[96:111]
ds_read_b64_tr_b16 v[24:25], v13 offset:128
ds_read_b64_tr_b16 v[26:27], v13 offset:1664
v_mfma_f32_32x32x16_bf16 v[112:127], v[44:47], a[60:63], v[112:127]
ds_read_b64_tr_b16 v[28:29], v15 offset:128
ds_read_b64_tr_b16 v[30:31], v15 offset:1664
v_mfma_f32_32x32x16_bf16 v[128:143], v[48:51], a[56:59], v[128:143]
ds_read_b64_tr_b16 v[32:33], v13 offset:256
ds_read_b64_tr_b16 v[34:35], v13 offset:1792
v_mfma_f32_32x32x16_bf16 v[144:159], v[48:51], a[60:63], v[144:159]
ds_read_b64_tr_b16 v[36:37], v15 offset:256
ds_read_b64_tr_b16 v[38:39], v15 offset:1792
v_mfma_f32_32x32x16_bf16 v[160:175], v[52:55], a[56:59], v[160:175]
s_add_u32 s43, s56, 3145728
s_add_u32 m0, s62, 0
s_nop 0
buffer_load_dwordx4 v4, s[8:11], s43 offen lds
s_add_u32 m0, s62, 1024
s_nop 0
buffer_load_dwordx4 v5, s[8:11], s43 offen lds
s_add_u32 m0, s62, 2048
s_nop 0
buffer_load_dwordx4 v6, s[8:11], s43 offen lds
s_add_u32 m0, s62, 3072
s_nop 0
buffer_load_dwordx4 v7, s[8:11], s43 offen lds
s_add_u32 m0, s62, 4096
s_nop 0
buffer_load_dwordx4 v8, s[8:11], s43 offen lds
s_add_u32 m0, s62, 5120
s_nop 0
buffer_load_dwordx4 v9, s[8:11], s43 offen lds
buffer_load_dwordx4 a[40:43], v11, s[4:7], s59 offen offset:3072 sc1
buffer_load_dwordx4 a[44:47], v12, s[4:7], s59 offen offset:3072 sc1
v_mfma_f32_32x32x16_bf16 v[176:191], v[52:55], a[60:63], v[176:191]
v_mfma_f32_32x32x16_bf16 v[192:207], v[56:59], a[56:59], v[192:207]
v_mfma_f32_32x32x16_bf16 v[208:223], v[56:59], a[60:63], v[208:223]
v_mfma_f32_32x32x16_bf16 v[224:239], v[60:63], a[56:59], v[224:239]
v_mfma_f32_32x32x16_bf16 v[240:255], v[60:63], a[60:63], v[240:255]
s_waitcnt lgkmcnt(0)
s_waitcnt vmcnt(26)
v_mfma_f32_32x32x16_bf16 v[64:79], v[16:19], a[64:67], v[64:79]
s_add_u32 s60, s57, 16384
ds_read_b64_tr_b16 v[40:41], v13 offset:6144
v_mfma_f32_32x32x16_bf16 v[80:95], v[16:19], a[68:71], v[80:95]
ds_read_b64_tr_b16 v[42:43], v13 offset:7680
ds_read_b64_tr_b16 v[44:45], v15 offset:6144
v_mfma_f32_32x32x16_bf16 v[96:111], v[20:23], a[64:67], v[96:111]
ds_read_b64_tr_b16 v[46:47], v15 offset:7680
ds_read_b64_tr_b16 v[48:49], v13 offset:6272
v_mfma_f32_32x32x16_bf16 v[112:127], v[20:23], a[68:71], v[112:127]
ds_read_b64_tr_b16 v[50:51], v13 offset:7808
ds_read_b64_tr_b16 v[52:53], v15 offset:6272
v_mfma_f32_32x32x16_bf16 v[128:143], v[24:27], a[64:67], v[128:143]
ds_read_b64_tr_b16 v[54:55], v15 offset:7808
ds_read_b64_tr_b16 v[56:57], v13 offset:6400
v_mfma_f32_32x32x16_bf16 v[144:159], v[24:27], a[68:71], v[144:159]
ds_read_b64_tr_b16 v[58:59], v13 offset:7936
ds_read_b64_tr_b16 v[60:61], v15 offset:6400
v_mfma_f32_32x32x16_bf16 v[160:175], v[28:31], a[64:67], v[160:175]
ds_read_b64_tr_b16 v[62:63], v15 offset:7936
buffer_load_dwordx4 a[48:51], v11, s[4:7], s60 offen offset:0 sc1
buffer_load_dwordx4 a[52:55], v12, s[4:7], s60 offen offset:0 sc1
v_mfma_f32_32x32x16_bf16 v[176:191], v[28:31], a[68:71], v[176:191]
v_mfma_f32_32x32x16_bf16 v[192:207], v[32:35], a[64:67], v[192:207]
v_mfma_f32_32x32x16_bf16 v[208:223], v[32:35], a[68:71], v[208:223]
v_mfma_f32_32x32x16_bf16 v[224:239], v[36:39], a[64:67], v[224:239]
v_mfma_f32_32x32x16_bf16 v[240:255], v[36:39], a[68:71], v[240:255]
s_waitcnt lgkmcnt(0)
s_waitcnt vmcnt(26)
v_mfma_f32_32x32x16_bf16 v[64:79], v[40:43], a[72:75], v[64:79]
ds_read_b64_tr_b16 v[16:17], v13 offset:12288
ds_read_b64_tr_b16 v[18:19], v13 offset:13824
v_mfma_f32_32x32x16_bf16 v[80:95], v[40:43], a[76:79], v[80:95]
ds_read_b64_tr_b16 v[20:21], v15 offset:12288
ds_read_b64_tr_b16 v[22:23], v15 offset:13824
v_mfma_f32_32x32x16_bf16 v[96:111], v[44:47], a[72:75], v[96:111]
ds_read_b64_tr_b16 v[24:25], v13 offset:12416
ds_read_b64_tr_b16 v[26:27], v13 offset:13952
v_mfma_f32_32x32x16_bf16 v[112:127], v[44:47], a[76:79], v[112:127]
ds_read_b64_tr_b16 v[28:29], v15 offset:12416
ds_read_b64_tr_b16 v[30:31], v15 offset:13952
v_mfma_f32_32x32x16_bf16 v[128:143], v[48:51], a[72:75], v[128:143]
ds_read_b64_tr_b16 v[32:33], v13 offset:12544
ds_read_b64_tr_b16 v[34:35], v13 offset:14080
v_mfma_f32_32x32x16_bf16 v[144:159], v[48:51], a[76:79], v[144:159]
ds_read_b64_tr_b16 v[36:37], v15 offset:12544
ds_read_b64_tr_b16 v[38:39], v15 offset:14080
v_mfma_f32_32x32x16_bf16 v[160:175], v[52:55], a[72:75], v[160:175]
buffer_load_dwordx4 a[56:59], v11, s[4:7], s60 offen offset:1024 sc1
buffer_load_dwordx4 a[60:63], v12, s[4:7], s60 offen offset:1024 sc1
v_mfma_f32_32x32x16_bf16 v[176:191], v[52:55], a[76:79], v[176:191]
v_mfma_f32_32x32x16_bf16 v[192:207], v[56:59], a[72:75], v[192:207]
v_mfma_f32_32x32x16_bf16 v[208:223], v[56:59], a[76:79], v[208:223]
v_mfma_f32_32x32x16_bf16 v[224:239], v[60:63], a[72:75], v[224:239]
v_mfma_f32_32x32x16_bf16 v[240:255], v[60:63], a[76:79], v[240:255]
s_waitcnt lgkmcnt(0)
s_waitcnt vmcnt(26)
v_mfma_f32_32x32x16_bf16 v[64:79], v[16:19], a[0:3], v[64:79]
ds_read_b64_tr_b16 v[40:41], v13 offset:18432
ds_read_b64_tr_b16 v[42:43], v13 offset:19968
v_mfma_f32_32x32x16_bf16 v[80:95], v[16:19], a[4:7], v[80:95]
ds_read_b64_tr_b16 v[44:45], v15 offset:18432
ds_read_b64_tr_b16 v[46:47], v15 offset:19968
v_mfma_f32_32x32x16_bf16 v[96:111], v[20:23], a[0:3], v[96:111]
ds_read_b64_tr_b16 v[48:49], v13 offset:18560
ds_read_b64_tr_b16 v[50:51], v13 offset:20096
v_mfma_f32_32x32x16_bf16 v[112:127], v[20:23], a[4:7], v[112:127]
ds_read_b64_tr_b16 v[52:53], v15 offset:18560
ds_read_b64_tr_b16 v[54:55], v15 offset:20096
v_mfma_f32_32x32x16_bf16 v[128:143], v[24:27], a[0:3], v[128:143]
ds_read_b64_tr_b16 v[56:57], v13 offset:18688
ds_read_b64_tr_b16 v[58:59], v13 offset:20224
v_mfma_f32_32x32x16_bf16 v[144:159], v[24:27], a[4:7], v[144:159]
ds_read_b64_tr_b16 v[60:61], v15 offset:18688
ds_read_b64_tr_b16 v[62:63], v15 offset:20224
v_mfma_f32_32x32x16_bf16 v[160:175], v[28:31], a[0:3], v[160:175]
buffer_load_dwordx4 a[64:67], v11, s[4:7], s60 offen offset:2048 sc1
buffer_load_dwordx4 a[68:71], v12, s[4:7], s60 offen offset:2048 sc1
v_mfma_f32_32x32x16_bf16 v[176:191], v[28:31], a[4:7], v[176:191]
v_mfma_f32_32x32x16_bf16 v[192:207], v[32:35], a[0:3], v[192:207]
v_mfma_f32_32x32x16_bf16 v[208:223], v[32:35], a[4:7], v[208:223]
v_mfma_f32_32x32x16_bf16 v[224:239], v[36:39], a[0:3], v[224:239]
v_mfma_f32_32x32x16_bf16 v[240:255], v[36:39], a[4:7], v[240:255]
s_waitcnt lgkmcnt(0)
s_waitcnt vmcnt(22)
s_barrier
s_waitcnt vmcnt(20)
v_mfma_f32_32x32x16_bf16 v[64:79], v[40:43], a[8:11], v[64:79]
ds_read_b64_tr_b16 v[16:17], v13 offset:24576
ds_read_b64_tr_b16 v[18:19], v13 offset:26112
v_mfma_f32_32x32x16_bf16 v[80:95], v[40:43], a[12:15], v[80:95]
ds_read_b64_tr_b16 v[20:21], v15 offset:24576
ds_read_b64_tr_b16 v[22:23], v15 offset:26112
v_mfma_f32_32x32x16_bf16 v[96:111], v[44:47], a[8:11], v[96:111]
ds_read_b64_tr_b16 v[24:25], v13 offset:24704
ds_read_b64_tr_b16 v[26:27], v13 offset:26240
v_mfma_f32_32x32x16_bf16 v[112:127], v[44:47], a[12:15], v[112:127]
ds_read_b64_tr_b16 v[28:29], v15 offset:24704
ds_read_b64_tr_b16 v[30:31], v15 offset:26240
v_mfma_f32_32x32x16_bf16 v[128:143], v[48:51], a[8:11], v[128:143]
ds_read_b64_tr_b16 v[32:33], v13 offset:24832
ds_read_b64_tr_b16 v[34:35], v13 offset:26368
v_mfma_f32_32x32x16_bf16 v[144:159], v[48:51], a[12:15], v[144:159]
ds_read_b64_tr_b16 v[36:37], v15 offset:24832
ds_read_b64_tr_b16 v[38:39], v15 offset:26368
v_mfma_f32_32x32x16_bf16 v[160:175], v[52:55], a[8:11], v[160:175]
s_add_u32 s43, s56, 3932160
s_add_u32 m0, s62, 24576
s_nop 0
buffer_load_dwordx4 v4, s[8:11], s43 offen lds
s_add_u32 m0, s62, 25600
s_nop 0
buffer_load_dwordx4 v5, s[8:11], s43 offen lds
s_add_u32 m0, s62, 26624
s_nop 0
buffer_load_dwordx4 v6, s[8:11], s43 offen lds
s_add_u32 m0, s62, 27648
s_nop 0
buffer_load_dwordx4 v7, s[8:11], s43 offen lds
s_add_u32 m0, s62, 28672
s_nop 0
buffer_load_dwordx4 v8, s[8:11], s43 offen lds
s_add_u32 m0, s62, 29696
s_nop 0
buffer_load_dwordx4 v9, s[8:11], s43 offen lds
buffer_load_dwordx4 a[72:75], v11, s[4:7], s60 offen offset:3072 sc1
buffer_load_dwordx4 a[76:79], v12, s[4:7], s60 offen offset:3072 sc1
v_mfma_f32_32x32x16_bf16 v[176:191], v[52:55], a[12:15], v[176:191]
v_mfma_f32_32x32x16_bf16 v[192:207], v[56:59], a[8:11], v[192:207]
v_mfma_f32_32x32x16_bf16 v[208:223], v[56:59], a[12:15], v[208:223]
v_mfma_f32_32x32x16_bf16 v[224:239], v[60:63], a[8:11], v[224:239]
v_mfma_f32_32x32x16_bf16 v[240:255], v[60:63], a[12:15], v[240:255]
s_waitcnt lgkmcnt(0)
s_waitcnt vmcnt(26)
v_mfma_f32_32x32x16_bf16 v[64:79], v[16:19], a[16:19], v[64:79]
s_add_u32 s61, s57, 20480
ds_read_b64_tr_b16 v[40:41], v13 offset:30720
v_mfma_f32_32x32x16_bf16 v[80:95], v[16:19], a[20:23], v[80:95]
ds_read_b64_tr_b16 v[42:43], v13 offset:32256
ds_read_b64_tr_b16 v[44:45], v15 offset:30720
v_mfma_f32_32x32x16_bf16 v[96:111], v[20:23], a[16:19], v[96:111]
ds_read_b64_tr_b16 v[46:47], v15 offset:32256
ds_read_b64_tr_b16 v[48:49], v13 offset:30848
v_mfma_f32_32x32x16_bf16 v[112:127], v[20:23], a[20:23], v[112:127]
ds_read_b64_tr_b16 v[50:51], v13 offset:32384
ds_read_b64_tr_b16 v[52:53], v15 offset:30848
v_mfma_f32_32x32x16_bf16 v[128:143], v[24:27], a[16:19], v[128:143]
ds_read_b64_tr_b16 v[54:55], v15 offset:32384
ds_read_b64_tr_b16 v[56:57], v13 offset:30976
v_mfma_f32_32x32x16_bf16 v[144:159], v[24:27], a[20:23], v[144:159]
ds_read_b64_tr_b16 v[58:59], v13 offset:32512
ds_read_b64_tr_b16 v[60:61], v15 offset:30976
v_mfma_f32_32x32x16_bf16 v[160:175], v[28:31], a[16:19], v[160:175]
ds_read_b64_tr_b16 v[62:63], v15 offset:32512
buffer_load_dwordx4 a[0:3], v11, s[4:7], s61 offen offset:0 sc1
buffer_load_dwordx4 a[4:7], v12, s[4:7], s61 offen offset:0 sc1
v_mfma_f32_32x32x16_bf16 v[176:191], v[28:31], a[20:23], v[176:191]
v_mfma_f32_32x32x16_bf16 v[192:207], v[32:35], a[16:19], v[192:207]
v_mfma_f32_32x32x16_bf16 v[208:223], v[32:35], a[20:23], v[208:223]
v_mfma_f32_32x32x16_bf16 v[224:239], v[36:39], a[16:19], v[224:239]
v_mfma_f32_32x32x16_bf16 v[240:255], v[36:39], a[20:23], v[240:255]
s_waitcnt lgkmcnt(0)
s_waitcnt vmcnt(26)
v_mfma_f32_32x32x16_bf16 v[64:79], v[40:43], a[24:27], v[64:79]
ds_read_b64_tr_b16 v[16:17], v13 offset:36864
ds_read_b64_tr_b16 v[18:19], v13 offset:38400
v_mfma_f32_32x32x16_bf16 v[80:95], v[40:43], a[28:31], v[80:95]
ds_read_b64_tr_b16 v[20:21], v15 offset:36864
ds_read_b64_tr_b16 v[22:23], v15 offset:38400
v_mfma_f32_32x32x16_bf16 v[96:111], v[44:47], a[24:27], v[96:111]
ds_read_b64_tr_b16 v[24:25], v13 offset:36992
ds_read_b64_tr_b16 v[26:27], v13 offset:38528
v_mfma_f32_32x32x16_bf16 v[112:127], v[44:47], a[28:31], v[112:127]
ds_read_b64_tr_b16 v[28:29], v15 offset:36992
ds_read_b64_tr_b16 v[30:31], v15 offset:38528
v_mfma_f32_32x32x16_bf16 v[128:143], v[48:51], a[24:27], v[128:143]
ds_read_b64_tr_b16 v[32:33], v13 offset:37120
ds_read_b64_tr_b16 v[34:35], v13 offset:38656
v_mfma_f32_32x32x16_bf16 v[144:159], v[48:51], a[28:31], v[144:159]
ds_read_b64_tr_b16 v[36:37], v15 offset:37120
ds_read_b64_tr_b16 v[38:39], v15 offset:38656
v_mfma_f32_32x32x16_bf16 v[160:175], v[52:55], a[24:27], v[160:175]
buffer_load_dwordx4 a[8:11], v11, s[4:7], s61 offen offset:1024 sc1
buffer_load_dwordx4 a[12:15], v12, s[4:7], s61 offen offset:1024 sc1
v_mfma_f32_32x32x16_bf16 v[176:191], v[52:55], a[28:31], v[176:191]
v_mfma_f32_32x32x16_bf16 v[192:207], v[56:59], a[24:27], v[192:207]
v_mfma_f32_32x32x16_bf16 v[208:223], v[56:59], a[28:31], v[208:223]
v_mfma_f32_32x32x16_bf16 v[224:239], v[60:63], a[24:27], v[224:239]
v_mfma_f32_32x32x16_bf16 v[240:255], v[60:63], a[28:31], v[240:255]
s_waitcnt lgkmcnt(0)
s_waitcnt vmcnt(26)
v_mfma_f32_32x32x16_bf16 v[64:79], v[16:19], a[32:35], v[64:79]
ds_read_b64_tr_b16 v[40:41], v13 offset:43008
ds_read_b64_tr_b16 v[42:43], v13 offset:44544
v_mfma_f32_32x32x16_bf16 v[80:95], v[16:19], a[36:39], v[80:95]
ds_read_b64_tr_b16 v[44:45], v15 offset:43008
ds_read_b64_tr_b16 v[46:47], v15 offset:44544
v_mfma_f32_32x32x16_bf16 v[96:111], v[20:23], a[32:35], v[96:111]
ds_read_b64_tr_b16 v[48:49], v13 offset:43136
ds_read_b64_tr_b16 v[50:51], v13 offset:44672
v_mfma_f32_32x32x16_bf16 v[112:127], v[20:23], a[36:39], v[112:127]
ds_read_b64_tr_b16 v[52:53], v15 offset:43136
ds_read_b64_tr_b16 v[54:55], v15 offset:44672
v_mfma_f32_32x32x16_bf16 v[128:143], v[24:27], a[32:35], v[128:143]
ds_read_b64_tr_b16 v[56:57], v13 offset:43264
ds_read_b64_tr_b16 v[58:59], v13 offset:44800
v_mfma_f32_32x32x16_bf16 v[144:159], v[24:27], a[36:39], v[144:159]
ds_read_b64_tr_b16 v[60:61], v15 offset:43264
ds_read_b64_tr_b16 v[62:63], v15 offset:44800
v_mfma_f32_32x32x16_bf16 v[160:175], v[28:31], a[32:35], v[160:175]
buffer_load_dwordx4 a[16:19], v11, s[4:7], s61 offen offset:2048 sc1
buffer_load_dwordx4 a[20:23], v12, s[4:7], s61 offen offset:2048 sc1
v_mfma_f32_32x32x16_bf16 v[176:191], v[28:31], a[36:39], v[176:191]
v_mfma_f32_32x32x16_bf16 v[192:207], v[32:35], a[32:35], v[192:207]
v_mfma_f32_32x32x16_bf16 v[208:223], v[32:35], a[36:39], v[208:223]
v_mfma_f32_32x32x16_bf16 v[224:239], v[36:39], a[32:35], v[224:239]
v_mfma_f32_32x32x16_bf16 v[240:255], v[36:39], a[36:39], v[240:255]
s_waitcnt lgkmcnt(0)
s_waitcnt vmcnt(22)
s_barrier
s_waitcnt vmcnt(20)
v_mfma_f32_32x32x16_bf16 v[64:79], v[40:43], a[40:43], v[64:79]
ds_read_b64_tr_b16 v[16:17], v2 offset:0
ds_read_b64_tr_b16 v[18:19], v2 offset:1536
v_mfma_f32_32x32x16_bf16 v[80:95], v[40:43], a[44:47], v[80:95]
ds_read_b64_tr_b16 v[20:21], v3 offset:0
ds_read_b64_tr_b16 v[22:23], v3 offset:1536
v_mfma_f32_32x32x16_bf16 v[96:111], v[44:47], a[40:43], v[96:111]
ds_read_b64_tr_b16 v[24:25], v2 offset:128
ds_read_b64_tr_b16 v[26:27], v2 offset:1664
v_mfma_f32_32x32x16_bf16 v[112:127], v[44:47], a[44:47], v[112:127]
ds_read_b64_tr_b16 v[28:29], v3 offset:128
ds_read_b64_tr_b16 v[30:31], v3 offset:1664
v_mfma_f32_32x32x16_bf16 v[128:143], v[48:51], a[40:43], v[128:143]
ds_read_b64_tr_b16 v[32:33], v2 offset:256
ds_read_b64_tr_b16 v[34:35], v2 offset:1792
v_mfma_f32_32x32x16_bf16 v[144:159], v[48:51], a[44:47], v[144:159]
ds_read_b64_tr_b16 v[36:37], v3 offset:256
ds_read_b64_tr_b16 v[38:39], v3 offset:1792
v_mfma_f32_32x32x16_bf16 v[160:175], v[52:55], a[40:43], v[160:175]
s_add_u32 s43, s56, 4718592
s_add_u32 m0, s62, 49152
s_nop 0
buffer_load_dwordx4 v4, s[8:11], s43 offen lds
s_add_u32 m0, s62, 50176
s_nop 0
buffer_load_dwordx4 v5, s[8:11], s43 offen lds
s_add_u32 m0, s62, 51200
s_nop 0
buffer_load_dwordx4 v6, s[8:11], s43 offen lds
s_add_u32 m0, s62, 52224
s_nop 0
buffer_load_dwordx4 v7, s[8:11], s43 offen lds
s_add_u32 m0, s62, 53248
s_nop 0
buffer_load_dwordx4 v8, s[8:11], s43 offen lds
s_add_u32 m0, s62, 54272
s_nop 0
buffer_load_dwordx4 v9, s[8:11], s43 offen lds
buffer_load_dwordx4 a[24:27], v11, s[4:7], s61 offen offset:3072 sc1
buffer_load_dwordx4 a[28:31], v12, s[4:7], s61 offen offset:3072 sc1
v_mfma_f32_32x32x16_bf16 v[176:191], v[52:55], a[44:47], v[176:191]
v_mfma_f32_32x32x16_bf16 v[192:207], v[56:59], a[40:43], v[192:207]
v_mfma_f32_32x32x16_bf16 v[208:223], v[56:59], a[44:47], v[208:223]
v_mfma_f32_32x32x16_bf16 v[224:239], v[60:63], a[40:43], v[224:239]
v_mfma_f32_32x32x16_bf16 v[240:255], v[60:63], a[44:47], v[240:255]
s_waitcnt lgkmcnt(0)
s_waitcnt vmcnt(26)
v_mfma_f32_32x32x16_bf16 v[64:79], v[16:19], a[48:51], v[64:79]
s_add_u32 s59, s57, 24576
ds_read_b64_tr_b16 v[40:41], v2 offset:6144
v_mfma_f32_32x32x16_bf16 v[80:95], v[16:19], a[52:55], v[80:95]
ds_read_b64_tr_b16 v[42:43], v2 offset:7680
ds_read_b64_tr_b16 v[44:45], v3 offset:6144
v_mfma_f32_32x32x16_bf16 v[96:111], v[20:23], a[48:51], v[96:111]
ds_read_b64_tr_b16 v[46:47], v3 offset:7680
ds_read_b64_tr_b16 v[48:49], v2 offset:6272
v_mfma_f32_32x32x16_bf16 v[112:127], v[20:23], a[52:55], v[112:127]
ds_read_b64_tr_b16 v[50:51], v2 offset:7808
ds_read_b64_tr_b16 v[52:53], v3 offset:6272
v_mfma_f32_32x32x16_bf16 v[128:143], v[24:27], a[48:51], v[128:143]
ds_read_b64_tr_b16 v[54:55], v3 offset:7808
ds_read_b64_tr_b16 v[56:57], v2 offset:6400
v_mfma_f32_32x32x16_bf16 v[144:159], v[24:27], a[52:55], v[144:159]
ds_read_b64_tr_b16 v[58:59], v2 offset:7936
ds_read_b64_tr_b16 v[60:61], v3 offset:6400
v_mfma_f32_32x32x16_bf16 v[160:175], v[28:31], a[48:51], v[160:175]
ds_read_b64_tr_b16 v[62:63], v3 offset:7936
buffer_load_dwordx4 a[32:35], v11, s[4:7], s59 offen offset:0 sc1
buffer_load_dwordx4 a[36:39], v12, s[4:7], s59 offen offset:0 sc1
v_mfma_f32_32x32x16_bf16 v[176:191], v[28:31], a[52:55], v[176:191]
v_mfma_f32_32x32x16_bf16 v[192:207], v[32:35], a[48:51], v[192:207]
v_mfma_f32_32x32x16_bf16 v[208:223], v[32:35], a[52:55], v[208:223]
v_mfma_f32_32x32x16_bf16 v[224:239], v[36:39], a[48:51], v[224:239]
v_mfma_f32_32x32x16_bf16 v[240:255], v[36:39], a[52:55], v[240:255]
s_waitcnt lgkmcnt(0)
s_waitcnt vmcnt(26)
v_mfma_f32_32x32x16_bf16 v[64:79], v[40:43], a[56:59], v[64:79]
ds_read_b64_tr_b16 v[16:17], v2 offset:12288
ds_read_b64_tr_b16 v[18:19], v2 offset:13824
v_mfma_f32_32x32x16_bf16 v[80:95], v[40:43], a[60:63], v[80:95]
ds_read_b64_tr_b16 v[20:21], v3 offset:12288
ds_read_b64_tr_b16 v[22:23], v3 offset:13824
v_mfma_f32_32x32x16_bf16 v[96:111], v[44:47], a[56:59], v[96:111]
ds_read_b64_tr_b16 v[24:25], v2 offset:12416
ds_read_b64_tr_b16 v[26:27], v2 offset:13952
v_mfma_f32_32x32x16_bf16 v[112:127], v[44:47], a[60:63], v[112:127]
ds_read_b64_tr_b16 v[28:29], v3 offset:12416
ds_read_b64_tr_b16 v[30:31], v3 offset:13952
v_mfma_f32_32x32x16_bf16 v[128:143], v[48:51], a[56:59], v[128:143]
ds_read_b64_tr_b16 v[32:33], v2 offset:12544
ds_read_b64_tr_b16 v[34:35], v2 offset:14080
v_mfma_f32_32x32x16_bf16 v[144:159], v[48:51], a[60:63], v[144:159]
ds_read_b64_tr_b16 v[36:37], v3 offset:12544
ds_read_b64_tr_b16 v[38:39], v3 offset:14080
v_mfma_f32_32x32x16_bf16 v[160:175], v[52:55], a[56:59], v[160:175]
buffer_load_dwordx4 a[40:43], v11, s[4:7], s59 offen offset:1024 sc1
buffer_load_dwordx4 a[44:47], v12, s[4:7], s59 offen offset:1024 sc1
v_mfma_f32_32x32x16_bf16 v[176:191], v[52:55], a[60:63], v[176:191]
v_mfma_f32_32x32x16_bf16 v[192:207], v[56:59], a[56:59], v[192:207]
v_mfma_f32_32x32x16_bf16 v[208:223], v[56:59], a[60:63], v[208:223]
v_mfma_f32_32x32x16_bf16 v[224:239], v[60:63], a[56:59], v[224:239]
v_mfma_f32_32x32x16_bf16 v[240:255], v[60:63], a[60:63], v[240:255]
s_waitcnt lgkmcnt(0)
s_waitcnt vmcnt(26)
v_mfma_f32_32x32x16_bf16 v[64:79], v[16:19], a[64:67], v[64:79]
ds_read_b64_tr_b16 v[40:41], v2 offset:18432
ds_read_b64_tr_b16 v[42:43], v2 offset:19968
v_mfma_f32_32x32x16_bf16 v[80:95], v[16:19], a[68:71], v[80:95]
ds_read_b64_tr_b16 v[44:45], v3 offset:18432
ds_read_b64_tr_b16 v[46:47], v3 offset:19968
v_mfma_f32_32x32x16_bf16 v[96:111], v[20:23], a[64:67], v[96:111]
ds_read_b64_tr_b16 v[48:49], v2 offset:18560
ds_read_b64_tr_b16 v[50:51], v2 offset:20096
v_mfma_f32_32x32x16_bf16 v[112:127], v[20:23], a[68:71], v[112:127]
ds_read_b64_tr_b16 v[52:53], v3 offset:18560
ds_read_b64_tr_b16 v[54:55], v3 offset:20096
v_mfma_f32_32x32x16_bf16 v[128:143], v[24:27], a[64:67], v[128:143]
ds_read_b64_tr_b16 v[56:57], v2 offset:18688
ds_read_b64_tr_b16 v[58:59], v2 offset:20224
v_mfma_f32_32x32x16_bf16 v[144:159], v[24:27], a[68:71], v[144:159]
ds_read_b64_tr_b16 v[60:61], v3 offset:18688
ds_read_b64_tr_b16 v[62:63], v3 offset:20224
v_mfma_f32_32x32x16_bf16 v[160:175], v[28:31], a[64:67], v[160:175]
buffer_load_dwordx4 a[48:51], v11, s[4:7], s59 offen offset:2048 sc1
buffer_load_dwordx4 a[52:55], v12, s[4:7], s59 offen offset:2048 sc1
v_mfma_f32_32x32x16_bf16 v[176:191], v[28:31], a[68:71], v[176:191]
v_mfma_f32_32x32x16_bf16 v[192:207], v[32:35], a[64:67], v[192:207]
v_mfma_f32_32x32x16_bf16 v[208:223], v[32:35], a[68:71], v[208:223]
v_mfma_f32_32x32x16_bf16 v[224:239], v[36:39], a[64:67], v[224:239]
v_mfma_f32_32x32x16_bf16 v[240:255], v[36:39], a[68:71], v[240:255]
s_waitcnt lgkmcnt(0)
s_waitcnt vmcnt(22)
s_barrier
s_waitcnt vmcnt(20)
v_mfma_f32_32x32x16_bf16 v[64:79], v[40:43], a[72:75], v[64:79]
ds_read_b64_tr_b16 v[16:17], v2 offset:24576
ds_read_b64_tr_b16 v[18:19], v2 offset:26112
v_mfma_f32_32x32x16_bf16 v[80:95], v[40:43], a[76:79], v[80:95]
ds_read_b64_tr_b16 v[20:21], v3 offset:24576
ds_read_b64_tr_b16 v[22:23], v3 offset:26112
v_mfma_f32_32x32x16_bf16 v[96:111], v[44:47], a[72:75], v[96:111]
ds_read_b64_tr_b16 v[24:25], v2 offset:24704
ds_read_b64_tr_b16 v[26:27], v2 offset:26240
v_mfma_f32_32x32x16_bf16 v[112:127], v[44:47], a[76:79], v[112:127]
ds_read_b64_tr_b16 v[28:29], v3 offset:24704
ds_read_b64_tr_b16 v[30:31], v3 offset:26240
v_mfma_f32_32x32x16_bf16 v[128:143], v[48:51], a[72:75], v[128:143]
ds_read_b64_tr_b16 v[32:33], v2 offset:24832
ds_read_b64_tr_b16 v[34:35], v2 offset:26368
v_mfma_f32_32x32x16_bf16 v[144:159], v[48:51], a[76:79], v[144:159]
ds_read_b64_tr_b16 v[36:37], v3 offset:24832
ds_read_b64_tr_b16 v[38:39], v3 offset:26368
v_mfma_f32_32x32x16_bf16 v[160:175], v[52:55], a[72:75], v[160:175]
s_add_u32 s43, s56, 5505024
s_add_u32 m0, s62, 73728
s_nop 0
buffer_load_dwordx4 v4, s[8:11], s43 offen lds
s_add_u32 m0, s62, 74752
s_nop 0
buffer_load_dwordx4 v5, s[8:11], s43 offen lds
s_add_u32 m0, s62, 75776
s_nop 0
buffer_load_dwordx4 v6, s[8:11], s43 offen lds
s_add_u32 m0, s62, 76800
s_nop 0
buffer_load_dwordx4 v7, s[8:11], s43 offen lds
s_add_u32 m0, s62, 77824
s_nop 0
buffer_load_dwordx4 v8, s[8:11], s43 offen lds
s_add_u32 m0, s62, 78848
s_nop 0
buffer_load_dwordx4 v9, s[8:11], s43 offen lds
buffer_load_dwordx4 a[56:59], v11, s[4:7], s59 offen offset:3072 sc1
buffer_load_dwordx4 a[60:63], v12, s[4:7], s59 offen offset:3072 sc1
v_mfma_f32_32x32x16_bf16 v[176:191], v[52:55], a[76:79], v[176:191]
v_mfma_f32_32x32x16_bf16 v[192:207], v[56:59], a[72:75], v[192:207]
v_mfma_f32_32x32x16_bf16 v[208:223], v[56:59], a[76:79], v[208:223]
v_mfma_f32_32x32x16_bf16 v[224:239], v[60:63], a[72:75], v[224:239]
v_mfma_f32_32x32x16_bf16 v[240:255], v[60:63], a[76:79], v[240:255]
s_waitcnt lgkmcnt(0)
s_waitcnt vmcnt(26)
v_mfma_f32_32x32x16_bf16 v[64:79], v[16:19], a[0:3], v[64:79]
s_add_u32 s60, s57, 28672
ds_read_b64_tr_b16 v[40:41], v2 offset:30720
v_mfma_f32_32x32x16_bf16 v[80:95], v[16:19], a[4:7], v[80:95]
ds_read_b64_tr_b16 v[42:43], v2 offset:32256
ds_read_b64_tr_b16 v[44:45], v3 offset:30720
v_mfma_f32_32x32x16_bf16 v[96:111], v[20:23], a[0:3], v[96:111]
ds_read_b64_tr_b16 v[46:47], v3 offset:32256
ds_read_b64_tr_b16 v[48:49], v2 offset:30848
v_mfma_f32_32x32x16_bf16 v[112:127], v[20:23], a[4:7], v[112:127]
ds_read_b64_tr_b16 v[50:51], v2 offset:32384
ds_read_b64_tr_b16 v[52:53], v3 offset:30848
v_mfma_f32_32x32x16_bf16 v[128:143], v[24:27], a[0:3], v[128:143]
ds_read_b64_tr_b16 v[54:55], v3 offset:32384
ds_read_b64_tr_b16 v[56:57], v2 offset:30976
v_mfma_f32_32x32x16_bf16 v[144:159], v[24:27], a[4:7], v[144:159]
ds_read_b64_tr_b16 v[58:59], v2 offset:32512
ds_read_b64_tr_b16 v[60:61], v3 offset:30976
v_mfma_f32_32x32x16_bf16 v[160:175], v[28:31], a[0:3], v[160:175]
ds_read_b64_tr_b16 v[62:63], v3 offset:32512
buffer_load_dwordx4 a[64:67], v11, s[4:7], s60 offen offset:0 sc1
buffer_load_dwordx4 a[68:71], v12, s[4:7], s60 offen offset:0 sc1
v_mfma_f32_32x32x16_bf16 v[176:191], v[28:31], a[4:7], v[176:191]
v_mfma_f32_32x32x16_bf16 v[192:207], v[32:35], a[0:3], v[192:207]
v_mfma_f32_32x32x16_bf16 v[208:223], v[32:35], a[4:7], v[208:223]
v_mfma_f32_32x32x16_bf16 v[224:239], v[36:39], a[0:3], v[224:239]
v_mfma_f32_32x32x16_bf16 v[240:255], v[36:39], a[4:7], v[240:255]
s_waitcnt lgkmcnt(0)
s_waitcnt vmcnt(26)
v_mfma_f32_32x32x16_bf16 v[64:79], v[40:43], a[8:11], v[64:79]
ds_read_b64_tr_b16 v[16:17], v2 offset:36864
ds_read_b64_tr_b16 v[18:19], v2 offset:38400
v_mfma_f32_32x32x16_bf16 v[80:95], v[40:43], a[12:15], v[80:95]
ds_read_b64_tr_b16 v[20:21], v3 offset:36864
ds_read_b64_tr_b16 v[22:23], v3 offset:38400
v_mfma_f32_32x32x16_bf16 v[96:111], v[44:47], a[8:11], v[96:111]
ds_read_b64_tr_b16 v[24:25], v2 offset:36992
ds_read_b64_tr_b16 v[26:27], v2 offset:38528
v_mfma_f32_32x32x16_bf16 v[112:127], v[44:47], a[12:15], v[112:127]
ds_read_b64_tr_b16 v[28:29], v3 offset:36992
ds_read_b64_tr_b16 v[30:31], v3 offset:38528
v_mfma_f32_32x32x16_bf16 v[128:143], v[48:51], a[8:11], v[128:143]
ds_read_b64_tr_b16 v[32:33], v2 offset:37120
ds_read_b64_tr_b16 v[34:35], v2 offset:38656
v_mfma_f32_32x32x16_bf16 v[144:159], v[48:51], a[12:15], v[144:159]
ds_read_b64_tr_b16 v[36:37], v3 offset:37120
ds_read_b64_tr_b16 v[38:39], v3 offset:38656
v_mfma_f32_32x32x16_bf16 v[160:175], v[52:55], a[8:11], v[160:175]
buffer_load_dwordx4 a[72:75], v11, s[4:7], s60 offen offset:1024 sc1
buffer_load_dwordx4 a[76:79], v12, s[4:7], s60 offen offset:1024 sc1
v_mfma_f32_32x32x16_bf16 v[176:191], v[52:55], a[12:15], v[176:191]
v_mfma_f32_32x32x16_bf16 v[192:207], v[56:59], a[8:11], v[192:207]
v_mfma_f32_32x32x16_bf16 v[208:223], v[56:59], a[12:15], v[208:223]
v_mfma_f32_32x32x16_bf16 v[224:239], v[60:63], a[8:11], v[224:239]
v_mfma_f32_32x32x16_bf16 v[240:255], v[60:63], a[12:15], v[240:255]
s_waitcnt lgkmcnt(0)
s_waitcnt vmcnt(26)
v_mfma_f32_32x32x16_bf16 v[64:79], v[16:19], a[16:19], v[64:79]
ds_read_b64_tr_b16 v[40:41], v2 offset:43008
ds_read_b64_tr_b16 v[42:43], v2 offset:44544
v_mfma_f32_32x32x16_bf16 v[80:95], v[16:19], a[20:23], v[80:95]
ds_read_b64_tr_b16 v[44:45], v3 offset:43008
ds_read_b64_tr_b16 v[46:47], v3 offset:44544
v_mfma_f32_32x32x16_bf16 v[96:111], v[20:23], a[16:19], v[96:111]
ds_read_b64_tr_b16 v[48:49], v2 offset:43136
ds_read_b64_tr_b16 v[50:51], v2 offset:44672
v_mfma_f32_32x32x16_bf16 v[112:127], v[20:23], a[20:23], v[112:127]
ds_read_b64_tr_b16 v[52:53], v3 offset:43136
ds_read_b64_tr_b16 v[54:55], v3 offset:44672
v_mfma_f32_32x32x16_bf16 v[128:143], v[24:27], a[16:19], v[128:143]
ds_read_b64_tr_b16 v[56:57], v2 offset:43264
ds_read_b64_tr_b16 v[58:59], v2 offset:44800
v_mfma_f32_32x32x16_bf16 v[144:159], v[24:27], a[20:23], v[144:159]
ds_read_b64_tr_b16 v[60:61], v3 offset:43264
ds_read_b64_tr_b16 v[62:63], v3 offset:44800
v_mfma_f32_32x32x16_bf16 v[160:175], v[28:31], a[16:19], v[160:175]
buffer_load_dwordx4 a[0:3], v11, s[4:7], s60 offen offset:2048 sc1
buffer_load_dwordx4 a[4:7], v12, s[4:7], s60 offen offset:2048 sc1
v_mfma_f32_32x32x16_bf16 v[176:191], v[28:31], a[20:23], v[176:191]
v_mfma_f32_32x32x16_bf16 v[192:207], v[32:35], a[16:19], v[192:207]
v_mfma_f32_32x32x16_bf16 v[208:223], v[32:35], a[20:23], v[208:223]
v_mfma_f32_32x32x16_bf16 v[224:239], v[36:39], a[16:19], v[224:239]
v_mfma_f32_32x32x16_bf16 v[240:255], v[36:39], a[20:23], v[240:255]
s_waitcnt lgkmcnt(0)
s_waitcnt vmcnt(22)
s_barrier
s_waitcnt vmcnt(20)
v_mfma_f32_32x32x16_bf16 v[64:79], v[40:43], a[24:27], v[64:79]
ds_read_b64_tr_b16 v[16:17], v13 offset:0
ds_read_b64_tr_b16 v[18:19], v13 offset:1536
v_mfma_f32_32x32x16_bf16 v[80:95], v[40:43], a[28:31], v[80:95]
ds_read_b64_tr_b16 v[20:21], v15 offset:0
ds_read_b64_tr_b16 v[22:23], v15 offset:1536
v_mfma_f32_32x32x16_bf16 v[96:111], v[44:47], a[24:27], v[96:111]
ds_read_b64_tr_b16 v[24:25], v13 offset:128
ds_read_b64_tr_b16 v[26:27], v13 offset:1664
v_mfma_f32_32x32x16_bf16 v[112:127], v[44:47], a[28:31], v[112:127]
ds_read_b64_tr_b16 v[28:29], v15 offset:128
ds_read_b64_tr_b16 v[30:31], v15 offset:1664
v_mfma_f32_32x32x16_bf16 v[128:143], v[48:51], a[24:27], v[128:143]
ds_read_b64_tr_b16 v[32:33], v13 offset:256
ds_read_b64_tr_b16 v[34:35], v13 offset:1792
v_mfma_f32_32x32x16_bf16 v[144:159], v[48:51], a[28:31], v[144:159]
ds_read_b64_tr_b16 v[36:37], v15 offset:256
ds_read_b64_tr_b16 v[38:39], v15 offset:1792
v_mfma_f32_32x32x16_bf16 v[160:175], v[52:55], a[24:27], v[160:175]
s_add_u32 s43, s56, 6291456
s_add_u32 m0, s62, 0
s_nop 0
buffer_load_dwordx4 v4, s[8:11], s43 offen lds
s_add_u32 m0, s62, 1024
s_nop 0
buffer_load_dwordx4 v5, s[8:11], s43 offen lds
s_add_u32 m0, s62, 2048
s_nop 0
buffer_load_dwordx4 v6, s[8:11], s43 offen lds
s_add_u32 m0, s62, 3072
s_nop 0
buffer_load_dwordx4 v7, s[8:11], s43 offen lds
s_add_u32 m0, s62, 4096
s_nop 0
buffer_load_dwordx4 v8, s[8:11], s43 offen lds
s_add_u32 m0, s62, 5120
s_nop 0
buffer_load_dwordx4 v9, s[8:11], s43 offen lds
buffer_load_dwordx4 a[8:11], v11, s[4:7], s60 offen offset:3072 sc1
buffer_load_dwordx4 a[12:15], v12, s[4:7], s60 offen offset:3072 sc1
v_mfma_f32_32x32x16_bf16 v[176:191], v[52:55], a[28:31], v[176:191]
v_mfma_f32_32x32x16_bf16 v[192:207], v[56:59], a[24:27], v[192:207]
v_mfma_f32_32x32x16_bf16 v[208:223], v[56:59], a[28:31], v[208:223]
v_mfma_f32_32x32x16_bf16 v[224:239], v[60:63], a[24:27], v[224:239]
v_mfma_f32_32x32x16_bf16 v[240:255], v[60:63], a[28:31], v[240:255]
s_waitcnt lgkmcnt(0)
s_waitcnt vmcnt(26)
v_mfma_f32_32x32x16_bf16 v[64:79], v[16:19], a[32:35], v[64:79]
s_add_u32 s61, s57, 32768
ds_read_b64_tr_b16 v[40:41], v13 offset:6144
v_mfma_f32_32x32x16_bf16 v[80:95], v[16:19], a[36:39], v[80:95]
ds_read_b64_tr_b16 v[42:43], v13 offset:7680
ds_read_b64_tr_b16 v[44:45], v15 offset:6144
v_mfma_f32_32x32x16_bf16 v[96:111], v[20:23], a[32:35], v[96:111]
ds_read_b64_tr_b16 v[46:47], v15 offset:7680
ds_read_b64_tr_b16 v[48:49], v13 offset:6272
v_mfma_f32_32x32x16_bf16 v[112:127], v[20:23], a[36:39], v[112:127]
ds_read_b64_tr_b16 v[50:51], v13 offset:7808
ds_read_b64_tr_b16 v[52:53], v15 offset:6272
v_mfma_f32_32x32x16_bf16 v[128:143], v[24:27], a[32:35], v[128:143]
ds_read_b64_tr_b16 v[54:55], v15 offset:7808
ds_read_b64_tr_b16 v[56:57], v13 offset:6400
v_mfma_f32_32x32x16_bf16 v[144:159], v[24:27], a[36:39], v[144:159]
ds_read_b64_tr_b16 v[58:59], v13 offset:7936
ds_read_b64_tr_b16 v[60:61], v15 offset:6400
v_mfma_f32_32x32x16_bf16 v[160:175], v[28:31], a[32:35], v[160:175]
ds_read_b64_tr_b16 v[62:63], v15 offset:7936
buffer_load_dwordx4 a[16:19], v11, s[4:7], s61 offen offset:0 sc1
buffer_load_dwordx4 a[20:23], v12, s[4:7], s61 offen offset:0 sc1
v_mfma_f32_32x32x16_bf16 v[176:191], v[28:31], a[36:39], v[176:191]
v_mfma_f32_32x32x16_bf16 v[192:207], v[32:35], a[32:35], v[192:207]
v_mfma_f32_32x32x16_bf16 v[208:223], v[32:35], a[36:39], v[208:223]
v_mfma_f32_32x32x16_bf16 v[224:239], v[36:39], a[32:35], v[224:239]
v_mfma_f32_32x32x16_bf16 v[240:255], v[36:39], a[36:39], v[240:255]
s_waitcnt lgkmcnt(0)
s_waitcnt vmcnt(26)
v_mfma_f32_32x32x16_bf16 v[64:79], v[40:43], a[40:43], v[64:79]
ds_read_b64_tr_b16 v[16:17], v13 offset:12288
ds_read_b64_tr_b16 v[18:19], v13 offset:13824
v_mfma_f32_32x32x16_bf16 v[80:95], v[40:43], a[44:47], v[80:95]
ds_read_b64_tr_b16 v[20:21], v15 offset:12288
ds_read_b64_tr_b16 v[22:23], v15 offset:13824
v_mfma_f32_32x32x16_bf16 v[96:111], v[44:47], a[40:43], v[96:111]
ds_read_b64_tr_b16 v[24:25], v13 offset:12416
ds_read_b64_tr_b16 v[26:27], v13 offset:13952
v_mfma_f32_32x32x16_bf16 v[112:127], v[44:47], a[44:47], v[112:127]
ds_read_b64_tr_b16 v[28:29], v15 offset:12416
ds_read_b64_tr_b16 v[30:31], v15 offset:13952
v_mfma_f32_32x32x16_bf16 v[128:143], v[48:51], a[40:43], v[128:143]
ds_read_b64_tr_b16 v[32:33], v13 offset:12544
ds_read_b64_tr_b16 v[34:35], v13 offset:14080
v_mfma_f32_32x32x16_bf16 v[144:159], v[48:51], a[44:47], v[144:159]
ds_read_b64_tr_b16 v[36:37], v15 offset:12544
ds_read_b64_tr_b16 v[38:39], v15 offset:14080
v_mfma_f32_32x32x16_bf16 v[160:175], v[52:55], a[40:43], v[160:175]
buffer_load_dwordx4 a[24:27], v11, s[4:7], s61 offen offset:1024 sc1
buffer_load_dwordx4 a[28:31], v12, s[4:7], s61 offen offset:1024 sc1
v_mfma_f32_32x32x16_bf16 v[176:191], v[52:55], a[44:47], v[176:191]
v_mfma_f32_32x32x16_bf16 v[192:207], v[56:59], a[40:43], v[192:207]
v_mfma_f32_32x32x16_bf16 v[208:223], v[56:59], a[44:47], v[208:223]
v_mfma_f32_32x32x16_bf16 v[224:239], v[60:63], a[40:43], v[224:239]
v_mfma_f32_32x32x16_bf16 v[240:255], v[60:63], a[44:47], v[240:255]
s_waitcnt lgkmcnt(0)
s_waitcnt vmcnt(26)
v_mfma_f32_32x32x16_bf16 v[64:79], v[16:19], a[48:51], v[64:79]
ds_read_b64_tr_b16 v[40:41], v13 offset:18432
ds_read_b64_tr_b16 v[42:43], v13 offset:19968
v_mfma_f32_32x32x16_bf16 v[80:95], v[16:19], a[52:55], v[80:95]
ds_read_b64_tr_b16 v[44:45], v15 offset:18432
ds_read_b64_tr_b16 v[46:47], v15 offset:19968
v_mfma_f32_32x32x16_bf16 v[96:111], v[20:23], a[48:51], v[96:111]
ds_read_b64_tr_b16 v[48:49], v13 offset:18560
ds_read_b64_tr_b16 v[50:51], v13 offset:20096
v_mfma_f32_32x32x16_bf16 v[112:127], v[20:23], a[52:55], v[112:127]
ds_read_b64_tr_b16 v[52:53], v15 offset:18560
ds_read_b64_tr_b16 v[54:55], v15 offset:20096
v_mfma_f32_32x32x16_bf16 v[128:143], v[24:27], a[48:51], v[128:143]
ds_read_b64_tr_b16 v[56:57], v13 offset:18688
ds_read_b64_tr_b16 v[58:59], v13 offset:20224
v_mfma_f32_32x32x16_bf16 v[144:159], v[24:27], a[52:55], v[144:159]
ds_read_b64_tr_b16 v[60:61], v15 offset:18688
ds_read_b64_tr_b16 v[62:63], v15 offset:20224
v_mfma_f32_32x32x16_bf16 v[160:175], v[28:31], a[48:51], v[160:175]
buffer_load_dwordx4 a[32:35], v11, s[4:7], s61 offen offset:2048 sc1
buffer_load_dwordx4 a[36:39], v12, s[4:7], s61 offen offset:2048 sc1
v_mfma_f32_32x32x16_bf16 v[176:191], v[28:31], a[52:55], v[176:191]
v_mfma_f32_32x32x16_bf16 v[192:207], v[32:35], a[48:51], v[192:207]
v_mfma_f32_32x32x16_bf16 v[208:223], v[32:35], a[52:55], v[208:223]
v_mfma_f32_32x32x16_bf16 v[224:239], v[36:39], a[48:51], v[224:239]
v_mfma_f32_32x32x16_bf16 v[240:255], v[36:39], a[52:55], v[240:255]
s_waitcnt lgkmcnt(0)
s_waitcnt vmcnt(22)
s_barrier
s_waitcnt vmcnt(20)
v_mfma_f32_32x32x16_bf16 v[64:79], v[40:43], a[56:59], v[64:79]
ds_read_b64_tr_b16 v[16:17], v13 offset:24576
ds_read_b64_tr_b16 v[18:19], v13 offset:26112
v_mfma_f32_32x32x16_bf16 v[80:95], v[40:43], a[60:63], v[80:95]
ds_read_b64_tr_b16 v[20:21], v15 offset:24576
ds_read_b64_tr_b16 v[22:23], v15 offset:26112
v_mfma_f32_32x32x16_bf16 v[96:111], v[44:47], a[56:59], v[96:111]
ds_read_b64_tr_b16 v[24:25], v13 offset:24704
ds_read_b64_tr_b16 v[26:27], v13 offset:26240
v_mfma_f32_32x32x16_bf16 v[112:127], v[44:47], a[60:63], v[112:127]
ds_read_b64_tr_b16 v[28:29], v15 offset:24704
ds_read_b64_tr_b16 v[30:31], v15 offset:26240
v_mfma_f32_32x32x16_bf16 v[128:143], v[48:51], a[56:59], v[128:143]
ds_read_b64_tr_b16 v[32:33], v13 offset:24832
ds_read_b64_tr_b16 v[34:35], v13 offset:26368
v_mfma_f32_32x32x16_bf16 v[144:159], v[48:51], a[60:63], v[144:159]
ds_read_b64_tr_b16 v[36:37], v15 offset:24832
ds_read_b64_tr_b16 v[38:39], v15 offset:26368
v_mfma_f32_32x32x16_bf16 v[160:175], v[52:55], a[56:59], v[160:175]
s_add_u32 s43, s56, 7077888
s_add_u32 m0, s62, 24576
s_nop 0
buffer_load_dwordx4 v4, s[8:11], s43 offen lds
s_add_u32 m0, s62, 25600
s_nop 0
buffer_load_dwordx4 v5, s[8:11], s43 offen lds
s_add_u32 m0, s62, 26624
s_nop 0
buffer_load_dwordx4 v6, s[8:11], s43 offen lds
s_add_u32 m0, s62, 27648
s_nop 0
buffer_load_dwordx4 v7, s[8:11], s43 offen lds
s_add_u32 m0, s62, 28672
s_nop 0
buffer_load_dwordx4 v8, s[8:11], s43 offen lds
s_add_u32 m0, s62, 29696
s_nop 0
buffer_load_dwordx4 v9, s[8:11], s43 offen lds
buffer_load_dwordx4 a[40:43], v11, s[4:7], s61 offen offset:3072 sc1
buffer_load_dwordx4 a[44:47], v12, s[4:7], s61 offen offset:3072 sc1
v_mfma_f32_32x32x16_bf16 v[176:191], v[52:55], a[60:63], v[176:191]
v_mfma_f32_32x32x16_bf16 v[192:207], v[56:59], a[56:59], v[192:207]
v_mfma_f32_32x32x16_bf16 v[208:223], v[56:59], a[60:63], v[208:223]
v_mfma_f32_32x32x16_bf16 v[224:239], v[60:63], a[56:59], v[224:239]
v_mfma_f32_32x32x16_bf16 v[240:255], v[60:63], a[60:63], v[240:255]
s_waitcnt lgkmcnt(0)
s_waitcnt vmcnt(26)
v_mfma_f32_32x32x16_bf16 v[64:79], v[16:19], a[64:67], v[64:79]
s_add_u32 s59, s57, 36864
ds_read_b64_tr_b16 v[40:41], v13 offset:30720
v_mfma_f32_32x32x16_bf16 v[80:95], v[16:19], a[68:71], v[80:95]
ds_read_b64_tr_b16 v[42:43], v13 offset:32256
ds_read_b64_tr_b16 v[44:45], v15 offset:30720
v_mfma_f32_32x32x16_bf16 v[96:111], v[20:23], a[64:67], v[96:111]
ds_read_b64_tr_b16 v[46:47], v15 offset:32256
ds_read_b64_tr_b16 v[48:49], v13 offset:30848
v_mfma_f32_32x32x16_bf16 v[112:127], v[20:23], a[68:71], v[112:127]
ds_read_b64_tr_b16 v[50:51], v13 offset:32384
ds_read_b64_tr_b16 v[52:53], v15 offset:30848
v_mfma_f32_32x32x16_bf16 v[128:143], v[24:27], a[64:67], v[128:143]
ds_read_b64_tr_b16 v[54:55], v15 offset:32384
ds_read_b64_tr_b16 v[56:57], v13 offset:30976
v_mfma_f32_32x32x16_bf16 v[144:159], v[24:27], a[68:71], v[144:159]
ds_read_b64_tr_b16 v[58:59], v13 offset:32512
ds_read_b64_tr_b16 v[60:61], v15 offset:30976
v_mfma_f32_32x32x16_bf16 v[160:175], v[28:31], a[64:67], v[160:175]
ds_read_b64_tr_b16 v[62:63], v15 offset:32512
buffer_load_dwordx4 a[48:51], v11, s[4:7], s59 offen offset:0 sc1
buffer_load_dwordx4 a[52:55], v12, s[4:7], s59 offen offset:0 sc1
v_mfma_f32_32x32x16_bf16 v[176:191], v[28:31], a[68:71], v[176:191]
v_mfma_f32_32x32x16_bf16 v[192:207], v[32:35], a[64:67], v[192:207]
v_mfma_f32_32x32x16_bf16 v[208:223], v[32:35], a[68:71], v[208:223]
v_mfma_f32_32x32x16_bf16 v[224:239], v[36:39], a[64:67], v[224:239]
v_mfma_f32_32x32x16_bf16 v[240:255], v[36:39], a[68:71], v[240:255]
s_waitcnt lgkmcnt(0)
s_waitcnt vmcnt(26)
v_mfma_f32_32x32x16_bf16 v[64:79], v[40:43], a[72:75], v[64:79]
ds_read_b64_tr_b16 v[16:17], v13 offset:36864
ds_read_b64_tr_b16 v[18:19], v13 offset:38400
v_mfma_f32_32x32x16_bf16 v[80:95], v[40:43], a[76:79], v[80:95]
ds_read_b64_tr_b16 v[20:21], v15 offset:36864
ds_read_b64_tr_b16 v[22:23], v15 offset:38400
v_mfma_f32_32x32x16_bf16 v[96:111], v[44:47], a[72:75], v[96:111]
ds_read_b64_tr_b16 v[24:25], v13 offset:36992
ds_read_b64_tr_b16 v[26:27], v13 offset:38528
v_mfma_f32_32x32x16_bf16 v[112:127], v[44:47], a[76:79], v[112:127]
ds_read_b64_tr_b16 v[28:29], v15 offset:36992
ds_read_b64_tr_b16 v[30:31], v15 offset:38528
v_mfma_f32_32x32x16_bf16 v[128:143], v[48:51], a[72:75], v[128:143]
ds_read_b64_tr_b16 v[32:33], v13 offset:37120
ds_read_b64_tr_b16 v[34:35], v13 offset:38656
v_mfma_f32_32x32x16_bf16 v[144:159], v[48:51], a[76:79], v[144:159]
ds_read_b64_tr_b16 v[36:37], v15 offset:37120
ds_read_b64_tr_b16 v[38:39], v15 offset:38656
v_mfma_f32_32x32x16_bf16 v[160:175], v[52:55], a[72:75], v[160:175]
buffer_load_dwordx4 a[56:59], v11, s[4:7], s59 offen offset:1024 sc1
buffer_load_dwordx4 a[60:63], v12, s[4:7], s59 offen offset:1024 sc1
v_mfma_f32_32x32x16_bf16 v[176:191], v[52:55], a[76:79], v[176:191]
v_mfma_f32_32x32x16_bf16 v[192:207], v[56:59], a[72:75], v[192:207]
v_mfma_f32_32x32x16_bf16 v[208:223], v[56:59], a[76:79], v[208:223]
v_mfma_f32_32x32x16_bf16 v[224:239], v[60:63], a[72:75], v[224:239]
v_mfma_f32_32x32x16_bf16 v[240:255], v[60:63], a[76:79], v[240:255]
s_waitcnt lgkmcnt(0)
s_waitcnt vmcnt(26)
v_mfma_f32_32x32x16_bf16 v[64:79], v[16:19], a[0:3], v[64:79]
ds_read_b64_tr_b16 v[40:41], v13 offset:43008
ds_read_b64_tr_b16 v[42:43], v13 offset:44544
v_mfma_f32_32x32x16_bf16 v[80:95], v[16:19], a[4:7], v[80:95]
ds_read_b64_tr_b16 v[44:45], v15 offset:43008
ds_read_b64_tr_b16 v[46:47], v15 offset:44544
v_mfma_f32_32x32x16_bf16 v[96:111], v[20:23], a[0:3], v[96:111]
ds_read_b64_tr_b16 v[48:49], v13 offset:43136
ds_read_b64_tr_b16 v[50:51], v13 offset:44672
v_mfma_f32_32x32x16_bf16 v[112:127], v[20:23], a[4:7], v[112:127]
ds_read_b64_tr_b16 v[52:53], v15 offset:43136
ds_read_b64_tr_b16 v[54:55], v15 offset:44672
v_mfma_f32_32x32x16_bf16 v[128:143], v[24:27], a[0:3], v[128:143]
ds_read_b64_tr_b16 v[56:57], v13 offset:43264
ds_read_b64_tr_b16 v[58:59], v13 offset:44800
v_mfma_f32_32x32x16_bf16 v[144:159], v[24:27], a[4:7], v[144:159]
ds_read_b64_tr_b16 v[60:61], v15 offset:43264
ds_read_b64_tr_b16 v[62:63], v15 offset:44800
v_mfma_f32_32x32x16_bf16 v[160:175], v[28:31], a[0:3], v[160:175]
buffer_load_dwordx4 a[64:67], v11, s[4:7], s59 offen offset:2048 sc1
buffer_load_dwordx4 a[68:71], v12, s[4:7], s59 offen offset:2048 sc1
v_mfma_f32_32x32x16_bf16 v[176:191], v[28:31], a[4:7], v[176:191]
v_mfma_f32_32x32x16_bf16 v[192:207], v[32:35], a[0:3], v[192:207]
v_mfma_f32_32x32x16_bf16 v[208:223], v[32:35], a[4:7], v[208:223]
v_mfma_f32_32x32x16_bf16 v[224:239], v[36:39], a[0:3], v[224:239]
v_mfma_f32_32x32x16_bf16 v[240:255], v[36:39], a[4:7], v[240:255]
s_waitcnt lgkmcnt(0)
s_waitcnt vmcnt(22)
s_barrier
s_waitcnt vmcnt(20)
v_mfma_f32_32x32x16_bf16 v[64:79], v[40:43], a[8:11], v[64:79]
ds_read_b64_tr_b16 v[16:17], v2 offset:0
ds_read_b64_tr_b16 v[18:19], v2 offset:1536
v_mfma_f32_32x32x16_bf16 v[80:95], v[40:43], a[12:15], v[80:95]
ds_read_b64_tr_b16 v[20:21], v3 offset:0
ds_read_b64_tr_b16 v[22:23], v3 offset:1536
v_mfma_f32_32x32x16_bf16 v[96:111], v[44:47], a[8:11], v[96:111]
ds_read_b64_tr_b16 v[24:25], v2 offset:128
ds_read_b64_tr_b16 v[26:27], v2 offset:1664
v_mfma_f32_32x32x16_bf16 v[112:127], v[44:47], a[12:15], v[112:127]
ds_read_b64_tr_b16 v[28:29], v3 offset:128
ds_read_b64_tr_b16 v[30:31], v3 offset:1664
v_mfma_f32_32x32x16_bf16 v[128:143], v[48:51], a[8:11], v[128:143]
ds_read_b64_tr_b16 v[32:33], v2 offset:256
ds_read_b64_tr_b16 v[34:35], v2 offset:1792
v_mfma_f32_32x32x16_bf16 v[144:159], v[48:51], a[12:15], v[144:159]
ds_read_b64_tr_b16 v[36:37], v3 offset:256
ds_read_b64_tr_b16 v[38:39], v3 offset:1792
v_mfma_f32_32x32x16_bf16 v[160:175], v[52:55], a[8:11], v[160:175]
buffer_load_dwordx4 a[72:75], v11, s[4:7], s59 offen offset:3072 sc1
buffer_load_dwordx4 a[76:79], v12, s[4:7], s59 offen offset:3072 sc1
v_mfma_f32_32x32x16_bf16 v[176:191], v[52:55], a[12:15], v[176:191]
v_mfma_f32_32x32x16_bf16 v[192:207], v[56:59], a[8:11], v[192:207]
v_mfma_f32_32x32x16_bf16 v[208:223], v[56:59], a[12:15], v[208:223]
v_mfma_f32_32x32x16_bf16 v[224:239], v[60:63], a[8:11], v[224:239]
v_mfma_f32_32x32x16_bf16 v[240:255], v[60:63], a[12:15], v[240:255]
s_waitcnt lgkmcnt(0)
s_waitcnt vmcnt(20)
v_mfma_f32_32x32x16_bf16 v[64:79], v[16:19], a[16:19], v[64:79]
ds_read_b64_tr_b16 v[40:41], v2 offset:6144
v_mfma_f32_32x32x16_bf16 v[80:95], v[16:19], a[20:23], v[80:95]
ds_read_b64_tr_b16 v[42:43], v2 offset:7680
ds_read_b64_tr_b16 v[44:45], v3 offset:6144
v_mfma_f32_32x32x16_bf16 v[96:111], v[20:23], a[16:19], v[96:111]
ds_read_b64_tr_b16 v[46:47], v3 offset:7680
ds_read_b64_tr_b16 v[48:49], v2 offset:6272
v_mfma_f32_32x32x16_bf16 v[112:127], v[20:23], a[20:23], v[112:127]
ds_read_b64_tr_b16 v[50:51], v2 offset:7808
ds_read_b64_tr_b16 v[52:53], v3 offset:6272
v_mfma_f32_32x32x16_bf16 v[128:143], v[24:27], a[16:19], v[128:143]
ds_read_b64_tr_b16 v[54:55], v3 offset:7808
ds_read_b64_tr_b16 v[56:57], v2 offset:6400
v_mfma_f32_32x32x16_bf16 v[144:159], v[24:27], a[20:23], v[144:159]
ds_read_b64_tr_b16 v[58:59], v2 offset:7936
ds_read_b64_tr_b16 v[60:61], v3 offset:6400
v_mfma_f32_32x32x16_bf16 v[160:175], v[28:31], a[16:19], v[160:175]
ds_read_b64_tr_b16 v[62:63], v3 offset:7936
v_mfma_f32_32x32x16_bf16 v[176:191], v[28:31], a[20:23], v[176:191]
v_mfma_f32_32x32x16_bf16 v[192:207], v[32:35], a[16:19], v[192:207]
v_mfma_f32_32x32x16_bf16 v[208:223], v[32:35], a[20:23], v[208:223]
v_mfma_f32_32x32x16_bf16 v[224:239], v[36:39], a[16:19], v[224:239]
v_mfma_f32_32x32x16_bf16 v[240:255], v[36:39], a[20:23], v[240:255]
s_waitcnt lgkmcnt(0)
s_waitcnt vmcnt(18)
v_mfma_f32_32x32x16_bf16 v[64:79], v[40:43], a[24:27], v[64:79]
ds_read_b64_tr_b16 v[16:17], v2 offset:12288
ds_read_b64_tr_b16 v[18:19], v2 offset:13824
v_mfma_f32_32x32x16_bf16 v[80:95], v[40:43], a[28:31], v[80:95]
ds_read_b64_tr_b16 v[20:21], v3 offset:12288
ds_read_b64_tr_b16 v[22:23], v3 offset:13824
v_mfma_f32_32x32x16_bf16 v[96:111], v[44:47], a[24:27], v[96:111]
ds_read_b64_tr_b16 v[24:25], v2 offset:12416
ds_read_b64_tr_b16 v[26:27], v2 offset:13952
v_mfma_f32_32x32x16_bf16 v[112:127], v[44:47], a[28:31], v[112:127]
ds_read_b64_tr_b16 v[28:29], v3 offset:12416
ds_read_b64_tr_b16 v[30:31], v3 offset:13952
v_mfma_f32_32x32x16_bf16 v[128:143], v[48:51], a[24:27], v[128:143]
ds_read_b64_tr_b16 v[32:33], v2 offset:12544
ds_read_b64_tr_b16 v[34:35], v2 offset:14080
v_mfma_f32_32x32x16_bf16 v[144:159], v[48:51], a[28:31], v[144:159]
ds_read_b64_tr_b16 v[36:37], v3 offset:12544
ds_read_b64_tr_b16 v[38:39], v3 offset:14080
v_mfma_f32_32x32x16_bf16 v[160:175], v[52:55], a[24:27], v[160:175]
v_mfma_f32_32x32x16_bf16 v[176:191], v[52:55], a[28:31], v[176:191]
v_mfma_f32_32x32x16_bf16 v[192:207], v[56:59], a[24:27], v[192:207]
v_mfma_f32_32x32x16_bf16 v[208:223], v[56:59], a[28:31], v[208:223]
v_mfma_f32_32x32x16_bf16 v[224:239], v[60:63], a[24:27], v[224:239]
v_mfma_f32_32x32x16_bf16 v[240:255], v[60:63], a[28:31], v[240:255]
s_waitcnt lgkmcnt(0)
s_waitcnt vmcnt(16)
v_mfma_f32_32x32x16_bf16 v[64:79], v[16:19], a[32:35], v[64:79]
ds_read_b64_tr_b16 v[40:41], v2 offset:18432
ds_read_b64_tr_b16 v[42:43], v2 offset:19968
v_mfma_f32_32x32x16_bf16 v[80:95], v[16:19], a[36:39], v[80:95]
ds_read_b64_tr_b16 v[44:45], v3 offset:18432
ds_read_b64_tr_b16 v[46:47], v3 offset:19968
v_mfma_f32_32x32x16_bf16 v[96:111], v[20:23], a[32:35], v[96:111]
ds_read_b64_tr_b16 v[48:49], v2 offset:18560
ds_read_b64_tr_b16 v[50:51], v2 offset:20096
v_mfma_f32_32x32x16_bf16 v[112:127], v[20:23], a[36:39], v[112:127]
ds_read_b64_tr_b16 v[52:53], v3 offset:18560
ds_read_b64_tr_b16 v[54:55], v3 offset:20096
v_mfma_f32_32x32x16_bf16 v[128:143], v[24:27], a[32:35], v[128:143]
ds_read_b64_tr_b16 v[56:57], v2 offset:18688
ds_read_b64_tr_b16 v[58:59], v2 offset:20224
v_mfma_f32_32x32x16_bf16 v[144:159], v[24:27], a[36:39], v[144:159]
ds_read_b64_tr_b16 v[60:61], v3 offset:18688
ds_read_b64_tr_b16 v[62:63], v3 offset:20224
v_mfma_f32_32x32x16_bf16 v[160:175], v[28:31], a[32:35], v[160:175]
v_mfma_f32_32x32x16_bf16 v[176:191], v[28:31], a[36:39], v[176:191]
v_mfma_f32_32x32x16_bf16 v[192:207], v[32:35], a[32:35], v[192:207]
v_mfma_f32_32x32x16_bf16 v[208:223], v[32:35], a[36:39], v[208:223]
v_mfma_f32_32x32x16_bf16 v[224:239], v[36:39], a[32:35], v[224:239]
v_mfma_f32_32x32x16_bf16 v[240:255], v[36:39], a[36:39], v[240:255]
s_waitcnt lgkmcnt(0)
s_waitcnt vmcnt(10)
s_barrier
s_waitcnt vmcnt(8)
v_mfma_f32_32x32x16_bf16 v[64:79], v[40:43], a[40:43], v[64:79]
ds_read_b64_tr_b16 v[16:17], v2 offset:24576
ds_read_b64_tr_b16 v[18:19], v2 offset:26112
v_mfma_f32_32x32x16_bf16 v[80:95], v[40:43], a[44:47], v[80:95]
ds_read_b64_tr_b16 v[20:21], v3 offset:24576
ds_read_b64_tr_b16 v[22:23], v3 offset:26112
v_mfma_f32_32x32x16_bf16 v[96:111], v[44:47], a[40:43], v[96:111]
ds_read_b64_tr_b16 v[24:25], v2 offset:24704
ds_read_b64_tr_b16 v[26:27], v2 offset:26240
v_mfma_f32_32x32x16_bf16 v[112:127], v[44:47], a[44:47], v[112:127]
ds_read_b64_tr_b16 v[28:29], v3 offset:24704
ds_read_b64_tr_b16 v[30:31], v3 offset:26240
v_mfma_f32_32x32x16_bf16 v[128:143], v[48:51], a[40:43], v[128:143]
ds_read_b64_tr_b16 v[32:33], v2 offset:24832
ds_read_b64_tr_b16 v[34:35], v2 offset:26368
v_mfma_f32_32x32x16_bf16 v[144:159], v[48:51], a[44:47], v[144:159]
ds_read_b64_tr_b16 v[36:37], v3 offset:24832
ds_read_b64_tr_b16 v[38:39], v3 offset:26368
v_mfma_f32_32x32x16_bf16 v[160:175], v[52:55], a[40:43], v[160:175]
v_mfma_f32_32x32x16_bf16 v[176:191], v[52:55], a[44:47], v[176:191]
v_mfma_f32_32x32x16_bf16 v[192:207], v[56:59], a[40:43], v[192:207]
v_mfma_f32_32x32x16_bf16 v[208:223], v[56:59], a[44:47], v[208:223]
v_mfma_f32_32x32x16_bf16 v[224:239], v[60:63], a[40:43], v[224:239]
v_mfma_f32_32x32x16_bf16 v[240:255], v[60:63], a[44:47], v[240:255]
s_waitcnt lgkmcnt(0)
s_waitcnt vmcnt(6)
v_mfma_f32_32x32x16_bf16 v[64:79], v[16:19], a[48:51], v[64:79]
ds_read_b64_tr_b16 v[40:41], v2 offset:30720
v_mfma_f32_32x32x16_bf16 v[80:95], v[16:19], a[52:55], v[80:95]
ds_read_b64_tr_b16 v[42:43], v2 offset:32256
ds_read_b64_tr_b16 v[44:45], v3 offset:30720
v_mfma_f32_32x32x16_bf16 v[96:111], v[20:23], a[48:51], v[96:111]
ds_read_b64_tr_b16 v[46:47], v3 offset:32256
ds_read_b64_tr_b16 v[48:49], v2 offset:30848
v_mfma_f32_32x32x16_bf16 v[112:127], v[20:23], a[52:55], v[112:127]
ds_read_b64_tr_b16 v[50:51], v2 offset:32384
ds_read_b64_tr_b16 v[52:53], v3 offset:30848
v_mfma_f32_32x32x16_bf16 v[128:143], v[24:27], a[48:51], v[128:143]
ds_read_b64_tr_b16 v[54:55], v3 offset:32384
ds_read_b64_tr_b16 v[56:57], v2 offset:30976
v_mfma_f32_32x32x16_bf16 v[144:159], v[24:27], a[52:55], v[144:159]
ds_read_b64_tr_b16 v[58:59], v2 offset:32512
ds_read_b64_tr_b16 v[60:61], v3 offset:30976
v_mfma_f32_32x32x16_bf16 v[160:175], v[28:31], a[48:51], v[160:175]
ds_read_b64_tr_b16 v[62:63], v3 offset:32512
v_mfma_f32_32x32x16_bf16 v[176:191], v[28:31], a[52:55], v[176:191]
v_mfma_f32_32x32x16_bf16 v[192:207], v[32:35], a[48:51], v[192:207]
v_mfma_f32_32x32x16_bf16 v[208:223], v[32:35], a[52:55], v[208:223]
v_mfma_f32_32x32x16_bf16 v[224:239], v[36:39], a[48:51], v[224:239]
v_mfma_f32_32x32x16_bf16 v[240:255], v[36:39], a[52:55], v[240:255]
s_waitcnt lgkmcnt(0)
s_waitcnt vmcnt(4)
v_mfma_f32_32x32x16_bf16 v[64:79], v[40:43], a[56:59], v[64:79]
ds_read_b64_tr_b16 v[16:17], v2 offset:36864
ds_read_b64_tr_b16 v[18:19], v2 offset:38400
v_mfma_f32_32x32x16_bf16 v[80:95], v[40:43], a[60:63], v[80:95]
ds_read_b64_tr_b16 v[20:21], v3 offset:36864
ds_read_b64_tr_b16 v[22:23], v3 offset:38400
v_mfma_f32_32x32x16_bf16 v[96:111], v[44:47], a[56:59], v[96:111]
ds_read_b64_tr_b16 v[24:25], v2 offset:36992
ds_read_b64_tr_b16 v[26:27], v2 offset:38528
v_mfma_f32_32x32x16_bf16 v[112:127], v[44:47], a[60:63], v[112:127]
ds_read_b64_tr_b16 v[28:29], v3 offset:36992
ds_read_b64_tr_b16 v[30:31], v3 offset:38528
v_mfma_f32_32x32x16_bf16 v[128:143], v[48:51], a[56:59], v[128:143]
ds_read_b64_tr_b16 v[32:33], v2 offset:37120
ds_read_b64_tr_b16 v[34:35], v2 offset:38656
v_mfma_f32_32x32x16_bf16 v[144:159], v[48:51], a[60:63], v[144:159]
ds_read_b64_tr_b16 v[36:37], v3 offset:37120
ds_read_b64_tr_b16 v[38:39], v3 offset:38656
v_mfma_f32_32x32x16_bf16 v[160:175], v[52:55], a[56:59], v[160:175]
v_mfma_f32_32x32x16_bf16 v[176:191], v[52:55], a[60:63], v[176:191]
v_mfma_f32_32x32x16_bf16 v[192:207], v[56:59], a[56:59], v[192:207]
v_mfma_f32_32x32x16_bf16 v[208:223], v[56:59], a[60:63], v[208:223]
v_mfma_f32_32x32x16_bf16 v[224:239], v[60:63], a[56:59], v[224:239]
v_mfma_f32_32x32x16_bf16 v[240:255], v[60:63], a[60:63], v[240:255]
s_waitcnt lgkmcnt(0)
s_waitcnt vmcnt(2)
v_mfma_f32_32x32x16_bf16 v[64:79], v[16:19], a[64:67], v[64:79]
ds_read_b64_tr_b16 v[40:41], v2 offset:43008
ds_read_b64_tr_b16 v[42:43], v2 offset:44544
v_mfma_f32_32x32x16_bf16 v[80:95], v[16:19], a[68:71], v[80:95]
ds_read_b64_tr_b16 v[44:45], v3 offset:43008
ds_read_b64_tr_b16 v[46:47], v3 offset:44544
v_mfma_f32_32x32x16_bf16 v[96:111], v[20:23], a[64:67], v[96:111]
ds_read_b64_tr_b16 v[48:49], v2 offset:43136
ds_read_b64_tr_b16 v[50:51], v2 offset:44672
v_mfma_f32_32x32x16_bf16 v[112:127], v[20:23], a[68:71], v[112:127]
ds_read_b64_tr_b16 v[52:53], v3 offset:43136
ds_read_b64_tr_b16 v[54:55], v3 offset:44672
v_mfma_f32_32x32x16_bf16 v[128:143], v[24:27], a[64:67], v[128:143]
ds_read_b64_tr_b16 v[56:57], v2 offset:43264
ds_read_b64_tr_b16 v[58:59], v2 offset:44800
v_mfma_f32_32x32x16_bf16 v[144:159], v[24:27], a[68:71], v[144:159]
ds_read_b64_tr_b16 v[60:61], v3 offset:43264
ds_read_b64_tr_b16 v[62:63], v3 offset:44800
v_mfma_f32_32x32x16_bf16 v[160:175], v[28:31], a[64:67], v[160:175]
v_mfma_f32_32x32x16_bf16 v[176:191], v[28:31], a[68:71], v[176:191]
v_mfma_f32_32x32x16_bf16 v[192:207], v[32:35], a[64:67], v[192:207]
v_mfma_f32_32x32x16_bf16 v[208:223], v[32:35], a[68:71], v[208:223]
v_mfma_f32_32x32x16_bf16 v[224:239], v[36:39], a[64:67], v[224:239]
v_mfma_f32_32x32x16_bf16 v[240:255], v[36:39], a[68:71], v[240:255]
s_waitcnt lgkmcnt(0)
s_waitcnt vmcnt(0)
v_mfma_f32_32x32x16_bf16 v[64:79], v[40:43], a[72:75], v[64:79]
v_mfma_f32_32x32x16_bf16 v[80:95], v[40:43], a[76:79], v[80:95]
v_mfma_f32_32x32x16_bf16 v[96:111], v[44:47], a[72:75], v[96:111]
v_mfma_f32_32x32x16_bf16 v[112:127], v[44:47], a[76:79], v[112:127]
v_mfma_f32_32x32x16_bf16 v[128:143], v[48:51], a[72:75], v[128:143]
v_mfma_f32_32x32x16_bf16 v[144:159], v[48:51], a[76:79], v[144:159]
v_mfma_f32_32x32x16_bf16 v[160:175], v[52:55], a[72:75], v[160:175]
v_mfma_f32_32x32x16_bf16 v[176:191], v[52:55], a[76:79], v[176:191]
v_mfma_f32_32x32x16_bf16 v[192:207], v[56:59], a[72:75], v[192:207]
v_mfma_f32_32x32x16_bf16 v[208:223], v[56:59], a[76:79], v[208:223]
v_mfma_f32_32x32x16_bf16 v[224:239], v[60:63], a[72:75], v[224:239]
v_mfma_f32_32x32x16_bf16 v[240:255], v[60:63], a[76:79], v[240:255]
s_cmp_eq_u32 s64, 2
s_cbranch_scc1 wp_vo
s_cmp_eq_u32 s24, 0
s_cbranch_scc0 tk7134
v_accvgpr_write_b32 a200, 1
s_mov_b64 exec, 1
buffer_atomic_add a200, off, s[28:31], s32 sc0
s_mov_b64 exec, -1
tk7134:
s_cmp_eq_u32 s64, 1
s_cbranch_scc1 wp_q
v_accvgpr_read_b32 v14, a106
v_accvgpr_read_b32 v15, a107
s_mov_b32 s40, 16777216
s_branch wp_kq
wp_q:
v_accvgpr_read_b32 v14, a108
v_accvgpr_read_b32 v15, a109
s_mov_b32 s40, 50331648
wp_kq:
s_lshl_b32 s42, s55, 2
s_add_u32 s42, s42, s24
s_mul_i32 s42, s42, 786432
s_mul_i32 s43, s54, 12288
s_add_u32 s42, s42, s43
s_add_u32 s42, s42, s40
s_add_u32 s43, s42, 0
v_cvt_pk_bf16_f32 v16, v64, v65
v_cvt_pk_bf16_f32 v17, v66, v67
v_cvt_pk_bf16_f32 v18, v72, v73
v_cvt_pk_bf16_f32 v19, v74, v75
buffer_store_dwordx4 v[16:19], v14, s[4:7], s43 offen sc1
v_cvt_pk_bf16_f32 v20, v68, v69
v_cvt_pk_bf16_f32 v21, v70, v71
v_cvt_pk_bf16_f32 v22, v76, v77
v_cvt_pk_bf16_f32 v23, v78, v79
buffer_store_dwordx4 v[20:23], v15, s[4:7], s43 offen sc1
s_add_u32 s43, s42, 2048
v_cvt_pk_bf16_f32 v24, v96, v97
v_cvt_pk_bf16_f32 v25, v98, v99
v_cvt_pk_bf16_f32 v26, v104, v105
v_cvt_pk_bf16_f32 v27, v106, v107
buffer_store_dwordx4 v[24:27], v14, s[4:7], s43 offen sc1
v_cvt_pk_bf16_f32 v28, v100, v101
v_cvt_pk_bf16_f32 v29, v102, v103
v_cvt_pk_bf16_f32 v30, v108, v109
v_cvt_pk_bf16_f32 v31, v110, v111
buffer_store_dwordx4 v[28:31], v15, s[4:7], s43 offen sc1
s_add_u32 s43, s42, 4096
v_cvt_pk_bf16_f32 v16, v128, v129
v_cvt_pk_bf16_f32 v17, v130, v131
v_cvt_pk_bf16_f32 v18, v136, v137
v_cvt_pk_bf16_f32 v19, v138, v139
buffer_store_dwordx4 v[16:19], v14, s[4:7], s43 offen sc1
v_cvt_pk_bf16_f32 v20, v132, v133
v_cvt_pk_bf16_f32 v21, v134, v135
v_cvt_pk_bf16_f32 v22, v140, v141
v_cvt_pk_bf16_f32 v23, v142, v143
buffer_store_dwordx4 v[20:23], v15, s[4:7], s43 offen sc1
s_add_u32 s43, s42, 6144
v_cvt_pk_bf16_f32 v24, v160, v161
v_cvt_pk_bf16_f32 v25, v162, v163
v_cvt_pk_bf16_f32 v26, v168, v169
v_cvt_pk_bf16_f32 v27, v170, v171
buffer_store_dwordx4 v[24:27], v14, s[4:7], s43 offen sc1
v_cvt_pk_bf16_f32 v28, v164, v165
v_cvt_pk_bf16_f32 v29, v166, v167
v_cvt_pk_bf16_f32 v30, v172, v173
v_cvt_pk_bf16_f32 v31, v174, v175
buffer_store_dwordx4 v[28:31], v15, s[4:7], s43 offen sc1
s_add_u32 s43, s42, 8192
v_cvt_pk_bf16_f32 v16, v192, v193
v_cvt_pk_bf16_f32 v17, v194, v195
v_cvt_pk_bf16_f32 v18, v200, v201
v_cvt_pk_bf16_f32 v19, v202, v203
buffer_store_dwordx4 v[16:19], v14, s[4:7], s43 offen sc1
v_cvt_pk_bf16_f32 v20, v196, v197
v_cvt_pk_bf16_f32 v21, v198, v199
v_cvt_pk_bf16_f32 v22, v204, v205
v_cvt_pk_bf16_f32 v23, v206, v207
buffer_store_dwordx4 v[20:23], v15, s[4:7], s43 offen sc1
s_add_u32 s43, s42, 10240
v_cvt_pk_bf16_f32 v24, v224, v225
v_cvt_pk_bf16_f32 v25, v226, v227
v_cvt_pk_bf16_f32 v26, v232, v233
v_cvt_pk_bf16_f32 v27, v234, v235
buffer_store_dwordx4 v[24:27], v14, s[4:7], s43 offen sc1
v_cvt_pk_bf16_f32 v28, v228, v229
v_cvt_pk_bf16_f32 v29, v230, v231
v_cvt_pk_bf16_f32 v30, v236, v237
v_cvt_pk_bf16_f32 v31, v238, v239
buffer_store_dwordx4 v[28:31], v15, s[4:7], s43 offen sc1
s_add_u32 s43, s42, 393216
v_cvt_pk_bf16_f32 v16, v80, v81
v_cvt_pk_bf16_f32 v17, v82, v83
v_cvt_pk_bf16_f32 v18, v88, v89
v_cvt_pk_bf16_f32 v19, v90, v91
buffer_store_dwordx4 v[16:19], v14, s[4:7], s43 offen sc1
v_cvt_pk_bf16_f32 v20, v84, v85
v_cvt_pk_bf16_f32 v21, v86, v87
v_cvt_pk_bf16_f32 v22, v92, v93
v_cvt_pk_bf16_f32 v23, v94, v95
buffer_store_dwordx4 v[20:23], v15, s[4:7], s43 offen sc1
s_add_u32 s43, s42, 395264
v_cvt_pk_bf16_f32 v24, v112, v113
v_cvt_pk_bf16_f32 v25, v114, v115
v_cvt_pk_bf16_f32 v26, v120, v121
v_cvt_pk_bf16_f32 v27, v122, v123
buffer_store_dwordx4 v[24:27], v14, s[4:7], s43 offen sc1
v_cvt_pk_bf16_f32 v28, v116, v117
v_cvt_pk_bf16_f32 v29, v118, v119
v_cvt_pk_bf16_f32 v30, v124, v125
v_cvt_pk_bf16_f32 v31, v126, v127
buffer_store_dwordx4 v[28:31], v15, s[4:7], s43 offen sc1
s_add_u32 s43, s42, 397312
v_cvt_pk_bf16_f32 v16, v144, v145
v_cvt_pk_bf16_f32 v17, v146, v147
v_cvt_pk_bf16_f32 v18, v152, v153
v_cvt_pk_bf16_f32 v19, v154, v155
buffer_store_dwordx4 v[16:19], v14, s[4:7], s43 offen sc1
v_cvt_pk_bf16_f32 v20, v148, v149
v_cvt_pk_bf16_f32 v21, v150, v151
v_cvt_pk_bf16_f32 v22, v156, v157
v_cvt_pk_bf16_f32 v23, v158, v159
buffer_store_dwordx4 v[20:23], v15, s[4:7], s43 offen sc1
s_add_u32 s43, s42, 399360
v_cvt_pk_bf16_f32 v24, v176, v177
v_cvt_pk_bf16_f32 v25, v178, v179
v_cvt_pk_bf16_f32 v26, v184, v185
v_cvt_pk_bf16_f32 v27, v186, v187
buffer_store_dwordx4 v[24:27], v14, s[4:7], s43 offen sc1
v_cvt_pk_bf16_f32 v28, v180, v181
v_cvt_pk_bf16_f32 v29, v182, v183
v_cvt_pk_bf16_f32 v30, v188, v189
v_cvt_pk_bf16_f32 v31, v190, v191
buffer_store_dwordx4 v[28:31], v15, s[4:7], s43 offen sc1
s_add_u32 s43, s42, 401408
v_cvt_pk_bf16_f32 v16, v208, v209
v_cvt_pk_bf16_f32 v17, v210, v211
v_cvt_pk_bf16_f32 v18, v216, v217
v_cvt_pk_bf16_f32 v19, v218, v219
buffer_store_dwordx4 v[16:19], v14, s[4:7], s43 offen sc1
v_cvt_pk_bf16_f32 v20, v212, v213
v_cvt_pk_bf16_f32 v21, v214, v215
v_cvt_pk_bf16_f32 v22, v220, v221
v_cvt_pk_bf16_f32 v23, v222, v223
buffer_store_dwordx4 v[20:23], v15, s[4:7], s43 offen sc1
s_add_u32 s43, s42, 403456
v_cvt_pk_bf16_f32 v24, v240, v241
v_cvt_pk_bf16_f32 v25, v242, v243
v_cvt_pk_bf16_f32 v26, v248, v249
v_cvt_pk_bf16_f32 v27, v250, v251
buffer_store_dwordx4 v[24:27], v14, s[4:7], s43 offen sc1
v_cvt_pk_bf16_f32 v28, v244, v245
v_cvt_pk_bf16_f32 v29, v246, v247
v_cvt_pk_bf16_f32 v30, v252, v253
v_cvt_pk_bf16_f32 v31, v254, v255
buffer_store_dwordx4 v[28:31], v15, s[4:7], s43 offen sc1
s_branch wp_end
wp_vo:
s_nop 7
s_barrier
v_cvt_pk_bf16_f32 v64, v64, v65
v_cvt_pk_bf16_f32 v65, v66, v67
v_cvt_pk_bf16_f32 v66, v68, v69
v_cvt_pk_bf16_f32 v67, v70, v71
v_cvt_pk_bf16_f32 v68, v72, v73
v_cvt_pk_bf16_f32 v69, v74, v75
v_cvt_pk_bf16_f32 v70, v76, v77
v_cvt_pk_bf16_f32 v71, v78, v79
v_cvt_pk_bf16_f32 v72, v80, v81
v_cvt_pk_bf16_f32 v73, v82, v83
v_cvt_pk_bf16_f32 v74, v84, v85
v_cvt_pk_bf16_f32 v75, v86, v87
v_cvt_pk_bf16_f32 v76, v88, v89
v_cvt_pk_bf16_f32 v77, v90, v91
v_cvt_pk_bf16_f32 v78, v92, v93
v_cvt_pk_bf16_f32 v79, v94, v95
v_cvt_pk_bf16_f32 v80, v96, v97
v_cvt_pk_bf16_f32 v81, v98, v99
v_cvt_pk_bf16_f32 v82, v100, v101
v_cvt_pk_bf16_f32 v83, v102, v103
v_cvt_pk_bf16_f32 v84, v104, v105
v_cvt_pk_bf16_f32 v85, v106, v107
v_cvt_pk_bf16_f32 v86, v108, v109
v_cvt_pk_bf16_f32 v87, v110, v111
v_cvt_pk_bf16_f32 v88, v112, v113
v_cvt_pk_bf16_f32 v89, v114, v115
v_cvt_pk_bf16_f32 v90, v116, v117
v_cvt_pk_bf16_f32 v91, v118, v119
v_cvt_pk_bf16_f32 v92, v120, v121
v_cvt_pk_bf16_f32 v93, v122, v123
v_cvt_pk_bf16_f32 v94, v124, v125
v_cvt_pk_bf16_f32 v95, v126, v127
v_cvt_pk_bf16_f32 v96, v128, v129
v_cvt_pk_bf16_f32 v97, v130, v131
v_cvt_pk_bf16_f32 v98, v132, v133
v_cvt_pk_bf16_f32 v99, v134, v135
v_cvt_pk_bf16_f32 v100, v136, v137
v_cvt_pk_bf16_f32 v101, v138, v139
v_cvt_pk_bf16_f32 v102, v140, v141
v_cvt_pk_bf16_f32 v103, v142, v143
v_cvt_pk_bf16_f32 v104, v144, v145
v_cvt_pk_bf16_f32 v105, v146, v147
v_cvt_pk_bf16_f32 v106, v148, v149
v_cvt_pk_bf16_f32 v107, v150, v151
v_cvt_pk_bf16_f32 v108, v152, v153
v_cvt_pk_bf16_f32 v109, v154, v155
v_cvt_pk_bf16_f32 v110, v156, v157
v_cvt_pk_bf16_f32 v111, v158, v159
v_cvt_pk_bf16_f32 v112, v160, v161
v_cvt_pk_bf16_f32 v113, v162, v163
v_cvt_pk_bf16_f32 v114, v164, v165
v_cvt_pk_bf16_f32 v115, v166, v167
v_cvt_pk_bf16_f32 v116, v168, v169
v_cvt_pk_bf16_f32 v117, v170, v171
v_cvt_pk_bf16_f32 v118, v172, v173
v_cvt_pk_bf16_f32 v119, v174, v175
v_cvt_pk_bf16_f32 v120, v176, v177
v_cvt_pk_bf16_f32 v121, v178, v179
v_cvt_pk_bf16_f32 v122, v180, v181
v_cvt_pk_bf16_f32 v123, v182, v183
v_cvt_pk_bf16_f32 v124, v184, v185
v_cvt_pk_bf16_f32 v125, v186, v187
v_cvt_pk_bf16_f32 v126, v188, v189
v_cvt_pk_bf16_f32 v127, v190, v191
v_cvt_pk_bf16_f32 v128, v192, v193
v_cvt_pk_bf16_f32 v129, v194, v195
v_cvt_pk_bf16_f32 v130, v196, v197
v_cvt_pk_bf16_f32 v131, v198, v199
v_cvt_pk_bf16_f32 v132, v200, v201
v_cvt_pk_bf16_f32 v133, v202, v203
v_cvt_pk_bf16_f32 v134, v204, v205
v_cvt_pk_bf16_f32 v135, v206, v207
v_cvt_pk_bf16_f32 v136, v208, v209
v_cvt_pk_bf16_f32 v137, v210, v211
v_cvt_pk_bf16_f32 v138, v212, v213
v_cvt_pk_bf16_f32 v139, v214, v215
v_cvt_pk_bf16_f32 v140, v216, v217
v_cvt_pk_bf16_f32 v141, v218, v219
v_cvt_pk_bf16_f32 v142, v220, v221
v_cvt_pk_bf16_f32 v143, v222, v223
v_cvt_pk_bf16_f32 v144, v224, v225
v_cvt_pk_bf16_f32 v145, v226, v227
v_cvt_pk_bf16_f32 v146, v228, v229
v_cvt_pk_bf16_f32 v147, v230, v231
v_cvt_pk_bf16_f32 v148, v232, v233
v_cvt_pk_bf16_f32 v149, v234, v235
v_cvt_pk_bf16_f32 v150, v236, v237
v_cvt_pk_bf16_f32 v151, v238, v239
v_cvt_pk_bf16_f32 v152, v240, v241
v_cvt_pk_bf16_f32 v153, v242, v243
v_cvt_pk_bf16_f32 v154, v244, v245
v_cvt_pk_bf16_f32 v155, v246, v247
v_cvt_pk_bf16_f32 v156, v248, v249
v_cvt_pk_bf16_f32 v157, v250, v251
v_cvt_pk_bf16_f32 v158, v252, v253
v_cvt_pk_bf16_f32 v159, v254, v255
v_accvgpr_read_b32 v4, a110
v_accvgpr_read_b32 v2, a111
v_accvgpr_read_b32 v3, a112
v_accvgpr_read_b32 v13, a113
v_accvgpr_read_b32 v15, a114
v_accvgpr_read_b32 v14, a115
s_mul_i32 s56, s54, 245760
s_lshl_b32 s42, s55, 2
s_add_u32 s42, s42, s24
s_mul_i32 s58, s42, 2621440
s_lshl_b32 s43, s54, 10
s_add_u32 s58, s58, s43
s_add_u32 s58, s58, 83886080
s_add_u32 s43, s56, 0
s_add_u32 m0, s62, 0
s_nop 0
buffer_load_dwordx4 v4, s[12:15], s43 offen lds
s_add_u32 s43, s56, 10240
s_add_u32 m0, s62, 1024
s_nop 0
buffer_load_dwordx4 v4, s[12:15], s43 offen lds
s_add_u32 s43, s56, 20480
s_add_u32 m0, s62, 2048
s_nop 0
buffer_load_dwordx4 v4, s[12:15], s43 offen lds
s_add_u32 s43, s56, 30720
s_add_u32 m0, s62, 3072
s_nop 0
buffer_load_dwordx4 v4, s[12:15], s43 offen lds
s_add_u32 s43, s56, 40960
s_add_u32 m0, s62, 4096
s_nop 0
buffer_load_dwordx4 v4, s[12:15], s43 offen lds
s_add_u32 s43, s56, 51200
s_add_u32 m0, s62, 5120
s_nop 0
buffer_load_dwordx4 v4, s[12:15], s43 offen lds
s_add_u32 s43, s56, 128
s_add_u32 m0, s62, 24576
s_nop 0
buffer_load_dwordx4 v4, s[12:15], s43 offen lds
s_add_u32 s43, s56, 10368
s_add_u32 m0, s62, 25600
s_nop 0
buffer_load_dwordx4 v4, s[12:15], s43 offen lds
s_add_u32 s43, s56, 20608
s_add_u32 m0, s62, 26624
s_nop 0
buffer_load_dwordx4 v4, s[12:15], s43 offen lds
s_add_u32 s43, s56, 30848
s_add_u32 m0, s62, 27648
s_nop 0
buffer_load_dwordx4 v4, s[12:15], s43 offen lds
s_add_u32 s43, s56, 41088
s_add_u32 m0, s62, 28672
s_nop 0
buffer_load_dwordx4 v4, s[12:15], s43 offen lds
s_add_u32 s43, s56, 51328
s_add_u32 m0, s62, 29696
s_nop 0
buffer_load_dwordx4 v4, s[12:15], s43 offen lds
s_add_u32 s43, s56, 256
s_add_u32 m0, s62, 49152
s_nop 0
buffer_load_dwordx4 v4, s[12:15], s43 offen lds
s_add_u32 s43, s56, 10496
s_add_u32 m0, s62, 50176
s_nop 0
buffer_load_dwordx4 v4, s[12:15], s43 offen lds
s_add_u32 s43, s56, 20736
s_add_u32 m0, s62, 51200
s_nop 0
buffer_load_dwordx4 v4, s[12:15], s43 offen lds
s_add_u32 s43, s56, 30976
s_add_u32 m0, s62, 52224
s_nop 0
buffer_load_dwordx4 v4, s[12:15], s43 offen lds
s_add_u32 s43, s56, 41216
s_add_u32 m0, s62, 53248
s_nop 0
buffer_load_dwordx4 v4, s[12:15], s43 offen lds
s_add_u32 s43, s56, 51456
s_add_u32 m0, s62, 54272
s_nop 0
buffer_load_dwordx4 v4, s[12:15], s43 offen lds
s_waitcnt vmcnt(12)
s_barrier
ds_read_b64_tr_b16 v[16:17], v2 offset:0
ds_read_b64_tr_b16 v[18:19], v2 offset:1024
ds_read_b64_tr_b16 v[20:21], v2 offset:2048
ds_read_b64_tr_b16 v[22:23], v2 offset:3072
ds_read_b64_tr_b16 v[24:25], v2 offset:4096
ds_read_b64_tr_b16 v[26:27], v2 offset:5120
ds_read_b64_tr_b16 v[28:29], v2 offset:6144
ds_read_b64_tr_b16 v[30:31], v2 offset:7168
ds_read_b64_tr_b16 v[32:33], v2 offset:8192
ds_read_b64_tr_b16 v[34:35], v2 offset:9216
ds_read_b64_tr_b16 v[36:37], v2 offset:10240
ds_read_b64_tr_b16 v[38:39], v2 offset:11264
s_waitcnt lgkmcnt(10)
v_mfma_f32_32x32x16_bf16 v[160:175], v[64:67], v[16:19], 0
v_mfma_f32_32x32x16_bf16 v[176:191], v[72:75], v[16:19], 0
ds_read_b64_tr_b16 v[40:41], v2 offset:12288
ds_read_b64_tr_b16 v[42:43], v2 offset:13312
s_waitcnt lgkmcnt(10)
v_mfma_f32_32x32x16_bf16 v[160:175], v[68:71], v[20:23], v[160:175]
v_mfma_f32_32x32x16_bf16 v[176:191], v[76:79], v[20:23], v[176:191]
ds_read_b64_tr_b16 v[44:45], v2 offset:14336
ds_read_b64_tr_b16 v[46:47], v2 offset:15360
s_waitcnt lgkmcnt(10)
v_mfma_f32_32x32x16_bf16 v[160:175], v[80:83], v[24:27], v[160:175]
v_mfma_f32_32x32x16_bf16 v[176:191], v[88:91], v[24:27], v[176:191]
ds_read_b64_tr_b16 v[16:17], v2 offset:16384
ds_read_b64_tr_b16 v[18:19], v2 offset:17408
s_waitcnt lgkmcnt(10)
v_mfma_f32_32x32x16_bf16 v[160:175], v[84:87], v[28:31], v[160:175]
v_mfma_f32_32x32x16_bf16 v[176:191], v[92:95], v[28:31], v[176:191]
ds_read_b64_tr_b16 v[20:21], v2 offset:18432
ds_read_b64_tr_b16 v[22:23], v2 offset:19456
s_waitcnt lgkmcnt(10)
v_mfma_f32_32x32x16_bf16 v[160:175], v[96:99], v[32:35], v[160:175]
v_mfma_f32_32x32x16_bf16 v[176:191], v[104:107], v[32:35], v[176:191]
ds_read_b64_tr_b16 v[24:25], v2 offset:20480
ds_read_b64_tr_b16 v[26:27], v2 offset:21504
s_waitcnt lgkmcnt(10)
v_mfma_f32_32x32x16_bf16 v[160:175], v[100:103], v[36:39], v[160:175]
v_mfma_f32_32x32x16_bf16 v[176:191], v[108:111], v[36:39], v[176:191]
ds_read_b64_tr_b16 v[28:29], v2 offset:22528
ds_read_b64_tr_b16 v[30:31], v2 offset:23552
s_waitcnt lgkmcnt(10)
v_mfma_f32_32x32x16_bf16 v[160:175], v[112:115], v[40:43], v[160:175]
v_mfma_f32_32x32x16_bf16 v[176:191], v[120:123], v[40:43], v[176:191]
ds_read_b64_tr_b16 v[32:33], v3 offset:0
ds_read_b64_tr_b16 v[34:35], v3 offset:1024
s_waitcnt lgkmcnt(10)
v_mfma_f32_32x32x16_bf16 v[160:175], v[116:119], v[44:47], v[160:175]
v_mfma_f32_32x32x16_bf16 v[176:191], v[124:127], v[44:47], v[176:191]
ds_read_b64_tr_b16 v[36:37], v3 offset:2048
ds_read_b64_tr_b16 v[38:39], v3 offset:3072
s_waitcnt lgkmcnt(10)
v_mfma_f32_32x32x16_bf16 v[160:175], v[128:131], v[16:19], v[160:175]
v_mfma_f32_32x32x16_bf16 v[176:191], v[136:139], v[16:19], v[176:191]
ds_read_b64_tr_b16 v[40:41], v3 offset:4096
ds_read_b64_tr_b16 v[42:43], v3 offset:5120
s_waitcnt lgkmcnt(10)
v_mfma_f32_32x32x16_bf16 v[160:175], v[132:135], v[20:23], v[160:175]
v_mfma_f32_32x32x16_bf16 v[176:191], v[140:143], v[20:23], v[176:191]
ds_read_b64_tr_b16 v[44:45], v3 offset:6144
ds_read_b64_tr_b16 v[46:47], v3 offset:7168
s_waitcnt lgkmcnt(10)
v_mfma_f32_32x32x16_bf16 v[160:175], v[144:147], v[24:27], v[160:175]
v_mfma_f32_32x32x16_bf16 v[176:191], v[152:155], v[24:27], v[176:191]
ds_read_b64_tr_b16 v[16:17], v3 offset:8192
ds_read_b64_tr_b16 v[18:19], v3 offset:9216
s_waitcnt lgkmcnt(10)
v_mfma_f32_32x32x16_bf16 v[160:175], v[148:151], v[28:31], v[160:175]
v_mfma_f32_32x32x16_bf16 v[176:191], v[156:159], v[28:31], v[176:191]
ds_read_b64_tr_b16 v[20:21], v3 offset:10240
ds_read_b64_tr_b16 v[22:23], v3 offset:11264
s_waitcnt lgkmcnt(10)
v_mfma_f32_32x32x16_bf16 v[192:207], v[64:67], v[32:35], 0
v_mfma_f32_32x32x16_bf16 v[208:223], v[72:75], v[32:35], 0
ds_read_b64_tr_b16 v[24:25], v3 offset:12288
ds_read_b64_tr_b16 v[26:27], v3 offset:13312
s_waitcnt lgkmcnt(10)
v_mfma_f32_32x32x16_bf16 v[192:207], v[68:71], v[36:39], v[192:207]
v_mfma_f32_32x32x16_bf16 v[208:223], v[76:79], v[36:39], v[208:223]
ds_read_b64_tr_b16 v[28:29], v3 offset:14336
ds_read_b64_tr_b16 v[30:31], v3 offset:15360
s_waitcnt lgkmcnt(10)
v_mfma_f32_32x32x16_bf16 v[192:207], v[80:83], v[40:43], v[192:207]
s_add_u32 s65, s58, 0
v_cvt_pk_bf16_f32 v48, v160, v161
v_mfma_f32_32x32x16_bf16 v[208:223], v[88:91], v[40:43], v[208:223]
v_cvt_pk_bf16_f32 v49, v162, v163
v_cvt_pk_bf16_f32 v50, v164, v165
ds_read_b64_tr_b16 v[32:33], v3 offset:16384
ds_read_b64_tr_b16 v[34:35], v3 offset:17408
s_waitcnt lgkmcnt(10)
v_mfma_f32_32x32x16_bf16 v[192:207], v[84:87], v[44:47], v[192:207]
v_cvt_pk_bf16_f32 v51, v166, v167
buffer_store_dwordx4 v[48:51], v14, s[4:7], s65 offen offset:0 sc1
v_mfma_f32_32x32x16_bf16 v[208:223], v[92:95], v[44:47], v[208:223]
v_cvt_pk_bf16_f32 v52, v168, v169
v_cvt_pk_bf16_f32 v53, v170, v171
ds_read_b64_tr_b16 v[36:37], v3 offset:18432
ds_read_b64_tr_b16 v[38:39], v3 offset:19456
s_waitcnt lgkmcnt(10)
v_mfma_f32_32x32x16_bf16 v[192:207], v[96:99], v[16:19], v[192:207]
v_cvt_pk_bf16_f32 v54, v172, v173
v_cvt_pk_bf16_f32 v55, v174, v175
v_mfma_f32_32x32x16_bf16 v[208:223], v[104:107], v[16:19], v[208:223]
buffer_store_dwordx4 v[52:55], v14, s[4:7], s65 offen offset:512 sc1
s_add_u32 s66, s58, 1310720
ds_read_b64_tr_b16 v[40:41], v3 offset:20480
ds_read_b64_tr_b16 v[42:43], v3 offset:21504
s_waitcnt lgkmcnt(10)
v_mfma_f32_32x32x16_bf16 v[192:207], v[100:103], v[20:23], v[192:207]
v_cvt_pk_bf16_f32 v56, v176, v177
v_cvt_pk_bf16_f32 v57, v178, v179
v_mfma_f32_32x32x16_bf16 v[208:223], v[108:111], v[20:23], v[208:223]
v_cvt_pk_bf16_f32 v58, v180, v181
v_cvt_pk_bf16_f32 v59, v182, v183
ds_read_b64_tr_b16 v[44:45], v3 offset:22528
ds_read_b64_tr_b16 v[46:47], v3 offset:23552
s_waitcnt lgkmcnt(10)
v_mfma_f32_32x32x16_bf16 v[192:207], v[112:115], v[24:27], v[192:207]
buffer_store_dwordx4 v[56:59], v14, s[4:7], s66 offen offset:0 sc1
v_cvt_pk_bf16_f32 v60, v184, v185
v_mfma_f32_32x32x16_bf16 v[208:223], v[120:123], v[24:27], v[208:223]
v_cvt_pk_bf16_f32 v61, v186, v187
v_cvt_pk_bf16_f32 v62, v188, v189
s_waitcnt vmcnt(9)
s_barrier
s_add_u32 s43, s56, 384
s_add_u32 m0, s62, 73728
s_nop 0
buffer_load_dwordx4 v4, s[12:15], s43 offen lds
s_add_u32 s43, s56, 10624
s_add_u32 m0, s62, 74752
s_nop 0
buffer_load_dwordx4 v4, s[12:15], s43 offen lds
s_add_u32 s43, s56, 20864
s_add_u32 m0, s62, 75776
s_nop 0
buffer_load_dwordx4 v4, s[12:15], s43 offen lds
s_add_u32 s43, s56, 31104
s_add_u32 m0, s62, 76800
s_nop 0
buffer_load_dwordx4 v4, s[12:15], s43 offen lds
s_add_u32 s43, s56, 41344
s_add_u32 m0, s62, 77824
s_nop 0
buffer_load_dwordx4 v4, s[12:15], s43 offen lds
s_add_u32 s43, s56, 51584
s_add_u32 m0, s62, 78848
s_nop 0
buffer_load_dwordx4 v4, s[12:15], s43 offen lds
ds_read_b64_tr_b16 v[16:17], v2 offset:24576
ds_read_b64_tr_b16 v[18:19], v2 offset:25600
s_waitcnt lgkmcnt(10)
v_mfma_f32_32x32x16_bf16 v[192:207], v[116:119], v[28:31], v[192:207]
v_cvt_pk_bf16_f32 v63, v190, v191
buffer_store_dwordx4 v[60:63], v14, s[4:7], s66 offen offset:512 sc1
v_mfma_f32_32x32x16_bf16 v[208:223], v[124:127], v[28:31], v[208:223]
ds_read_b64_tr_b16 v[20:21], v2 offset:26624
ds_read_b64_tr_b16 v[22:23], v2 offset:27648
s_waitcnt lgkmcnt(10)
v_mfma_f32_32x32x16_bf16 v[192:207], v[128:131], v[32:35], v[192:207]
v_mfma_f32_32x32x16_bf16 v[208:223], v[136:139], v[32:35], v[208:223]
ds_read_b64_tr_b16 v[24:25], v2 offset:28672
ds_read_b64_tr_b16 v[26:27], v2 offset:29696
s_waitcnt lgkmcnt(10)
v_mfma_f32_32x32x16_bf16 v[192:207], v[132:135], v[36:39], v[192:207]
v_mfma_f32_32x32x16_bf16 v[208:223], v[140:143], v[36:39], v[208:223]
ds_read_b64_tr_b16 v[28:29], v2 offset:30720
ds_read_b64_tr_b16 v[30:31], v2 offset:31744
s_waitcnt lgkmcnt(10)
v_mfma_f32_32x32x16_bf16 v[192:207], v[144:147], v[40:43], v[192:207]
v_mfma_f32_32x32x16_bf16 v[208:223], v[152:155], v[40:43], v[208:223]
ds_read_b64_tr_b16 v[32:33], v2 offset:32768
ds_read_b64_tr_b16 v[34:35], v2 offset:33792
s_waitcnt lgkmcnt(10)
v_mfma_f32_32x32x16_bf16 v[192:207], v[148:151], v[44:47], v[192:207]
v_mfma_f32_32x32x16_bf16 v[208:223], v[156:159], v[44:47], v[208:223]
ds_read_b64_tr_b16 v[36:37], v2 offset:34816
ds_read_b64_tr_b16 v[38:39], v2 offset:35840
s_waitcnt lgkmcnt(10)
v_mfma_f32_32x32x16_bf16 v[160:175], v[64:67], v[16:19], 0
v_mfma_f32_32x32x16_bf16 v[176:191], v[72:75], v[16:19], 0
ds_read_b64_tr_b16 v[40:41], v2 offset:36864
ds_read_b64_tr_b16 v[42:43], v2 offset:37888
s_waitcnt lgkmcnt(10)
v_mfma_f32_32x32x16_bf16 v[160:175], v[68:71], v[20:23], v[160:175]
v_mfma_f32_32x32x16_bf16 v[176:191], v[76:79], v[20:23], v[176:191]
ds_read_b64_tr_b16 v[44:45], v2 offset:38912
ds_read_b64_tr_b16 v[46:47], v2 offset:39936
s_waitcnt lgkmcnt(10)
v_mfma_f32_32x32x16_bf16 v[160:175], v[80:83], v[24:27], v[160:175]
s_add_u32 s65, s58, 65536
v_cvt_pk_bf16_f32 v48, v192, v193
v_mfma_f32_32x32x16_bf16 v[176:191], v[88:91], v[24:27], v[176:191]
v_cvt_pk_bf16_f32 v49, v194, v195
v_cvt_pk_bf16_f32 v50, v196, v197
ds_read_b64_tr_b16 v[16:17], v2 offset:40960
ds_read_b64_tr_b16 v[18:19], v2 offset:41984
s_waitcnt lgkmcnt(10)
v_mfma_f32_32x32x16_bf16 v[160:175], v[84:87], v[28:31], v[160:175]
v_cvt_pk_bf16_f32 v51, v198, v199
buffer_store_dwordx4 v[48:51], v14, s[4:7], s65 offen offset:0 sc1
v_mfma_f32_32x32x16_bf16 v[176:191], v[92:95], v[28:31], v[176:191]
v_cvt_pk_bf16_f32 v52, v200, v201
v_cvt_pk_bf16_f32 v53, v202, v203
ds_read_b64_tr_b16 v[20:21], v2 offset:43008
ds_read_b64_tr_b16 v[22:23], v2 offset:44032
s_waitcnt lgkmcnt(10)
v_mfma_f32_32x32x16_bf16 v[160:175], v[96:99], v[32:35], v[160:175]
v_cvt_pk_bf16_f32 v54, v204, v205
v_cvt_pk_bf16_f32 v55, v206, v207
v_mfma_f32_32x32x16_bf16 v[176:191], v[104:107], v[32:35], v[176:191]
buffer_store_dwordx4 v[52:55], v14, s[4:7], s65 offen offset:512 sc1
s_add_u32 s66, s58, 1376256
ds_read_b64_tr_b16 v[24:25], v2 offset:45056
ds_read_b64_tr_b16 v[26:27], v2 offset:46080
s_waitcnt lgkmcnt(10)
v_mfma_f32_32x32x16_bf16 v[160:175], v[100:103], v[36:39], v[160:175]
v_cvt_pk_bf16_f32 v56, v208, v209
v_cvt_pk_bf16_f32 v57, v210, v211
v_mfma_f32_32x32x16_bf16 v[176:191], v[108:111], v[36:39], v[176:191]
v_cvt_pk_bf16_f32 v58, v212, v213
v_cvt_pk_bf16_f32 v59, v214, v215
ds_read_b64_tr_b16 v[28:29], v2 offset:47104
ds_read_b64_tr_b16 v[30:31], v2 offset:48128
s_waitcnt lgkmcnt(10)
v_mfma_f32_32x32x16_bf16 v[160:175], v[112:115], v[40:43], v[160:175]
buffer_store_dwordx4 v[56:59], v14, s[4:7], s66 offen offset:0 sc1
v_cvt_pk_bf16_f32 v60, v216, v217
v_mfma_f32_32x32x16_bf16 v[176:191], v[120:123], v[40:43], v[176:191]
v_cvt_pk_bf16_f32 v61, v218, v219
v_cvt_pk_bf16_f32 v62, v220, v221
ds_read_b64_tr_b16 v[32:33], v3 offset:24576
ds_read_b64_tr_b16 v[34:35], v3 offset:25600
s_waitcnt lgkmcnt(10)
v_mfma_f32_32x32x16_bf16 v[160:175], v[116:119], v[44:47], v[160:175]
v_cvt_pk_bf16_f32 v63, v222, v223
buffer_store_dwordx4 v[60:63], v14, s[4:7], s66 offen offset:512 sc1
v_mfma_f32_32x32x16_bf16 v[176:191], v[124:127], v[44:47], v[176:191]
ds_read_b64_tr_b16 v[36:37], v3 offset:26624
ds_read_b64_tr_b16 v[38:39], v3 offset:27648
s_waitcnt lgkmcnt(10)
v_mfma_f32_32x32x16_bf16 v[160:175], v[128:131], v[16:19], v[160:175]
v_mfma_f32_32x32x16_bf16 v[176:191], v[136:139], v[16:19], v[176:191]
ds_read_b64_tr_b16 v[40:41], v3 offset:28672
ds_read_b64_tr_b16 v[42:43], v3 offset:29696
s_waitcnt lgkmcnt(10)
v_mfma_f32_32x32x16_bf16 v[160:175], v[132:135], v[20:23], v[160:175]
v_mfma_f32_32x32x16_bf16 v[176:191], v[140:143], v[20:23], v[176:191]
ds_read_b64_tr_b16 v[44:45], v3 offset:30720
ds_read_b64_tr_b16 v[46:47], v3 offset:31744
s_waitcnt lgkmcnt(10)
v_mfma_f32_32x32x16_bf16 v[160:175], v[144:147], v[24:27], v[160:175]
v_mfma_f32_32x32x16_bf16 v[176:191], v[152:155], v[24:27], v[176:191]
ds_read_b64_tr_b16 v[16:17], v3 offset:32768
ds_read_b64_tr_b16 v[18:19], v3 offset:33792
s_waitcnt lgkmcnt(10)
v_mfma_f32_32x32x16_bf16 v[160:175], v[148:151], v[28:31], v[160:175]
v_mfma_f32_32x32x16_bf16 v[176:191], v[156:159], v[28:31], v[176:191]
ds_read_b64_tr_b16 v[20:21], v3 offset:34816
ds_read_b64_tr_b16 v[22:23], v3 offset:35840
s_waitcnt lgkmcnt(10)
v_mfma_f32_32x32x16_bf16 v[192:207], v[64:67], v[32:35], 0
v_mfma_f32_32x32x16_bf16 v[208:223], v[72:75], v[32:35], 0
ds_read_b64_tr_b16 v[24:25], v3 offset:36864
ds_read_b64_tr_b16 v[26:27], v3 offset:37888
s_waitcnt lgkmcnt(10)
v_mfma_f32_32x32x16_bf16 v[192:207], v[68:71], v[36:39], v[192:207]
v_mfma_f32_32x32x16_bf16 v[208:223], v[76:79], v[36:39], v[208:223]
ds_read_b64_tr_b16 v[28:29], v3 offset:38912
ds_read_b64_tr_b16 v[30:31], v3 offset:39936
s_waitcnt lgkmcnt(10)
v_mfma_f32_32x32x16_bf16 v[192:207], v[80:83], v[40:43], v[192:207]
s_add_u32 s65, s58, 131072
v_cvt_pk_bf16_f32 v48, v160, v161
v_mfma_f32_32x32x16_bf16 v[208:223], v[88:91], v[40:43], v[208:223]
v_cvt_pk_bf16_f32 v49, v162, v163
v_cvt_pk_bf16_f32 v50, v164, v165
ds_read_b64_tr_b16 v[32:33], v3 offset:40960
ds_read_b64_tr_b16 v[34:35], v3 offset:41984
s_waitcnt lgkmcnt(10)
v_mfma_f32_32x32x16_bf16 v[192:207], v[84:87], v[44:47], v[192:207]
v_cvt_pk_bf16_f32 v51, v166, v167
buffer_store_dwordx4 v[48:51], v14, s[4:7], s65 offen offset:0 sc1
v_mfma_f32_32x32x16_bf16 v[208:223], v[92:95], v[44:47], v[208:223]
v_cvt_pk_bf16_f32 v52, v168, v169
v_cvt_pk_bf16_f32 v53, v170, v171
ds_read_b64_tr_b16 v[36:37], v3 offset:43008
ds_read_b64_tr_b16 v[38:39], v3 offset:44032
s_waitcnt lgkmcnt(10)
v_mfma_f32_32x32x16_bf16 v[192:207], v[96:99], v[16:19], v[192:207]
v_cvt_pk_bf16_f32 v54, v172, v173
v_cvt_pk_bf16_f32 v55, v174, v175
v_mfma_f32_32x32x16_bf16 v[208:223], v[104:107], v[16:19], v[208:223]
buffer_store_dwordx4 v[52:55], v14, s[4:7], s65 offen offset:512 sc1
s_add_u32 s66, s58, 1441792
ds_read_b64_tr_b16 v[40:41], v3 offset:45056
ds_read_b64_tr_b16 v[42:43], v3 offset:46080
s_waitcnt lgkmcnt(10)
v_mfma_f32_32x32x16_bf16 v[192:207], v[100:103], v[20:23], v[192:207]
v_cvt_pk_bf16_f32 v56, v176, v177
v_cvt_pk_bf16_f32 v57, v178, v179
v_mfma_f32_32x32x16_bf16 v[208:223], v[108:111], v[20:23], v[208:223]
v_cvt_pk_bf16_f32 v58, v180, v181
v_cvt_pk_bf16_f32 v59, v182, v183
ds_read_b64_tr_b16 v[44:45], v3 offset:47104
ds_read_b64_tr_b16 v[46:47], v3 offset:48128
s_waitcnt lgkmcnt(10)
v_mfma_f32_32x32x16_bf16 v[192:207], v[112:115], v[24:27], v[192:207]
buffer_store_dwordx4 v[56:59], v14, s[4:7], s66 offen offset:0 sc1
v_cvt_pk_bf16_f32 v60, v184, v185
v_mfma_f32_32x32x16_bf16 v[208:223], v[120:123], v[24:27], v[208:223]
v_cvt_pk_bf16_f32 v61, v186, v187
v_cvt_pk_bf16_f32 v62, v188, v189
s_waitcnt vmcnt(17)
s_barrier
s_add_u32 s43, s56, 512
s_add_u32 m0, s62, 0
s_nop 0
buffer_load_dwordx4 v4, s[12:15], s43 offen lds
s_add_u32 s43, s56, 10752
s_add_u32 m0, s62, 1024
s_nop 0
buffer_load_dwordx4 v4, s[12:15], s43 offen lds
s_add_u32 s43, s56, 20992
s_add_u32 m0, s62, 2048
s_nop 0
buffer_load_dwordx4 v4, s[12:15], s43 offen lds
s_add_u32 s43, s56, 31232
s_add_u32 m0, s62, 3072
s_nop 0
buffer_load_dwordx4 v4, s[12:15], s43 offen lds
s_add_u32 s43, s56, 41472
s_add_u32 m0, s62, 4096
s_nop 0
buffer_load_dwordx4 v4, s[12:15], s43 offen lds
s_add_u32 s43, s56, 51712
s_add_u32 m0, s62, 5120
s_nop 0
buffer_load_dwordx4 v4, s[12:15], s43 offen lds
ds_read_b64_tr_b16 v[16:17], v13 offset:0
ds_read_b64_tr_b16 v[18:19], v13 offset:1024
s_waitcnt lgkmcnt(10)
v_mfma_f32_32x32x16_bf16 v[192:207], v[116:119], v[28:31], v[192:207]
v_cvt_pk_bf16_f32 v63, v190, v191
buffer_store_dwordx4 v[60:63], v14, s[4:7], s66 offen offset:512 sc1
v_mfma_f32_32x32x16_bf16 v[208:223], v[124:127], v[28:31], v[208:223]
ds_read_b64_tr_b16 v[20:21], v13 offset:2048
ds_read_b64_tr_b16 v[22:23], v13 offset:3072
s_waitcnt lgkmcnt(10)
v_mfma_f32_32x32x16_bf16 v[192:207], v[128:131], v[32:35], v[192:207]
v_mfma_f32_32x32x16_bf16 v[208:223], v[136:139], v[32:35], v[208:223]
ds_read_b64_tr_b16 v[24:25], v13 offset:4096
ds_read_b64_tr_b16 v[26:27], v13 offset:5120
s_waitcnt lgkmcnt(10)
v_mfma_f32_32x32x16_bf16 v[192:207], v[132:135], v[36:39], v[192:207]
v_mfma_f32_32x32x16_bf16 v[208:223], v[140:143], v[36:39], v[208:223]
ds_read_b64_tr_b16 v[28:29], v13 offset:6144
ds_read_b64_tr_b16 v[30:31], v13 offset:7168
s_waitcnt lgkmcnt(10)
v_mfma_f32_32x32x16_bf16 v[192:207], v[144:147], v[40:43], v[192:207]
v_mfma_f32_32x32x16_bf16 v[208:223], v[152:155], v[40:43], v[208:223]
ds_read_b64_tr_b16 v[32:33], v13 offset:8192
ds_read_b64_tr_b16 v[34:35], v13 offset:9216
s_waitcnt lgkmcnt(10)
v_mfma_f32_32x32x16_bf16 v[192:207], v[148:151], v[44:47], v[192:207]
v_mfma_f32_32x32x16_bf16 v[208:223], v[156:159], v[44:47], v[208:223]
ds_read_b64_tr_b16 v[36:37], v13 offset:10240
ds_read_b64_tr_b16 v[38:39], v13 offset:11264
s_waitcnt lgkmcnt(10)
v_mfma_f32_32x32x16_bf16 v[160:175], v[64:67], v[16:19], 0
v_mfma_f32_32x32x16_bf16 v[176:191], v[72:75], v[16:19], 0
ds_read_b64_tr_b16 v[40:41], v13 offset:12288
ds_read_b64_tr_b16 v[42:43], v13 offset:13312
s_waitcnt lgkmcnt(10)
v_mfma_f32_32x32x16_bf16 v[160:175], v[68:71], v[20:23], v[160:175]
v_mfma_f32_32x32x16_bf16 v[176:191], v[76:79], v[20:23], v[176:191]
ds_read_b64_tr_b16 v[44:45], v13 offset:14336
ds_read_b64_tr_b16 v[46:47], v13 offset:15360
s_waitcnt lgkmcnt(10)
v_mfma_f32_32x32x16_bf16 v[160:175], v[80:83], v[24:27], v[160:175]
s_add_u32 s65, s58, 196608
v_cvt_pk_bf16_f32 v48, v192, v193
v_mfma_f32_32x32x16_bf16 v[176:191], v[88:91], v[24:27], v[176:191]
v_cvt_pk_bf16_f32 v49, v194, v195
v_cvt_pk_bf16_f32 v50, v196, v197
ds_read_b64_tr_b16 v[16:17], v13 offset:16384
ds_read_b64_tr_b16 v[18:19], v13 offset:17408
s_waitcnt lgkmcnt(10)
v_mfma_f32_32x32x16_bf16 v[160:175], v[84:87], v[28:31], v[160:175]
v_cvt_pk_bf16_f32 v51, v198, v199
buffer_store_dwordx4 v[48:51], v14, s[4:7], s65 offen offset:0 sc1
v_mfma_f32_32x32x16_bf16 v[176:191], v[92:95], v[28:31], v[176:191]
v_cvt_pk_bf16_f32 v52, v200, v201
v_cvt_pk_bf16_f32 v53, v202, v203
ds_read_b64_tr_b16 v[20:21], v13 offset:18432
ds_read_b64_tr_b16 v[22:23], v13 offset:19456
s_waitcnt lgkmcnt(10)
v_mfma_f32_32x32x16_bf16 v[160:175], v[96:99], v[32:35], v[160:175]
v_cvt_pk_bf16_f32 v54, v204, v205
v_cvt_pk_bf16_f32 v55, v206, v207
v_mfma_f32_32x32x16_bf16 v[176:191], v[104:107], v[32:35], v[176:191]
buffer_store_dwordx4 v[52:55], v14, s[4:7], s65 offen offset:512 sc1
s_add_u32 s66, s58, 1507328
ds_read_b64_tr_b16 v[24:25], v13 offset:20480
ds_read_b64_tr_b16 v[26:27], v13 offset:21504
s_waitcnt lgkmcnt(10)
v_mfma_f32_32x32x16_bf16 v[160:175], v[100:103], v[36:39], v[160:175]
v_cvt_pk_bf16_f32 v56, v208, v209
v_cvt_pk_bf16_f32 v57, v210, v211
v_mfma_f32_32x32x16_bf16 v[176:191], v[108:111], v[36:39], v[176:191]
v_cvt_pk_bf16_f32 v58, v212, v213
v_cvt_pk_bf16_f32 v59, v214, v215
ds_read_b64_tr_b16 v[28:29], v13 offset:22528
ds_read_b64_tr_b16 v[30:31], v13 offset:23552
s_waitcnt lgkmcnt(10)
v_mfma_f32_32x32x16_bf16 v[160:175], v[112:115], v[40:43], v[160:175]
buffer_store_dwordx4 v[56:59], v14, s[4:7], s66 offen offset:0 sc1
v_cvt_pk_bf16_f32 v60, v216, v217
v_mfma_f32_32x32x16_bf16 v[176:191], v[120:123], v[40:43], v[176:191]
v_cvt_pk_bf16_f32 v61, v218, v219
v_cvt_pk_bf16_f32 v62, v220, v221
ds_read_b64_tr_b16 v[32:33], v15 offset:0
ds_read_b64_tr_b16 v[34:35], v15 offset:1024
s_waitcnt lgkmcnt(10)
v_mfma_f32_32x32x16_bf16 v[160:175], v[116:119], v[44:47], v[160:175]
v_cvt_pk_bf16_f32 v63, v222, v223
buffer_store_dwordx4 v[60:63], v14, s[4:7], s66 offen offset:512 sc1
v_mfma_f32_32x32x16_bf16 v[176:191], v[124:127], v[44:47], v[176:191]
ds_read_b64_tr_b16 v[36:37], v15 offset:2048
ds_read_b64_tr_b16 v[38:39], v15 offset:3072
s_waitcnt lgkmcnt(10)
v_mfma_f32_32x32x16_bf16 v[160:175], v[128:131], v[16:19], v[160:175]
v_mfma_f32_32x32x16_bf16 v[176:191], v[136:139], v[16:19], v[176:191]
ds_read_b64_tr_b16 v[40:41], v15 offset:4096
ds_read_b64_tr_b16 v[42:43], v15 offset:5120
s_waitcnt lgkmcnt(10)
v_mfma_f32_32x32x16_bf16 v[160:175], v[132:135], v[20:23], v[160:175]
v_mfma_f32_32x32x16_bf16 v[176:191], v[140:143], v[20:23], v[176:191]
ds_read_b64_tr_b16 v[44:45], v15 offset:6144
ds_read_b64_tr_b16 v[46:47], v15 offset:7168
s_waitcnt lgkmcnt(10)
v_mfma_f32_32x32x16_bf16 v[160:175], v[144:147], v[24:27], v[160:175]
v_mfma_f32_32x32x16_bf16 v[176:191], v[152:155], v[24:27], v[176:191]
ds_read_b64_tr_b16 v[16:17], v15 offset:8192
ds_read_b64_tr_b16 v[18:19], v15 offset:9216
s_waitcnt lgkmcnt(10)
v_mfma_f32_32x32x16_bf16 v[160:175], v[148:151], v[28:31], v[160:175]
v_mfma_f32_32x32x16_bf16 v[176:191], v[156:159], v[28:31], v[176:191]
ds_read_b64_tr_b16 v[20:21], v15 offset:10240
ds_read_b64_tr_b16 v[22:23], v15 offset:11264
s_waitcnt lgkmcnt(10)
v_mfma_f32_32x32x16_bf16 v[192:207], v[64:67], v[32:35], 0
v_mfma_f32_32x32x16_bf16 v[208:223], v[72:75], v[32:35], 0
ds_read_b64_tr_b16 v[24:25], v15 offset:12288
ds_read_b64_tr_b16 v[26:27], v15 offset:13312
s_waitcnt lgkmcnt(10)
v_mfma_f32_32x32x16_bf16 v[192:207], v[68:71], v[36:39], v[192:207]
v_mfma_f32_32x32x16_bf16 v[208:223], v[76:79], v[36:39], v[208:223]
ds_read_b64_tr_b16 v[28:29], v15 offset:14336
ds_read_b64_tr_b16 v[30:31], v15 offset:15360
s_waitcnt lgkmcnt(10)
v_mfma_f32_32x32x16_bf16 v[192:207], v[80:83], v[40:43], v[192:207]
s_add_u32 s65, s58, 262144
v_cvt_pk_bf16_f32 v48, v160, v161
v_mfma_f32_32x32x16_bf16 v[208:223], v[88:91], v[40:43], v[208:223]
v_cvt_pk_bf16_f32 v49, v162, v163
v_cvt_pk_bf16_f32 v50, v164, v165
ds_read_b64_tr_b16 v[32:33], v15 offset:16384
ds_read_b64_tr_b16 v[34:35], v15 offset:17408
s_waitcnt lgkmcnt(10)
v_mfma_f32_32x32x16_bf16 v[192:207], v[84:87], v[44:47], v[192:207]
v_cvt_pk_bf16_f32 v51, v166, v167
buffer_store_dwordx4 v[48:51], v14, s[4:7], s65 offen offset:0 sc1
v_mfma_f32_32x32x16_bf16 v[208:223], v[92:95], v[44:47], v[208:223]
v_cvt_pk_bf16_f32 v52, v168, v169
v_cvt_pk_bf16_f32 v53, v170, v171
ds_read_b64_tr_b16 v[36:37], v15 offset:18432
ds_read_b64_tr_b16 v[38:39], v15 offset:19456
s_waitcnt lgkmcnt(10)
v_mfma_f32_32x32x16_bf16 v[192:207], v[96:99], v[16:19], v[192:207]
v_cvt_pk_bf16_f32 v54, v172, v173
v_cvt_pk_bf16_f32 v55, v174, v175
v_mfma_f32_32x32x16_bf16 v[208:223], v[104:107], v[16:19], v[208:223]
buffer_store_dwordx4 v[52:55], v14, s[4:7], s65 offen offset:512 sc1
s_add_u32 s66, s58, 1572864
ds_read_b64_tr_b16 v[40:41], v15 offset:20480
ds_read_b64_tr_b16 v[42:43], v15 offset:21504
s_waitcnt lgkmcnt(10)
v_mfma_f32_32x32x16_bf16 v[192:207], v[100:103], v[20:23], v[192:207]
v_cvt_pk_bf16_f32 v56, v176, v177
v_cvt_pk_bf16_f32 v57, v178, v179
v_mfma_f32_32x32x16_bf16 v[208:223], v[108:111], v[20:23], v[208:223]
v_cvt_pk_bf16_f32 v58, v180, v181
v_cvt_pk_bf16_f32 v59, v182, v183
ds_read_b64_tr_b16 v[44:45], v15 offset:22528
ds_read_b64_tr_b16 v[46:47], v15 offset:23552
s_waitcnt lgkmcnt(10)
v_mfma_f32_32x32x16_bf16 v[192:207], v[112:115], v[24:27], v[192:207]
buffer_store_dwordx4 v[56:59], v14, s[4:7], s66 offen offset:0 sc1
v_cvt_pk_bf16_f32 v60, v184, v185
v_mfma_f32_32x32x16_bf16 v[208:223], v[120:123], v[24:27], v[208:223]
v_cvt_pk_bf16_f32 v61, v186, v187
v_cvt_pk_bf16_f32 v62, v188, v189
s_waitcnt vmcnt(22)
s_barrier
s_add_u32 s43, s56, 640
s_add_u32 m0, s62, 24576
s_nop 0
buffer_load_dwordx4 v4, s[12:15], s43 offen lds
s_add_u32 s43, s56, 10880
s_add_u32 m0, s62, 25600
s_nop 0
buffer_load_dwordx4 v4, s[12:15], s43 offen lds
s_add_u32 s43, s56, 21120
s_add_u32 m0, s62, 26624
s_nop 0
buffer_load_dwordx4 v4, s[12:15], s43 offen lds
s_add_u32 s43, s56, 31360
s_add_u32 m0, s62, 27648
s_nop 0
buffer_load_dwordx4 v4, s[12:15], s43 offen lds
s_add_u32 s43, s56, 41600
s_add_u32 m0, s62, 28672
s_nop 0
buffer_load_dwordx4 v4, s[12:15], s43 offen lds
s_add_u32 s43, s56, 51840
s_add_u32 m0, s62, 29696
s_nop 0
buffer_load_dwordx4 v4, s[12:15], s43 offen lds
ds_read_b64_tr_b16 v[16:17], v13 offset:24576
ds_read_b64_tr_b16 v[18:19], v13 offset:25600
s_waitcnt lgkmcnt(10)
v_mfma_f32_32x32x16_bf16 v[192:207], v[116:119], v[28:31], v[192:207]
v_cvt_pk_bf16_f32 v63, v190, v191
buffer_store_dwordx4 v[60:63], v14, s[4:7], s66 offen offset:512 sc1
v_mfma_f32_32x32x16_bf16 v[208:223], v[124:127], v[28:31], v[208:223]
ds_read_b64_tr_b16 v[20:21], v13 offset:26624
ds_read_b64_tr_b16 v[22:23], v13 offset:27648
s_waitcnt lgkmcnt(10)
v_mfma_f32_32x32x16_bf16 v[192:207], v[128:131], v[32:35], v[192:207]
v_mfma_f32_32x32x16_bf16 v[208:223], v[136:139], v[32:35], v[208:223]
ds_read_b64_tr_b16 v[24:25], v13 offset:28672
ds_read_b64_tr_b16 v[26:27], v13 offset:29696
s_waitcnt lgkmcnt(10)
v_mfma_f32_32x32x16_bf16 v[192:207], v[132:135], v[36:39], v[192:207]
v_mfma_f32_32x32x16_bf16 v[208:223], v[140:143], v[36:39], v[208:223]
ds_read_b64_tr_b16 v[28:29], v13 offset:30720
ds_read_b64_tr_b16 v[30:31], v13 offset:31744
s_waitcnt lgkmcnt(10)
v_mfma_f32_32x32x16_bf16 v[192:207], v[144:147], v[40:43], v[192:207]
v_mfma_f32_32x32x16_bf16 v[208:223], v[152:155], v[40:43], v[208:223]
ds_read_b64_tr_b16 v[32:33], v13 offset:32768
ds_read_b64_tr_b16 v[34:35], v13 offset:33792
s_waitcnt lgkmcnt(10)
v_mfma_f32_32x32x16_bf16 v[192:207], v[148:151], v[44:47], v[192:207]
v_mfma_f32_32x32x16_bf16 v[208:223], v[156:159], v[44:47], v[208:223]
ds_read_b64_tr_b16 v[36:37], v13 offset:34816
ds_read_b64_tr_b16 v[38:39], v13 offset:35840
s_waitcnt lgkmcnt(10)
v_mfma_f32_32x32x16_bf16 v[160:175], v[64:67], v[16:19], 0
v_mfma_f32_32x32x16_bf16 v[176:191], v[72:75], v[16:19], 0
ds_read_b64_tr_b16 v[40:41], v13 offset:36864
ds_read_b64_tr_b16 v[42:43], v13 offset:37888
s_waitcnt lgkmcnt(10)
v_mfma_f32_32x32x16_bf16 v[160:175], v[68:71], v[20:23], v[160:175]
v_mfma_f32_32x32x16_bf16 v[176:191], v[76:79], v[20:23], v[176:191]
ds_read_b64_tr_b16 v[44:45], v13 offset:38912
ds_read_b64_tr_b16 v[46:47], v13 offset:39936
s_waitcnt lgkmcnt(10)
v_mfma_f32_32x32x16_bf16 v[160:175], v[80:83], v[24:27], v[160:175]
s_add_u32 s65, s58, 327680
v_cvt_pk_bf16_f32 v48, v192, v193
v_mfma_f32_32x32x16_bf16 v[176:191], v[88:91], v[24:27], v[176:191]
v_cvt_pk_bf16_f32 v49, v194, v195
v_cvt_pk_bf16_f32 v50, v196, v197
ds_read_b64_tr_b16 v[16:17], v13 offset:40960
ds_read_b64_tr_b16 v[18:19], v13 offset:41984
s_waitcnt lgkmcnt(10)
v_mfma_f32_32x32x16_bf16 v[160:175], v[84:87], v[28:31], v[160:175]
v_cvt_pk_bf16_f32 v51, v198, v199
buffer_store_dwordx4 v[48:51], v14, s[4:7], s65 offen offset:0 sc1
v_mfma_f32_32x32x16_bf16 v[176:191], v[92:95], v[28:31], v[176:191]
v_cvt_pk_bf16_f32 v52, v200, v201
v_cvt_pk_bf16_f32 v53, v202, v203
ds_read_b64_tr_b16 v[20:21], v13 offset:43008
ds_read_b64_tr_b16 v[22:23], v13 offset:44032
s_waitcnt lgkmcnt(10)
v_mfma_f32_32x32x16_bf16 v[160:175], v[96:99], v[32:35], v[160:175]
v_cvt_pk_bf16_f32 v54, v204, v205
v_cvt_pk_bf16_f32 v55, v206, v207
v_mfma_f32_32x32x16_bf16 v[176:191], v[104:107], v[32:35], v[176:191]
buffer_store_dwordx4 v[52:55], v14, s[4:7], s65 offen offset:512 sc1
s_add_u32 s66, s58, 1638400
ds_read_b64_tr_b16 v[24:25], v13 offset:45056
ds_read_b64_tr_b16 v[26:27], v13 offset:46080
s_waitcnt lgkmcnt(10)
v_mfma_f32_32x32x16_bf16 v[160:175], v[100:103], v[36:39], v[160:175]
v_cvt_pk_bf16_f32 v56, v208, v209
v_cvt_pk_bf16_f32 v57, v210, v211
v_mfma_f32_32x32x16_bf16 v[176:191], v[108:111], v[36:39], v[176:191]
v_cvt_pk_bf16_f32 v58, v212, v213
v_cvt_pk_bf16_f32 v59, v214, v215
ds_read_b64_tr_b16 v[28:29], v13 offset:47104
ds_read_b64_tr_b16 v[30:31], v13 offset:48128
s_waitcnt lgkmcnt(10)
v_mfma_f32_32x32x16_bf16 v[160:175], v[112:115], v[40:43], v[160:175]
buffer_store_dwordx4 v[56:59], v14, s[4:7], s66 offen offset:0 sc1
v_cvt_pk_bf16_f32 v60, v216, v217
v_mfma_f32_32x32x16_bf16 v[176:191], v[120:123], v[40:43], v[176:191]
v_cvt_pk_bf16_f32 v61, v218, v219
v_cvt_pk_bf16_f32 v62, v220, v221
ds_read_b64_tr_b16 v[32:33], v15 offset:24576
ds_read_b64_tr_b16 v[34:35], v15 offset:25600
s_waitcnt lgkmcnt(10)
v_mfma_f32_32x32x16_bf16 v[160:175], v[116:119], v[44:47], v[160:175]
v_cvt_pk_bf16_f32 v63, v222, v223
buffer_store_dwordx4 v[60:63], v14, s[4:7], s66 offen offset:512 sc1
v_mfma_f32_32x32x16_bf16 v[176:191], v[124:127], v[44:47], v[176:191]
ds_read_b64_tr_b16 v[36:37], v15 offset:26624
ds_read_b64_tr_b16 v[38:39], v15 offset:27648
s_waitcnt lgkmcnt(10)
v_mfma_f32_32x32x16_bf16 v[160:175], v[128:131], v[16:19], v[160:175]
v_mfma_f32_32x32x16_bf16 v[176:191], v[136:139], v[16:19], v[176:191]
ds_read_b64_tr_b16 v[40:41], v15 offset:28672
ds_read_b64_tr_b16 v[42:43], v15 offset:29696
s_waitcnt lgkmcnt(10)
v_mfma_f32_32x32x16_bf16 v[160:175], v[132:135], v[20:23], v[160:175]
v_mfma_f32_32x32x16_bf16 v[176:191], v[140:143], v[20:23], v[176:191]
ds_read_b64_tr_b16 v[44:45], v15 offset:30720
ds_read_b64_tr_b16 v[46:47], v15 offset:31744
s_waitcnt lgkmcnt(10)
v_mfma_f32_32x32x16_bf16 v[160:175], v[144:147], v[24:27], v[160:175]
v_mfma_f32_32x32x16_bf16 v[176:191], v[152:155], v[24:27], v[176:191]
ds_read_b64_tr_b16 v[16:17], v15 offset:32768
ds_read_b64_tr_b16 v[18:19], v15 offset:33792
s_waitcnt lgkmcnt(10)
v_mfma_f32_32x32x16_bf16 v[160:175], v[148:151], v[28:31], v[160:175]
v_mfma_f32_32x32x16_bf16 v[176:191], v[156:159], v[28:31], v[176:191]
ds_read_b64_tr_b16 v[20:21], v15 offset:34816
ds_read_b64_tr_b16 v[22:23], v15 offset:35840
s_waitcnt lgkmcnt(10)
v_mfma_f32_32x32x16_bf16 v[192:207], v[64:67], v[32:35], 0
v_mfma_f32_32x32x16_bf16 v[208:223], v[72:75], v[32:35], 0
ds_read_b64_tr_b16 v[24:25], v15 offset:36864
ds_read_b64_tr_b16 v[26:27], v15 offset:37888
s_waitcnt lgkmcnt(10)
v_mfma_f32_32x32x16_bf16 v[192:207], v[68:71], v[36:39], v[192:207]
v_mfma_f32_32x32x16_bf16 v[208:223], v[76:79], v[36:39], v[208:223]
ds_read_b64_tr_b16 v[28:29], v15 offset:38912
ds_read_b64_tr_b16 v[30:31], v15 offset:39936
s_waitcnt lgkmcnt(10)
v_mfma_f32_32x32x16_bf16 v[192:207], v[80:83], v[40:43], v[192:207]
s_add_u32 s65, s58, 393216
v_cvt_pk_bf16_f32 v48, v160, v161
v_mfma_f32_32x32x16_bf16 v[208:223], v[88:91], v[40:43], v[208:223]
v_cvt_pk_bf16_f32 v49, v162, v163
v_cvt_pk_bf16_f32 v50, v164, v165
ds_read_b64_tr_b16 v[32:33], v15 offset:40960
ds_read_b64_tr_b16 v[34:35], v15 offset:41984
s_waitcnt lgkmcnt(10)
v_mfma_f32_32x32x16_bf16 v[192:207], v[84:87], v[44:47], v[192:207]
v_cvt_pk_bf16_f32 v51, v166, v167
buffer_store_dwordx4 v[48:51], v14, s[4:7], s65 offen offset:0 sc1
v_mfma_f32_32x32x16_bf16 v[208:223], v[92:95], v[44:47], v[208:223]
v_cvt_pk_bf16_f32 v52, v168, v169
v_cvt_pk_bf16_f32 v53, v170, v171
ds_read_b64_tr_b16 v[36:37], v15 offset:43008
ds_read_b64_tr_b16 v[38:39], v15 offset:44032
s_waitcnt lgkmcnt(10)
v_mfma_f32_32x32x16_bf16 v[192:207], v[96:99], v[16:19], v[192:207]
v_cvt_pk_bf16_f32 v54, v172, v173
v_cvt_pk_bf16_f32 v55, v174, v175
v_mfma_f32_32x32x16_bf16 v[208:223], v[104:107], v[16:19], v[208:223]
buffer_store_dwordx4 v[52:55], v14, s[4:7], s65 offen offset:512 sc1
s_add_u32 s66, s58, 1703936
ds_read_b64_tr_b16 v[40:41], v15 offset:45056
ds_read_b64_tr_b16 v[42:43], v15 offset:46080
s_waitcnt lgkmcnt(10)
v_mfma_f32_32x32x16_bf16 v[192:207], v[100:103], v[20:23], v[192:207]
v_cvt_pk_bf16_f32 v56, v176, v177
v_cvt_pk_bf16_f32 v57, v178, v179
v_mfma_f32_32x32x16_bf16 v[208:223], v[108:111], v[20:23], v[208:223]
v_cvt_pk_bf16_f32 v58, v180, v181
v_cvt_pk_bf16_f32 v59, v182, v183
ds_read_b64_tr_b16 v[44:45], v15 offset:47104
ds_read_b64_tr_b16 v[46:47], v15 offset:48128
s_waitcnt lgkmcnt(10)
v_mfma_f32_32x32x16_bf16 v[192:207], v[112:115], v[24:27], v[192:207]
buffer_store_dwordx4 v[56:59], v14, s[4:7], s66 offen offset:0 sc1
v_cvt_pk_bf16_f32 v60, v184, v185
v_mfma_f32_32x32x16_bf16 v[208:223], v[120:123], v[24:27], v[208:223]
v_cvt_pk_bf16_f32 v61, v186, v187
v_cvt_pk_bf16_f32 v62, v188, v189
s_waitcnt vmcnt(22)
s_barrier
s_add_u32 s43, s56, 768
s_add_u32 m0, s62, 49152
s_nop 0
buffer_load_dwordx4 v4, s[12:15], s43 offen lds
s_add_u32 s43, s56, 11008
s_add_u32 m0, s62, 50176
s_nop 0
buffer_load_dwordx4 v4, s[12:15], s43 offen lds
s_add_u32 s43, s56, 21248
s_add_u32 m0, s62, 51200
s_nop 0
buffer_load_dwordx4 v4, s[12:15], s43 offen lds
s_add_u32 s43, s56, 31488
s_add_u32 m0, s62, 52224
s_nop 0
buffer_load_dwordx4 v4, s[12:15], s43 offen lds
s_add_u32 s43, s56, 41728
s_add_u32 m0, s62, 53248
s_nop 0
buffer_load_dwordx4 v4, s[12:15], s43 offen lds
s_add_u32 s43, s56, 51968
s_add_u32 m0, s62, 54272
s_nop 0
buffer_load_dwordx4 v4, s[12:15], s43 offen lds
ds_read_b64_tr_b16 v[16:17], v2 offset:0
ds_read_b64_tr_b16 v[18:19], v2 offset:1024
s_waitcnt lgkmcnt(10)
v_mfma_f32_32x32x16_bf16 v[192:207], v[116:119], v[28:31], v[192:207]
v_cvt_pk_bf16_f32 v63, v190, v191
buffer_store_dwordx4 v[60:63], v14, s[4:7], s66 offen offset:512 sc1
v_mfma_f32_32x32x16_bf16 v[208:223], v[124:127], v[28:31], v[208:223]
ds_read_b64_tr_b16 v[20:21], v2 offset:2048
ds_read_b64_tr_b16 v[22:23], v2 offset:3072
s_waitcnt lgkmcnt(10)
v_mfma_f32_32x32x16_bf16 v[192:207], v[128:131], v[32:35], v[192:207]
v_mfma_f32_32x32x16_bf16 v[208:223], v[136:139], v[32:35], v[208:223]
ds_read_b64_tr_b16 v[24:25], v2 offset:4096
ds_read_b64_tr_b16 v[26:27], v2 offset:5120
s_waitcnt lgkmcnt(10)
v_mfma_f32_32x32x16_bf16 v[192:207], v[132:135], v[36:39], v[192:207]
v_mfma_f32_32x32x16_bf16 v[208:223], v[140:143], v[36:39], v[208:223]
ds_read_b64_tr_b16 v[28:29], v2 offset:6144
ds_read_b64_tr_b16 v[30:31], v2 offset:7168
s_waitcnt lgkmcnt(10)
v_mfma_f32_32x32x16_bf16 v[192:207], v[144:147], v[40:43], v[192:207]
v_mfma_f32_32x32x16_bf16 v[208:223], v[152:155], v[40:43], v[208:223]
ds_read_b64_tr_b16 v[32:33], v2 offset:8192
ds_read_b64_tr_b16 v[34:35], v2 offset:9216
s_waitcnt lgkmcnt(10)
v_mfma_f32_32x32x16_bf16 v[192:207], v[148:151], v[44:47], v[192:207]
v_mfma_f32_32x32x16_bf16 v[208:223], v[156:159], v[44:47], v[208:223]
ds_read_b64_tr_b16 v[36:37], v2 offset:10240
ds_read_b64_tr_b16 v[38:39], v2 offset:11264
s_waitcnt lgkmcnt(10)
v_mfma_f32_32x32x16_bf16 v[160:175], v[64:67], v[16:19], 0
v_mfma_f32_32x32x16_bf16 v[176:191], v[72:75], v[16:19], 0
ds_read_b64_tr_b16 v[40:41], v2 offset:12288
ds_read_b64_tr_b16 v[42:43], v2 offset:13312
s_waitcnt lgkmcnt(10)
v_mfma_f32_32x32x16_bf16 v[160:175], v[68:71], v[20:23], v[160:175]
v_mfma_f32_32x32x16_bf16 v[176:191], v[76:79], v[20:23], v[176:191]
ds_read_b64_tr_b16 v[44:45], v2 offset:14336
ds_read_b64_tr_b16 v[46:47], v2 offset:15360
s_waitcnt lgkmcnt(10)
v_mfma_f32_32x32x16_bf16 v[160:175], v[80:83], v[24:27], v[160:175]
s_add_u32 s65, s58, 458752
v_cvt_pk_bf16_f32 v48, v192, v193
v_mfma_f32_32x32x16_bf16 v[176:191], v[88:91], v[24:27], v[176:191]
v_cvt_pk_bf16_f32 v49, v194, v195
v_cvt_pk_bf16_f32 v50, v196, v197
ds_read_b64_tr_b16 v[16:17], v2 offset:16384
ds_read_b64_tr_b16 v[18:19], v2 offset:17408
s_waitcnt lgkmcnt(10)
v_mfma_f32_32x32x16_bf16 v[160:175], v[84:87], v[28:31], v[160:175]
v_cvt_pk_bf16_f32 v51, v198, v199
buffer_store_dwordx4 v[48:51], v14, s[4:7], s65 offen offset:0 sc1
v_mfma_f32_32x32x16_bf16 v[176:191], v[92:95], v[28:31], v[176:191]
v_cvt_pk_bf16_f32 v52, v200, v201
v_cvt_pk_bf16_f32 v53, v202, v203
ds_read_b64_tr_b16 v[20:21], v2 offset:18432
ds_read_b64_tr_b16 v[22:23], v2 offset:19456
s_waitcnt lgkmcnt(10)
v_mfma_f32_32x32x16_bf16 v[160:175], v[96:99], v[32:35], v[160:175]
v_cvt_pk_bf16_f32 v54, v204, v205
v_cvt_pk_bf16_f32 v55, v206, v207
v_mfma_f32_32x32x16_bf16 v[176:191], v[104:107], v[32:35], v[176:191]
buffer_store_dwordx4 v[52:55], v14, s[4:7], s65 offen offset:512 sc1
s_add_u32 s66, s58, 1769472
ds_read_b64_tr_b16 v[24:25], v2 offset:20480
ds_read_b64_tr_b16 v[26:27], v2 offset:21504
s_waitcnt lgkmcnt(10)
v_mfma_f32_32x32x16_bf16 v[160:175], v[100:103], v[36:39], v[160:175]
v_cvt_pk_bf16_f32 v56, v208, v209
v_cvt_pk_bf16_f32 v57, v210, v211
v_mfma_f32_32x32x16_bf16 v[176:191], v[108:111], v[36:39], v[176:191]
v_cvt_pk_bf16_f32 v58, v212, v213
v_cvt_pk_bf16_f32 v59, v214, v215
ds_read_b64_tr_b16 v[28:29], v2 offset:22528
ds_read_b64_tr_b16 v[30:31], v2 offset:23552
s_waitcnt lgkmcnt(10)
v_mfma_f32_32x32x16_bf16 v[160:175], v[112:115], v[40:43], v[160:175]
buffer_store_dwordx4 v[56:59], v14, s[4:7], s66 offen offset:0 sc1
v_cvt_pk_bf16_f32 v60, v216, v217
v_mfma_f32_32x32x16_bf16 v[176:191], v[120:123], v[40:43], v[176:191]
v_cvt_pk_bf16_f32 v61, v218, v219
v_cvt_pk_bf16_f32 v62, v220, v221
ds_read_b64_tr_b16 v[32:33], v3 offset:0
ds_read_b64_tr_b16 v[34:35], v3 offset:1024
s_waitcnt lgkmcnt(10)
v_mfma_f32_32x32x16_bf16 v[160:175], v[116:119], v[44:47], v[160:175]
v_cvt_pk_bf16_f32 v63, v222, v223
buffer_store_dwordx4 v[60:63], v14, s[4:7], s66 offen offset:512 sc1
v_mfma_f32_32x32x16_bf16 v[176:191], v[124:127], v[44:47], v[176:191]
ds_read_b64_tr_b16 v[36:37], v3 offset:2048
ds_read_b64_tr_b16 v[38:39], v3 offset:3072
s_waitcnt lgkmcnt(10)
v_mfma_f32_32x32x16_bf16 v[160:175], v[128:131], v[16:19], v[160:175]
v_mfma_f32_32x32x16_bf16 v[176:191], v[136:139], v[16:19], v[176:191]
ds_read_b64_tr_b16 v[40:41], v3 offset:4096
ds_read_b64_tr_b16 v[42:43], v3 offset:5120
s_waitcnt lgkmcnt(10)
v_mfma_f32_32x32x16_bf16 v[160:175], v[132:135], v[20:23], v[160:175]
v_mfma_f32_32x32x16_bf16 v[176:191], v[140:143], v[20:23], v[176:191]
ds_read_b64_tr_b16 v[44:45], v3 offset:6144
ds_read_b64_tr_b16 v[46:47], v3 offset:7168
s_waitcnt lgkmcnt(10)
v_mfma_f32_32x32x16_bf16 v[160:175], v[144:147], v[24:27], v[160:175]
v_mfma_f32_32x32x16_bf16 v[176:191], v[152:155], v[24:27], v[176:191]
ds_read_b64_tr_b16 v[16:17], v3 offset:8192
ds_read_b64_tr_b16 v[18:19], v3 offset:9216
s_waitcnt lgkmcnt(10)
v_mfma_f32_32x32x16_bf16 v[160:175], v[148:151], v[28:31], v[160:175]
v_mfma_f32_32x32x16_bf16 v[176:191], v[156:159], v[28:31], v[176:191]
ds_read_b64_tr_b16 v[20:21], v3 offset:10240
ds_read_b64_tr_b16 v[22:23], v3 offset:11264
s_waitcnt lgkmcnt(10)
v_mfma_f32_32x32x16_bf16 v[192:207], v[64:67], v[32:35], 0
v_mfma_f32_32x32x16_bf16 v[208:223], v[72:75], v[32:35], 0
ds_read_b64_tr_b16 v[24:25], v3 offset:12288
ds_read_b64_tr_b16 v[26:27], v3 offset:13312
s_waitcnt lgkmcnt(10)
v_mfma_f32_32x32x16_bf16 v[192:207], v[68:71], v[36:39], v[192:207]
v_mfma_f32_32x32x16_bf16 v[208:223], v[76:79], v[36:39], v[208:223]
ds_read_b64_tr_b16 v[28:29], v3 offset:14336
ds_read_b64_tr_b16 v[30:31], v3 offset:15360
s_waitcnt lgkmcnt(10)
v_mfma_f32_32x32x16_bf16 v[192:207], v[80:83], v[40:43], v[192:207]
s_add_u32 s65, s58, 524288
v_cvt_pk_bf16_f32 v48, v160, v161
v_mfma_f32_32x32x16_bf16 v[208:223], v[88:91], v[40:43], v[208:223]
v_cvt_pk_bf16_f32 v49, v162, v163
v_cvt_pk_bf16_f32 v50, v164, v165
ds_read_b64_tr_b16 v[32:33], v3 offset:16384
ds_read_b64_tr_b16 v[34:35], v3 offset:17408
s_waitcnt lgkmcnt(10)
v_mfma_f32_32x32x16_bf16 v[192:207], v[84:87], v[44:47], v[192:207]
v_cvt_pk_bf16_f32 v51, v166, v167
buffer_store_dwordx4 v[48:51], v14, s[4:7], s65 offen offset:0 sc1
v_mfma_f32_32x32x16_bf16 v[208:223], v[92:95], v[44:47], v[208:223]
v_cvt_pk_bf16_f32 v52, v168, v169
v_cvt_pk_bf16_f32 v53, v170, v171
ds_read_b64_tr_b16 v[36:37], v3 offset:18432
ds_read_b64_tr_b16 v[38:39], v3 offset:19456
s_waitcnt lgkmcnt(10)
v_mfma_f32_32x32x16_bf16 v[192:207], v[96:99], v[16:19], v[192:207]
v_cvt_pk_bf16_f32 v54, v172, v173
v_cvt_pk_bf16_f32 v55, v174, v175
v_mfma_f32_32x32x16_bf16 v[208:223], v[104:107], v[16:19], v[208:223]
buffer_store_dwordx4 v[52:55], v14, s[4:7], s65 offen offset:512 sc1
s_add_u32 s66, s58, 1835008
ds_read_b64_tr_b16 v[40:41], v3 offset:20480
ds_read_b64_tr_b16 v[42:43], v3 offset:21504
s_waitcnt lgkmcnt(10)
v_mfma_f32_32x32x16_bf16 v[192:207], v[100:103], v[20:23], v[192:207]
v_cvt_pk_bf16_f32 v56, v176, v177
v_cvt_pk_bf16_f32 v57, v178, v179
v_mfma_f32_32x32x16_bf16 v[208:223], v[108:111], v[20:23], v[208:223]
v_cvt_pk_bf16_f32 v58, v180, v181
v_cvt_pk_bf16_f32 v59, v182, v183
ds_read_b64_tr_b16 v[44:45], v3 offset:22528
ds_read_b64_tr_b16 v[46:47], v3 offset:23552
s_waitcnt lgkmcnt(10)
v_mfma_f32_32x32x16_bf16 v[192:207], v[112:115], v[24:27], v[192:207]
buffer_store_dwordx4 v[56:59], v14, s[4:7], s66 offen offset:0 sc1
v_cvt_pk_bf16_f32 v60, v184, v185
v_mfma_f32_32x32x16_bf16 v[208:223], v[120:123], v[24:27], v[208:223]
v_cvt_pk_bf16_f32 v61, v186, v187
v_cvt_pk_bf16_f32 v62, v188, v189
s_waitcnt vmcnt(22)
s_barrier
s_add_u32 s43, s56, 896
s_add_u32 m0, s62, 73728
s_nop 0
buffer_load_dwordx4 v4, s[12:15], s43 offen lds
s_add_u32 s43, s56, 11136
s_add_u32 m0, s62, 74752
s_nop 0
buffer_load_dwordx4 v4, s[12:15], s43 offen lds
s_add_u32 s43, s56, 21376
s_add_u32 m0, s62, 75776
s_nop 0
buffer_load_dwordx4 v4, s[12:15], s43 offen lds
s_add_u32 s43, s56, 31616
s_add_u32 m0, s62, 76800
s_nop 0
buffer_load_dwordx4 v4, s[12:15], s43 offen lds
s_add_u32 s43, s56, 41856
s_add_u32 m0, s62, 77824
s_nop 0
buffer_load_dwordx4 v4, s[12:15], s43 offen lds
s_add_u32 s43, s56, 52096
s_add_u32 m0, s62, 78848
s_nop 0
buffer_load_dwordx4 v4, s[12:15], s43 offen lds
ds_read_b64_tr_b16 v[16:17], v2 offset:24576
ds_read_b64_tr_b16 v[18:19], v2 offset:25600
s_waitcnt lgkmcnt(10)
v_mfma_f32_32x32x16_bf16 v[192:207], v[116:119], v[28:31], v[192:207]
v_cvt_pk_bf16_f32 v63, v190, v191
buffer_store_dwordx4 v[60:63], v14, s[4:7], s66 offen offset:512 sc1
v_mfma_f32_32x32x16_bf16 v[208:223], v[124:127], v[28:31], v[208:223]
ds_read_b64_tr_b16 v[20:21], v2 offset:26624
ds_read_b64_tr_b16 v[22:23], v2 offset:27648
s_waitcnt lgkmcnt(10)
v_mfma_f32_32x32x16_bf16 v[192:207], v[128:131], v[32:35], v[192:207]
v_mfma_f32_32x32x16_bf16 v[208:223], v[136:139], v[32:35], v[208:223]
ds_read_b64_tr_b16 v[24:25], v2 offset:28672
ds_read_b64_tr_b16 v[26:27], v2 offset:29696
s_waitcnt lgkmcnt(10)
v_mfma_f32_32x32x16_bf16 v[192:207], v[132:135], v[36:39], v[192:207]
v_mfma_f32_32x32x16_bf16 v[208:223], v[140:143], v[36:39], v[208:223]
ds_read_b64_tr_b16 v[28:29], v2 offset:30720
ds_read_b64_tr_b16 v[30:31], v2 offset:31744
s_waitcnt lgkmcnt(10)
v_mfma_f32_32x32x16_bf16 v[192:207], v[144:147], v[40:43], v[192:207]
v_mfma_f32_32x32x16_bf16 v[208:223], v[152:155], v[40:43], v[208:223]
ds_read_b64_tr_b16 v[32:33], v2 offset:32768
ds_read_b64_tr_b16 v[34:35], v2 offset:33792
s_waitcnt lgkmcnt(10)
v_mfma_f32_32x32x16_bf16 v[192:207], v[148:151], v[44:47], v[192:207]
v_mfma_f32_32x32x16_bf16 v[208:223], v[156:159], v[44:47], v[208:223]
ds_read_b64_tr_b16 v[36:37], v2 offset:34816
ds_read_b64_tr_b16 v[38:39], v2 offset:35840
s_waitcnt lgkmcnt(10)
v_mfma_f32_32x32x16_bf16 v[160:175], v[64:67], v[16:19], 0
v_mfma_f32_32x32x16_bf16 v[176:191], v[72:75], v[16:19], 0
ds_read_b64_tr_b16 v[40:41], v2 offset:36864
ds_read_b64_tr_b16 v[42:43], v2 offset:37888
s_waitcnt lgkmcnt(10)
v_mfma_f32_32x32x16_bf16 v[160:175], v[68:71], v[20:23], v[160:175]
v_mfma_f32_32x32x16_bf16 v[176:191], v[76:79], v[20:23], v[176:191]
ds_read_b64_tr_b16 v[44:45], v2 offset:38912
ds_read_b64_tr_b16 v[46:47], v2 offset:39936
s_waitcnt lgkmcnt(10)
v_mfma_f32_32x32x16_bf16 v[160:175], v[80:83], v[24:27], v[160:175]
s_add_u32 s65, s58, 589824
v_cvt_pk_bf16_f32 v48, v192, v193
v_mfma_f32_32x32x16_bf16 v[176:191], v[88:91], v[24:27], v[176:191]
v_cvt_pk_bf16_f32 v49, v194, v195
v_cvt_pk_bf16_f32 v50, v196, v197
ds_read_b64_tr_b16 v[16:17], v2 offset:40960
ds_read_b64_tr_b16 v[18:19], v2 offset:41984
s_waitcnt lgkmcnt(10)
v_mfma_f32_32x32x16_bf16 v[160:175], v[84:87], v[28:31], v[160:175]
v_cvt_pk_bf16_f32 v51, v198, v199
buffer_store_dwordx4 v[48:51], v14, s[4:7], s65 offen offset:0 sc1
v_mfma_f32_32x32x16_bf16 v[176:191], v[92:95], v[28:31], v[176:191]
v_cvt_pk_bf16_f32 v52, v200, v201
v_cvt_pk_bf16_f32 v53, v202, v203
ds_read_b64_tr_b16 v[20:21], v2 offset:43008
ds_read_b64_tr_b16 v[22:23], v2 offset:44032
s_waitcnt lgkmcnt(10)
v_mfma_f32_32x32x16_bf16 v[160:175], v[96:99], v[32:35], v[160:175]
v_cvt_pk_bf16_f32 v54, v204, v205
v_cvt_pk_bf16_f32 v55, v206, v207
v_mfma_f32_32x32x16_bf16 v[176:191], v[104:107], v[32:35], v[176:191]
buffer_store_dwordx4 v[52:55], v14, s[4:7], s65 offen offset:512 sc1
s_add_u32 s66, s58, 1900544
ds_read_b64_tr_b16 v[24:25], v2 offset:45056
ds_read_b64_tr_b16 v[26:27], v2 offset:46080
s_waitcnt lgkmcnt(10)
v_mfma_f32_32x32x16_bf16 v[160:175], v[100:103], v[36:39], v[160:175]
v_cvt_pk_bf16_f32 v56, v208, v209
v_cvt_pk_bf16_f32 v57, v210, v211
v_mfma_f32_32x32x16_bf16 v[176:191], v[108:111], v[36:39], v[176:191]
v_cvt_pk_bf16_f32 v58, v212, v213
v_cvt_pk_bf16_f32 v59, v214, v215
ds_read_b64_tr_b16 v[28:29], v2 offset:47104
ds_read_b64_tr_b16 v[30:31], v2 offset:48128
s_waitcnt lgkmcnt(10)
v_mfma_f32_32x32x16_bf16 v[160:175], v[112:115], v[40:43], v[160:175]
buffer_store_dwordx4 v[56:59], v14, s[4:7], s66 offen offset:0 sc1
v_cvt_pk_bf16_f32 v60, v216, v217
v_mfma_f32_32x32x16_bf16 v[176:191], v[120:123], v[40:43], v[176:191]
v_cvt_pk_bf16_f32 v61, v218, v219
v_cvt_pk_bf16_f32 v62, v220, v221
ds_read_b64_tr_b16 v[32:33], v3 offset:24576
ds_read_b64_tr_b16 v[34:35], v3 offset:25600
s_waitcnt lgkmcnt(10)
v_mfma_f32_32x32x16_bf16 v[160:175], v[116:119], v[44:47], v[160:175]
v_cvt_pk_bf16_f32 v63, v222, v223
buffer_store_dwordx4 v[60:63], v14, s[4:7], s66 offen offset:512 sc1
v_mfma_f32_32x32x16_bf16 v[176:191], v[124:127], v[44:47], v[176:191]
ds_read_b64_tr_b16 v[36:37], v3 offset:26624
ds_read_b64_tr_b16 v[38:39], v3 offset:27648
s_waitcnt lgkmcnt(10)
v_mfma_f32_32x32x16_bf16 v[160:175], v[128:131], v[16:19], v[160:175]
v_mfma_f32_32x32x16_bf16 v[176:191], v[136:139], v[16:19], v[176:191]
ds_read_b64_tr_b16 v[40:41], v3 offset:28672
ds_read_b64_tr_b16 v[42:43], v3 offset:29696
s_waitcnt lgkmcnt(10)
v_mfma_f32_32x32x16_bf16 v[160:175], v[132:135], v[20:23], v[160:175]
v_mfma_f32_32x32x16_bf16 v[176:191], v[140:143], v[20:23], v[176:191]
ds_read_b64_tr_b16 v[44:45], v3 offset:30720
ds_read_b64_tr_b16 v[46:47], v3 offset:31744
s_waitcnt lgkmcnt(10)
v_mfma_f32_32x32x16_bf16 v[160:175], v[144:147], v[24:27], v[160:175]
v_mfma_f32_32x32x16_bf16 v[176:191], v[152:155], v[24:27], v[176:191]
ds_read_b64_tr_b16 v[16:17], v3 offset:32768
ds_read_b64_tr_b16 v[18:19], v3 offset:33792
s_waitcnt lgkmcnt(10)
v_mfma_f32_32x32x16_bf16 v[160:175], v[148:151], v[28:31], v[160:175]
v_mfma_f32_32x32x16_bf16 v[176:191], v[156:159], v[28:31], v[176:191]
ds_read_b64_tr_b16 v[20:21], v3 offset:34816
ds_read_b64_tr_b16 v[22:23], v3 offset:35840
s_waitcnt lgkmcnt(10)
v_mfma_f32_32x32x16_bf16 v[192:207], v[64:67], v[32:35], 0
v_mfma_f32_32x32x16_bf16 v[208:223], v[72:75], v[32:35], 0
ds_read_b64_tr_b16 v[24:25], v3 offset:36864
ds_read_b64_tr_b16 v[26:27], v3 offset:37888
s_waitcnt lgkmcnt(10)
v_mfma_f32_32x32x16_bf16 v[192:207], v[68:71], v[36:39], v[192:207]
v_mfma_f32_32x32x16_bf16 v[208:223], v[76:79], v[36:39], v[208:223]
ds_read_b64_tr_b16 v[28:29], v3 offset:38912
ds_read_b64_tr_b16 v[30:31], v3 offset:39936
s_waitcnt lgkmcnt(10)
v_mfma_f32_32x32x16_bf16 v[192:207], v[80:83], v[40:43], v[192:207]
s_add_u32 s65, s58, 655360
v_cvt_pk_bf16_f32 v48, v160, v161
v_mfma_f32_32x32x16_bf16 v[208:223], v[88:91], v[40:43], v[208:223]
v_cvt_pk_bf16_f32 v49, v162, v163
v_cvt_pk_bf16_f32 v50, v164, v165
ds_read_b64_tr_b16 v[32:33], v3 offset:40960
ds_read_b64_tr_b16 v[34:35], v3 offset:41984
s_waitcnt lgkmcnt(10)
v_mfma_f32_32x32x16_bf16 v[192:207], v[84:87], v[44:47], v[192:207]
v_cvt_pk_bf16_f32 v51, v166, v167
buffer_store_dwordx4 v[48:51], v14, s[4:7], s65 offen offset:0 sc1
v_mfma_f32_32x32x16_bf16 v[208:223], v[92:95], v[44:47], v[208:223]
v_cvt_pk_bf16_f32 v52, v168, v169
v_cvt_pk_bf16_f32 v53, v170, v171
ds_read_b64_tr_b16 v[36:37], v3 offset:43008
ds_read_b64_tr_b16 v[38:39], v3 offset:44032
s_waitcnt lgkmcnt(10)
v_mfma_f32_32x32x16_bf16 v[192:207], v[96:99], v[16:19], v[192:207]
v_cvt_pk_bf16_f32 v54, v172, v173
v_cvt_pk_bf16_f32 v55, v174, v175
v_mfma_f32_32x32x16_bf16 v[208:223], v[104:107], v[16:19], v[208:223]
buffer_store_dwordx4 v[52:55], v14, s[4:7], s65 offen offset:512 sc1
s_add_u32 s66, s58, 1966080
ds_read_b64_tr_b16 v[40:41], v3 offset:45056
ds_read_b64_tr_b16 v[42:43], v3 offset:46080
s_waitcnt lgkmcnt(10)
v_mfma_f32_32x32x16_bf16 v[192:207], v[100:103], v[20:23], v[192:207]
v_cvt_pk_bf16_f32 v56, v176, v177
v_cvt_pk_bf16_f32 v57, v178, v179
v_mfma_f32_32x32x16_bf16 v[208:223], v[108:111], v[20:23], v[208:223]
v_cvt_pk_bf16_f32 v58, v180, v181
v_cvt_pk_bf16_f32 v59, v182, v183
ds_read_b64_tr_b16 v[44:45], v3 offset:47104
ds_read_b64_tr_b16 v[46:47], v3 offset:48128
s_waitcnt lgkmcnt(10)
v_mfma_f32_32x32x16_bf16 v[192:207], v[112:115], v[24:27], v[192:207]
buffer_store_dwordx4 v[56:59], v14, s[4:7], s66 offen offset:0 sc1
v_cvt_pk_bf16_f32 v60, v184, v185
v_mfma_f32_32x32x16_bf16 v[208:223], v[120:123], v[24:27], v[208:223]
v_cvt_pk_bf16_f32 v61, v186, v187
v_cvt_pk_bf16_f32 v62, v188, v189
s_waitcnt vmcnt(22)
s_barrier
s_add_u32 s43, s56, 1024
s_add_u32 m0, s62, 0
s_nop 0
buffer_load_dwordx4 v4, s[12:15], s43 offen lds
s_add_u32 s43, s56, 11264
s_add_u32 m0, s62, 1024
s_nop 0
buffer_load_dwordx4 v4, s[12:15], s43 offen lds
s_add_u32 s43, s56, 21504
s_add_u32 m0, s62, 2048
s_nop 0
buffer_load_dwordx4 v4, s[12:15], s43 offen lds
s_add_u32 s43, s56, 31744
s_add_u32 m0, s62, 3072
s_nop 0
buffer_load_dwordx4 v4, s[12:15], s43 offen lds
s_add_u32 s43, s56, 41984
s_add_u32 m0, s62, 4096
s_nop 0
buffer_load_dwordx4 v4, s[12:15], s43 offen lds
s_add_u32 s43, s56, 52224
s_add_u32 m0, s62, 5120
s_nop 0
buffer_load_dwordx4 v4, s[12:15], s43 offen lds
ds_read_b64_tr_b16 v[16:17], v13 offset:0
ds_read_b64_tr_b16 v[18:19], v13 offset:1024
s_waitcnt lgkmcnt(10)
v_mfma_f32_32x32x16_bf16 v[192:207], v[116:119], v[28:31], v[192:207]
v_cvt_pk_bf16_f32 v63, v190, v191
buffer_store_dwordx4 v[60:63], v14, s[4:7], s66 offen offset:512 sc1
v_mfma_f32_32x32x16_bf16 v[208:223], v[124:127], v[28:31], v[208:223]
ds_read_b64_tr_b16 v[20:21], v13 offset:2048
ds_read_b64_tr_b16 v[22:23], v13 offset:3072
s_waitcnt lgkmcnt(10)
v_mfma_f32_32x32x16_bf16 v[192:207], v[128:131], v[32:35], v[192:207]
v_mfma_f32_32x32x16_bf16 v[208:223], v[136:139], v[32:35], v[208:223]
ds_read_b64_tr_b16 v[24:25], v13 offset:4096
ds_read_b64_tr_b16 v[26:27], v13 offset:5120
s_waitcnt lgkmcnt(10)
v_mfma_f32_32x32x16_bf16 v[192:207], v[132:135], v[36:39], v[192:207]
v_mfma_f32_32x32x16_bf16 v[208:223], v[140:143], v[36:39], v[208:223]
ds_read_b64_tr_b16 v[28:29], v13 offset:6144
ds_read_b64_tr_b16 v[30:31], v13 offset:7168
s_waitcnt lgkmcnt(10)
v_mfma_f32_32x32x16_bf16 v[192:207], v[144:147], v[40:43], v[192:207]
v_mfma_f32_32x32x16_bf16 v[208:223], v[152:155], v[40:43], v[208:223]
ds_read_b64_tr_b16 v[32:33], v13 offset:8192
ds_read_b64_tr_b16 v[34:35], v13 offset:9216
s_waitcnt lgkmcnt(10)
v_mfma_f32_32x32x16_bf16 v[192:207], v[148:151], v[44:47], v[192:207]
v_mfma_f32_32x32x16_bf16 v[208:223], v[156:159], v[44:47], v[208:223]
ds_read_b64_tr_b16 v[36:37], v13 offset:10240
ds_read_b64_tr_b16 v[38:39], v13 offset:11264
s_waitcnt lgkmcnt(10)
v_mfma_f32_32x32x16_bf16 v[160:175], v[64:67], v[16:19], 0
v_mfma_f32_32x32x16_bf16 v[176:191], v[72:75], v[16:19], 0
ds_read_b64_tr_b16 v[40:41], v13 offset:12288
ds_read_b64_tr_b16 v[42:43], v13 offset:13312
s_waitcnt lgkmcnt(10)
v_mfma_f32_32x32x16_bf16 v[160:175], v[68:71], v[20:23], v[160:175]
v_mfma_f32_32x32x16_bf16 v[176:191], v[76:79], v[20:23], v[176:191]
ds_read_b64_tr_b16 v[44:45], v13 offset:14336
ds_read_b64_tr_b16 v[46:47], v13 offset:15360
s_waitcnt lgkmcnt(10)
v_mfma_f32_32x32x16_bf16 v[160:175], v[80:83], v[24:27], v[160:175]
s_add_u32 s65, s58, 720896
v_cvt_pk_bf16_f32 v48, v192, v193
v_mfma_f32_32x32x16_bf16 v[176:191], v[88:91], v[24:27], v[176:191]
v_cvt_pk_bf16_f32 v49, v194, v195
v_cvt_pk_bf16_f32 v50, v196, v197
ds_read_b64_tr_b16 v[16:17], v13 offset:16384
ds_read_b64_tr_b16 v[18:19], v13 offset:17408
s_waitcnt lgkmcnt(10)
v_mfma_f32_32x32x16_bf16 v[160:175], v[84:87], v[28:31], v[160:175]
v_cvt_pk_bf16_f32 v51, v198, v199
buffer_store_dwordx4 v[48:51], v14, s[4:7], s65 offen offset:0 sc1
v_mfma_f32_32x32x16_bf16 v[176:191], v[92:95], v[28:31], v[176:191]
v_cvt_pk_bf16_f32 v52, v200, v201
v_cvt_pk_bf16_f32 v53, v202, v203
ds_read_b64_tr_b16 v[20:21], v13 offset:18432
ds_read_b64_tr_b16 v[22:23], v13 offset:19456
s_waitcnt lgkmcnt(10)
v_mfma_f32_32x32x16_bf16 v[160:175], v[96:99], v[32:35], v[160:175]
v_cvt_pk_bf16_f32 v54, v204, v205
v_cvt_pk_bf16_f32 v55, v206, v207
v_mfma_f32_32x32x16_bf16 v[176:191], v[104:107], v[32:35], v[176:191]
buffer_store_dwordx4 v[52:55], v14, s[4:7], s65 offen offset:512 sc1
s_add_u32 s66, s58, 2031616
ds_read_b64_tr_b16 v[24:25], v13 offset:20480
ds_read_b64_tr_b16 v[26:27], v13 offset:21504
s_waitcnt lgkmcnt(10)
v_mfma_f32_32x32x16_bf16 v[160:175], v[100:103], v[36:39], v[160:175]
v_cvt_pk_bf16_f32 v56, v208, v209
v_cvt_pk_bf16_f32 v57, v210, v211
v_mfma_f32_32x32x16_bf16 v[176:191], v[108:111], v[36:39], v[176:191]
v_cvt_pk_bf16_f32 v58, v212, v213
v_cvt_pk_bf16_f32 v59, v214, v215
ds_read_b64_tr_b16 v[28:29], v13 offset:22528
ds_read_b64_tr_b16 v[30:31], v13 offset:23552
s_waitcnt lgkmcnt(10)
v_mfma_f32_32x32x16_bf16 v[160:175], v[112:115], v[40:43], v[160:175]
buffer_store_dwordx4 v[56:59], v14, s[4:7], s66 offen offset:0 sc1
v_cvt_pk_bf16_f32 v60, v216, v217
v_mfma_f32_32x32x16_bf16 v[176:191], v[120:123], v[40:43], v[176:191]
v_cvt_pk_bf16_f32 v61, v218, v219
v_cvt_pk_bf16_f32 v62, v220, v221
ds_read_b64_tr_b16 v[32:33], v15 offset:0
ds_read_b64_tr_b16 v[34:35], v15 offset:1024
s_waitcnt lgkmcnt(10)
v_mfma_f32_32x32x16_bf16 v[160:175], v[116:119], v[44:47], v[160:175]
v_cvt_pk_bf16_f32 v63, v222, v223
buffer_store_dwordx4 v[60:63], v14, s[4:7], s66 offen offset:512 sc1
v_mfma_f32_32x32x16_bf16 v[176:191], v[124:127], v[44:47], v[176:191]
ds_read_b64_tr_b16 v[36:37], v15 offset:2048
ds_read_b64_tr_b16 v[38:39], v15 offset:3072
s_waitcnt lgkmcnt(10)
v_mfma_f32_32x32x16_bf16 v[160:175], v[128:131], v[16:19], v[160:175]
v_mfma_f32_32x32x16_bf16 v[176:191], v[136:139], v[16:19], v[176:191]
ds_read_b64_tr_b16 v[40:41], v15 offset:4096
ds_read_b64_tr_b16 v[42:43], v15 offset:5120
s_waitcnt lgkmcnt(10)
v_mfma_f32_32x32x16_bf16 v[160:175], v[132:135], v[20:23], v[160:175]
v_mfma_f32_32x32x16_bf16 v[176:191], v[140:143], v[20:23], v[176:191]
ds_read_b64_tr_b16 v[44:45], v15 offset:6144
ds_read_b64_tr_b16 v[46:47], v15 offset:7168
s_waitcnt lgkmcnt(10)
v_mfma_f32_32x32x16_bf16 v[160:175], v[144:147], v[24:27], v[160:175]
v_mfma_f32_32x32x16_bf16 v[176:191], v[152:155], v[24:27], v[176:191]
ds_read_b64_tr_b16 v[16:17], v15 offset:8192
ds_read_b64_tr_b16 v[18:19], v15 offset:9216
s_waitcnt lgkmcnt(10)
v_mfma_f32_32x32x16_bf16 v[160:175], v[148:151], v[28:31], v[160:175]
v_mfma_f32_32x32x16_bf16 v[176:191], v[156:159], v[28:31], v[176:191]
ds_read_b64_tr_b16 v[20:21], v15 offset:10240
ds_read_b64_tr_b16 v[22:23], v15 offset:11264
s_waitcnt lgkmcnt(10)
v_mfma_f32_32x32x16_bf16 v[192:207], v[64:67], v[32:35], 0
v_mfma_f32_32x32x16_bf16 v[208:223], v[72:75], v[32:35], 0
ds_read_b64_tr_b16 v[24:25], v15 offset:12288
ds_read_b64_tr_b16 v[26:27], v15 offset:13312
s_waitcnt lgkmcnt(10)
v_mfma_f32_32x32x16_bf16 v[192:207], v[68:71], v[36:39], v[192:207]
v_mfma_f32_32x32x16_bf16 v[208:223], v[76:79], v[36:39], v[208:223]
ds_read_b64_tr_b16 v[28:29], v15 offset:14336
ds_read_b64_tr_b16 v[30:31], v15 offset:15360
s_waitcnt lgkmcnt(10)
v_mfma_f32_32x32x16_bf16 v[192:207], v[80:83], v[40:43], v[192:207]
s_add_u32 s65, s58, 786432
v_cvt_pk_bf16_f32 v48, v160, v161
v_mfma_f32_32x32x16_bf16 v[208:223], v[88:91], v[40:43], v[208:223]
v_cvt_pk_bf16_f32 v49, v162, v163
v_cvt_pk_bf16_f32 v50, v164, v165
ds_read_b64_tr_b16 v[32:33], v15 offset:16384
ds_read_b64_tr_b16 v[34:35], v15 offset:17408
s_waitcnt lgkmcnt(10)
v_mfma_f32_32x32x16_bf16 v[192:207], v[84:87], v[44:47], v[192:207]
v_cvt_pk_bf16_f32 v51, v166, v167
buffer_store_dwordx4 v[48:51], v14, s[4:7], s65 offen offset:0 sc1
v_mfma_f32_32x32x16_bf16 v[208:223], v[92:95], v[44:47], v[208:223]
v_cvt_pk_bf16_f32 v52, v168, v169
v_cvt_pk_bf16_f32 v53, v170, v171
ds_read_b64_tr_b16 v[36:37], v15 offset:18432
ds_read_b64_tr_b16 v[38:39], v15 offset:19456
s_waitcnt lgkmcnt(10)
v_mfma_f32_32x32x16_bf16 v[192:207], v[96:99], v[16:19], v[192:207]
v_cvt_pk_bf16_f32 v54, v172, v173
v_cvt_pk_bf16_f32 v55, v174, v175
v_mfma_f32_32x32x16_bf16 v[208:223], v[104:107], v[16:19], v[208:223]
buffer_store_dwordx4 v[52:55], v14, s[4:7], s65 offen offset:512 sc1
s_add_u32 s66, s58, 2097152
ds_read_b64_tr_b16 v[40:41], v15 offset:20480
ds_read_b64_tr_b16 v[42:43], v15 offset:21504
s_waitcnt lgkmcnt(10)
v_mfma_f32_32x32x16_bf16 v[192:207], v[100:103], v[20:23], v[192:207]
v_cvt_pk_bf16_f32 v56, v176, v177
v_cvt_pk_bf16_f32 v57, v178, v179
v_mfma_f32_32x32x16_bf16 v[208:223], v[108:111], v[20:23], v[208:223]
v_cvt_pk_bf16_f32 v58, v180, v181
v_cvt_pk_bf16_f32 v59, v182, v183
ds_read_b64_tr_b16 v[44:45], v15 offset:22528
ds_read_b64_tr_b16 v[46:47], v15 offset:23552
s_waitcnt lgkmcnt(10)
v_mfma_f32_32x32x16_bf16 v[192:207], v[112:115], v[24:27], v[192:207]
buffer_store_dwordx4 v[56:59], v14, s[4:7], s66 offen offset:0 sc1
v_cvt_pk_bf16_f32 v60, v184, v185
v_mfma_f32_32x32x16_bf16 v[208:223], v[120:123], v[24:27], v[208:223]
v_cvt_pk_bf16_f32 v61, v186, v187
v_cvt_pk_bf16_f32 v62, v188, v189
s_waitcnt vmcnt(22)
s_barrier
s_add_u32 s43, s56, 1152
s_add_u32 m0, s62, 24576
s_nop 0
buffer_load_dwordx4 v4, s[12:15], s43 offen lds
s_add_u32 s43, s56, 11392
s_add_u32 m0, s62, 25600
s_nop 0
buffer_load_dwordx4 v4, s[12:15], s43 offen lds
s_add_u32 s43, s56, 21632
s_add_u32 m0, s62, 26624
s_nop 0
buffer_load_dwordx4 v4, s[12:15], s43 offen lds
s_add_u32 s43, s56, 31872
s_add_u32 m0, s62, 27648
s_nop 0
buffer_load_dwordx4 v4, s[12:15], s43 offen lds
s_add_u32 s43, s56, 42112
s_add_u32 m0, s62, 28672
s_nop 0
buffer_load_dwordx4 v4, s[12:15], s43 offen lds
s_add_u32 s43, s56, 52352
s_add_u32 m0, s62, 29696
s_nop 0
buffer_load_dwordx4 v4, s[12:15], s43 offen lds
ds_read_b64_tr_b16 v[16:17], v13 offset:24576
ds_read_b64_tr_b16 v[18:19], v13 offset:25600
s_waitcnt lgkmcnt(10)
v_mfma_f32_32x32x16_bf16 v[192:207], v[116:119], v[28:31], v[192:207]
v_cvt_pk_bf16_f32 v63, v190, v191
buffer_store_dwordx4 v[60:63], v14, s[4:7], s66 offen offset:512 sc1
v_mfma_f32_32x32x16_bf16 v[208:223], v[124:127], v[28:31], v[208:223]
ds_read_b64_tr_b16 v[20:21], v13 offset:26624
ds_read_b64_tr_b16 v[22:23], v13 offset:27648
s_waitcnt lgkmcnt(10)
v_mfma_f32_32x32x16_bf16 v[192:207], v[128:131], v[32:35], v[192:207]
v_mfma_f32_32x32x16_bf16 v[208:223], v[136:139], v[32:35], v[208:223]
ds_read_b64_tr_b16 v[24:25], v13 offset:28672
ds_read_b64_tr_b16 v[26:27], v13 offset:29696
s_waitcnt lgkmcnt(10)
v_mfma_f32_32x32x16_bf16 v[192:207], v[132:135], v[36:39], v[192:207]
v_mfma_f32_32x32x16_bf16 v[208:223], v[140:143], v[36:39], v[208:223]
ds_read_b64_tr_b16 v[28:29], v13 offset:30720
ds_read_b64_tr_b16 v[30:31], v13 offset:31744
s_waitcnt lgkmcnt(10)
v_mfma_f32_32x32x16_bf16 v[192:207], v[144:147], v[40:43], v[192:207]
v_mfma_f32_32x32x16_bf16 v[208:223], v[152:155], v[40:43], v[208:223]
ds_read_b64_tr_b16 v[32:33], v13 offset:32768
ds_read_b64_tr_b16 v[34:35], v13 offset:33792
s_waitcnt lgkmcnt(10)
v_mfma_f32_32x32x16_bf16 v[192:207], v[148:151], v[44:47], v[192:207]
v_mfma_f32_32x32x16_bf16 v[208:223], v[156:159], v[44:47], v[208:223]
ds_read_b64_tr_b16 v[36:37], v13 offset:34816
ds_read_b64_tr_b16 v[38:39], v13 offset:35840
s_waitcnt lgkmcnt(10)
v_mfma_f32_32x32x16_bf16 v[160:175], v[64:67], v[16:19], 0
v_mfma_f32_32x32x16_bf16 v[176:191], v[72:75], v[16:19], 0
ds_read_b64_tr_b16 v[40:41], v13 offset:36864
ds_read_b64_tr_b16 v[42:43], v13 offset:37888
s_waitcnt lgkmcnt(10)
v_mfma_f32_32x32x16_bf16 v[160:175], v[68:71], v[20:23], v[160:175]
v_mfma_f32_32x32x16_bf16 v[176:191], v[76:79], v[20:23], v[176:191]
ds_read_b64_tr_b16 v[44:45], v13 offset:38912
ds_read_b64_tr_b16 v[46:47], v13 offset:39936
s_waitcnt lgkmcnt(10)
v_mfma_f32_32x32x16_bf16 v[160:175], v[80:83], v[24:27], v[160:175]
s_add_u32 s65, s58, 851968
v_cvt_pk_bf16_f32 v48, v192, v193
v_mfma_f32_32x32x16_bf16 v[176:191], v[88:91], v[24:27], v[176:191]
v_cvt_pk_bf16_f32 v49, v194, v195
v_cvt_pk_bf16_f32 v50, v196, v197
ds_read_b64_tr_b16 v[16:17], v13 offset:40960
ds_read_b64_tr_b16 v[18:19], v13 offset:41984
s_waitcnt lgkmcnt(10)
v_mfma_f32_32x32x16_bf16 v[160:175], v[84:87], v[28:31], v[160:175]
v_cvt_pk_bf16_f32 v51, v198, v199
buffer_store_dwordx4 v[48:51], v14, s[4:7], s65 offen offset:0 sc1
v_mfma_f32_32x32x16_bf16 v[176:191], v[92:95], v[28:31], v[176:191]
v_cvt_pk_bf16_f32 v52, v200, v201
v_cvt_pk_bf16_f32 v53, v202, v203
ds_read_b64_tr_b16 v[20:21], v13 offset:43008
ds_read_b64_tr_b16 v[22:23], v13 offset:44032
s_waitcnt lgkmcnt(10)
v_mfma_f32_32x32x16_bf16 v[160:175], v[96:99], v[32:35], v[160:175]
v_cvt_pk_bf16_f32 v54, v204, v205
v_cvt_pk_bf16_f32 v55, v206, v207
v_mfma_f32_32x32x16_bf16 v[176:191], v[104:107], v[32:35], v[176:191]
buffer_store_dwordx4 v[52:55], v14, s[4:7], s65 offen offset:512 sc1
s_add_u32 s66, s58, 2162688
ds_read_b64_tr_b16 v[24:25], v13 offset:45056
ds_read_b64_tr_b16 v[26:27], v13 offset:46080
s_waitcnt lgkmcnt(10)
v_mfma_f32_32x32x16_bf16 v[160:175], v[100:103], v[36:39], v[160:175]
v_cvt_pk_bf16_f32 v56, v208, v209
v_cvt_pk_bf16_f32 v57, v210, v211
v_mfma_f32_32x32x16_bf16 v[176:191], v[108:111], v[36:39], v[176:191]
v_cvt_pk_bf16_f32 v58, v212, v213
v_cvt_pk_bf16_f32 v59, v214, v215
ds_read_b64_tr_b16 v[28:29], v13 offset:47104
ds_read_b64_tr_b16 v[30:31], v13 offset:48128
s_waitcnt lgkmcnt(10)
v_mfma_f32_32x32x16_bf16 v[160:175], v[112:115], v[40:43], v[160:175]
buffer_store_dwordx4 v[56:59], v14, s[4:7], s66 offen offset:0 sc1
v_cvt_pk_bf16_f32 v60, v216, v217
v_mfma_f32_32x32x16_bf16 v[176:191], v[120:123], v[40:43], v[176:191]
v_cvt_pk_bf16_f32 v61, v218, v219
v_cvt_pk_bf16_f32 v62, v220, v221
ds_read_b64_tr_b16 v[32:33], v15 offset:24576
ds_read_b64_tr_b16 v[34:35], v15 offset:25600
s_waitcnt lgkmcnt(10)
v_mfma_f32_32x32x16_bf16 v[160:175], v[116:119], v[44:47], v[160:175]
v_cvt_pk_bf16_f32 v63, v222, v223
buffer_store_dwordx4 v[60:63], v14, s[4:7], s66 offen offset:512 sc1
v_mfma_f32_32x32x16_bf16 v[176:191], v[124:127], v[44:47], v[176:191]
ds_read_b64_tr_b16 v[36:37], v15 offset:26624
ds_read_b64_tr_b16 v[38:39], v15 offset:27648
s_waitcnt lgkmcnt(10)
v_mfma_f32_32x32x16_bf16 v[160:175], v[128:131], v[16:19], v[160:175]
v_mfma_f32_32x32x16_bf16 v[176:191], v[136:139], v[16:19], v[176:191]
ds_read_b64_tr_b16 v[40:41], v15 offset:28672
ds_read_b64_tr_b16 v[42:43], v15 offset:29696
s_waitcnt lgkmcnt(10)
v_mfma_f32_32x32x16_bf16 v[160:175], v[132:135], v[20:23], v[160:175]
v_mfma_f32_32x32x16_bf16 v[176:191], v[140:143], v[20:23], v[176:191]
ds_read_b64_tr_b16 v[44:45], v15 offset:30720
ds_read_b64_tr_b16 v[46:47], v15 offset:31744
s_waitcnt lgkmcnt(10)
v_mfma_f32_32x32x16_bf16 v[160:175], v[144:147], v[24:27], v[160:175]
v_mfma_f32_32x32x16_bf16 v[176:191], v[152:155], v[24:27], v[176:191]
ds_read_b64_tr_b16 v[16:17], v15 offset:32768
ds_read_b64_tr_b16 v[18:19], v15 offset:33792
s_waitcnt lgkmcnt(10)
v_mfma_f32_32x32x16_bf16 v[160:175], v[148:151], v[28:31], v[160:175]
v_mfma_f32_32x32x16_bf16 v[176:191], v[156:159], v[28:31], v[176:191]
ds_read_b64_tr_b16 v[20:21], v15 offset:34816
ds_read_b64_tr_b16 v[22:23], v15 offset:35840
s_waitcnt lgkmcnt(10)
v_mfma_f32_32x32x16_bf16 v[192:207], v[64:67], v[32:35], 0
v_mfma_f32_32x32x16_bf16 v[208:223], v[72:75], v[32:35], 0
ds_read_b64_tr_b16 v[24:25], v15 offset:36864
ds_read_b64_tr_b16 v[26:27], v15 offset:37888
s_waitcnt lgkmcnt(10)
v_mfma_f32_32x32x16_bf16 v[192:207], v[68:71], v[36:39], v[192:207]
v_mfma_f32_32x32x16_bf16 v[208:223], v[76:79], v[36:39], v[208:223]
ds_read_b64_tr_b16 v[28:29], v15 offset:38912
ds_read_b64_tr_b16 v[30:31], v15 offset:39936
s_waitcnt lgkmcnt(10)
v_mfma_f32_32x32x16_bf16 v[192:207], v[80:83], v[40:43], v[192:207]
s_add_u32 s65, s58, 917504
v_cvt_pk_bf16_f32 v48, v160, v161
v_mfma_f32_32x32x16_bf16 v[208:223], v[88:91], v[40:43], v[208:223]
v_cvt_pk_bf16_f32 v49, v162, v163
v_cvt_pk_bf16_f32 v50, v164, v165
ds_read_b64_tr_b16 v[32:33], v15 offset:40960
ds_read_b64_tr_b16 v[34:35], v15 offset:41984
s_waitcnt lgkmcnt(10)
v_mfma_f32_32x32x16_bf16 v[192:207], v[84:87], v[44:47], v[192:207]
v_cvt_pk_bf16_f32 v51, v166, v167
buffer_store_dwordx4 v[48:51], v14, s[4:7], s65 offen offset:0 sc1
v_mfma_f32_32x32x16_bf16 v[208:223], v[92:95], v[44:47], v[208:223]
v_cvt_pk_bf16_f32 v52, v168, v169
v_cvt_pk_bf16_f32 v53, v170, v171
ds_read_b64_tr_b16 v[36:37], v15 offset:43008
ds_read_b64_tr_b16 v[38:39], v15 offset:44032
s_waitcnt lgkmcnt(10)
v_mfma_f32_32x32x16_bf16 v[192:207], v[96:99], v[16:19], v[192:207]
v_cvt_pk_bf16_f32 v54, v172, v173
v_cvt_pk_bf16_f32 v55, v174, v175
v_mfma_f32_32x32x16_bf16 v[208:223], v[104:107], v[16:19], v[208:223]
buffer_store_dwordx4 v[52:55], v14, s[4:7], s65 offen offset:512 sc1
s_add_u32 s66, s58, 2228224
ds_read_b64_tr_b16 v[40:41], v15 offset:45056
ds_read_b64_tr_b16 v[42:43], v15 offset:46080
s_waitcnt lgkmcnt(10)
v_mfma_f32_32x32x16_bf16 v[192:207], v[100:103], v[20:23], v[192:207]
v_cvt_pk_bf16_f32 v56, v176, v177
v_cvt_pk_bf16_f32 v57, v178, v179
v_mfma_f32_32x32x16_bf16 v[208:223], v[108:111], v[20:23], v[208:223]
v_cvt_pk_bf16_f32 v58, v180, v181
v_cvt_pk_bf16_f32 v59, v182, v183
ds_read_b64_tr_b16 v[44:45], v15 offset:47104
ds_read_b64_tr_b16 v[46:47], v15 offset:48128
s_waitcnt lgkmcnt(10)
v_mfma_f32_32x32x16_bf16 v[192:207], v[112:115], v[24:27], v[192:207]
buffer_store_dwordx4 v[56:59], v14, s[4:7], s66 offen offset:0 sc1
v_cvt_pk_bf16_f32 v60, v184, v185
v_mfma_f32_32x32x16_bf16 v[208:223], v[120:123], v[24:27], v[208:223]
v_cvt_pk_bf16_f32 v61, v186, v187
v_cvt_pk_bf16_f32 v62, v188, v189
s_waitcnt vmcnt(22)
s_barrier
ds_read_b64_tr_b16 v[16:17], v2 offset:0
ds_read_b64_tr_b16 v[18:19], v2 offset:1024
s_waitcnt lgkmcnt(10)
v_mfma_f32_32x32x16_bf16 v[192:207], v[116:119], v[28:31], v[192:207]
v_cvt_pk_bf16_f32 v63, v190, v191
buffer_store_dwordx4 v[60:63], v14, s[4:7], s66 offen offset:512 sc1
v_mfma_f32_32x32x16_bf16 v[208:223], v[124:127], v[28:31], v[208:223]
ds_read_b64_tr_b16 v[20:21], v2 offset:2048
ds_read_b64_tr_b16 v[22:23], v2 offset:3072
s_waitcnt lgkmcnt(10)
v_mfma_f32_32x32x16_bf16 v[192:207], v[128:131], v[32:35], v[192:207]
v_mfma_f32_32x32x16_bf16 v[208:223], v[136:139], v[32:35], v[208:223]
ds_read_b64_tr_b16 v[24:25], v2 offset:4096
ds_read_b64_tr_b16 v[26:27], v2 offset:5120
s_waitcnt lgkmcnt(10)
v_mfma_f32_32x32x16_bf16 v[192:207], v[132:135], v[36:39], v[192:207]
v_mfma_f32_32x32x16_bf16 v[208:223], v[140:143], v[36:39], v[208:223]
ds_read_b64_tr_b16 v[28:29], v2 offset:6144
ds_read_b64_tr_b16 v[30:31], v2 offset:7168
s_waitcnt lgkmcnt(10)
v_mfma_f32_32x32x16_bf16 v[192:207], v[144:147], v[40:43], v[192:207]
v_mfma_f32_32x32x16_bf16 v[208:223], v[152:155], v[40:43], v[208:223]
ds_read_b64_tr_b16 v[32:33], v2 offset:8192
ds_read_b64_tr_b16 v[34:35], v2 offset:9216
s_waitcnt lgkmcnt(10)
v_mfma_f32_32x32x16_bf16 v[192:207], v[148:151], v[44:47], v[192:207]
v_mfma_f32_32x32x16_bf16 v[208:223], v[156:159], v[44:47], v[208:223]
ds_read_b64_tr_b16 v[36:37], v2 offset:10240
ds_read_b64_tr_b16 v[38:39], v2 offset:11264
s_waitcnt lgkmcnt(10)
v_mfma_f32_32x32x16_bf16 v[160:175], v[64:67], v[16:19], 0
v_mfma_f32_32x32x16_bf16 v[176:191], v[72:75], v[16:19], 0
ds_read_b64_tr_b16 v[40:41], v2 offset:12288
ds_read_b64_tr_b16 v[42:43], v2 offset:13312
s_waitcnt lgkmcnt(10)
v_mfma_f32_32x32x16_bf16 v[160:175], v[68:71], v[20:23], v[160:175]
v_mfma_f32_32x32x16_bf16 v[176:191], v[76:79], v[20:23], v[176:191]
ds_read_b64_tr_b16 v[44:45], v2 offset:14336
ds_read_b64_tr_b16 v[46:47], v2 offset:15360
s_waitcnt lgkmcnt(10)
v_mfma_f32_32x32x16_bf16 v[160:175], v[80:83], v[24:27], v[160:175]
s_add_u32 s65, s58, 983040
v_cvt_pk_bf16_f32 v48, v192, v193
v_mfma_f32_32x32x16_bf16 v[176:191], v[88:91], v[24:27], v[176:191]
v_cvt_pk_bf16_f32 v49, v194, v195
v_cvt_pk_bf16_f32 v50, v196, v197
ds_read_b64_tr_b16 v[16:17], v2 offset:16384
ds_read_b64_tr_b16 v[18:19], v2 offset:17408
s_waitcnt lgkmcnt(10)
v_mfma_f32_32x32x16_bf16 v[160:175], v[84:87], v[28:31], v[160:175]
v_cvt_pk_bf16_f32 v51, v198, v199
buffer_store_dwordx4 v[48:51], v14, s[4:7], s65 offen offset:0 sc1
v_mfma_f32_32x32x16_bf16 v[176:191], v[92:95], v[28:31], v[176:191]
v_cvt_pk_bf16_f32 v52, v200, v201
v_cvt_pk_bf16_f32 v53, v202, v203
ds_read_b64_tr_b16 v[20:21], v2 offset:18432
ds_read_b64_tr_b16 v[22:23], v2 offset:19456
s_waitcnt lgkmcnt(10)
v_mfma_f32_32x32x16_bf16 v[160:175], v[96:99], v[32:35], v[160:175]
v_cvt_pk_bf16_f32 v54, v204, v205
v_cvt_pk_bf16_f32 v55, v206, v207
v_mfma_f32_32x32x16_bf16 v[176:191], v[104:107], v[32:35], v[176:191]
buffer_store_dwordx4 v[52:55], v14, s[4:7], s65 offen offset:512 sc1
s_add_u32 s66, s58, 2293760
ds_read_b64_tr_b16 v[24:25], v2 offset:20480
ds_read_b64_tr_b16 v[26:27], v2 offset:21504
s_waitcnt lgkmcnt(10)
v_mfma_f32_32x32x16_bf16 v[160:175], v[100:103], v[36:39], v[160:175]
v_cvt_pk_bf16_f32 v56, v208, v209
v_cvt_pk_bf16_f32 v57, v210, v211
v_mfma_f32_32x32x16_bf16 v[176:191], v[108:111], v[36:39], v[176:191]
v_cvt_pk_bf16_f32 v58, v212, v213
v_cvt_pk_bf16_f32 v59, v214, v215
ds_read_b64_tr_b16 v[28:29], v2 offset:22528
ds_read_b64_tr_b16 v[30:31], v2 offset:23552
s_waitcnt lgkmcnt(10)
v_mfma_f32_32x32x16_bf16 v[160:175], v[112:115], v[40:43], v[160:175]
buffer_store_dwordx4 v[56:59], v14, s[4:7], s66 offen offset:0 sc1
v_cvt_pk_bf16_f32 v60, v216, v217
v_mfma_f32_32x32x16_bf16 v[176:191], v[120:123], v[40:43], v[176:191]
v_cvt_pk_bf16_f32 v61, v218, v219
v_cvt_pk_bf16_f32 v62, v220, v221
ds_read_b64_tr_b16 v[32:33], v3 offset:0
ds_read_b64_tr_b16 v[34:35], v3 offset:1024
s_waitcnt lgkmcnt(10)
v_mfma_f32_32x32x16_bf16 v[160:175], v[116:119], v[44:47], v[160:175]
v_cvt_pk_bf16_f32 v63, v222, v223
buffer_store_dwordx4 v[60:63], v14, s[4:7], s66 offen offset:512 sc1
v_mfma_f32_32x32x16_bf16 v[176:191], v[124:127], v[44:47], v[176:191]
ds_read_b64_tr_b16 v[36:37], v3 offset:2048
ds_read_b64_tr_b16 v[38:39], v3 offset:3072
s_waitcnt lgkmcnt(10)
v_mfma_f32_32x32x16_bf16 v[160:175], v[128:131], v[16:19], v[160:175]
v_mfma_f32_32x32x16_bf16 v[176:191], v[136:139], v[16:19], v[176:191]
ds_read_b64_tr_b16 v[40:41], v3 offset:4096
ds_read_b64_tr_b16 v[42:43], v3 offset:5120
s_waitcnt lgkmcnt(10)
v_mfma_f32_32x32x16_bf16 v[160:175], v[132:135], v[20:23], v[160:175]
v_mfma_f32_32x32x16_bf16 v[176:191], v[140:143], v[20:23], v[176:191]
ds_read_b64_tr_b16 v[44:45], v3 offset:6144
ds_read_b64_tr_b16 v[46:47], v3 offset:7168
s_waitcnt lgkmcnt(10)
v_mfma_f32_32x32x16_bf16 v[160:175], v[144:147], v[24:27], v[160:175]
v_mfma_f32_32x32x16_bf16 v[176:191], v[152:155], v[24:27], v[176:191]
ds_read_b64_tr_b16 v[16:17], v3 offset:8192
ds_read_b64_tr_b16 v[18:19], v3 offset:9216
s_waitcnt lgkmcnt(10)
v_mfma_f32_32x32x16_bf16 v[160:175], v[148:151], v[28:31], v[160:175]
v_mfma_f32_32x32x16_bf16 v[176:191], v[156:159], v[28:31], v[176:191]
ds_read_b64_tr_b16 v[20:21], v3 offset:10240
ds_read_b64_tr_b16 v[22:23], v3 offset:11264
s_waitcnt lgkmcnt(10)
v_mfma_f32_32x32x16_bf16 v[192:207], v[64:67], v[32:35], 0
v_mfma_f32_32x32x16_bf16 v[208:223], v[72:75], v[32:35], 0
ds_read_b64_tr_b16 v[24:25], v3 offset:12288
ds_read_b64_tr_b16 v[26:27], v3 offset:13312
s_waitcnt lgkmcnt(10)
v_mfma_f32_32x32x16_bf16 v[192:207], v[68:71], v[36:39], v[192:207]
v_mfma_f32_32x32x16_bf16 v[208:223], v[76:79], v[36:39], v[208:223]
ds_read_b64_tr_b16 v[28:29], v3 offset:14336
ds_read_b64_tr_b16 v[30:31], v3 offset:15360
s_waitcnt lgkmcnt(10)
v_mfma_f32_32x32x16_bf16 v[192:207], v[80:83], v[40:43], v[192:207]
s_add_u32 s65, s58, 1048576
v_cvt_pk_bf16_f32 v48, v160, v161
v_mfma_f32_32x32x16_bf16 v[208:223], v[88:91], v[40:43], v[208:223]
v_cvt_pk_bf16_f32 v49, v162, v163
v_cvt_pk_bf16_f32 v50, v164, v165
ds_read_b64_tr_b16 v[32:33], v3 offset:16384
ds_read_b64_tr_b16 v[34:35], v3 offset:17408
s_waitcnt lgkmcnt(10)
v_mfma_f32_32x32x16_bf16 v[192:207], v[84:87], v[44:47], v[192:207]
v_cvt_pk_bf16_f32 v51, v166, v167
buffer_store_dwordx4 v[48:51], v14, s[4:7], s65 offen offset:0 sc1
v_mfma_f32_32x32x16_bf16 v[208:223], v[92:95], v[44:47], v[208:223]
v_cvt_pk_bf16_f32 v52, v168, v169
v_cvt_pk_bf16_f32 v53, v170, v171
ds_read_b64_tr_b16 v[36:37], v3 offset:18432
ds_read_b64_tr_b16 v[38:39], v3 offset:19456
s_waitcnt lgkmcnt(10)
v_mfma_f32_32x32x16_bf16 v[192:207], v[96:99], v[16:19], v[192:207]
v_cvt_pk_bf16_f32 v54, v172, v173
v_cvt_pk_bf16_f32 v55, v174, v175
v_mfma_f32_32x32x16_bf16 v[208:223], v[104:107], v[16:19], v[208:223]
buffer_store_dwordx4 v[52:55], v14, s[4:7], s65 offen offset:512 sc1
s_add_u32 s66, s58, 2359296
ds_read_b64_tr_b16 v[40:41], v3 offset:20480
ds_read_b64_tr_b16 v[42:43], v3 offset:21504
s_waitcnt lgkmcnt(10)
v_mfma_f32_32x32x16_bf16 v[192:207], v[100:103], v[20:23], v[192:207]
v_cvt_pk_bf16_f32 v56, v176, v177
v_cvt_pk_bf16_f32 v57, v178, v179
v_mfma_f32_32x32x16_bf16 v[208:223], v[108:111], v[20:23], v[208:223]
v_cvt_pk_bf16_f32 v58, v180, v181
v_cvt_pk_bf16_f32 v59, v182, v183
ds_read_b64_tr_b16 v[44:45], v3 offset:22528
ds_read_b64_tr_b16 v[46:47], v3 offset:23552
s_waitcnt lgkmcnt(10)
v_mfma_f32_32x32x16_bf16 v[192:207], v[112:115], v[24:27], v[192:207]
buffer_store_dwordx4 v[56:59], v14, s[4:7], s66 offen offset:0 sc1
v_cvt_pk_bf16_f32 v60, v184, v185
v_mfma_f32_32x32x16_bf16 v[208:223], v[120:123], v[24:27], v[208:223]
v_cvt_pk_bf16_f32 v61, v186, v187
v_cvt_pk_bf16_f32 v62, v188, v189
s_waitcnt vmcnt(16)
s_barrier
ds_read_b64_tr_b16 v[16:17], v2 offset:24576
ds_read_b64_tr_b16 v[18:19], v2 offset:25600
s_waitcnt lgkmcnt(10)
v_mfma_f32_32x32x16_bf16 v[192:207], v[116:119], v[28:31], v[192:207]
v_cvt_pk_bf16_f32 v63, v190, v191
buffer_store_dwordx4 v[60:63], v14, s[4:7], s66 offen offset:512 sc1
v_mfma_f32_32x32x16_bf16 v[208:223], v[124:127], v[28:31], v[208:223]
ds_read_b64_tr_b16 v[20:21], v2 offset:26624
ds_read_b64_tr_b16 v[22:23], v2 offset:27648
s_waitcnt lgkmcnt(10)
v_mfma_f32_32x32x16_bf16 v[192:207], v[128:131], v[32:35], v[192:207]
v_mfma_f32_32x32x16_bf16 v[208:223], v[136:139], v[32:35], v[208:223]
ds_read_b64_tr_b16 v[24:25], v2 offset:28672
ds_read_b64_tr_b16 v[26:27], v2 offset:29696
s_waitcnt lgkmcnt(10)
v_mfma_f32_32x32x16_bf16 v[192:207], v[132:135], v[36:39], v[192:207]
v_mfma_f32_32x32x16_bf16 v[208:223], v[140:143], v[36:39], v[208:223]
ds_read_b64_tr_b16 v[28:29], v2 offset:30720
ds_read_b64_tr_b16 v[30:31], v2 offset:31744
s_waitcnt lgkmcnt(10)
v_mfma_f32_32x32x16_bf16 v[192:207], v[144:147], v[40:43], v[192:207]
v_mfma_f32_32x32x16_bf16 v[208:223], v[152:155], v[40:43], v[208:223]
ds_read_b64_tr_b16 v[32:33], v2 offset:32768
ds_read_b64_tr_b16 v[34:35], v2 offset:33792
s_waitcnt lgkmcnt(10)
v_mfma_f32_32x32x16_bf16 v[192:207], v[148:151], v[44:47], v[192:207]
v_mfma_f32_32x32x16_bf16 v[208:223], v[156:159], v[44:47], v[208:223]
ds_read_b64_tr_b16 v[36:37], v2 offset:34816
ds_read_b64_tr_b16 v[38:39], v2 offset:35840
s_waitcnt lgkmcnt(10)
v_mfma_f32_32x32x16_bf16 v[160:175], v[64:67], v[16:19], 0
v_mfma_f32_32x32x16_bf16 v[176:191], v[72:75], v[16:19], 0
ds_read_b64_tr_b16 v[40:41], v2 offset:36864
ds_read_b64_tr_b16 v[42:43], v2 offset:37888
s_waitcnt lgkmcnt(10)
v_mfma_f32_32x32x16_bf16 v[160:175], v[68:71], v[20:23], v[160:175]
v_mfma_f32_32x32x16_bf16 v[176:191], v[76:79], v[20:23], v[176:191]
s_cmp_eq_u32 s24, 0
s_cbranch_scc0 tk9077
v_accvgpr_write_b32 a200, 1
s_mov_b64 exec, 1
buffer_atomic_add a200, off, s[28:31], s32 sc0
s_mov_b64 exec, -1
tk9077:
ds_read_b64_tr_b16 v[44:45], v2 offset:38912
ds_read_b64_tr_b16 v[46:47], v2 offset:39936
s_waitcnt lgkmcnt(10)
v_mfma_f32_32x32x16_bf16 v[160:175], v[80:83], v[24:27], v[160:175]
s_add_u32 s65, s58, 1114112
v_cvt_pk_bf16_f32 v48, v192, v193
v_mfma_f32_32x32x16_bf16 v[176:191], v[88:91], v[24:27], v[176:191]
v_cvt_pk_bf16_f32 v49, v194, v195
v_cvt_pk_bf16_f32 v50, v196, v197
ds_read_b64_tr_b16 v[16:17], v2 offset:40960
ds_read_b64_tr_b16 v[18:19], v2 offset:41984
s_waitcnt lgkmcnt(10)
v_mfma_f32_32x32x16_bf16 v[160:175], v[84:87], v[28:31], v[160:175]
v_cvt_pk_bf16_f32 v51, v198, v199
buffer_store_dwordx4 v[48:51], v14, s[4:7], s65 offen offset:0 sc1
v_mfma_f32_32x32x16_bf16 v[176:191], v[92:95], v[28:31], v[176:191]
v_cvt_pk_bf16_f32 v52, v200, v201
v_cvt_pk_bf16_f32 v53, v202, v203
ds_read_b64_tr_b16 v[20:21], v2 offset:43008
ds_read_b64_tr_b16 v[22:23], v2 offset:44032
s_waitcnt lgkmcnt(10)
v_mfma_f32_32x32x16_bf16 v[160:175], v[96:99], v[32:35], v[160:175]
v_cvt_pk_bf16_f32 v54, v204, v205
v_cvt_pk_bf16_f32 v55, v206, v207
v_mfma_f32_32x32x16_bf16 v[176:191], v[104:107], v[32:35], v[176:191]
buffer_store_dwordx4 v[52:55], v14, s[4:7], s65 offen offset:512 sc1
s_add_u32 s66, s58, 2424832
ds_read_b64_tr_b16 v[24:25], v2 offset:45056
ds_read_b64_tr_b16 v[26:27], v2 offset:46080
s_waitcnt lgkmcnt(10)
v_mfma_f32_32x32x16_bf16 v[160:175], v[100:103], v[36:39], v[160:175]
v_cvt_pk_bf16_f32 v56, v208, v209
v_cvt_pk_bf16_f32 v57, v210, v211
v_mfma_f32_32x32x16_bf16 v[176:191], v[108:111], v[36:39], v[176:191]
v_cvt_pk_bf16_f32 v58, v212, v213
v_cvt_pk_bf16_f32 v59, v214, v215
ds_read_b64_tr_b16 v[28:29], v2 offset:47104
ds_read_b64_tr_b16 v[30:31], v2 offset:48128
s_waitcnt lgkmcnt(10)
v_mfma_f32_32x32x16_bf16 v[160:175], v[112:115], v[40:43], v[160:175]
buffer_store_dwordx4 v[56:59], v14, s[4:7], s66 offen offset:0 sc1
v_cvt_pk_bf16_f32 v60, v216, v217
v_mfma_f32_32x32x16_bf16 v[176:191], v[120:123], v[40:43], v[176:191]
v_cvt_pk_bf16_f32 v61, v218, v219
v_cvt_pk_bf16_f32 v62, v220, v221
ds_read_b64_tr_b16 v[32:33], v3 offset:24576
ds_read_b64_tr_b16 v[34:35], v3 offset:25600
s_waitcnt lgkmcnt(10)
v_mfma_f32_32x32x16_bf16 v[160:175], v[116:119], v[44:47], v[160:175]
v_cvt_pk_bf16_f32 v63, v222, v223
buffer_store_dwordx4 v[60:63], v14, s[4:7], s66 offen offset:512 sc1
v_mfma_f32_32x32x16_bf16 v[176:191], v[124:127], v[44:47], v[176:191]
ds_read_b64_tr_b16 v[36:37], v3 offset:26624
ds_read_b64_tr_b16 v[38:39], v3 offset:27648
s_waitcnt lgkmcnt(10)
v_mfma_f32_32x32x16_bf16 v[160:175], v[128:131], v[16:19], v[160:175]
v_mfma_f32_32x32x16_bf16 v[176:191], v[136:139], v[16:19], v[176:191]
ds_read_b64_tr_b16 v[40:41], v3 offset:28672
ds_read_b64_tr_b16 v[42:43], v3 offset:29696
s_waitcnt lgkmcnt(10)
v_mfma_f32_32x32x16_bf16 v[160:175], v[132:135], v[20:23], v[160:175]
v_mfma_f32_32x32x16_bf16 v[176:191], v[140:143], v[20:23], v[176:191]
ds_read_b64_tr_b16 v[44:45], v3 offset:30720
ds_read_b64_tr_b16 v[46:47], v3 offset:31744
s_waitcnt lgkmcnt(10)
v_mfma_f32_32x32x16_bf16 v[160:175], v[144:147], v[24:27], v[160:175]
v_mfma_f32_32x32x16_bf16 v[176:191], v[152:155], v[24:27], v[176:191]
ds_read_b64_tr_b16 v[16:17], v3 offset:32768
ds_read_b64_tr_b16 v[18:19], v3 offset:33792
s_waitcnt lgkmcnt(10)
v_mfma_f32_32x32x16_bf16 v[160:175], v[148:151], v[28:31], v[160:175]
v_mfma_f32_32x32x16_bf16 v[176:191], v[156:159], v[28:31], v[176:191]
ds_read_b64_tr_b16 v[20:21], v3 offset:34816
ds_read_b64_tr_b16 v[22:23], v3 offset:35840
s_waitcnt lgkmcnt(10)
v_mfma_f32_32x32x16_bf16 v[192:207], v[64:67], v[32:35], 0
v_mfma_f32_32x32x16_bf16 v[208:223], v[72:75], v[32:35], 0
ds_read_b64_tr_b16 v[24:25], v3 offset:36864
ds_read_b64_tr_b16 v[26:27], v3 offset:37888
s_waitcnt lgkmcnt(10)
v_mfma_f32_32x32x16_bf16 v[192:207], v[68:71], v[36:39], v[192:207]
v_mfma_f32_32x32x16_bf16 v[208:223], v[76:79], v[36:39], v[208:223]
ds_read_b64_tr_b16 v[28:29], v3 offset:38912
ds_read_b64_tr_b16 v[30:31], v3 offset:39936
s_waitcnt lgkmcnt(10)
v_mfma_f32_32x32x16_bf16 v[192:207], v[80:83], v[40:43], v[192:207]
s_add_u32 s65, s58, 1179648
v_cvt_pk_bf16_f32 v48, v160, v161
v_mfma_f32_32x32x16_bf16 v[208:223], v[88:91], v[40:43], v[208:223]
v_cvt_pk_bf16_f32 v49, v162, v163
v_cvt_pk_bf16_f32 v50, v164, v165
ds_read_b64_tr_b16 v[32:33], v3 offset:40960
ds_read_b64_tr_b16 v[34:35], v3 offset:41984
s_waitcnt lgkmcnt(10)
v_mfma_f32_32x32x16_bf16 v[192:207], v[84:87], v[44:47], v[192:207]
v_cvt_pk_bf16_f32 v51, v166, v167
buffer_store_dwordx4 v[48:51], v14, s[4:7], s65 offen offset:0 sc1
v_mfma_f32_32x32x16_bf16 v[208:223], v[92:95], v[44:47], v[208:223]
v_cvt_pk_bf16_f32 v52, v168, v169
v_cvt_pk_bf16_f32 v53, v170, v171
ds_read_b64_tr_b16 v[36:37], v3 offset:43008
ds_read_b64_tr_b16 v[38:39], v3 offset:44032
s_waitcnt lgkmcnt(10)
v_mfma_f32_32x32x16_bf16 v[192:207], v[96:99], v[16:19], v[192:207]
v_cvt_pk_bf16_f32 v54, v172, v173
v_cvt_pk_bf16_f32 v55, v174, v175
v_mfma_f32_32x32x16_bf16 v[208:223], v[104:107], v[16:19], v[208:223]
buffer_store_dwordx4 v[52:55], v14, s[4:7], s65 offen offset:512 sc1
s_add_u32 s66, s58, 2490368
ds_read_b64_tr_b16 v[40:41], v3 offset:45056
ds_read_b64_tr_b16 v[42:43], v3 offset:46080
s_waitcnt lgkmcnt(10)
v_mfma_f32_32x32x16_bf16 v[192:207], v[100:103], v[20:23], v[192:207]
v_cvt_pk_bf16_f32 v56, v176, v177
v_cvt_pk_bf16_f32 v57, v178, v179
v_mfma_f32_32x32x16_bf16 v[208:223], v[108:111], v[20:23], v[208:223]
v_cvt_pk_bf16_f32 v58, v180, v181
v_cvt_pk_bf16_f32 v59, v182, v183
ds_read_b64_tr_b16 v[44:45], v3 offset:47104
ds_read_b64_tr_b16 v[46:47], v3 offset:48128
s_waitcnt lgkmcnt(10)
v_mfma_f32_32x32x16_bf16 v[192:207], v[112:115], v[24:27], v[192:207]
buffer_store_dwordx4 v[56:59], v14, s[4:7], s66 offen offset:0 sc1
v_cvt_pk_bf16_f32 v60, v184, v185
v_mfma_f32_32x32x16_bf16 v[208:223], v[120:123], v[24:27], v[208:223]
v_cvt_pk_bf16_f32 v61, v186, v187
v_cvt_pk_bf16_f32 v62, v188, v189
s_waitcnt lgkmcnt(8)
v_mfma_f32_32x32x16_bf16 v[192:207], v[116:119], v[28:31], v[192:207]
v_cvt_pk_bf16_f32 v63, v190, v191
buffer_store_dwordx4 v[60:63], v14, s[4:7], s66 offen offset:512 sc1
v_mfma_f32_32x32x16_bf16 v[208:223], v[124:127], v[28:31], v[208:223]
s_waitcnt lgkmcnt(6)
v_mfma_f32_32x32x16_bf16 v[192:207], v[128:131], v[32:35], v[192:207]
v_mfma_f32_32x32x16_bf16 v[208:223], v[136:139], v[32:35], v[208:223]
s_waitcnt lgkmcnt(4)
v_mfma_f32_32x32x16_bf16 v[192:207], v[132:135], v[36:39], v[192:207]
v_mfma_f32_32x32x16_bf16 v[208:223], v[140:143], v[36:39], v[208:223]
s_waitcnt lgkmcnt(2)
v_mfma_f32_32x32x16_bf16 v[192:207], v[144:147], v[40:43], v[192:207]
v_mfma_f32_32x32x16_bf16 v[208:223], v[152:155], v[40:43], v[208:223]
s_waitcnt lgkmcnt(0)
v_mfma_f32_32x32x16_bf16 v[192:207], v[148:151], v[44:47], v[192:207]
v_mfma_f32_32x32x16_bf16 v[208:223], v[156:159], v[44:47], v[208:223]
s_add_u32 s65, s58, 1245184
s_nop 9
v_cvt_pk_bf16_f32 v48, v192, v193
v_cvt_pk_bf16_f32 v49, v194, v195
v_cvt_pk_bf16_f32 v50, v196, v197
v_cvt_pk_bf16_f32 v51, v198, v199
buffer_store_dwordx4 v[48:51], v14, s[4:7], s65 offen offset:0 sc1
v_cvt_pk_bf16_f32 v52, v200, v201
v_cvt_pk_bf16_f32 v53, v202, v203
v_cvt_pk_bf16_f32 v54, v204, v205
v_cvt_pk_bf16_f32 v55, v206, v207
buffer_store_dwordx4 v[52:55], v14, s[4:7], s65 offen offset:512 sc1
s_add_u32 s66, s58, 2555904
v_cvt_pk_bf16_f32 v56, v208, v209
v_cvt_pk_bf16_f32 v57, v210, v211
v_cvt_pk_bf16_f32 v58, v212, v213
v_cvt_pk_bf16_f32 v59, v214, v215
buffer_store_dwordx4 v[56:59], v14, s[4:7], s66 offen offset:0 sc1
v_cvt_pk_bf16_f32 v60, v216, v217
v_cvt_pk_bf16_f32 v61, v218, v219
v_cvt_pk_bf16_f32 v62, v220, v221
v_cvt_pk_bf16_f32 v63, v222, v223
buffer_store_dwordx4 v[60:63], v14, s[4:7], s66 offen offset:512 sc1
wp_end:
s_waitcnt vmcnt(0)
s_branch w_taskdone
w_taskdone:
s_lshl_b32 s65, s64, 4
s_lshl_b32 s66, s55, 1
s_add_u32 s65, s65, s66
s_mov_b32 s66, 2
s_branch wk_sig
wk_p1:
s_cmp_eq_u32 s64, 0
s_cselect_b32 s8, s70, s68
s_cselect_b32 s9, s71, s69
s_cmp_eq_u32 s64, 2
s_cselect_b32 s8, s72, s8
s_cselect_b32 s9, s73, s9
s_and_b32 s9, s9, 0xffff
s_mov_b32 s10, 7864320
s_mov_b32 s11, 0x20000
s_mov_b32 s12, s74
s_and_b32 s13, s75, 0xffff
s_mov_b32 s14, 7864320
s_mov_b32 s15, 0x20000
v_accvgpr_read_b32 v4, a96
v_accvgpr_read_b32 v5, a97
v_accvgpr_read_b32 v6, a98
v_accvgpr_read_b32 v7, a99
v_accvgpr_read_b32 v8, a100
v_accvgpr_read_b32 v9, a101
v_accvgpr_read_b32 v2, a102
v_accvgpr_read_b32 v3, a103
v_accvgpr_read_b32 v13, a104
v_accvgpr_read_b32 v15, a105
s_mul_i32 s40, s24, 40960
v_add_u32 v11, s40, v1
s_mul_i32 s57, s55, 163840
s_add_u32 s57, s57, 8388608
s_mul_i32 s56, s54, 384
s_add_u32 s43, s56, 0
s_add_u32 m0, s62, 0
s_nop 0
buffer_load_dwordx4 v4, s[8:11], s43 offen lds
s_add_u32 m0, s62, 1024
s_nop 0
buffer_load_dwordx4 v5, s[8:11], s43 offen lds
s_add_u32 m0, s62, 2048
s_nop 0
buffer_load_dwordx4 v6, s[8:11], s43 offen lds
s_add_u32 m0, s62, 3072
s_nop 0
buffer_load_dwordx4 v7, s[8:11], s43 offen lds
s_add_u32 m0, s62, 4096
s_nop 0
buffer_load_dwordx4 v8, s[8:11], s43 offen lds
s_add_u32 m0, s62, 5120
s_nop 0
buffer_load_dwordx4 v9, s[8:11], s43 offen lds
s_add_u32 s43, s56, 786432
s_add_u32 m0, s62, 24576
s_nop 0
buffer_load_dwordx4 v4, s[8:11], s43 offen lds
s_add_u32 m0, s62, 25600
s_nop 0
buffer_load_dwordx4 v5, s[8:11], s43 offen lds
s_add_u32 m0, s62, 26624
s_nop 0
buffer_load_dwordx4 v6, s[8:11], s43 offen lds
s_add_u32 m0, s62, 27648
s_nop 0
buffer_load_dwordx4 v7, s[8:11], s43 offen lds
s_add_u32 m0, s62, 28672
s_nop 0
buffer_load_dwordx4 v8, s[8:11], s43 offen lds
s_add_u32 m0, s62, 29696
s_nop 0
buffer_load_dwordx4 v9, s[8:11], s43 offen lds
s_add_u32 s43, s56, 1572864
s_add_u32 m0, s62, 49152
s_nop 0
buffer_load_dwordx4 v4, s[8:11], s43 offen lds
s_add_u32 m0, s62, 50176
s_nop 0
buffer_load_dwordx4 v5, s[8:11], s43 offen lds
s_add_u32 m0, s62, 51200
s_nop 0
buffer_load_dwordx4 v6, s[8:11], s43 offen lds
s_add_u32 m0, s62, 52224
s_nop 0
buffer_load_dwordx4 v7, s[8:11], s43 offen lds
s_add_u32 m0, s62, 53248
s_nop 0
buffer_load_dwordx4 v8, s[8:11], s43 offen lds
s_add_u32 m0, s62, 54272
s_nop 0
buffer_load_dwordx4 v9, s[8:11], s43 offen lds
s_add_u32 s59, s57, 0
s_add_u32 s60, s57, 4096
s_add_u32 s61, s57, 8192
buffer_load_dwordx4 a[0:3], v11, s[4:7], s59 offen offset:0 sc1
buffer_load_dwordx4 a[8:11], v11, s[4:7], s59 offen offset:1024 sc1
buffer_load_dwordx4 a[16:19], v11, s[4:7], s59 offen offset:2048 sc1
buffer_load_dwordx4 a[24:27], v11, s[4:7], s59 offen offset:3072 sc1
buffer_load_dwordx4 a[32:35], v11, s[4:7], s60 offen offset:0 sc1
buffer_load_dwordx4 a[40:43], v11, s[4:7], s60 offen offset:1024 sc1
buffer_load_dwordx4 a[48:51], v11, s[4:7], s60 offen offset:2048 sc1
buffer_load_dwordx4 a[56:59], v11, s[4:7], s60 offen offset:3072 sc1
s_waitcnt vmcnt(20)
s_barrier
ds_read_b64_tr_b16 v[16:17], v2 offset:0
ds_read_b64_tr_b16 v[18:19], v2 offset:1536
ds_read_b64_tr_b16 v[20:21], v3 offset:0
ds_read_b64_tr_b16 v[22:23], v3 offset:1536
ds_read_b64_tr_b16 v[24:25], v2 offset:128
ds_read_b64_tr_b16 v[26:27], v2 offset:1664
ds_read_b64_tr_b16 v[28:29], v3 offset:128
ds_read_b64_tr_b16 v[30:31], v3 offset:1664
ds_read_b64_tr_b16 v[32:33], v2 offset:256
ds_read_b64_tr_b16 v[34:35], v2 offset:1792
ds_read_b64_tr_b16 v[36:37], v3 offset:256
ds_read_b64_tr_b16 v[38:39], v3 offset:1792
s_waitcnt lgkmcnt(0)
s_waitcnt vmcnt(7)
v_mfma_f32_32x32x16_bf16 v[64:79], v[16:19], a[0:3], 0
s_add_u32 s61, s57, 8192
ds_read_b64_tr_b16 v[40:41], v2 offset:6144
ds_read_b64_tr_b16 v[42:43], v2 offset:7680
v_mfma_f32_32x32x16_bf16 v[80:95], v[20:23], a[0:3], 0
ds_read_b64_tr_b16 v[44:45], v3 offset:6144
ds_read_b64_tr_b16 v[46:47], v3 offset:7680
ds_read_b64_tr_b16 v[48:49], v2 offset:6272
v_mfma_f32_32x32x16_bf16 v[96:111], v[24:27], a[0:3], 0
ds_read_b64_tr_b16 v[50:51], v2 offset:7808
ds_read_b64_tr_b16 v[52:53], v3 offset:6272
ds_read_b64_tr_b16 v[54:55], v3 offset:7808
v_mfma_f32_32x32x16_bf16 v[112:127], v[28:31], a[0:3], 0
ds_read_b64_tr_b16 v[56:57], v2 offset:6400
ds_read_b64_tr_b16 v[58:59], v2 offset:7936
ds_read_b64_tr_b16 v[60:61], v3 offset:6400
v_mfma_f32_32x32x16_bf16 v[128:143], v[32:35], a[0:3], 0
ds_read_b64_tr_b16 v[62:63], v3 offset:7936
buffer_load_dwordx4 a[64:67], v11, s[4:7], s61 offen offset:0 sc1
v_mfma_f32_32x32x16_bf16 v[144:159], v[36:39], a[0:3], 0
s_waitcnt lgkmcnt(0)
s_waitcnt vmcnt(7)
v_mfma_f32_32x32x16_bf16 v[64:79], v[40:43], a[8:11], v[64:79]
ds_read_b64_tr_b16 v[16:17], v2 offset:12288
ds_read_b64_tr_b16 v[18:19], v2 offset:13824
ds_read_b64_tr_b16 v[20:21], v3 offset:12288
v_mfma_f32_32x32x16_bf16 v[80:95], v[44:47], a[8:11], v[80:95]
ds_read_b64_tr_b16 v[22:23], v3 offset:13824
ds_read_b64_tr_b16 v[24:25], v2 offset:12416
ds_read_b64_tr_b16 v[26:27], v2 offset:13952
v_mfma_f32_32x32x16_bf16 v[96:111], v[48:51], a[8:11], v[96:111]
ds_read_b64_tr_b16 v[28:29], v3 offset:12416
ds_read_b64_tr_b16 v[30:31], v3 offset:13952
ds_read_b64_tr_b16 v[32:33], v2 offset:12544
v_mfma_f32_32x32x16_bf16 v[112:127], v[52:55], a[8:11], v[112:127]
ds_read_b64_tr_b16 v[34:35], v2 offset:14080
ds_read_b64_tr_b16 v[36:37], v3 offset:12544
ds_read_b64_tr_b16 v[38:39], v3 offset:14080
v_mfma_f32_32x32x16_bf16 v[128:143], v[56:59], a[8:11], v[128:143]
buffer_load_dwordx4 a[72:75], v11, s[4:7], s61 offen offset:1024 sc1
v_mfma_f32_32x32x16_bf16 v[144:159], v[60:63], a[8:11], v[144:159]
s_waitcnt lgkmcnt(0)
s_waitcnt vmcnt(7)
v_mfma_f32_32x32x16_bf16 v[64:79], v[16:19], a[16:19], v[64:79]
ds_read_b64_tr_b16 v[40:41], v2 offset:18432
ds_read_b64_tr_b16 v[42:43], v2 offset:19968
ds_read_b64_tr_b16 v[44:45], v3 offset:18432
v_mfma_f32_32x32x16_bf16 v[80:95], v[20:23], a[16:19], v[80:95]
ds_read_b64_tr_b16 v[46:47], v3 offset:19968
ds_read_b64_tr_b16 v[48:49], v2 offset:18560
ds_read_b64_tr_b16 v[50:51], v2 offset:20096
v_mfma_f32_32x32x16_bf16 v[96:111], v[24:27], a[16:19], v[96:111]
ds_read_b64_tr_b16 v[52:53], v3 offset:18560
ds_read_b64_tr_b16 v[54:55], v3 offset:20096
ds_read_b64_tr_b16 v[56:57], v2 offset:18688
v_mfma_f32_32x32x16_bf16 v[112:127], v[28:31], a[16:19], v[112:127]
ds_read_b64_tr_b16 v[58:59], v2 offset:20224
ds_read_b64_tr_b16 v[60:61], v3 offset:18688
ds_read_b64_tr_b16 v[62:63], v3 offset:20224
v_mfma_f32_32x32x16_bf16 v[128:143], v[32:35], a[16:19], v[128:143]
buffer_load_dwordx4 a[0:3], v11, s[4:7], s61 offen offset:2048 sc1
v_mfma_f32_32x32x16_bf16 v[144:159], v[36:39], a[16:19], v[144:159]
s_waitcnt lgkmcnt(0)
s_barrier
s_waitcnt vmcnt(7)
v_mfma_f32_32x32x16_bf16 v[64:79], v[40:43], a[24:27], v[64:79]
ds_read_b64_tr_b16 v[16:17], v2 offset:24576
ds_read_b64_tr_b16 v[18:19], v2 offset:26112
ds_read_b64_tr_b16 v[20:21], v3 offset:24576
v_mfma_f32_32x32x16_bf16 v[80:95], v[44:47], a[24:27], v[80:95]
ds_read_b64_tr_b16 v[22:23], v3 offset:26112
ds_read_b64_tr_b16 v[24:25], v2 offset:24704
ds_read_b64_tr_b16 v[26:27], v2 offset:26240
v_mfma_f32_32x32x16_bf16 v[96:111], v[48:51], a[24:27], v[96:111]
ds_read_b64_tr_b16 v[28:29], v3 offset:24704
ds_read_b64_tr_b16 v[30:31], v3 offset:26240
ds_read_b64_tr_b16 v[32:33], v2 offset:24832
v_mfma_f32_32x32x16_bf16 v[112:127], v[52:55], a[24:27], v[112:127]
ds_read_b64_tr_b16 v[34:35], v2 offset:26368
ds_read_b64_tr_b16 v[36:37], v3 offset:24832
ds_read_b64_tr_b16 v[38:39], v3 offset:26368
v_mfma_f32_32x32x16_bf16 v[128:143], v[56:59], a[24:27], v[128:143]
s_add_u32 s43, s56, 2359296
s_add_u32 m0, s62, 73728
s_nop 0
buffer_load_dwordx4 v4, s[8:11], s43 offen lds
s_add_u32 m0, s62, 74752
s_nop 0
buffer_load_dwordx4 v5, s[8:11], s43 offen lds
s_add_u32 m0, s62, 75776
s_nop 0
buffer_load_dwordx4 v6, s[8:11], s43 offen lds
s_add_u32 m0, s62, 76800
s_nop 0
buffer_load_dwordx4 v7, s[8:11], s43 offen lds
s_add_u32 m0, s62, 77824
s_nop 0
buffer_load_dwordx4 v8, s[8:11], s43 offen lds
s_add_u32 m0, s62, 78848
s_nop 0
buffer_load_dwordx4 v9, s[8:11], s43 offen lds
buffer_load_dwordx4 a[8:11], v11, s[4:7], s61 offen offset:3072 sc1
v_mfma_f32_32x32x16_bf16 v[144:159], v[60:63], a[24:27], v[144:159]
s_waitcnt lgkmcnt(0)
s_waitcnt vmcnt(13)
v_mfma_f32_32x32x16_bf16 v[64:79], v[16:19], a[32:35], v[64:79]
s_add_u32 s59, s57, 12288
ds_read_b64_tr_b16 v[40:41], v2 offset:30720
ds_read_b64_tr_b16 v[42:43], v2 offset:32256
v_mfma_f32_32x32x16_bf16 v[80:95], v[20:23], a[32:35], v[80:95]
ds_read_b64_tr_b16 v[44:45], v3 offset:30720
ds_read_b64_tr_b16 v[46:47], v3 offset:32256
ds_read_b64_tr_b16 v[48:49], v2 offset:30848
v_mfma_f32_32x32x16_bf16 v[96:111], v[24:27], a[32:35], v[96:111]
ds_read_b64_tr_b16 v[50:51], v2 offset:32384
ds_read_b64_tr_b16 v[52:53], v3 offset:30848
ds_read_b64_tr_b16 v[54:55], v3 offset:32384
v_mfma_f32_32x32x16_bf16 v[112:127], v[28:31], a[32:35], v[112:127]
ds_read_b64_tr_b16 v[56:57], v2 offset:30976
ds_read_b64_tr_b16 v[58:59], v2 offset:32512
ds_read_b64_tr_b16 v[60:61], v3 offset:30976
v_mfma_f32_32x32x16_bf16 v[128:143], v[32:35], a[32:35], v[128:143]
ds_read_b64_tr_b16 v[62:63], v3 offset:32512
buffer_load_dwordx4 a[16:19], v11, s[4:7], s59 offen offset:0 sc1
v_mfma_f32_32x32x16_bf16 v[144:159], v[36:39], a[32:35], v[144:159]
s_waitcnt lgkmcnt(0)
s_waitcnt vmcnt(13)
v_mfma_f32_32x32x16_bf16 v[64:79], v[40:43], a[40:43], v[64:79]
ds_read_b64_tr_b16 v[16:17], v2 offset:36864
ds_read_b64_tr_b16 v[18:19], v2 offset:38400
ds_read_b64_tr_b16 v[20:21], v3 offset:36864
v_mfma_f32_32x32x16_bf16 v[80:95], v[44:47], a[40:43], v[80:95]
ds_read_b64_tr_b16 v[22:23], v3 offset:38400
ds_read_b64_tr_b16 v[24:25], v2 offset:36992
ds_read_b64_tr_b16 v[26:27], v2 offset:38528
v_mfma_f32_32x32x16_bf16 v[96:111], v[48:51], a[40:43], v[96:111]
ds_read_b64_tr_b16 v[28:29], v3 offset:36992
ds_read_b64_tr_b16 v[30:31], v3 offset:38528
ds_read_b64_tr_b16 v[32:33], v2 offset:37120
v_mfma_f32_32x32x16_bf16 v[112:127], v[52:55], a[40:43], v[112:127]
ds_read_b64_tr_b16 v[34:35], v2 offset:38656
ds_read_b64_tr_b16 v[36:37], v3 offset:37120
ds_read_b64_tr_b16 v[38:39], v3 offset:38656
v_mfma_f32_32x32x16_bf16 v[128:143], v[56:59], a[40:43], v[128:143]
buffer_load_dwordx4 a[24:27], v11, s[4:7], s59 offen offset:1024 sc1
v_mfma_f32_32x32x16_bf16 v[144:159], v[60:63], a[40:43], v[144:159]
s_waitcnt lgkmcnt(0)
s_waitcnt vmcnt(13)
v_mfma_f32_32x32x16_bf16 v[64:79], v[16:19], a[48:51], v[64:79]
ds_read_b64_tr_b16 v[40:41], v2 offset:43008
ds_read_b64_tr_b16 v[42:43], v2 offset:44544
ds_read_b64_tr_b16 v[44:45], v3 offset:43008
v_mfma_f32_32x32x16_bf16 v[80:95], v[20:23], a[48:51], v[80:95]
ds_read_b64_tr_b16 v[46:47], v3 offset:44544
ds_read_b64_tr_b16 v[48:49], v2 offset:43136
ds_read_b64_tr_b16 v[50:51], v2 offset:44672
v_mfma_f32_32x32x16_bf16 v[96:111], v[24:27], a[48:51], v[96:111]
ds_read_b64_tr_b16 v[52:53], v3 offset:43136
ds_read_b64_tr_b16 v[54:55], v3 offset:44672
ds_read_b64_tr_b16 v[56:57], v2 offset:43264
v_mfma_f32_32x32x16_bf16 v[112:127], v[28:31], a[48:51], v[112:127]
ds_read_b64_tr_b16 v[58:59], v2 offset:44800
ds_read_b64_tr_b16 v[60:61], v3 offset:43264
ds_read_b64_tr_b16 v[62:63], v3 offset:44800
v_mfma_f32_32x32x16_bf16 v[128:143], v[32:35], a[48:51], v[128:143]
buffer_load_dwordx4 a[32:35], v11, s[4:7], s59 offen offset:2048 sc1
v_mfma_f32_32x32x16_bf16 v[144:159], v[36:39], a[48:51], v[144:159]
s_waitcnt lgkmcnt(0)
s_barrier
s_waitcnt vmcnt(13)
v_mfma_f32_32x32x16_bf16 v[64:79], v[40:43], a[56:59], v[64:79]
ds_read_b64_tr_b16 v[16:17], v13 offset:0
ds_read_b64_tr_b16 v[18:19], v13 offset:1536
ds_read_b64_tr_b16 v[20:21], v15 offset:0
v_mfma_f32_32x32x16_bf16 v[80:95], v[44:47], a[56:59], v[80:95]
ds_read_b64_tr_b16 v[22:23], v15 offset:1536
ds_read_b64_tr_b16 v[24:25], v13 offset:128
ds_read_b64_tr_b16 v[26:27], v13 offset:1664
v_mfma_f32_32x32x16_bf16 v[96:111], v[48:51], a[56:59], v[96:111]
ds_read_b64_tr_b16 v[28:29], v15 offset:128
ds_read_b64_tr_b16 v[30:31], v15 offset:1664
ds_read_b64_tr_b16 v[32:33], v13 offset:256
v_mfma_f32_32x32x16_bf16 v[112:127], v[52:55], a[56:59], v[112:127]
ds_read_b64_tr_b16 v[34:35], v13 offset:1792
ds_read_b64_tr_b16 v[36:37], v15 offset:256
ds_read_b64_tr_b16 v[38:39], v15 offset:1792
v_mfma_f32_32x32x16_bf16 v[128:143], v[56:59], a[56:59], v[128:143]
s_add_u32 s43, s56, 3145728
s_add_u32 m0, s62, 0
s_nop 0
buffer_load_dwordx4 v4, s[8:11], s43 offen lds
s_add_u32 m0, s62, 1024
s_nop 0
buffer_load_dwordx4 v5, s[8:11], s43 offen lds
s_add_u32 m0, s62, 2048
s_nop 0
buffer_load_dwordx4 v6, s[8:11], s43 offen lds
s_add_u32 m0, s62, 3072
s_nop 0
buffer_load_dwordx4 v7, s[8:11], s43 offen lds
s_add_u32 m0, s62, 4096
s_nop 0
buffer_load_dwordx4 v8, s[8:11], s43 offen lds
s_add_u32 m0, s62, 5120
s_nop 0
buffer_load_dwordx4 v9, s[8:11], s43 offen lds
buffer_load_dwordx4 a[40:43], v11, s[4:7], s59 offen offset:3072 sc1
v_mfma_f32_32x32x16_bf16 v[144:159], v[60:63], a[56:59], v[144:159]
s_waitcnt lgkmcnt(0)
s_waitcnt vmcnt(19)
v_mfma_f32_32x32x16_bf16 v[64:79], v[16:19], a[64:67], v[64:79]
s_add_u32 s60, s57, 16384
ds_read_b64_tr_b16 v[40:41], v13 offset:6144
ds_read_b64_tr_b16 v[42:43], v13 offset:7680
v_mfma_f32_32x32x16_bf16 v[80:95], v[20:23], a[64:67], v[80:95]
ds_read_b64_tr_b16 v[44:45], v15 offset:6144
ds_read_b64_tr_b16 v[46:47], v15 offset:7680
ds_read_b64_tr_b16 v[48:49], v13 offset:6272
v_mfma_f32_32x32x16_bf16 v[96:111], v[24:27], a[64:67], v[96:111]
ds_read_b64_tr_b16 v[50:51], v13 offset:7808
ds_read_b64_tr_b16 v[52:53], v15 offset:6272
ds_read_b64_tr_b16 v[54:55], v15 offset:7808
v_mfma_f32_32x32x16_bf16 v[112:127], v[28:31], a[64:67], v[112:127]
ds_read_b64_tr_b16 v[56:57], v13 offset:6400
ds_read_b64_tr_b16 v[58:59], v13 offset:7936
ds_read_b64_tr_b16 v[60:61], v15 offset:6400
v_mfma_f32_32x32x16_bf16 v[128:143], v[32:35], a[64:67], v[128:143]
ds_read_b64_tr_b16 v[62:63], v15 offset:7936
buffer_load_dwordx4 a[48:51], v11, s[4:7], s60 offen offset:0 sc1
v_mfma_f32_32x32x16_bf16 v[144:159], v[36:39], a[64:67], v[144:159]
s_waitcnt lgkmcnt(0)
s_waitcnt vmcnt(19)
v_mfma_f32_32x32x16_bf16 v[64:79], v[40:43], a[72:75], v[64:79]
ds_read_b64_tr_b16 v[16:17], v13 offset:12288
ds_read_b64_tr_b16 v[18:19], v13 offset:13824
ds_read_b64_tr_b16 v[20:21], v15 offset:12288
v_mfma_f32_32x32x16_bf16 v[80:95], v[44:47], a[72:75], v[80:95]
ds_read_b64_tr_b16 v[22:23], v15 offset:13824
ds_read_b64_tr_b16 v[24:25], v13 offset:12416
ds_read_b64_tr_b16 v[26:27], v13 offset:13952
v_mfma_f32_32x32x16_bf16 v[96:111], v[48:51], a[72:75], v[96:111]
ds_read_b64_tr_b16 v[28:29], v15 offset:12416
ds_read_b64_tr_b16 v[30:31], v15 offset:13952
ds_read_b64_tr_b16 v[32:33], v13 offset:12544
v_mfma_f32_32x32x16_bf16 v[112:127], v[52:55], a[72:75], v[112:127]
ds_read_b64_tr_b16 v[34:35], v13 offset:14080
ds_read_b64_tr_b16 v[36:37], v15 offset:12544
ds_read_b64_tr_b16 v[38:39], v15 offset:14080
v_mfma_f32_32x32x16_bf16 v[128:143], v[56:59], a[72:75], v[128:143]
buffer_load_dwordx4 a[56:59], v11, s[4:7], s60 offen offset:1024 sc1
v_mfma_f32_32x32x16_bf16 v[144:159], v[60:63], a[72:75], v[144:159]
s_waitcnt lgkmcnt(0)
s_waitcnt vmcnt(19)
v_mfma_f32_32x32x16_bf16 v[64:79], v[16:19], a[0:3], v[64:79]
ds_read_b64_tr_b16 v[40:41], v13 offset:18432
ds_read_b64_tr_b16 v[42:43], v13 offset:19968
ds_read_b64_tr_b16 v[44:45], v15 offset:18432
v_mfma_f32_32x32x16_bf16 v[80:95], v[20:23], a[0:3], v[80:95]
ds_read_b64_tr_b16 v[46:47], v15 offset:19968
ds_read_b64_tr_b16 v[48:49], v13 offset:18560
ds_read_b64_tr_b16 v[50:51], v13 offset:20096
v_mfma_f32_32x32x16_bf16 v[96:111], v[24:27], a[0:3], v[96:111]
ds_read_b64_tr_b16 v[52:53], v15 offset:18560
ds_read_b64_tr_b16 v[54:55], v15 offset:20096
ds_read_b64_tr_b16 v[56:57], v13 offset:18688
v_mfma_f32_32x32x16_bf16 v[112:127], v[28:31], a[0:3], v[112:127]
ds_read_b64_tr_b16 v[58:59], v13 offset:20224
ds_read_b64_tr_b16 v[60:61], v15 offset:18688
ds_read_b64_tr_b16 v[62:63], v15 offset:20224
v_mfma_f32_32x32x16_bf16 v[128:143], v[32:35], a[0:3], v[128:143]
buffer_load_dwordx4 a[64:67], v11, s[4:7], s60 offen offset:2048 sc1
v_mfma_f32_32x32x16_bf16 v[144:159], v[36:39], a[0:3], v[144:159]
s_waitcnt lgkmcnt(0)
s_waitcnt vmcnt(14)
s_barrier
s_waitcnt vmcnt(13)
v_mfma_f32_32x32x16_bf16 v[64:79], v[40:43], a[8:11], v[64:79]
ds_read_b64_tr_b16 v[16:17], v13 offset:24576
ds_read_b64_tr_b16 v[18:19], v13 offset:26112
ds_read_b64_tr_b16 v[20:21], v15 offset:24576
v_mfma_f32_32x32x16_bf16 v[80:95], v[44:47], a[8:11], v[80:95]
ds_read_b64_tr_b16 v[22:23], v15 offset:26112
ds_read_b64_tr_b16 v[24:25], v13 offset:24704
ds_read_b64_tr_b16 v[26:27], v13 offset:26240
v_mfma_f32_32x32x16_bf16 v[96:111], v[48:51], a[8:11], v[96:111]
ds_read_b64_tr_b16 v[28:29], v15 offset:24704
ds_read_b64_tr_b16 v[30:31], v15 offset:26240
ds_read_b64_tr_b16 v[32:33], v13 offset:24832
v_mfma_f32_32x32x16_bf16 v[112:127], v[52:55], a[8:11], v[112:127]
ds_read_b64_tr_b16 v[34:35], v13 offset:26368
ds_read_b64_tr_b16 v[36:37], v15 offset:24832
ds_read_b64_tr_b16 v[38:39], v15 offset:26368
v_mfma_f32_32x32x16_bf16 v[128:143], v[56:59], a[8:11], v[128:143]
s_add_u32 s43, s56, 3932160
s_add_u32 m0, s62, 24576
s_nop 0
buffer_load_dwordx4 v4, s[8:11], s43 offen lds
s_add_u32 m0, s62, 25600
s_nop 0
buffer_load_dwordx4 v5, s[8:11], s43 offen lds
s_add_u32 m0, s62, 26624
s_nop 0
buffer_load_dwordx4 v6, s[8:11], s43 offen lds
s_add_u32 m0, s62, 27648
s_nop 0
buffer_load_dwordx4 v7, s[8:11], s43 offen lds
s_add_u32 m0, s62, 28672
s_nop 0
buffer_load_dwordx4 v8, s[8:11], s43 offen lds
s_add_u32 m0, s62, 29696
s_nop 0
buffer_load_dwordx4 v9, s[8:11], s43 offen lds
buffer_load_dwordx4 a[72:75], v11, s[4:7], s60 offen offset:3072 sc1
v_mfma_f32_32x32x16_bf16 v[144:159], v[60:63], a[8:11], v[144:159]
s_waitcnt lgkmcnt(0)
s_waitcnt vmcnt(19)
v_mfma_f32_32x32x16_bf16 v[64:79], v[16:19], a[16:19], v[64:79]
s_add_u32 s61, s57, 20480
ds_read_b64_tr_b16 v[40:41], v13 offset:30720
ds_read_b64_tr_b16 v[42:43], v13 offset:32256
v_mfma_f32_32x32x16_bf16 v[80:95], v[20:23], a[16:19], v[80:95]
ds_read_b64_tr_b16 v[44:45], v15 offset:30720
ds_read_b64_tr_b16 v[46:47], v15 offset:32256
ds_read_b64_tr_b16 v[48:49], v13 offset:30848
v_mfma_f32_32x32x16_bf16 v[96:111], v[24:27], a[16:19], v[96:111]
ds_read_b64_tr_b16 v[50:51], v13 offset:32384
ds_read_b64_tr_b16 v[52:53], v15 offset:30848
ds_read_b64_tr_b16 v[54:55], v15 offset:32384
v_mfma_f32_32x32x16_bf16 v[112:127], v[28:31], a[16:19], v[112:127]
ds_read_b64_tr_b16 v[56:57], v13 offset:30976
ds_read_b64_tr_b16 v[58:59], v13 offset:32512
ds_read_b64_tr_b16 v[60:61], v15 offset:30976
v_mfma_f32_32x32x16_bf16 v[128:143], v[32:35], a[16:19], v[128:143]
ds_read_b64_tr_b16 v[62:63], v15 offset:32512
buffer_load_dwordx4 a[0:3], v11, s[4:7], s61 offen offset:0 sc1
v_mfma_f32_32x32x16_bf16 v[144:159], v[36:39], a[16:19], v[144:159]
s_waitcnt lgkmcnt(0)
s_waitcnt vmcnt(19)
v_mfma_f32_32x32x16_bf16 v[64:79], v[40:43], a[24:27], v[64:79]
ds_read_b64_tr_b16 v[16:17], v13 offset:36864
ds_read_b64_tr_b16 v[18:19], v13 offset:38400
ds_read_b64_tr_b16 v[20:21], v15 offset:36864
v_mfma_f32_32x32x16_bf16 v[80:95], v[44:47], a[24:27], v[80:95]
ds_read_b64_tr_b16 v[22:23], v15 offset:38400
ds_read_b64_tr_b16 v[24:25], v13 offset:36992
ds_read_b64_tr_b16 v[26:27], v13 offset:38528
v_mfma_f32_32x32x16_bf16 v[96:111], v[48:51], a[24:27], v[96:111]
ds_read_b64_tr_b16 v[28:29], v15 offset:36992
ds_read_b64_tr_b16 v[30:31], v15 offset:38528
ds_read_b64_tr_b16 v[32:33], v13 offset:37120
v_mfma_f32_32x32x16_bf16 v[112:127], v[52:55], a[24:27], v[112:127]
ds_read_b64_tr_b16 v[34:35], v13 offset:38656
ds_read_b64_tr_b16 v[36:37], v15 offset:37120
ds_read_b64_tr_b16 v[38:39], v15 offset:38656
v_mfma_f32_32x32x16_bf16 v[128:143], v[56:59], a[24:27], v[128:143]
buffer_load_dwordx4 a[8:11], v11, s[4:7], s61 offen offset:1024 sc1
v_mfma_f32_32x32x16_bf16 v[144:159], v[60:63], a[24:27], v[144:159]
s_waitcnt lgkmcnt(0)
s_waitcnt vmcnt(19)
v_mfma_f32_32x32x16_bf16 v[64:79], v[16:19], a[32:35], v[64:79]
ds_read_b64_tr_b16 v[40:41], v13 offset:43008
ds_read_b64_tr_b16 v[42:43], v13 offset:44544
ds_read_b64_tr_b16 v[44:45], v15 offset:43008
v_mfma_f32_32x32x16_bf16 v[80:95], v[20:23], a[32:35], v[80:95]
ds_read_b64_tr_b16 v[46:47], v15 offset:44544
ds_read_b64_tr_b16 v[48:49], v13 offset:43136
ds_read_b64_tr_b16 v[50:51], v13 offset:44672
v_mfma_f32_32x32x16_bf16 v[96:111], v[24:27], a[32:35], v[96:111]
ds_read_b64_tr_b16 v[52:53], v15 offset:43136
ds_read_b64_tr_b16 v[54:55], v15 offset:44672
ds_read_b64_tr_b16 v[56:57], v13 offset:43264
v_mfma_f32_32x32x16_bf16 v[112:127], v[28:31], a[32:35], v[112:127]
ds_read_b64_tr_b16 v[58:59], v13 offset:44800
ds_read_b64_tr_b16 v[60:61], v15 offset:43264
ds_read_b64_tr_b16 v[62:63], v15 offset:44800
v_mfma_f32_32x32x16_bf16 v[128:143], v[32:35], a[32:35], v[128:143]
buffer_load_dwordx4 a[16:19], v11, s[4:7], s61 offen offset:2048 sc1
v_mfma_f32_32x32x16_bf16 v[144:159], v[36:39], a[32:35], v[144:159]
s_waitcnt lgkmcnt(0)
s_waitcnt vmcnt(14)
s_barrier
s_waitcnt vmcnt(13)
v_mfma_f32_32x32x16_bf16 v[64:79], v[40:43], a[40:43], v[64:79]
ds_read_b64_tr_b16 v[16:17], v2 offset:0
ds_read_b64_tr_b16 v[18:19], v2 offset:1536
ds_read_b64_tr_b16 v[20:21], v3 offset:0
v_mfma_f32_32x32x16_bf16 v[80:95], v[44:47], a[40:43], v[80:95]
ds_read_b64_tr_b16 v[22:23], v3 offset:1536
ds_read_b64_tr_b16 v[24:25], v2 offset:128
ds_read_b64_tr_b16 v[26:27], v2 offset:1664
v_mfma_f32_32x32x16_bf16 v[96:111], v[48:51], a[40:43], v[96:111]
ds_read_b64_tr_b16 v[28:29], v3 offset:128
ds_read_b64_tr_b16 v[30:31], v3 offset:1664
ds_read_b64_tr_b16 v[32:33], v2 offset:256
v_mfma_f32_32x32x16_bf16 v[112:127], v[52:55], a[40:43], v[112:127]
ds_read_b64_tr_b16 v[34:35], v2 offset:1792
ds_read_b64_tr_b16 v[36:37], v3 offset:256
ds_read_b64_tr_b16 v[38:39], v3 offset:1792
v_mfma_f32_32x32x16_bf16 v[128:143], v[56:59], a[40:43], v[128:143]
s_add_u32 s43, s56, 4718592
s_add_u32 m0, s62, 49152
s_nop 0
buffer_load_dwordx4 v4, s[8:11], s43 offen lds
s_add_u32 m0, s62, 50176
s_nop 0
buffer_load_dwordx4 v5, s[8:11], s43 offen lds
s_add_u32 m0, s62, 51200
s_nop 0
buffer_load_dwordx4 v6, s[8:11], s43 offen lds
s_add_u32 m0, s62, 52224
s_nop 0
buffer_load_dwordx4 v7, s[8:11], s43 offen lds
s_add_u32 m0, s62, 53248
s_nop 0
buffer_load_dwordx4 v8, s[8:11], s43 offen lds
s_add_u32 m0, s62, 54272
s_nop 0
buffer_load_dwordx4 v9, s[8:11], s43 offen lds
buffer_load_dwordx4 a[24:27], v11, s[4:7], s61 offen offset:3072 sc1
v_mfma_f32_32x32x16_bf16 v[144:159], v[60:63], a[40:43], v[144:159]
s_waitcnt lgkmcnt(0)
s_waitcnt vmcnt(19)
v_mfma_f32_32x32x16_bf16 v[64:79], v[16:19], a[48:51], v[64:79]
s_add_u32 s59, s57, 24576
ds_read_b64_tr_b16 v[40:41], v2 offset:6144
ds_read_b64_tr_b16 v[42:43], v2 offset:7680
v_mfma_f32_32x32x16_bf16 v[80:95], v[20:23], a[48:51], v[80:95]
ds_read_b64_tr_b16 v[44:45], v3 offset:6144
ds_read_b64_tr_b16 v[46:47], v3 offset:7680
ds_read_b64_tr_b16 v[48:49], v2 offset:6272
v_mfma_f32_32x32x16_bf16 v[96:111], v[24:27], a[48:51], v[96:111]
ds_read_b64_tr_b16 v[50:51], v2 offset:7808
ds_read_b64_tr_b16 v[52:53], v3 offset:6272
ds_read_b64_tr_b16 v[54:55], v3 offset:7808
v_mfma_f32_32x32x16_bf16 v[112:127], v[28:31], a[48:51], v[112:127]
ds_read_b64_tr_b16 v[56:57], v2 offset:6400
ds_read_b64_tr_b16 v[58:59], v2 offset:7936
ds_read_b64_tr_b16 v[60:61], v3 offset:6400
v_mfma_f32_32x32x16_bf16 v[128:143], v[32:35], a[48:51], v[128:143]
ds_read_b64_tr_b16 v[62:63], v3 offset:7936
buffer_load_dwordx4 a[32:35], v11, s[4:7], s59 offen offset:0 sc1
v_mfma_f32_32x32x16_bf16 v[144:159], v[36:39], a[48:51], v[144:159]
s_waitcnt lgkmcnt(0)
s_waitcnt vmcnt(19)
v_mfma_f32_32x32x16_bf16 v[64:79], v[40:43], a[56:59], v[64:79]
ds_read_b64_tr_b16 v[16:17], v2 offset:12288
ds_read_b64_tr_b16 v[18:19], v2 offset:13824
ds_read_b64_tr_b16 v[20:21], v3 offset:12288
v_mfma_f32_32x32x16_bf16 v[80:95], v[44:47], a[56:59], v[80:95]
ds_read_b64_tr_b16 v[22:23], v3 offset:13824
ds_read_b64_tr_b16 v[24:25], v2 offset:12416
ds_read_b64_tr_b16 v[26:27], v2 offset:13952
v_mfma_f32_32x32x16_bf16 v[96:111], v[48:51], a[56:59], v[96:111]
ds_read_b64_tr_b16 v[28:29], v3 offset:12416
ds_read_b64_tr_b16 v[30:31], v3 offset:13952
ds_read_b64_tr_b16 v[32:33], v2 offset:12544
v_mfma_f32_32x32x16_bf16 v[112:127], v[52:55], a[56:59], v[112:127]
ds_read_b64_tr_b16 v[34:35], v2 offset:14080
ds_read_b64_tr_b16 v[36:37], v3 offset:12544
ds_read_b64_tr_b16 v[38:39], v3 offset:14080
v_mfma_f32_32x32x16_bf16 v[128:143], v[56:59], a[56:59], v[128:143]
buffer_load_dwordx4 a[40:43], v11, s[4:7], s59 offen offset:1024 sc1
v_mfma_f32_32x32x16_bf16 v[144:159], v[60:63], a[56:59], v[144:159]
s_waitcnt lgkmcnt(0)
s_waitcnt vmcnt(19)
v_mfma_f32_32x32x16_bf16 v[64:79], v[16:19], a[64:67], v[64:79]
ds_read_b64_tr_b16 v[40:41], v2 offset:18432
ds_read_b64_tr_b16 v[42:43], v2 offset:19968
ds_read_b64_tr_b16 v[44:45], v3 offset:18432
v_mfma_f32_32x32x16_bf16 v[80:95], v[20:23], a[64:67], v[80:95]
ds_read_b64_tr_b16 v[46:47], v3 offset:19968
ds_read_b64_tr_b16 v[48:49], v2 offset:18560
ds_read_b64_tr_b16 v[50:51], v2 offset:20096
v_mfma_f32_32x32x16_bf16 v[96:111], v[24:27], a[64:67], v[96:111]
ds_read_b64_tr_b16 v[52:53], v3 offset:18560
ds_read_b64_tr_b16 v[54:55], v3 offset:20096
ds_read_b64_tr_b16 v[56:57], v2 offset:18688
v_mfma_f32_32x32x16_bf16 v[112:127], v[28:31], a[64:67], v[112:127]
ds_read_b64_tr_b16 v[58:59], v2 offset:20224
ds_read_b64_tr_b16 v[60:61], v3 offset:18688
ds_read_b64_tr_b16 v[62:63], v3 offset:20224
v_mfma_f32_32x32x16_bf16 v[128:143], v[32:35], a[64:67], v[128:143]
buffer_load_dwordx4 a[48:51], v11, s[4:7], s59 offen offset:2048 sc1
v_mfma_f32_32x32x16_bf16 v[144:159], v[36:39], a[64:67], v[144:159]
s_waitcnt lgkmcnt(0)
s_waitcnt vmcnt(14)
s_barrier
s_waitcnt vmcnt(13)
v_mfma_f32_32x32x16_bf16 v[64:79], v[40:43], a[72:75], v[64:79]
ds_read_b64_tr_b16 v[16:17], v2 offset:24576
ds_read_b64_tr_b16 v[18:19], v2 offset:26112
ds_read_b64_tr_b16 v[20:21], v3 offset:24576
v_mfma_f32_32x32x16_bf16 v[80:95], v[44:47], a[72:75], v[80:95]
ds_read_b64_tr_b16 v[22:23], v3 offset:26112
ds_read_b64_tr_b16 v[24:25], v2 offset:24704
ds_read_b64_tr_b16 v[26:27], v2 offset:26240
v_mfma_f32_32x32x16_bf16 v[96:111], v[48:51], a[72:75], v[96:111]
ds_read_b64_tr_b16 v[28:29], v3 offset:24704
ds_read_b64_tr_b16 v[30:31], v3 offset:26240
ds_read_b64_tr_b16 v[32:33], v2 offset:24832
v_mfma_f32_32x32x16_bf16 v[112:127], v[52:55], a[72:75], v[112:127]
ds_read_b64_tr_b16 v[34:35], v2 offset:26368
ds_read_b64_tr_b16 v[36:37], v3 offset:24832
ds_read_b64_tr_b16 v[38:39], v3 offset:26368
v_mfma_f32_32x32x16_bf16 v[128:143], v[56:59], a[72:75], v[128:143]
s_add_u32 s43, s56, 5505024
s_add_u32 m0, s62, 73728
s_nop 0
buffer_load_dwordx4 v4, s[8:11], s43 offen lds
s_add_u32 m0, s62, 74752
s_nop 0
buffer_load_dwordx4 v5, s[8:11], s43 offen lds
s_add_u32 m0, s62, 75776
s_nop 0
buffer_load_dwordx4 v6, s[8:11], s43 offen lds
s_add_u32 m0, s62, 76800
s_nop 0
buffer_load_dwordx4 v7, s[8:11], s43 offen lds
s_add_u32 m0, s62, 77824
s_nop 0
buffer_load_dwordx4 v8, s[8:11], s43 offen lds
s_add_u32 m0, s62, 78848
s_nop 0
buffer_load_dwordx4 v9, s[8:11], s43 offen lds
buffer_load_dwordx4 a[56:59], v11, s[4:7], s59 offen offset:3072 sc1
v_mfma_f32_32x32x16_bf16 v[144:159], v[60:63], a[72:75], v[144:159]
s_waitcnt lgkmcnt(0)
s_waitcnt vmcnt(19)
v_mfma_f32_32x32x16_bf16 v[64:79], v[16:19], a[0:3], v[64:79]
s_add_u32 s60, s57, 28672
ds_read_b64_tr_b16 v[40:41], v2 offset:30720
ds_read_b64_tr_b16 v[42:43], v2 offset:32256
v_mfma_f32_32x32x16_bf16 v[80:95], v[20:23], a[0:3], v[80:95]
ds_read_b64_tr_b16 v[44:45], v3 offset:30720
ds_read_b64_tr_b16 v[46:47], v3 offset:32256
ds_read_b64_tr_b16 v[48:49], v2 offset:30848
v_mfma_f32_32x32x16_bf16 v[96:111], v[24:27], a[0:3], v[96:111]
ds_read_b64_tr_b16 v[50:51], v2 offset:32384
ds_read_b64_tr_b16 v[52:53], v3 offset:30848
ds_read_b64_tr_b16 v[54:55], v3 offset:32384
v_mfma_f32_32x32x16_bf16 v[112:127], v[28:31], a[0:3], v[112:127]
ds_read_b64_tr_b16 v[56:57], v2 offset:30976
ds_read_b64_tr_b16 v[58:59], v2 offset:32512
ds_read_b64_tr_b16 v[60:61], v3 offset:30976
v_mfma_f32_32x32x16_bf16 v[128:143], v[32:35], a[0:3], v[128:143]
ds_read_b64_tr_b16 v[62:63], v3 offset:32512
buffer_load_dwordx4 a[64:67], v11, s[4:7], s60 offen offset:0 sc1
v_mfma_f32_32x32x16_bf16 v[144:159], v[36:39], a[0:3], v[144:159]
s_waitcnt lgkmcnt(0)
s_waitcnt vmcnt(19)
v_mfma_f32_32x32x16_bf16 v[64:79], v[40:43], a[8:11], v[64:79]
ds_read_b64_tr_b16 v[16:17], v2 offset:36864
ds_read_b64_tr_b16 v[18:19], v2 offset:38400
ds_read_b64_tr_b16 v[20:21], v3 offset:36864
v_mfma_f32_32x32x16_bf16 v[80:95], v[44:47], a[8:11], v[80:95]
ds_read_b64_tr_b16 v[22:23], v3 offset:38400
ds_read_b64_tr_b16 v[24:25], v2 offset:36992
ds_read_b64_tr_b16 v[26:27], v2 offset:38528
v_mfma_f32_32x32x16_bf16 v[96:111], v[48:51], a[8:11], v[96:111]
ds_read_b64_tr_b16 v[28:29], v3 offset:36992
ds_read_b64_tr_b16 v[30:31], v3 offset:38528
ds_read_b64_tr_b16 v[32:33], v2 offset:37120
v_mfma_f32_32x32x16_bf16 v[112:127], v[52:55], a[8:11], v[112:127]
ds_read_b64_tr_b16 v[34:35], v2 offset:38656
ds_read_b64_tr_b16 v[36:37], v3 offset:37120
ds_read_b64_tr_b16 v[38:39], v3 offset:38656
v_mfma_f32_32x32x16_bf16 v[128:143], v[56:59], a[8:11], v[128:143]
buffer_load_dwordx4 a[72:75], v11, s[4:7], s60 offen offset:1024 sc1
v_mfma_f32_32x32x16_bf16 v[144:159], v[60:63], a[8:11], v[144:159]
s_waitcnt lgkmcnt(0)
s_waitcnt vmcnt(19)
v_mfma_f32_32x32x16_bf16 v[64:79], v[16:19], a[16:19], v[64:79]
ds_read_b64_tr_b16 v[40:41], v2 offset:43008
ds_read_b64_tr_b16 v[42:43], v2 offset:44544
ds_read_b64_tr_b16 v[44:45], v3 offset:43008
v_mfma_f32_32x32x16_bf16 v[80:95], v[20:23], a[16:19], v[80:95]
ds_read_b64_tr_b16 v[46:47], v3 offset:44544
ds_read_b64_tr_b16 v[48:49], v2 offset:43136
ds_read_b64_tr_b16 v[50:51], v2 offset:44672
v_mfma_f32_32x32x16_bf16 v[96:111], v[24:27], a[16:19], v[96:111]
ds_read_b64_tr_b16 v[52:53], v3 offset:43136
ds_read_b64_tr_b16 v[54:55], v3 offset:44672
ds_read_b64_tr_b16 v[56:57], v2 offset:43264
v_mfma_f32_32x32x16_bf16 v[112:127], v[28:31], a[16:19], v[112:127]
ds_read_b64_tr_b16 v[58:59], v2 offset:44800
ds_read_b64_tr_b16 v[60:61], v3 offset:43264
ds_read_b64_tr_b16 v[62:63], v3 offset:44800
v_mfma_f32_32x32x16_bf16 v[128:143], v[32:35], a[16:19], v[128:143]
buffer_load_dwordx4 a[0:3], v11, s[4:7], s60 offen offset:2048 sc1
v_mfma_f32_32x32x16_bf16 v[144:159], v[36:39], a[16:19], v[144:159]
s_waitcnt lgkmcnt(0)
s_waitcnt vmcnt(14)
s_barrier
s_waitcnt vmcnt(13)
v_mfma_f32_32x32x16_bf16 v[64:79], v[40:43], a[24:27], v[64:79]
ds_read_b64_tr_b16 v[16:17], v13 offset:0
ds_read_b64_tr_b16 v[18:19], v13 offset:1536
ds_read_b64_tr_b16 v[20:21], v15 offset:0
v_mfma_f32_32x32x16_bf16 v[80:95], v[44:47], a[24:27], v[80:95]
ds_read_b64_tr_b16 v[22:23], v15 offset:1536
ds_read_b64_tr_b16 v[24:25], v13 offset:128
ds_read_b64_tr_b16 v[26:27], v13 offset:1664
v_mfma_f32_32x32x16_bf16 v[96:111], v[48:51], a[24:27], v[96:111]
ds_read_b64_tr_b16 v[28:29], v15 offset:128
ds_read_b64_tr_b16 v[30:31], v15 offset:1664
ds_read_b64_tr_b16 v[32:33], v13 offset:256
v_mfma_f32_32x32x16_bf16 v[112:127], v[52:55], a[24:27], v[112:127]
ds_read_b64_tr_b16 v[34:35], v13 offset:1792
ds_read_b64_tr_b16 v[36:37], v15 offset:256
ds_read_b64_tr_b16 v[38:39], v15 offset:1792
v_mfma_f32_32x32x16_bf16 v[128:143], v[56:59], a[24:27], v[128:143]
s_add_u32 s43, s56, 6291456
s_add_u32 m0, s62, 0
s_nop 0
buffer_load_dwordx4 v4, s[8:11], s43 offen lds
s_add_u32 m0, s62, 1024
s_nop 0
buffer_load_dwordx4 v5, s[8:11], s43 offen lds
s_add_u32 m0, s62, 2048
s_nop 0
buffer_load_dwordx4 v6, s[8:11], s43 offen lds
s_add_u32 m0, s62, 3072
s_nop 0
buffer_load_dwordx4 v7, s[8:11], s43 offen lds
s_add_u32 m0, s62, 4096
s_nop 0
buffer_load_dwordx4 v8, s[8:11], s43 offen lds
s_add_u32 m0, s62, 5120
s_nop 0
buffer_load_dwordx4 v9, s[8:11], s43 offen lds
buffer_load_dwordx4 a[8:11], v11, s[4:7], s60 offen offset:3072 sc1
v_mfma_f32_32x32x16_bf16 v[144:159], v[60:63], a[24:27], v[144:159]
s_waitcnt lgkmcnt(0)
s_waitcnt vmcnt(19)
v_mfma_f32_32x32x16_bf16 v[64:79], v[16:19], a[32:35], v[64:79]
s_add_u32 s61, s57, 32768
ds_read_b64_tr_b16 v[40:41], v13 offset:6144
ds_read_b64_tr_b16 v[42:43], v13 offset:7680
v_mfma_f32_32x32x16_bf16 v[80:95], v[20:23], a[32:35], v[80:95]
ds_read_b64_tr_b16 v[44:45], v15 offset:6144
ds_read_b64_tr_b16 v[46:47], v15 offset:7680
ds_read_b64_tr_b16 v[48:49], v13 offset:6272
v_mfma_f32_32x32x16_bf16 v[96:111], v[24:27], a[32:35], v[96:111]
ds_read_b64_tr_b16 v[50:51], v13 offset:7808
ds_read_b64_tr_b16 v[52:53], v15 offset:6272
ds_read_b64_tr_b16 v[54:55], v15 offset:7808
v_mfma_f32_32x32x16_bf16 v[112:127], v[28:31], a[32:35], v[112:127]
ds_read_b64_tr_b16 v[56:57], v13 offset:6400
ds_read_b64_tr_b16 v[58:59], v13 offset:7936
ds_read_b64_tr_b16 v[60:61], v15 offset:6400
v_mfma_f32_32x32x16_bf16 v[128:143], v[32:35], a[32:35], v[128:143]
ds_read_b64_tr_b16 v[62:63], v15 offset:7936
buffer_load_dwordx4 a[16:19], v11, s[4:7], s61 offen offset:0 sc1
v_mfma_f32_32x32x16_bf16 v[144:159], v[36:39], a[32:35], v[144:159]
s_waitcnt lgkmcnt(0)
s_waitcnt vmcnt(19)
v_mfma_f32_32x32x16_bf16 v[64:79], v[40:43], a[40:43], v[64:79]
ds_read_b64_tr_b16 v[16:17], v13 offset:12288
ds_read_b64_tr_b16 v[18:19], v13 offset:13824
ds_read_b64_tr_b16 v[20:21], v15 offset:12288
v_mfma_f32_32x32x16_bf16 v[80:95], v[44:47], a[40:43], v[80:95]
ds_read_b64_tr_b16 v[22:23], v15 offset:13824
ds_read_b64_tr_b16 v[24:25], v13 offset:12416
ds_read_b64_tr_b16 v[26:27], v13 offset:13952
v_mfma_f32_32x32x16_bf16 v[96:111], v[48:51], a[40:43], v[96:111]
ds_read_b64_tr_b16 v[28:29], v15 offset:12416
ds_read_b64_tr_b16 v[30:31], v15 offset:13952
ds_read_b64_tr_b16 v[32:33], v13 offset:12544
v_mfma_f32_32x32x16_bf16 v[112:127], v[52:55], a[40:43], v[112:127]
ds_read_b64_tr_b16 v[34:35], v13 offset:14080
ds_read_b64_tr_b16 v[36:37], v15 offset:12544
ds_read_b64_tr_b16 v[38:39], v15 offset:14080
v_mfma_f32_32x32x16_bf16 v[128:143], v[56:59], a[40:43], v[128:143]
buffer_load_dwordx4 a[24:27], v11, s[4:7], s61 offen offset:1024 sc1
v_mfma_f32_32x32x16_bf16 v[144:159], v[60:63], a[40:43], v[144:159]
s_waitcnt lgkmcnt(0)
s_waitcnt vmcnt(19)
v_mfma_f32_32x32x16_bf16 v[64:79], v[16:19], a[48:51], v[64:79]
ds_read_b64_tr_b16 v[40:41], v13 offset:18432
ds_read_b64_tr_b16 v[42:43], v13 offset:19968
ds_read_b64_tr_b16 v[44:45], v15 offset:18432
v_mfma_f32_32x32x16_bf16 v[80:95], v[20:23], a[48:51], v[80:95]
ds_read_b64_tr_b16 v[46:47], v15 offset:19968
ds_read_b64_tr_b16 v[48:49], v13 offset:18560
ds_read_b64_tr_b16 v[50:51], v13 offset:20096
v_mfma_f32_32x32x16_bf16 v[96:111], v[24:27], a[48:51], v[96:111]
ds_read_b64_tr_b16 v[52:53], v15 offset:18560
ds_read_b64_tr_b16 v[54:55], v15 offset:20096
ds_read_b64_tr_b16 v[56:57], v13 offset:18688
v_mfma_f32_32x32x16_bf16 v[112:127], v[28:31], a[48:51], v[112:127]
ds_read_b64_tr_b16 v[58:59], v13 offset:20224
ds_read_b64_tr_b16 v[60:61], v15 offset:18688
ds_read_b64_tr_b16 v[62:63], v15 offset:20224
v_mfma_f32_32x32x16_bf16 v[128:143], v[32:35], a[48:51], v[128:143]
buffer_load_dwordx4 a[32:35], v11, s[4:7], s61 offen offset:2048 sc1
v_mfma_f32_32x32x16_bf16 v[144:159], v[36:39], a[48:51], v[144:159]
s_waitcnt lgkmcnt(0)
s_waitcnt vmcnt(14)
s_barrier
s_waitcnt vmcnt(13)
v_mfma_f32_32x32x16_bf16 v[64:79], v[40:43], a[56:59], v[64:79]
ds_read_b64_tr_b16 v[16:17], v13 offset:24576
ds_read_b64_tr_b16 v[18:19], v13 offset:26112
ds_read_b64_tr_b16 v[20:21], v15 offset:24576
v_mfma_f32_32x32x16_bf16 v[80:95], v[44:47], a[56:59], v[80:95]
ds_read_b64_tr_b16 v[22:23], v15 offset:26112
ds_read_b64_tr_b16 v[24:25], v13 offset:24704
ds_read_b64_tr_b16 v[26:27], v13 offset:26240
v_mfma_f32_32x32x16_bf16 v[96:111], v[48:51], a[56:59], v[96:111]
ds_read_b64_tr_b16 v[28:29], v15 offset:24704
ds_read_b64_tr_b16 v[30:31], v15 offset:26240
ds_read_b64_tr_b16 v[32:33], v13 offset:24832
v_mfma_f32_32x32x16_bf16 v[112:127], v[52:55], a[56:59], v[112:127]
ds_read_b64_tr_b16 v[34:35], v13 offset:26368
ds_read_b64_tr_b16 v[36:37], v15 offset:24832
ds_read_b64_tr_b16 v[38:39], v15 offset:26368
v_mfma_f32_32x32x16_bf16 v[128:143], v[56:59], a[56:59], v[128:143]
s_add_u32 s43, s56, 7077888
s_add_u32 m0, s62, 24576
s_nop 0
buffer_load_dwordx4 v4, s[8:11], s43 offen lds
s_add_u32 m0, s62, 25600
s_nop 0
buffer_load_dwordx4 v5, s[8:11], s43 offen lds
s_add_u32 m0, s62, 26624
s_nop 0
buffer_load_dwordx4 v6, s[8:11], s43 offen lds
s_add_u32 m0, s62, 27648
s_nop 0
buffer_load_dwordx4 v7, s[8:11], s43 offen lds
s_add_u32 m0, s62, 28672
s_nop 0
buffer_load_dwordx4 v8, s[8:11], s43 offen lds
s_add_u32 m0, s62, 29696
s_nop 0
buffer_load_dwordx4 v9, s[8:11], s43 offen lds
buffer_load_dwordx4 a[40:43], v11, s[4:7], s61 offen offset:3072 sc1
v_mfma_f32_32x32x16_bf16 v[144:159], v[60:63], a[56:59], v[144:159]
s_waitcnt lgkmcnt(0)
s_waitcnt vmcnt(19)
v_mfma_f32_32x32x16_bf16 v[64:79], v[16:19], a[64:67], v[64:79]
s_add_u32 s59, s57, 36864
ds_read_b64_tr_b16 v[40:41], v13 offset:30720
ds_read_b64_tr_b16 v[42:43], v13 offset:32256
v_mfma_f32_32x32x16_bf16 v[80:95], v[20:23], a[64:67], v[80:95]
ds_read_b64_tr_b16 v[44:45], v15 offset:30720
ds_read_b64_tr_b16 v[46:47], v15 offset:32256
ds_read_b64_tr_b16 v[48:49], v13 offset:30848
v_mfma_f32_32x32x16_bf16 v[96:111], v[24:27], a[64:67], v[96:111]
ds_read_b64_tr_b16 v[50:51], v13 offset:32384
ds_read_b64_tr_b16 v[52:53], v15 offset:30848
ds_read_b64_tr_b16 v[54:55], v15 offset:32384
v_mfma_f32_32x32x16_bf16 v[112:127], v[28:31], a[64:67], v[112:127]
ds_read_b64_tr_b16 v[56:57], v13 offset:30976
ds_read_b64_tr_b16 v[58:59], v13 offset:32512
ds_read_b64_tr_b16 v[60:61], v15 offset:30976
v_mfma_f32_32x32x16_bf16 v[128:143], v[32:35], a[64:67], v[128:143]
ds_read_b64_tr_b16 v[62:63], v15 offset:32512
buffer_load_dwordx4 a[48:51], v11, s[4:7], s59 offen offset:0 sc1
v_mfma_f32_32x32x16_bf16 v[144:159], v[36:39], a[64:67], v[144:159]
s_waitcnt lgkmcnt(0)
s_waitcnt vmcnt(19)
v_mfma_f32_32x32x16_bf16 v[64:79], v[40:43], a[72:75], v[64:79]
ds_read_b64_tr_b16 v[16:17], v13 offset:36864
ds_read_b64_tr_b16 v[18:19], v13 offset:38400
ds_read_b64_tr_b16 v[20:21], v15 offset:36864
v_mfma_f32_32x32x16_bf16 v[80:95], v[44:47], a[72:75], v[80:95]
ds_read_b64_tr_b16 v[22:23], v15 offset:38400
ds_read_b64_tr_b16 v[24:25], v13 offset:36992
ds_read_b64_tr_b16 v[26:27], v13 offset:38528
v_mfma_f32_32x32x16_bf16 v[96:111], v[48:51], a[72:75], v[96:111]
ds_read_b64_tr_b16 v[28:29], v15 offset:36992
ds_read_b64_tr_b16 v[30:31], v15 offset:38528
ds_read_b64_tr_b16 v[32:33], v13 offset:37120
v_mfma_f32_32x32x16_bf16 v[112:127], v[52:55], a[72:75], v[112:127]
ds_read_b64_tr_b16 v[34:35], v13 offset:38656
ds_read_b64_tr_b16 v[36:37], v15 offset:37120
ds_read_b64_tr_b16 v[38:39], v15 offset:38656
v_mfma_f32_32x32x16_bf16 v[128:143], v[56:59], a[72:75], v[128:143]
buffer_load_dwordx4 a[56:59], v11, s[4:7], s59 offen offset:1024 sc1
v_mfma_f32_32x32x16_bf16 v[144:159], v[60:63], a[72:75], v[144:159]
s_waitcnt lgkmcnt(0)
s_waitcnt vmcnt(19)
v_mfma_f32_32x32x16_bf16 v[64:79], v[16:19], a[0:3], v[64:79]
ds_read_b64_tr_b16 v[40:41], v13 offset:43008
ds_read_b64_tr_b16 v[42:43], v13 offset:44544
ds_read_b64_tr_b16 v[44:45], v15 offset:43008
v_mfma_f32_32x32x16_bf16 v[80:95], v[20:23], a[0:3], v[80:95]
ds_read_b64_tr_b16 v[46:47], v15 offset:44544
ds_read_b64_tr_b16 v[48:49], v13 offset:43136
ds_read_b64_tr_b16 v[50:51], v13 offset:44672
v_mfma_f32_32x32x16_bf16 v[96:111], v[24:27], a[0:3], v[96:111]
ds_read_b64_tr_b16 v[52:53], v15 offset:43136
ds_read_b64_tr_b16 v[54:55], v15 offset:44672
ds_read_b64_tr_b16 v[56:57], v13 offset:43264
v_mfma_f32_32x32x16_bf16 v[112:127], v[28:31], a[0:3], v[112:127]
ds_read_b64_tr_b16 v[58:59], v13 offset:44800
ds_read_b64_tr_b16 v[60:61], v15 offset:43264
ds_read_b64_tr_b16 v[62:63], v15 offset:44800
v_mfma_f32_32x32x16_bf16 v[128:143], v[32:35], a[0:3], v[128:143]
buffer_load_dwordx4 a[64:67], v11, s[4:7], s59 offen offset:2048 sc1
v_mfma_f32_32x32x16_bf16 v[144:159], v[36:39], a[0:3], v[144:159]
s_waitcnt lgkmcnt(0)
s_waitcnt vmcnt(14)
s_barrier
s_waitcnt vmcnt(13)
v_mfma_f32_32x32x16_bf16 v[64:79], v[40:43], a[8:11], v[64:79]
ds_read_b64_tr_b16 v[16:17], v2 offset:0
ds_read_b64_tr_b16 v[18:19], v2 offset:1536
ds_read_b64_tr_b16 v[20:21], v3 offset:0
v_mfma_f32_32x32x16_bf16 v[80:95], v[44:47], a[8:11], v[80:95]
ds_read_b64_tr_b16 v[22:23], v3 offset:1536
ds_read_b64_tr_b16 v[24:25], v2 offset:128
ds_read_b64_tr_b16 v[26:27], v2 offset:1664
v_mfma_f32_32x32x16_bf16 v[96:111], v[48:51], a[8:11], v[96:111]
ds_read_b64_tr_b16 v[28:29], v3 offset:128
ds_read_b64_tr_b16 v[30:31], v3 offset:1664
ds_read_b64_tr_b16 v[32:33], v2 offset:256
v_mfma_f32_32x32x16_bf16 v[112:127], v[52:55], a[8:11], v[112:127]
ds_read_b64_tr_b16 v[34:35], v2 offset:1792
ds_read_b64_tr_b16 v[36:37], v3 offset:256
ds_read_b64_tr_b16 v[38:39], v3 offset:1792
v_mfma_f32_32x32x16_bf16 v[128:143], v[56:59], a[8:11], v[128:143]
buffer_load_dwordx4 a[72:75], v11, s[4:7], s59 offen offset:3072 sc1
v_mfma_f32_32x32x16_bf16 v[144:159], v[60:63], a[8:11], v[144:159]
s_waitcnt lgkmcnt(0)
s_waitcnt vmcnt(13)
v_mfma_f32_32x32x16_bf16 v[64:79], v[16:19], a[16:19], v[64:79]
ds_read_b64_tr_b16 v[40:41], v2 offset:6144
ds_read_b64_tr_b16 v[42:43], v2 offset:7680
v_mfma_f32_32x32x16_bf16 v[80:95], v[20:23], a[16:19], v[80:95]
ds_read_b64_tr_b16 v[44:45], v3 offset:6144
ds_read_b64_tr_b16 v[46:47], v3 offset:7680
ds_read_b64_tr_b16 v[48:49], v2 offset:6272
v_mfma_f32_32x32x16_bf16 v[96:111], v[24:27], a[16:19], v[96:111]
ds_read_b64_tr_b16 v[50:51], v2 offset:7808
ds_read_b64_tr_b16 v[52:53], v3 offset:6272
ds_read_b64_tr_b16 v[54:55], v3 offset:7808
v_mfma_f32_32x32x16_bf16 v[112:127], v[28:31], a[16:19], v[112:127]
ds_read_b64_tr_b16 v[56:57], v2 offset:6400
ds_read_b64_tr_b16 v[58:59], v2 offset:7936
ds_read_b64_tr_b16 v[60:61], v3 offset:6400
v_mfma_f32_32x32x16_bf16 v[128:143], v[32:35], a[16:19], v[128:143]
ds_read_b64_tr_b16 v[62:63], v3 offset:7936
v_mfma_f32_32x32x16_bf16 v[144:159], v[36:39], a[16:19], v[144:159]
s_waitcnt lgkmcnt(0)
s_waitcnt vmcnt(12)
v_mfma_f32_32x32x16_bf16 v[64:79], v[40:43], a[24:27], v[64:79]
ds_read_b64_tr_b16 v[16:17], v2 offset:12288
ds_read_b64_tr_b16 v[18:19], v2 offset:13824
ds_read_b64_tr_b16 v[20:21], v3 offset:12288
v_mfma_f32_32x32x16_bf16 v[80:95], v[44:47], a[24:27], v[80:95]
ds_read_b64_tr_b16 v[22:23], v3 offset:13824
ds_read_b64_tr_b16 v[24:25], v2 offset:12416
ds_read_b64_tr_b16 v[26:27], v2 offset:13952
v_mfma_f32_32x32x16_bf16 v[96:111], v[48:51], a[24:27], v[96:111]
ds_read_b64_tr_b16 v[28:29], v3 offset:12416
ds_read_b64_tr_b16 v[30:31], v3 offset:13952
ds_read_b64_tr_b16 v[32:33], v2 offset:12544
v_mfma_f32_32x32x16_bf16 v[112:127], v[52:55], a[24:27], v[112:127]
ds_read_b64_tr_b16 v[34:35], v2 offset:14080
ds_read_b64_tr_b16 v[36:37], v3 offset:12544
ds_read_b64_tr_b16 v[38:39], v3 offset:14080
v_mfma_f32_32x32x16_bf16 v[128:143], v[56:59], a[24:27], v[128:143]
v_mfma_f32_32x32x16_bf16 v[144:159], v[60:63], a[24:27], v[144:159]
s_waitcnt lgkmcnt(0)
s_waitcnt vmcnt(11)
v_mfma_f32_32x32x16_bf16 v[64:79], v[16:19], a[32:35], v[64:79]
ds_read_b64_tr_b16 v[40:41], v2 offset:18432
ds_read_b64_tr_b16 v[42:43], v2 offset:19968
ds_read_b64_tr_b16 v[44:45], v3 offset:18432
v_mfma_f32_32x32x16_bf16 v[80:95], v[20:23], a[32:35], v[80:95]
ds_read_b64_tr_b16 v[46:47], v3 offset:19968
ds_read_b64_tr_b16 v[48:49], v2 offset:18560
ds_read_b64_tr_b16 v[50:51], v2 offset:20096
v_mfma_f32_32x32x16_bf16 v[96:111], v[24:27], a[32:35], v[96:111]
ds_read_b64_tr_b16 v[52:53], v3 offset:18560
ds_read_b64_tr_b16 v[54:55], v3 offset:20096
ds_read_b64_tr_b16 v[56:57], v2 offset:18688
v_mfma_f32_32x32x16_bf16 v[112:127], v[28:31], a[32:35], v[112:127]
ds_read_b64_tr_b16 v[58:59], v2 offset:20224
ds_read_b64_tr_b16 v[60:61], v3 offset:18688
ds_read_b64_tr_b16 v[62:63], v3 offset:20224
v_mfma_f32_32x32x16_bf16 v[128:143], v[32:35], a[32:35], v[128:143]
v_mfma_f32_32x32x16_bf16 v[144:159], v[36:39], a[32:35], v[144:159]
s_waitcnt lgkmcnt(0)
s_waitcnt vmcnt(5)
s_barrier
s_waitcnt vmcnt(4)
v_mfma_f32_32x32x16_bf16 v[64:79], v[40:43], a[40:43], v[64:79]
ds_read_b64_tr_b16 v[16:17], v2 offset:24576
ds_read_b64_tr_b16 v[18:19], v2 offset:26112
ds_read_b64_tr_b16 v[20:21], v3 offset:24576
v_mfma_f32_32x32x16_bf16 v[80:95], v[44:47], a[40:43], v[80:95]
ds_read_b64_tr_b16 v[22:23], v3 offset:26112
ds_read_b64_tr_b16 v[24:25], v2 offset:24704
ds_read_b64_tr_b16 v[26:27], v2 offset:26240
v_mfma_f32_32x32x16_bf16 v[96:111], v[48:51], a[40:43], v[96:111]
ds_read_b64_tr_b16 v[28:29], v3 offset:24704
ds_read_b64_tr_b16 v[30:31], v3 offset:26240
ds_read_b64_tr_b16 v[32:33], v2 offset:24832
v_mfma_f32_32x32x16_bf16 v[112:127], v[52:55], a[40:43], v[112:127]
ds_read_b64_tr_b16 v[34:35], v2 offset:26368
ds_read_b64_tr_b16 v[36:37], v3 offset:24832
ds_read_b64_tr_b16 v[38:39], v3 offset:26368
v_mfma_f32_32x32x16_bf16 v[128:143], v[56:59], a[40:43], v[128:143]
v_mfma_f32_32x32x16_bf16 v[144:159], v[60:63], a[40:43], v[144:159]
s_waitcnt lgkmcnt(0)
s_waitcnt vmcnt(3)
v_mfma_f32_32x32x16_bf16 v[64:79], v[16:19], a[48:51], v[64:79]
ds_read_b64_tr_b16 v[40:41], v2 offset:30720
ds_read_b64_tr_b16 v[42:43], v2 offset:32256
v_mfma_f32_32x32x16_bf16 v[80:95], v[20:23], a[48:51], v[80:95]
ds_read_b64_tr_b16 v[44:45], v3 offset:30720
ds_read_b64_tr_b16 v[46:47], v3 offset:32256
ds_read_b64_tr_b16 v[48:49], v2 offset:30848
v_mfma_f32_32x32x16_bf16 v[96:111], v[24:27], a[48:51], v[96:111]
ds_read_b64_tr_b16 v[50:51], v2 offset:32384
ds_read_b64_tr_b16 v[52:53], v3 offset:30848
ds_read_b64_tr_b16 v[54:55], v3 offset:32384
v_mfma_f32_32x32x16_bf16 v[112:127], v[28:31], a[48:51], v[112:127]
ds_read_b64_tr_b16 v[56:57], v2 offset:30976
ds_read_b64_tr_b16 v[58:59], v2 offset:32512
ds_read_b64_tr_b16 v[60:61], v3 offset:30976
v_mfma_f32_32x32x16_bf16 v[128:143], v[32:35], a[48:51], v[128:143]
ds_read_b64_tr_b16 v[62:63], v3 offset:32512
v_mfma_f32_32x32x16_bf16 v[144:159], v[36:39], a[48:51], v[144:159]
s_waitcnt lgkmcnt(0)
s_waitcnt vmcnt(2)
v_mfma_f32_32x32x16_bf16 v[64:79], v[40:43], a[56:59], v[64:79]
ds_read_b64_tr_b16 v[16:17], v2 offset:36864
ds_read_b64_tr_b16 v[18:19], v2 offset:38400
ds_read_b64_tr_b16 v[20:21], v3 offset:36864
v_mfma_f32_32x32x16_bf16 v[80:95], v[44:47], a[56:59], v[80:95]
ds_read_b64_tr_b16 v[22:23], v3 offset:38400
ds_read_b64_tr_b16 v[24:25], v2 offset:36992
ds_read_b64_tr_b16 v[26:27], v2 offset:38528
v_mfma_f32_32x32x16_bf16 v[96:111], v[48:51], a[56:59], v[96:111]
ds_read_b64_tr_b16 v[28:29], v3 offset:36992
ds_read_b64_tr_b16 v[30:31], v3 offset:38528
ds_read_b64_tr_b16 v[32:33], v2 offset:37120
v_mfma_f32_32x32x16_bf16 v[112:127], v[52:55], a[56:59], v[112:127]
ds_read_b64_tr_b16 v[34:35], v2 offset:38656
ds_read_b64_tr_b16 v[36:37], v3 offset:37120
ds_read_b64_tr_b16 v[38:39], v3 offset:38656
v_mfma_f32_32x32x16_bf16 v[128:143], v[56:59], a[56:59], v[128:143]
v_mfma_f32_32x32x16_bf16 v[144:159], v[60:63], a[56:59], v[144:159]
s_waitcnt lgkmcnt(0)
s_waitcnt vmcnt(1)
v_mfma_f32_32x32x16_bf16 v[64:79], v[16:19], a[64:67], v[64:79]
ds_read_b64_tr_b16 v[40:41], v2 offset:43008
ds_read_b64_tr_b16 v[42:43], v2 offset:44544
ds_read_b64_tr_b16 v[44:45], v3 offset:43008
v_mfma_f32_32x32x16_bf16 v[80:95], v[20:23], a[64:67], v[80:95]
ds_read_b64_tr_b16 v[46:47], v3 offset:44544
ds_read_b64_tr_b16 v[48:49], v2 offset:43136
ds_read_b64_tr_b16 v[50:51], v2 offset:44672
v_mfma_f32_32x32x16_bf16 v[96:111], v[24:27], a[64:67], v[96:111]
ds_read_b64_tr_b16 v[52:53], v3 offset:43136
ds_read_b64_tr_b16 v[54:55], v3 offset:44672
ds_read_b64_tr_b16 v[56:57], v2 offset:43264
v_mfma_f32_32x32x16_bf16 v[112:127], v[28:31], a[64:67], v[112:127]
ds_read_b64_tr_b16 v[58:59], v2 offset:44800
ds_read_b64_tr_b16 v[60:61], v3 offset:43264
ds_read_b64_tr_b16 v[62:63], v3 offset:44800
v_mfma_f32_32x32x16_bf16 v[128:143], v[32:35], a[64:67], v[128:143]
v_mfma_f32_32x32x16_bf16 v[144:159], v[36:39], a[64:67], v[144:159]
s_waitcnt lgkmcnt(0)
s_waitcnt vmcnt(0)
v_mfma_f32_32x32x16_bf16 v[64:79], v[40:43], a[72:75], v[64:79]
v_mfma_f32_32x32x16_bf16 v[80:95], v[44:47], a[72:75], v[80:95]
v_mfma_f32_32x32x16_bf16 v[96:111], v[48:51], a[72:75], v[96:111]
v_mfma_f32_32x32x16_bf16 v[112:127], v[52:55], a[72:75], v[112:127]
v_mfma_f32_32x32x16_bf16 v[128:143], v[56:59], a[72:75], v[128:143]
v_mfma_f32_32x32x16_bf16 v[144:159], v[60:63], a[72:75], v[144:159]
s_cmp_eq_u32 s64, 2
s_cbranch_scc1 yp_vo
s_cmp_eq_u32 s24, 0
s_cbranch_scc0 tk10289
v_accvgpr_write_b32 a200, 1
s_mov_b64 exec, 1
buffer_atomic_add a200, off, s[28:31], s32 sc0
s_mov_b64 exec, -1
tk10289:
s_cmp_eq_u32 s64, 1
s_cbranch_scc1 yp_q
v_accvgpr_read_b32 v14, a106
v_accvgpr_read_b32 v15, a107
s_mov_b32 s40, 16777216
s_branch yp_kq
yp_q:
v_accvgpr_read_b32 v14, a108
v_accvgpr_read_b32 v15, a109
s_mov_b32 s40, 50331648
yp_kq:
s_lshl_b32 s42, s55, 2
s_add_u32 s42, s42, s24
s_mul_i32 s42, s42, 393216
s_mul_i32 s43, s54, 12288
s_add_u32 s42, s42, s43
s_add_u32 s42, s42, s40
s_add_u32 s43, s42, 0
v_cvt_pk_bf16_f32 v16, v64, v65
v_cvt_pk_bf16_f32 v17, v66, v67
v_cvt_pk_bf16_f32 v18, v72, v73
v_cvt_pk_bf16_f32 v19, v74, v75
buffer_store_dwordx4 v[16:19], v14, s[4:7], s43 offen sc1
v_cvt_pk_bf16_f32 v20, v68, v69
v_cvt_pk_bf16_f32 v21, v70, v71
v_cvt_pk_bf16_f32 v22, v76, v77
v_cvt_pk_bf16_f32 v23, v78, v79
buffer_store_dwordx4 v[20:23], v15, s[4:7], s43 offen sc1
s_add_u32 s43, s42, 2048
v_cvt_pk_bf16_f32 v24, v80, v81
v_cvt_pk_bf16_f32 v25, v82, v83
v_cvt_pk_bf16_f32 v26, v88, v89
v_cvt_pk_bf16_f32 v27, v90, v91
buffer_store_dwordx4 v[24:27], v14, s[4:7], s43 offen sc1
v_cvt_pk_bf16_f32 v28, v84, v85
v_cvt_pk_bf16_f32 v29, v86, v87
v_cvt_pk_bf16_f32 v30, v92, v93
v_cvt_pk_bf16_f32 v31, v94, v95
buffer_store_dwordx4 v[28:31], v15, s[4:7], s43 offen sc1
s_add_u32 s43, s42, 4096
v_cvt_pk_bf16_f32 v16, v96, v97
v_cvt_pk_bf16_f32 v17, v98, v99
v_cvt_pk_bf16_f32 v18, v104, v105
v_cvt_pk_bf16_f32 v19, v106, v107
buffer_store_dwordx4 v[16:19], v14, s[4:7], s43 offen sc1
v_cvt_pk_bf16_f32 v20, v100, v101
v_cvt_pk_bf16_f32 v21, v102, v103
v_cvt_pk_bf16_f32 v22, v108, v109
v_cvt_pk_bf16_f32 v23, v110, v111
buffer_store_dwordx4 v[20:23], v15, s[4:7], s43 offen sc1
s_add_u32 s43, s42, 6144
v_cvt_pk_bf16_f32 v24, v112, v113
v_cvt_pk_bf16_f32 v25, v114, v115
v_cvt_pk_bf16_f32 v26, v120, v121
v_cvt_pk_bf16_f32 v27, v122, v123
buffer_store_dwordx4 v[24:27], v14, s[4:7], s43 offen sc1
v_cvt_pk_bf16_f32 v28, v116, v117
v_cvt_pk_bf16_f32 v29, v118, v119
v_cvt_pk_bf16_f32 v30, v124, v125
v_cvt_pk_bf16_f32 v31, v126, v127
buffer_store_dwordx4 v[28:31], v15, s[4:7], s43 offen sc1
s_add_u32 s43, s42, 8192
v_cvt_pk_bf16_f32 v16, v128, v129
v_cvt_pk_bf16_f32 v17, v130, v131
v_cvt_pk_bf16_f32 v18, v136, v137
v_cvt_pk_bf16_f32 v19, v138, v139
buffer_store_dwordx4 v[16:19], v14, s[4:7], s43 offen sc1
v_cvt_pk_bf16_f32 v20, v132, v133
v_cvt_pk_bf16_f32 v21, v134, v135
v_cvt_pk_bf16_f32 v22, v140, v141
v_cvt_pk_bf16_f32 v23, v142, v143
buffer_store_dwordx4 v[20:23], v15, s[4:7], s43 offen sc1
s_add_u32 s43, s42, 10240
v_cvt_pk_bf16_f32 v24, v144, v145
v_cvt_pk_bf16_f32 v25, v146, v147
v_cvt_pk_bf16_f32 v26, v152, v153
v_cvt_pk_bf16_f32 v27, v154, v155
buffer_store_dwordx4 v[24:27], v14, s[4:7], s43 offen sc1
v_cvt_pk_bf16_f32 v28, v148, v149
v_cvt_pk_bf16_f32 v29, v150, v151
v_cvt_pk_bf16_f32 v30, v156, v157
v_cvt_pk_bf16_f32 v31, v158, v159
buffer_store_dwordx4 v[28:31], v15, s[4:7], s43 offen sc1
s_branch yp_end
yp_vo:
s_nop 7
s_barrier
v_cvt_pk_bf16_f32 v64, v64, v65
v_cvt_pk_bf16_f32 v65, v66, v67
v_cvt_pk_bf16_f32 v66, v68, v69
v_cvt_pk_bf16_f32 v67, v70, v71
v_cvt_pk_bf16_f32 v68, v72, v73
v_cvt_pk_bf16_f32 v69, v74, v75
v_cvt_pk_bf16_f32 v70, v76, v77
v_cvt_pk_bf16_f32 v71, v78, v79
v_cvt_pk_bf16_f32 v72, v80, v81
v_cvt_pk_bf16_f32 v73, v82, v83
v_cvt_pk_bf16_f32 v74, v84, v85
v_cvt_pk_bf16_f32 v75, v86, v87
v_cvt_pk_bf16_f32 v76, v88, v89
v_cvt_pk_bf16_f32 v77, v90, v91
v_cvt_pk_bf16_f32 v78, v92, v93
v_cvt_pk_bf16_f32 v79, v94, v95
v_cvt_pk_bf16_f32 v80, v96, v97
v_cvt_pk_bf16_f32 v81, v98, v99
v_cvt_pk_bf16_f32 v82, v100, v101
v_cvt_pk_bf16_f32 v83, v102, v103
v_cvt_pk_bf16_f32 v84, v104, v105
v_cvt_pk_bf16_f32 v85, v106, v107
v_cvt_pk_bf16_f32 v86, v108, v109
v_cvt_pk_bf16_f32 v87, v110, v111
v_cvt_pk_bf16_f32 v88, v112, v113
v_cvt_pk_bf16_f32 v89, v114, v115
v_cvt_pk_bf16_f32 v90, v116, v117
v_cvt_pk_bf16_f32 v91, v118, v119
v_cvt_pk_bf16_f32 v92, v120, v121
v_cvt_pk_bf16_f32 v93, v122, v123
v_cvt_pk_bf16_f32 v94, v124, v125
v_cvt_pk_bf16_f32 v95, v126, v127
v_cvt_pk_bf16_f32 v96, v128, v129
v_cvt_pk_bf16_f32 v97, v130, v131
v_cvt_pk_bf16_f32 v98, v132, v133
v_cvt_pk_bf16_f32 v99, v134, v135
v_cvt_pk_bf16_f32 v100, v136, v137
v_cvt_pk_bf16_f32 v101, v138, v139
v_cvt_pk_bf16_f32 v102, v140, v141
v_cvt_pk_bf16_f32 v103, v142, v143
v_cvt_pk_bf16_f32 v104, v144, v145
v_cvt_pk_bf16_f32 v105, v146, v147
v_cvt_pk_bf16_f32 v106, v148, v149
v_cvt_pk_bf16_f32 v107, v150, v151
v_cvt_pk_bf16_f32 v108, v152, v153
v_cvt_pk_bf16_f32 v109, v154, v155
v_cvt_pk_bf16_f32 v110, v156, v157
v_cvt_pk_bf16_f32 v111, v158, v159
v_accvgpr_read_b32 v4, a110
v_accvgpr_read_b32 v2, a111
v_accvgpr_read_b32 v3, a112
v_accvgpr_read_b32 v13, a113
v_accvgpr_read_b32 v15, a114
v_accvgpr_read_b32 v14, a115
s_mul_i32 s56, s54, 245760
s_lshl_b32 s42, s55, 2
s_add_u32 s42, s42, s24
s_mul_i32 s58, s42, 1310720
s_lshl_b32 s43, s54, 10
s_add_u32 s58, s58, s43
s_add_u32 s58, s58, 83886080
s_mul_i32 s43, s95, 640
s_add_u32 s56, s56, s43
s_mul_i32 s43, s95, 655360
s_add_u32 s58, s58, s43
s_add_u32 s43, s56, 0
s_add_u32 m0, s62, 0
s_nop 0
buffer_load_dwordx4 v4, s[12:15], s43 offen lds
s_add_u32 s43, s56, 10240
s_add_u32 m0, s62, 1024
s_nop 0
buffer_load_dwordx4 v4, s[12:15], s43 offen lds
s_add_u32 s43, s56, 20480
s_add_u32 m0, s62, 2048
s_nop 0
buffer_load_dwordx4 v4, s[12:15], s43 offen lds
s_add_u32 s43, s56, 30720
s_add_u32 m0, s62, 3072
s_nop 0
buffer_load_dwordx4 v4, s[12:15], s43 offen lds
s_add_u32 s43, s56, 40960
s_add_u32 m0, s62, 4096
s_nop 0
buffer_load_dwordx4 v4, s[12:15], s43 offen lds
s_add_u32 s43, s56, 51200
s_add_u32 m0, s62, 5120
s_nop 0
buffer_load_dwordx4 v4, s[12:15], s43 offen lds
s_add_u32 s43, s56, 128
s_add_u32 m0, s62, 24576
s_nop 0
buffer_load_dwordx4 v4, s[12:15], s43 offen lds
s_add_u32 s43, s56, 10368
s_add_u32 m0, s62, 25600
s_nop 0
buffer_load_dwordx4 v4, s[12:15], s43 offen lds
s_add_u32 s43, s56, 20608
s_add_u32 m0, s62, 26624
s_nop 0
buffer_load_dwordx4 v4, s[12:15], s43 offen lds
s_add_u32 s43, s56, 30848
s_add_u32 m0, s62, 27648
s_nop 0
buffer_load_dwordx4 v4, s[12:15], s43 offen lds
s_add_u32 s43, s56, 41088
s_add_u32 m0, s62, 28672
s_nop 0
buffer_load_dwordx4 v4, s[12:15], s43 offen lds
s_add_u32 s43, s56, 51328
s_add_u32 m0, s62, 29696
s_nop 0
buffer_load_dwordx4 v4, s[12:15], s43 offen lds
s_add_u32 s43, s56, 256
s_add_u32 m0, s62, 49152
s_nop 0
buffer_load_dwordx4 v4, s[12:15], s43 offen lds
s_add_u32 s43, s56, 10496
s_add_u32 m0, s62, 50176
s_nop 0
buffer_load_dwordx4 v4, s[12:15], s43 offen lds
s_add_u32 s43, s56, 20736
s_add_u32 m0, s62, 51200
s_nop 0
buffer_load_dwordx4 v4, s[12:15], s43 offen lds
s_add_u32 s43, s56, 30976
s_add_u32 m0, s62, 52224
s_nop 0
buffer_load_dwordx4 v4, s[12:15], s43 offen lds
s_add_u32 s43, s56, 41216
s_add_u32 m0, s62, 53248
s_nop 0
buffer_load_dwordx4 v4, s[12:15], s43 offen lds
s_add_u32 s43, s56, 51456
s_add_u32 m0, s62, 54272
s_nop 0
buffer_load_dwordx4 v4, s[12:15], s43 offen lds
s_waitcnt vmcnt(12)
s_barrier
ds_read_b64_tr_b16 v[16:17], v2 offset:0
ds_read_b64_tr_b16 v[18:19], v2 offset:1024
ds_read_b64_tr_b16 v[20:21], v2 offset:2048
ds_read_b64_tr_b16 v[22:23], v2 offset:3072
ds_read_b64_tr_b16 v[24:25], v2 offset:4096
ds_read_b64_tr_b16 v[26:27], v2 offset:5120
ds_read_b64_tr_b16 v[28:29], v2 offset:6144
ds_read_b64_tr_b16 v[30:31], v2 offset:7168
ds_read_b64_tr_b16 v[32:33], v2 offset:8192
ds_read_b64_tr_b16 v[34:35], v2 offset:9216
ds_read_b64_tr_b16 v[36:37], v2 offset:10240
ds_read_b64_tr_b16 v[38:39], v2 offset:11264
s_waitcnt lgkmcnt(10)
v_mfma_f32_32x32x16_bf16 v[112:127], v[64:67], v[16:19], 0
ds_read_b64_tr_b16 v[40:41], v2 offset:12288
ds_read_b64_tr_b16 v[42:43], v2 offset:13312
s_waitcnt lgkmcnt(10)
v_mfma_f32_32x32x16_bf16 v[112:127], v[68:71], v[20:23], v[112:127]
ds_read_b64_tr_b16 v[44:45], v2 offset:14336
ds_read_b64_tr_b16 v[46:47], v2 offset:15360
s_waitcnt lgkmcnt(10)
v_mfma_f32_32x32x16_bf16 v[112:127], v[72:75], v[24:27], v[112:127]
ds_read_b64_tr_b16 v[16:17], v2 offset:16384
ds_read_b64_tr_b16 v[18:19], v2 offset:17408
s_waitcnt lgkmcnt(10)
v_mfma_f32_32x32x16_bf16 v[112:127], v[76:79], v[28:31], v[112:127]
ds_read_b64_tr_b16 v[20:21], v2 offset:18432
ds_read_b64_tr_b16 v[22:23], v2 offset:19456
s_waitcnt lgkmcnt(10)
v_mfma_f32_32x32x16_bf16 v[112:127], v[80:83], v[32:35], v[112:127]
ds_read_b64_tr_b16 v[24:25], v2 offset:20480
ds_read_b64_tr_b16 v[26:27], v2 offset:21504
s_waitcnt lgkmcnt(10)
v_mfma_f32_32x32x16_bf16 v[112:127], v[84:87], v[36:39], v[112:127]
ds_read_b64_tr_b16 v[28:29], v2 offset:22528
ds_read_b64_tr_b16 v[30:31], v2 offset:23552
s_waitcnt lgkmcnt(10)
v_mfma_f32_32x32x16_bf16 v[112:127], v[88:91], v[40:43], v[112:127]
ds_read_b64_tr_b16 v[32:33], v3 offset:0
ds_read_b64_tr_b16 v[34:35], v3 offset:1024
s_waitcnt lgkmcnt(10)
v_mfma_f32_32x32x16_bf16 v[112:127], v[92:95], v[44:47], v[112:127]
ds_read_b64_tr_b16 v[36:37], v3 offset:2048
ds_read_b64_tr_b16 v[38:39], v3 offset:3072
s_waitcnt lgkmcnt(10)
v_mfma_f32_32x32x16_bf16 v[112:127], v[96:99], v[16:19], v[112:127]
ds_read_b64_tr_b16 v[40:41], v3 offset:4096
ds_read_b64_tr_b16 v[42:43], v3 offset:5120
s_waitcnt lgkmcnt(10)
v_mfma_f32_32x32x16_bf16 v[112:127], v[100:103], v[20:23], v[112:127]
ds_read_b64_tr_b16 v[44:45], v3 offset:6144
ds_read_b64_tr_b16 v[46:47], v3 offset:7168
s_waitcnt lgkmcnt(10)
v_mfma_f32_32x32x16_bf16 v[112:127], v[104:107], v[24:27], v[112:127]
ds_read_b64_tr_b16 v[16:17], v3 offset:8192
ds_read_b64_tr_b16 v[18:19], v3 offset:9216
s_waitcnt lgkmcnt(10)
v_mfma_f32_32x32x16_bf16 v[112:127], v[108:111], v[28:31], v[112:127]
ds_read_b64_tr_b16 v[20:21], v3 offset:10240
ds_read_b64_tr_b16 v[22:23], v3 offset:11264
s_waitcnt lgkmcnt(10)
v_mfma_f32_32x32x16_bf16 v[128:143], v[64:67], v[32:35], 0
ds_read_b64_tr_b16 v[24:25], v3 offset:12288
ds_read_b64_tr_b16 v[26:27], v3 offset:13312
s_waitcnt lgkmcnt(10)
v_mfma_f32_32x32x16_bf16 v[128:143], v[68:71], v[36:39], v[128:143]
ds_read_b64_tr_b16 v[28:29], v3 offset:14336
ds_read_b64_tr_b16 v[30:31], v3 offset:15360
s_waitcnt lgkmcnt(10)
v_mfma_f32_32x32x16_bf16 v[128:143], v[72:75], v[40:43], v[128:143]
s_add_u32 s65, s58, 0
v_cvt_pk_bf16_f32 v48, v112, v113
ds_read_b64_tr_b16 v[32:33], v3 offset:16384
ds_read_b64_tr_b16 v[34:35], v3 offset:17408
s_waitcnt lgkmcnt(10)
v_mfma_f32_32x32x16_bf16 v[128:143], v[76:79], v[44:47], v[128:143]
v_cvt_pk_bf16_f32 v49, v114, v115
v_cvt_pk_bf16_f32 v50, v116, v117
ds_read_b64_tr_b16 v[36:37], v3 offset:18432
ds_read_b64_tr_b16 v[38:39], v3 offset:19456
s_waitcnt lgkmcnt(10)
v_mfma_f32_32x32x16_bf16 v[128:143], v[80:83], v[16:19], v[128:143]
v_cvt_pk_bf16_f32 v51, v118, v119
buffer_store_dwordx4 v[48:51], v14, s[4:7], s65 offen offset:0 sc1
ds_read_b64_tr_b16 v[40:41], v3 offset:20480
ds_read_b64_tr_b16 v[42:43], v3 offset:21504
s_waitcnt lgkmcnt(10)
v_mfma_f32_32x32x16_bf16 v[128:143], v[84:87], v[20:23], v[128:143]
v_cvt_pk_bf16_f32 v52, v120, v121
v_cvt_pk_bf16_f32 v53, v122, v123
ds_read_b64_tr_b16 v[44:45], v3 offset:22528
ds_read_b64_tr_b16 v[46:47], v3 offset:23552
s_waitcnt lgkmcnt(10)
v_mfma_f32_32x32x16_bf16 v[128:143], v[88:91], v[24:27], v[128:143]
v_cvt_pk_bf16_f32 v54, v124, v125
v_cvt_pk_bf16_f32 v55, v126, v127
s_waitcnt vmcnt(7)
s_barrier
s_add_u32 s43, s56, 384
s_add_u32 m0, s62, 73728
s_nop 0
buffer_load_dwordx4 v4, s[12:15], s43 offen lds
s_add_u32 s43, s56, 10624
s_add_u32 m0, s62, 74752
s_nop 0
buffer_load_dwordx4 v4, s[12:15], s43 offen lds
s_add_u32 s43, s56, 20864
s_add_u32 m0, s62, 75776
s_nop 0
buffer_load_dwordx4 v4, s[12:15], s43 offen lds
s_add_u32 s43, s56, 31104
s_add_u32 m0, s62, 76800
s_nop 0
buffer_load_dwordx4 v4, s[12:15], s43 offen lds
s_add_u32 s43, s56, 41344
s_add_u32 m0, s62, 77824
s_nop 0
buffer_load_dwordx4 v4, s[12:15], s43 offen lds
s_add_u32 s43, s56, 51584
s_add_u32 m0, s62, 78848
s_nop 0
buffer_load_dwordx4 v4, s[12:15], s43 offen lds
ds_read_b64_tr_b16 v[16:17], v2 offset:24576
ds_read_b64_tr_b16 v[18:19], v2 offset:25600
s_waitcnt lgkmcnt(10)
v_mfma_f32_32x32x16_bf16 v[128:143], v[92:95], v[28:31], v[128:143]
buffer_store_dwordx4 v[52:55], v14, s[4:7], s65 offen offset:512 sc1
ds_read_b64_tr_b16 v[20:21], v2 offset:26624
ds_read_b64_tr_b16 v[22:23], v2 offset:27648
s_waitcnt lgkmcnt(10)
v_mfma_f32_32x32x16_bf16 v[128:143], v[96:99], v[32:35], v[128:143]
ds_read_b64_tr_b16 v[24:25], v2 offset:28672
ds_read_b64_tr_b16 v[26:27], v2 offset:29696
s_waitcnt lgkmcnt(10)
v_mfma_f32_32x32x16_bf16 v[128:143], v[100:103], v[36:39], v[128:143]
ds_read_b64_tr_b16 v[28:29], v2 offset:30720
ds_read_b64_tr_b16 v[30:31], v2 offset:31744
s_waitcnt lgkmcnt(10)
v_mfma_f32_32x32x16_bf16 v[128:143], v[104:107], v[40:43], v[128:143]
ds_read_b64_tr_b16 v[32:33], v2 offset:32768
ds_read_b64_tr_b16 v[34:35], v2 offset:33792
s_waitcnt lgkmcnt(10)
v_mfma_f32_32x32x16_bf16 v[128:143], v[108:111], v[44:47], v[128:143]
ds_read_b64_tr_b16 v[36:37], v2 offset:34816
ds_read_b64_tr_b16 v[38:39], v2 offset:35840
s_waitcnt lgkmcnt(10)
v_mfma_f32_32x32x16_bf16 v[112:127], v[64:67], v[16:19], 0
ds_read_b64_tr_b16 v[40:41], v2 offset:36864
ds_read_b64_tr_b16 v[42:43], v2 offset:37888
s_waitcnt lgkmcnt(10)
v_mfma_f32_32x32x16_bf16 v[112:127], v[68:71], v[20:23], v[112:127]
ds_read_b64_tr_b16 v[44:45], v2 offset:38912
ds_read_b64_tr_b16 v[46:47], v2 offset:39936
s_waitcnt lgkmcnt(10)
v_mfma_f32_32x32x16_bf16 v[112:127], v[72:75], v[24:27], v[112:127]
s_add_u32 s65, s58, 65536
v_cvt_pk_bf16_f32 v48, v128, v129
ds_read_b64_tr_b16 v[16:17], v2 offset:40960
ds_read_b64_tr_b16 v[18:19], v2 offset:41984
s_waitcnt lgkmcnt(10)
v_mfma_f32_32x32x16_bf16 v[112:127], v[76:79], v[28:31], v[112:127]
v_cvt_pk_bf16_f32 v49, v130, v131
v_cvt_pk_bf16_f32 v50, v132, v133
ds_read_b64_tr_b16 v[20:21], v2 offset:43008
ds_read_b64_tr_b16 v[22:23], v2 offset:44032
s_waitcnt lgkmcnt(10)
v_mfma_f32_32x32x16_bf16 v[112:127], v[80:83], v[32:35], v[112:127]
v_cvt_pk_bf16_f32 v51, v134, v135
buffer_store_dwordx4 v[48:51], v14, s[4:7], s65 offen offset:0 sc1
ds_read_b64_tr_b16 v[24:25], v2 offset:45056
ds_read_b64_tr_b16 v[26:27], v2 offset:46080
s_waitcnt lgkmcnt(10)
v_mfma_f32_32x32x16_bf16 v[112:127], v[84:87], v[36:39], v[112:127]
v_cvt_pk_bf16_f32 v52, v136, v137
v_cvt_pk_bf16_f32 v53, v138, v139
ds_read_b64_tr_b16 v[28:29], v2 offset:47104
ds_read_b64_tr_b16 v[30:31], v2 offset:48128
s_waitcnt lgkmcnt(10)
v_mfma_f32_32x32x16_bf16 v[112:127], v[88:91], v[40:43], v[112:127]
v_cvt_pk_bf16_f32 v54, v140, v141
v_cvt_pk_bf16_f32 v55, v142, v143
ds_read_b64_tr_b16 v[32:33], v3 offset:24576
ds_read_b64_tr_b16 v[34:35], v3 offset:25600
s_waitcnt lgkmcnt(10)
v_mfma_f32_32x32x16_bf16 v[112:127], v[92:95], v[44:47], v[112:127]
buffer_store_dwordx4 v[52:55], v14, s[4:7], s65 offen offset:512 sc1
ds_read_b64_tr_b16 v[36:37], v3 offset:26624
ds_read_b64_tr_b16 v[38:39], v3 offset:27648
s_waitcnt lgkmcnt(10)
v_mfma_f32_32x32x16_bf16 v[112:127], v[96:99], v[16:19], v[112:127]
ds_read_b64_tr_b16 v[40:41], v3 offset:28672
ds_read_b64_tr_b16 v[42:43], v3 offset:29696
s_waitcnt lgkmcnt(10)
v_mfma_f32_32x32x16_bf16 v[112:127], v[100:103], v[20:23], v[112:127]
ds_read_b64_tr_b16 v[44:45], v3 offset:30720
ds_read_b64_tr_b16 v[46:47], v3 offset:31744
s_waitcnt lgkmcnt(10)
v_mfma_f32_32x32x16_bf16 v[112:127], v[104:107], v[24:27], v[112:127]
ds_read_b64_tr_b16 v[16:17], v3 offset:32768
ds_read_b64_tr_b16 v[18:19], v3 offset:33792
s_waitcnt lgkmcnt(10)
v_mfma_f32_32x32x16_bf16 v[112:127], v[108:111], v[28:31], v[112:127]
ds_read_b64_tr_b16 v[20:21], v3 offset:34816
ds_read_b64_tr_b16 v[22:23], v3 offset:35840
s_waitcnt lgkmcnt(10)
v_mfma_f32_32x32x16_bf16 v[128:143], v[64:67], v[32:35], 0
ds_read_b64_tr_b16 v[24:25], v3 offset:36864
ds_read_b64_tr_b16 v[26:27], v3 offset:37888
s_waitcnt lgkmcnt(10)
v_mfma_f32_32x32x16_bf16 v[128:143], v[68:71], v[36:39], v[128:143]
ds_read_b64_tr_b16 v[28:29], v3 offset:38912
ds_read_b64_tr_b16 v[30:31], v3 offset:39936
s_waitcnt lgkmcnt(10)
v_mfma_f32_32x32x16_bf16 v[128:143], v[72:75], v[40:43], v[128:143]
s_add_u32 s65, s58, 131072
v_cvt_pk_bf16_f32 v48, v112, v113
ds_read_b64_tr_b16 v[32:33], v3 offset:40960
ds_read_b64_tr_b16 v[34:35], v3 offset:41984
s_waitcnt lgkmcnt(10)
v_mfma_f32_32x32x16_bf16 v[128:143], v[76:79], v[44:47], v[128:143]
v_cvt_pk_bf16_f32 v49, v114, v115
v_cvt_pk_bf16_f32 v50, v116, v117
ds_read_b64_tr_b16 v[36:37], v3 offset:43008
ds_read_b64_tr_b16 v[38:39], v3 offset:44032
s_waitcnt lgkmcnt(10)
v_mfma_f32_32x32x16_bf16 v[128:143], v[80:83], v[16:19], v[128:143]
v_cvt_pk_bf16_f32 v51, v118, v119
buffer_store_dwordx4 v[48:51], v14, s[4:7], s65 offen offset:0 sc1
ds_read_b64_tr_b16 v[40:41], v3 offset:45056
ds_read_b64_tr_b16 v[42:43], v3 offset:46080
s_waitcnt lgkmcnt(10)
v_mfma_f32_32x32x16_bf16 v[128:143], v[84:87], v[20:23], v[128:143]
v_cvt_pk_bf16_f32 v52, v120, v121
v_cvt_pk_bf16_f32 v53, v122, v123
ds_read_b64_tr_b16 v[44:45], v3 offset:47104
ds_read_b64_tr_b16 v[46:47], v3 offset:48128
s_waitcnt lgkmcnt(10)
v_mfma_f32_32x32x16_bf16 v[128:143], v[88:91], v[24:27], v[128:143]
v_cvt_pk_bf16_f32 v54, v124, v125
v_cvt_pk_bf16_f32 v55, v126, v127
s_waitcnt vmcnt(11)
s_barrier
s_add_u32 s43, s56, 512
s_add_u32 m0, s62, 0
s_nop 0
buffer_load_dwordx4 v4, s[12:15], s43 offen lds
s_add_u32 s43, s56, 10752
s_add_u32 m0, s62, 1024
s_nop 0
buffer_load_dwordx4 v4, s[12:15], s43 offen lds
s_add_u32 s43, s56, 20992
s_add_u32 m0, s62, 2048
s_nop 0
buffer_load_dwordx4 v4, s[12:15], s43 offen lds
s_add_u32 s43, s56, 31232
s_add_u32 m0, s62, 3072
s_nop 0
buffer_load_dwordx4 v4, s[12:15], s43 offen lds
s_add_u32 s43, s56, 41472
s_add_u32 m0, s62, 4096
s_nop 0
buffer_load_dwordx4 v4, s[12:15], s43 offen lds
s_add_u32 s43, s56, 51712
s_add_u32 m0, s62, 5120
s_nop 0
buffer_load_dwordx4 v4, s[12:15], s43 offen lds
ds_read_b64_tr_b16 v[16:17], v13 offset:0
ds_read_b64_tr_b16 v[18:19], v13 offset:1024
s_waitcnt lgkmcnt(10)
v_mfma_f32_32x32x16_bf16 v[128:143], v[92:95], v[28:31], v[128:143]
buffer_store_dwordx4 v[52:55], v14, s[4:7], s65 offen offset:512 sc1
ds_read_b64_tr_b16 v[20:21], v13 offset:2048
ds_read_b64_tr_b16 v[22:23], v13 offset:3072
s_waitcnt lgkmcnt(10)
v_mfma_f32_32x32x16_bf16 v[128:143], v[96:99], v[32:35], v[128:143]
ds_read_b64_tr_b16 v[24:25], v13 offset:4096
ds_read_b64_tr_b16 v[26:27], v13 offset:5120
s_waitcnt lgkmcnt(10)
v_mfma_f32_32x32x16_bf16 v[128:143], v[100:103], v[36:39], v[128:143]
ds_read_b64_tr_b16 v[28:29], v13 offset:6144
ds_read_b64_tr_b16 v[30:31], v13 offset:7168
s_waitcnt lgkmcnt(10)
v_mfma_f32_32x32x16_bf16 v[128:143], v[104:107], v[40:43], v[128:143]
ds_read_b64_tr_b16 v[32:33], v13 offset:8192
ds_read_b64_tr_b16 v[34:35], v13 offset:9216
s_waitcnt lgkmcnt(10)
v_mfma_f32_32x32x16_bf16 v[128:143], v[108:111], v[44:47], v[128:143]
ds_read_b64_tr_b16 v[36:37], v13 offset:10240
ds_read_b64_tr_b16 v[38:39], v13 offset:11264
s_waitcnt lgkmcnt(10)
v_mfma_f32_32x32x16_bf16 v[112:127], v[64:67], v[16:19], 0
ds_read_b64_tr_b16 v[40:41], v13 offset:12288
ds_read_b64_tr_b16 v[42:43], v13 offset:13312
s_waitcnt lgkmcnt(10)
v_mfma_f32_32x32x16_bf16 v[112:127], v[68:71], v[20:23], v[112:127]
ds_read_b64_tr_b16 v[44:45], v13 offset:14336
ds_read_b64_tr_b16 v[46:47], v13 offset:15360
s_waitcnt lgkmcnt(10)
v_mfma_f32_32x32x16_bf16 v[112:127], v[72:75], v[24:27], v[112:127]
s_add_u32 s65, s58, 196608
v_cvt_pk_bf16_f32 v48, v128, v129
ds_read_b64_tr_b16 v[16:17], v13 offset:16384
ds_read_b64_tr_b16 v[18:19], v13 offset:17408
s_waitcnt lgkmcnt(10)
v_mfma_f32_32x32x16_bf16 v[112:127], v[76:79], v[28:31], v[112:127]
v_cvt_pk_bf16_f32 v49, v130, v131
v_cvt_pk_bf16_f32 v50, v132, v133
ds_read_b64_tr_b16 v[20:21], v13 offset:18432
ds_read_b64_tr_b16 v[22:23], v13 offset:19456
s_waitcnt lgkmcnt(10)
v_mfma_f32_32x32x16_bf16 v[112:127], v[80:83], v[32:35], v[112:127]
v_cvt_pk_bf16_f32 v51, v134, v135
buffer_store_dwordx4 v[48:51], v14, s[4:7], s65 offen offset:0 sc1
ds_read_b64_tr_b16 v[24:25], v13 offset:20480
ds_read_b64_tr_b16 v[26:27], v13 offset:21504
s_waitcnt lgkmcnt(10)
v_mfma_f32_32x32x16_bf16 v[112:127], v[84:87], v[36:39], v[112:127]
v_cvt_pk_bf16_f32 v52, v136, v137
v_cvt_pk_bf16_f32 v53, v138, v139
ds_read_b64_tr_b16 v[28:29], v13 offset:22528
ds_read_b64_tr_b16 v[30:31], v13 offset:23552
s_waitcnt lgkmcnt(10)
v_mfma_f32_32x32x16_bf16 v[112:127], v[88:91], v[40:43], v[112:127]
v_cvt_pk_bf16_f32 v54, v140, v141
v_cvt_pk_bf16_f32 v55, v142, v143
ds_read_b64_tr_b16 v[32:33], v15 offset:0
ds_read_b64_tr_b16 v[34:35], v15 offset:1024
s_waitcnt lgkmcnt(10)
v_mfma_f32_32x32x16_bf16 v[112:127], v[92:95], v[44:47], v[112:127]
buffer_store_dwordx4 v[52:55], v14, s[4:7], s65 offen offset:512 sc1
ds_read_b64_tr_b16 v[36:37], v15 offset:2048
ds_read_b64_tr_b16 v[38:39], v15 offset:3072
s_waitcnt lgkmcnt(10)
v_mfma_f32_32x32x16_bf16 v[112:127], v[96:99], v[16:19], v[112:127]
ds_read_b64_tr_b16 v[40:41], v15 offset:4096
ds_read_b64_tr_b16 v[42:43], v15 offset:5120
s_waitcnt lgkmcnt(10)
v_mfma_f32_32x32x16_bf16 v[112:127], v[100:103], v[20:23], v[112:127]
ds_read_b64_tr_b16 v[44:45], v15 offset:6144
ds_read_b64_tr_b16 v[46:47], v15 offset:7168
s_waitcnt lgkmcnt(10)
v_mfma_f32_32x32x16_bf16 v[112:127], v[104:107], v[24:27], v[112:127]
ds_read_b64_tr_b16 v[16:17], v15 offset:8192
ds_read_b64_tr_b16 v[18:19], v15 offset:9216
s_waitcnt lgkmcnt(10)
v_mfma_f32_32x32x16_bf16 v[112:127], v[108:111], v[28:31], v[112:127]
ds_read_b64_tr_b16 v[20:21], v15 offset:10240
ds_read_b64_tr_b16 v[22:23], v15 offset:11264
s_waitcnt lgkmcnt(10)
v_mfma_f32_32x32x16_bf16 v[128:143], v[64:67], v[32:35], 0
ds_read_b64_tr_b16 v[24:25], v15 offset:12288
ds_read_b64_tr_b16 v[26:27], v15 offset:13312
s_waitcnt lgkmcnt(10)
v_mfma_f32_32x32x16_bf16 v[128:143], v[68:71], v[36:39], v[128:143]
ds_read_b64_tr_b16 v[28:29], v15 offset:14336
ds_read_b64_tr_b16 v[30:31], v15 offset:15360
s_waitcnt lgkmcnt(10)
v_mfma_f32_32x32x16_bf16 v[128:143], v[72:75], v[40:43], v[128:143]
s_add_u32 s65, s58, 262144
v_cvt_pk_bf16_f32 v48, v112, v113
ds_read_b64_tr_b16 v[32:33], v15 offset:16384
ds_read_b64_tr_b16 v[34:35], v15 offset:17408
s_waitcnt lgkmcnt(10)
v_mfma_f32_32x32x16_bf16 v[128:143], v[76:79], v[44:47], v[128:143]
v_cvt_pk_bf16_f32 v49, v114, v115
v_cvt_pk_bf16_f32 v50, v116, v117
ds_read_b64_tr_b16 v[36:37], v15 offset:18432
ds_read_b64_tr_b16 v[38:39], v15 offset:19456
s_waitcnt lgkmcnt(10)
v_mfma_f32_32x32x16_bf16 v[128:143], v[80:83], v[16:19], v[128:143]
v_cvt_pk_bf16_f32 v51, v118, v119
buffer_store_dwordx4 v[48:51], v14, s[4:7], s65 offen offset:0 sc1
ds_read_b64_tr_b16 v[40:41], v15 offset:20480
ds_read_b64_tr_b16 v[42:43], v15 offset:21504
s_waitcnt lgkmcnt(10)
v_mfma_f32_32x32x16_bf16 v[128:143], v[84:87], v[20:23], v[128:143]
v_cvt_pk_bf16_f32 v52, v120, v121
v_cvt_pk_bf16_f32 v53, v122, v123
ds_read_b64_tr_b16 v[44:45], v15 offset:22528
ds_read_b64_tr_b16 v[46:47], v15 offset:23552
s_waitcnt lgkmcnt(10)
v_mfma_f32_32x32x16_bf16 v[128:143], v[88:91], v[24:27], v[128:143]
v_cvt_pk_bf16_f32 v54, v124, v125
v_cvt_pk_bf16_f32 v55, v126, v127
s_waitcnt vmcnt(14)
s_barrier
ds_read_b64_tr_b16 v[16:17], v13 offset:24576
ds_read_b64_tr_b16 v[18:19], v13 offset:25600
s_waitcnt lgkmcnt(10)
v_mfma_f32_32x32x16_bf16 v[128:143], v[92:95], v[28:31], v[128:143]
buffer_store_dwordx4 v[52:55], v14, s[4:7], s65 offen offset:512 sc1
ds_read_b64_tr_b16 v[20:21], v13 offset:26624
ds_read_b64_tr_b16 v[22:23], v13 offset:27648
s_waitcnt lgkmcnt(10)
v_mfma_f32_32x32x16_bf16 v[128:143], v[96:99], v[32:35], v[128:143]
ds_read_b64_tr_b16 v[24:25], v13 offset:28672
ds_read_b64_tr_b16 v[26:27], v13 offset:29696
s_waitcnt lgkmcnt(10)
v_mfma_f32_32x32x16_bf16 v[128:143], v[100:103], v[36:39], v[128:143]
ds_read_b64_tr_b16 v[28:29], v13 offset:30720
ds_read_b64_tr_b16 v[30:31], v13 offset:31744
s_waitcnt lgkmcnt(10)
v_mfma_f32_32x32x16_bf16 v[128:143], v[104:107], v[40:43], v[128:143]
ds_read_b64_tr_b16 v[32:33], v13 offset:32768
ds_read_b64_tr_b16 v[34:35], v13 offset:33792
s_waitcnt lgkmcnt(10)
v_mfma_f32_32x32x16_bf16 v[128:143], v[108:111], v[44:47], v[128:143]
ds_read_b64_tr_b16 v[36:37], v13 offset:34816
ds_read_b64_tr_b16 v[38:39], v13 offset:35840
s_waitcnt lgkmcnt(10)
v_mfma_f32_32x32x16_bf16 v[112:127], v[64:67], v[16:19], 0
ds_read_b64_tr_b16 v[40:41], v13 offset:36864
ds_read_b64_tr_b16 v[42:43], v13 offset:37888
s_waitcnt lgkmcnt(10)
v_mfma_f32_32x32x16_bf16 v[112:127], v[68:71], v[20:23], v[112:127]
ds_read_b64_tr_b16 v[44:45], v13 offset:38912
ds_read_b64_tr_b16 v[46:47], v13 offset:39936
s_waitcnt lgkmcnt(10)
v_mfma_f32_32x32x16_bf16 v[112:127], v[72:75], v[24:27], v[112:127]
s_add_u32 s65, s58, 327680
v_cvt_pk_bf16_f32 v48, v128, v129
ds_read_b64_tr_b16 v[16:17], v13 offset:40960
ds_read_b64_tr_b16 v[18:19], v13 offset:41984
s_waitcnt lgkmcnt(10)
v_mfma_f32_32x32x16_bf16 v[112:127], v[76:79], v[28:31], v[112:127]
v_cvt_pk_bf16_f32 v49, v130, v131
v_cvt_pk_bf16_f32 v50, v132, v133
ds_read_b64_tr_b16 v[20:21], v13 offset:43008
ds_read_b64_tr_b16 v[22:23], v13 offset:44032
s_waitcnt lgkmcnt(10)
v_mfma_f32_32x32x16_bf16 v[112:127], v[80:83], v[32:35], v[112:127]
v_cvt_pk_bf16_f32 v51, v134, v135
buffer_store_dwordx4 v[48:51], v14, s[4:7], s65 offen offset:0 sc1
ds_read_b64_tr_b16 v[24:25], v13 offset:45056
ds_read_b64_tr_b16 v[26:27], v13 offset:46080
s_waitcnt lgkmcnt(10)
v_mfma_f32_32x32x16_bf16 v[112:127], v[84:87], v[36:39], v[112:127]
v_cvt_pk_bf16_f32 v52, v136, v137
v_cvt_pk_bf16_f32 v53, v138, v139
ds_read_b64_tr_b16 v[28:29], v13 offset:47104
ds_read_b64_tr_b16 v[30:31], v13 offset:48128
s_waitcnt lgkmcnt(10)
v_mfma_f32_32x32x16_bf16 v[112:127], v[88:91], v[40:43], v[112:127]
v_cvt_pk_bf16_f32 v54, v140, v141
v_cvt_pk_bf16_f32 v55, v142, v143
ds_read_b64_tr_b16 v[32:33], v15 offset:24576
ds_read_b64_tr_b16 v[34:35], v15 offset:25600
s_waitcnt lgkmcnt(10)
v_mfma_f32_32x32x16_bf16 v[112:127], v[92:95], v[44:47], v[112:127]
buffer_store_dwordx4 v[52:55], v14, s[4:7], s65 offen offset:512 sc1
ds_read_b64_tr_b16 v[36:37], v15 offset:26624
ds_read_b64_tr_b16 v[38:39], v15 offset:27648
s_waitcnt lgkmcnt(10)
v_mfma_f32_32x32x16_bf16 v[112:127], v[96:99], v[16:19], v[112:127]
ds_read_b64_tr_b16 v[40:41], v15 offset:28672
ds_read_b64_tr_b16 v[42:43], v15 offset:29696
s_waitcnt lgkmcnt(10)
v_mfma_f32_32x32x16_bf16 v[112:127], v[100:103], v[20:23], v[112:127]
ds_read_b64_tr_b16 v[44:45], v15 offset:30720
ds_read_b64_tr_b16 v[46:47], v15 offset:31744
s_waitcnt lgkmcnt(10)
v_mfma_f32_32x32x16_bf16 v[112:127], v[104:107], v[24:27], v[112:127]
ds_read_b64_tr_b16 v[16:17], v15 offset:32768
ds_read_b64_tr_b16 v[18:19], v15 offset:33792
s_waitcnt lgkmcnt(10)
v_mfma_f32_32x32x16_bf16 v[112:127], v[108:111], v[28:31], v[112:127]
ds_read_b64_tr_b16 v[20:21], v15 offset:34816
ds_read_b64_tr_b16 v[22:23], v15 offset:35840
s_waitcnt lgkmcnt(10)
v_mfma_f32_32x32x16_bf16 v[128:143], v[64:67], v[32:35], 0
ds_read_b64_tr_b16 v[24:25], v15 offset:36864
ds_read_b64_tr_b16 v[26:27], v15 offset:37888
s_waitcnt lgkmcnt(10)
v_mfma_f32_32x32x16_bf16 v[128:143], v[68:71], v[36:39], v[128:143]
ds_read_b64_tr_b16 v[28:29], v15 offset:38912
ds_read_b64_tr_b16 v[30:31], v15 offset:39936
s_waitcnt lgkmcnt(10)
v_mfma_f32_32x32x16_bf16 v[128:143], v[72:75], v[40:43], v[128:143]
s_add_u32 s65, s58, 393216
v_cvt_pk_bf16_f32 v48, v112, v113
ds_read_b64_tr_b16 v[32:33], v15 offset:40960
ds_read_b64_tr_b16 v[34:35], v15 offset:41984
s_waitcnt lgkmcnt(10)
v_mfma_f32_32x32x16_bf16 v[128:143], v[76:79], v[44:47], v[128:143]
v_cvt_pk_bf16_f32 v49, v114, v115
v_cvt_pk_bf16_f32 v50, v116, v117
ds_read_b64_tr_b16 v[36:37], v15 offset:43008
ds_read_b64_tr_b16 v[38:39], v15 offset:44032
s_waitcnt lgkmcnt(10)
v_mfma_f32_32x32x16_bf16 v[128:143], v[80:83], v[16:19], v[128:143]
v_cvt_pk_bf16_f32 v51, v118, v119
buffer_store_dwordx4 v[48:51], v14, s[4:7], s65 offen offset:0 sc1
ds_read_b64_tr_b16 v[40:41], v15 offset:45056
ds_read_b64_tr_b16 v[42:43], v15 offset:46080
s_waitcnt lgkmcnt(10)
v_mfma_f32_32x32x16_bf16 v[128:143], v[84:87], v[20:23], v[128:143]
v_cvt_pk_bf16_f32 v52, v120, v121
v_cvt_pk_bf16_f32 v53, v122, v123
ds_read_b64_tr_b16 v[44:45], v15 offset:47104
ds_read_b64_tr_b16 v[46:47], v15 offset:48128
s_waitcnt lgkmcnt(10)
v_mfma_f32_32x32x16_bf16 v[128:143], v[88:91], v[24:27], v[128:143]
v_cvt_pk_bf16_f32 v54, v124, v125
v_cvt_pk_bf16_f32 v55, v126, v127
s_waitcnt vmcnt(8)
s_barrier
ds_read_b64_tr_b16 v[16:17], v2 offset:0
ds_read_b64_tr_b16 v[18:19], v2 offset:1024
s_waitcnt lgkmcnt(10)
v_mfma_f32_32x32x16_bf16 v[128:143], v[92:95], v[28:31], v[128:143]
buffer_store_dwordx4 v[52:55], v14, s[4:7], s65 offen offset:512 sc1
ds_read_b64_tr_b16 v[20:21], v2 offset:2048
ds_read_b64_tr_b16 v[22:23], v2 offset:3072
s_waitcnt lgkmcnt(10)
v_mfma_f32_32x32x16_bf16 v[128:143], v[96:99], v[32:35], v[128:143]
ds_read_b64_tr_b16 v[24:25], v2 offset:4096
ds_read_b64_tr_b16 v[26:27], v2 offset:5120
s_waitcnt lgkmcnt(10)
v_mfma_f32_32x32x16_bf16 v[128:143], v[100:103], v[36:39], v[128:143]
ds_read_b64_tr_b16 v[28:29], v2 offset:6144
ds_read_b64_tr_b16 v[30:31], v2 offset:7168
s_waitcnt lgkmcnt(10)
v_mfma_f32_32x32x16_bf16 v[128:143], v[104:107], v[40:43], v[128:143]
ds_read_b64_tr_b16 v[32:33], v2 offset:8192
ds_read_b64_tr_b16 v[34:35], v2 offset:9216
s_waitcnt lgkmcnt(10)
v_mfma_f32_32x32x16_bf16 v[128:143], v[108:111], v[44:47], v[128:143]
ds_read_b64_tr_b16 v[36:37], v2 offset:10240
ds_read_b64_tr_b16 v[38:39], v2 offset:11264
s_waitcnt lgkmcnt(10)
v_mfma_f32_32x32x16_bf16 v[112:127], v[64:67], v[16:19], 0
ds_read_b64_tr_b16 v[40:41], v2 offset:12288
ds_read_b64_tr_b16 v[42:43], v2 offset:13312
s_waitcnt lgkmcnt(10)
v_mfma_f32_32x32x16_bf16 v[112:127], v[68:71], v[20:23], v[112:127]
s_cmp_eq_u32 s24, 0
s_cbranch_scc0 tk11027
v_accvgpr_write_b32 a200, 1
s_mov_b64 exec, 1
buffer_atomic_add a200, off, s[28:31], s32 sc0
s_mov_b64 exec, -1
tk11027:
ds_read_b64_tr_b16 v[44:45], v2 offset:14336
ds_read_b64_tr_b16 v[46:47], v2 offset:15360
s_waitcnt lgkmcnt(10)
v_mfma_f32_32x32x16_bf16 v[112:127], v[72:75], v[24:27], v[112:127]
s_add_u32 s65, s58, 458752
v_cvt_pk_bf16_f32 v48, v128, v129
ds_read_b64_tr_b16 v[16:17], v2 offset:16384
ds_read_b64_tr_b16 v[18:19], v2 offset:17408
s_waitcnt lgkmcnt(10)
v_mfma_f32_32x32x16_bf16 v[112:127], v[76:79], v[28:31], v[112:127]
v_cvt_pk_bf16_f32 v49, v130, v131
v_cvt_pk_bf16_f32 v50, v132, v133
ds_read_b64_tr_b16 v[20:21], v2 offset:18432
ds_read_b64_tr_b16 v[22:23], v2 offset:19456
s_waitcnt lgkmcnt(10)
v_mfma_f32_32x32x16_bf16 v[112:127], v[80:83], v[32:35], v[112:127]
v_cvt_pk_bf16_f32 v51, v134, v135
buffer_store_dwordx4 v[48:51], v14, s[4:7], s65 offen offset:0 sc1
ds_read_b64_tr_b16 v[24:25], v2 offset:20480
ds_read_b64_tr_b16 v[26:27], v2 offset:21504
s_waitcnt lgkmcnt(10)
v_mfma_f32_32x32x16_bf16 v[112:127], v[84:87], v[36:39], v[112:127]
v_cvt_pk_bf16_f32 v52, v136, v137
v_cvt_pk_bf16_f32 v53, v138, v139
ds_read_b64_tr_b16 v[28:29], v2 offset:22528
ds_read_b64_tr_b16 v[30:31], v2 offset:23552
s_waitcnt lgkmcnt(10)
v_mfma_f32_32x32x16_bf16 v[112:127], v[88:91], v[40:43], v[112:127]
v_cvt_pk_bf16_f32 v54, v140, v141
v_cvt_pk_bf16_f32 v55, v142, v143
ds_read_b64_tr_b16 v[32:33], v3 offset:0
ds_read_b64_tr_b16 v[34:35], v3 offset:1024
s_waitcnt lgkmcnt(10)
v_mfma_f32_32x32x16_bf16 v[112:127], v[92:95], v[44:47], v[112:127]
buffer_store_dwordx4 v[52:55], v14, s[4:7], s65 offen offset:512 sc1
ds_read_b64_tr_b16 v[36:37], v3 offset:2048
ds_read_b64_tr_b16 v[38:39], v3 offset:3072
s_waitcnt lgkmcnt(10)
v_mfma_f32_32x32x16_bf16 v[112:127], v[96:99], v[16:19], v[112:127]
ds_read_b64_tr_b16 v[40:41], v3 offset:4096
ds_read_b64_tr_b16 v[42:43], v3 offset:5120
s_waitcnt lgkmcnt(10)
v_mfma_f32_32x32x16_bf16 v[112:127], v[100:103], v[20:23], v[112:127]
ds_read_b64_tr_b16 v[44:45], v3 offset:6144
ds_read_b64_tr_b16 v[46:47], v3 offset:7168
s_waitcnt lgkmcnt(10)
v_mfma_f32_32x32x16_bf16 v[112:127], v[104:107], v[24:27], v[112:127]
ds_read_b64_tr_b16 v[16:17], v3 offset:8192
ds_read_b64_tr_b16 v[18:19], v3 offset:9216
s_waitcnt lgkmcnt(10)
v_mfma_f32_32x32x16_bf16 v[112:127], v[108:111], v[28:31], v[112:127]
ds_read_b64_tr_b16 v[20:21], v3 offset:10240
ds_read_b64_tr_b16 v[22:23], v3 offset:11264
s_waitcnt lgkmcnt(10)
v_mfma_f32_32x32x16_bf16 v[128:143], v[64:67], v[32:35], 0
ds_read_b64_tr_b16 v[24:25], v3 offset:12288
ds_read_b64_tr_b16 v[26:27], v3 offset:13312
s_waitcnt lgkmcnt(10)
v_mfma_f32_32x32x16_bf16 v[128:143], v[68:71], v[36:39], v[128:143]
ds_read_b64_tr_b16 v[28:29], v3 offset:14336
ds_read_b64_tr_b16 v[30:31], v3 offset:15360
s_waitcnt lgkmcnt(10)
v_mfma_f32_32x32x16_bf16 v[128:143], v[72:75], v[40:43], v[128:143]
s_add_u32 s65, s58, 524288
v_cvt_pk_bf16_f32 v48, v112, v113
ds_read_b64_tr_b16 v[32:33], v3 offset:16384
ds_read_b64_tr_b16 v[34:35], v3 offset:17408
s_waitcnt lgkmcnt(10)
v_mfma_f32_32x32x16_bf16 v[128:143], v[76:79], v[44:47], v[128:143]
v_cvt_pk_bf16_f32 v49, v114, v115
v_cvt_pk_bf16_f32 v50, v116, v117
ds_read_b64_tr_b16 v[36:37], v3 offset:18432
ds_read_b64_tr_b16 v[38:39], v3 offset:19456
s_waitcnt lgkmcnt(10)
v_mfma_f32_32x32x16_bf16 v[128:143], v[80:83], v[16:19], v[128:143]
v_cvt_pk_bf16_f32 v51, v118, v119
buffer_store_dwordx4 v[48:51], v14, s[4:7], s65 offen offset:0 sc1
ds_read_b64_tr_b16 v[40:41], v3 offset:20480
ds_read_b64_tr_b16 v[42:43], v3 offset:21504
s_waitcnt lgkmcnt(10)
v_mfma_f32_32x32x16_bf16 v[128:143], v[84:87], v[20:23], v[128:143]
v_cvt_pk_bf16_f32 v52, v120, v121
v_cvt_pk_bf16_f32 v53, v122, v123
ds_read_b64_tr_b16 v[44:45], v3 offset:22528
ds_read_b64_tr_b16 v[46:47], v3 offset:23552
s_waitcnt lgkmcnt(10)
v_mfma_f32_32x32x16_bf16 v[128:143], v[88:91], v[24:27], v[128:143]
v_cvt_pk_bf16_f32 v54, v124, v125
v_cvt_pk_bf16_f32 v55, v126, v127
s_waitcnt lgkmcnt(8)
v_mfma_f32_32x32x16_bf16 v[128:143], v[92:95], v[28:31], v[128:143]
buffer_store_dwordx4 v[52:55], v14, s[4:7], s65 offen offset:512 sc1
s_waitcnt lgkmcnt(6)
v_mfma_f32_32x32x16_bf16 v[128:143], v[96:99], v[32:35], v[128:143]
s_waitcnt lgkmcnt(4)
v_mfma_f32_32x32x16_bf16 v[128:143], v[100:103], v[36:39], v[128:143]
s_waitcnt lgkmcnt(2)
v_mfma_f32_32x32x16_bf16 v[128:143], v[104:107], v[40:43], v[128:143]
s_waitcnt lgkmcnt(0)
v_mfma_f32_32x32x16_bf16 v[128:143], v[108:111], v[44:47], v[128:143]
s_add_u32 s65, s58, 589824
s_nop 10
v_cvt_pk_bf16_f32 v48, v128, v129
v_cvt_pk_bf16_f32 v49, v130, v131
v_cvt_pk_bf16_f32 v50, v132, v133
v_cvt_pk_bf16_f32 v51, v134, v135
buffer_store_dwordx4 v[48:51], v14, s[4:7], s65 offen offset:0 sc1
v_cvt_pk_bf16_f32 v52, v136, v137
v_cvt_pk_bf16_f32 v53, v138, v139
v_cvt_pk_bf16_f32 v54, v140, v141
v_cvt_pk_bf16_f32 v55, v142, v143
buffer_store_dwordx4 v[52:55], v14, s[4:7], s65 offen offset:512 sc1
yp_end:
s_waitcnt vmcnt(0)
s_branch y_taskdone
y_taskdone:
s_lshl_b32 s65, s64, 4
s_add_u32 s65, s65, s55
s_mov_b32 s66, 1
s_branch wk_sig
wk_gu:
s_lshl_b32 s54, s93, 2
s_add_u32 s54, s54, s65
s_cmp_eq_u32 s64, 3
s_cbranch_scc1 z_gu
z_gu:
s_mov_b32 s8, s76
s_and_b32 s9, s77, 0xffff
s_mov_b32 s10, 1966080
s_mov_b32 s11, 0x20000
s_mov_b32 s12, s78
s_and_b32 s13, s79, 0xffff
s_mov_b32 s14, 1966080
s_mov_b32 s15, 0x20000
v_accvgpr_read_b32 v4, a116
v_accvgpr_read_b32 v5, a117
v_accvgpr_read_b32 v6, a118
v_accvgpr_read_b32 v2, a119
v_accvgpr_read_b32 v13, a120
s_mul_i32 s40, s24, 81920
v_add_u32 v11, s40, v1
v_add_u32 v12, 40960, v11
s_mul_i32 s57, s55, 327680
s_add_u32 s57, s57, 8388608
s_mul_i32 s56, s54, 192
s_mul_i32 s62, s24, 3072
s_add_u32 s43, s56, 0
s_add_u32 m0, s62, 0
s_nop 0
buffer_load_dwordx4 v4, s[8:11], s43 offen lds
s_add_u32 m0, s62, 1024
s_nop 0
buffer_load_dwordx4 v5, s[8:11], s43 offen lds
s_add_u32 m0, s62, 2048
s_nop 0
buffer_load_dwordx4 v6, s[8:11], s43 offen lds
s_add_u32 m0, s62, 12288
s_nop 0
buffer_load_dwordx4 v4, s[12:15], s43 offen lds
s_add_u32 m0, s62, 13312
s_nop 0
buffer_load_dwordx4 v5, s[12:15], s43 offen lds
s_add_u32 m0, s62, 14336
s_nop 0
buffer_load_dwordx4 v6, s[12:15], s43 offen lds
s_add_u32 s43, s56, 196608
s_add_u32 m0, s62, 24576
s_nop 0
buffer_load_dwordx4 v4, s[8:11], s43 offen lds
s_add_u32 m0, s62, 25600
s_nop 0
buffer_load_dwordx4 v5, s[8:11], s43 offen lds
s_add_u32 m0, s62, 26624
s_nop 0
buffer_load_dwordx4 v6, s[8:11], s43 offen lds
s_add_u32 m0, s62, 36864
s_nop 0
buffer_load_dwordx4 v4, s[12:15], s43 offen lds
s_add_u32 m0, s62, 37888
s_nop 0
buffer_load_dwordx4 v5, s[12:15], s43 offen lds
s_add_u32 m0, s62, 38912
s_nop 0
buffer_load_dwordx4 v6, s[12:15], s43 offen lds
s_add_u32 s43, s56, 393216
s_add_u32 m0, s62, 49152
s_nop 0
buffer_load_dwordx4 v4, s[8:11], s43 offen lds
s_add_u32 m0, s62, 50176
s_nop 0
buffer_load_dwordx4 v5, s[8:11], s43 offen lds
s_add_u32 m0, s62, 51200
s_nop 0
buffer_load_dwordx4 v6, s[8:11], s43 offen lds
s_add_u32 m0, s62, 61440
s_nop 0
buffer_load_dwordx4 v4, s[12:15], s43 offen lds
s_add_u32 m0, s62, 62464
s_nop 0
buffer_load_dwordx4 v5, s[12:15], s43 offen lds
s_add_u32 m0, s62, 63488
s_nop 0
buffer_load_dwordx4 v6, s[12:15], s43 offen lds
s_add_u32 s59, s57, 0
s_add_u32 s60, s57, 4096
s_add_u32 s61, s57, 8192
buffer_load_dwordx4 a[0:3], v11, s[4:7], s59 offen offset:0 sc1
buffer_load_dwordx4 a[4:7], v12, s[4:7], s59 offen offset:0 sc1
buffer_load_dwordx4 a[8:11], v11, s[4:7], s59 offen offset:1024 sc1
buffer_load_dwordx4 a[12:15], v12, s[4:7], s59 offen offset:1024 sc1
buffer_load_dwordx4 a[16:19], v11, s[4:7], s59 offen offset:2048 sc1
buffer_load_dwordx4 a[20:23], v12, s[4:7], s59 offen offset:2048 sc1
buffer_load_dwordx4 a[24:27], v11, s[4:7], s59 offen offset:3072 sc1
buffer_load_dwordx4 a[28:31], v12, s[4:7], s59 offen offset:3072 sc1
buffer_load_dwordx4 a[32:35], v11, s[4:7], s60 offen offset:0 sc1
buffer_load_dwordx4 a[36:39], v12, s[4:7], s60 offen offset:0 sc1
buffer_load_dwordx4 a[40:43], v11, s[4:7], s60 offen offset:1024 sc1
buffer_load_dwordx4 a[44:47], v12, s[4:7], s60 offen offset:1024 sc1
buffer_load_dwordx4 a[48:51], v11, s[4:7], s60 offen offset:2048 sc1
buffer_load_dwordx4 a[52:55], v12, s[4:7], s60 offen offset:2048 sc1
buffer_load_dwordx4 a[56:59], v11, s[4:7], s60 offen offset:3072 sc1
buffer_load_dwordx4 a[60:63], v12, s[4:7], s60 offen offset:3072 sc1
s_waitcnt vmcnt(28)
s_barrier
ds_read_b64_tr_b16 v[16:17], v2 offset:0
ds_read_b64_tr_b16 v[18:19], v2 offset:768
ds_read_b64_tr_b16 v[20:21], v2 offset:64
ds_read_b64_tr_b16 v[22:23], v2 offset:832
ds_read_b64_tr_b16 v[24:25], v2 offset:128
ds_read_b64_tr_b16 v[26:27], v2 offset:896
ds_read_b64_tr_b16 v[28:29], v2 offset:12288
ds_read_b64_tr_b16 v[30:31], v2 offset:13056
ds_read_b64_tr_b16 v[32:33], v2 offset:12352
ds_read_b64_tr_b16 v[34:35], v2 offset:13120
ds_read_b64_tr_b16 v[36:37], v2 offset:12416
ds_read_b64_tr_b16 v[38:39], v2 offset:13184
s_waitcnt lgkmcnt(0)
s_waitcnt vmcnt(14)
v_mfma_f32_32x32x16_bf16 v[64:79], v[16:19], a[0:3], 0
s_add_u32 s61, s57, 8192
ds_read_b64_tr_b16 v[40:41], v2 offset:3072
v_mfma_f32_32x32x16_bf16 v[80:95], v[16:19], a[4:7], 0
ds_read_b64_tr_b16 v[42:43], v2 offset:3840
ds_read_b64_tr_b16 v[44:45], v2 offset:3136
v_mfma_f32_32x32x16_bf16 v[96:111], v[20:23], a[0:3], 0
ds_read_b64_tr_b16 v[46:47], v2 offset:3904
ds_read_b64_tr_b16 v[48:49], v2 offset:3200
v_mfma_f32_32x32x16_bf16 v[112:127], v[20:23], a[4:7], 0
ds_read_b64_tr_b16 v[50:51], v2 offset:3968
ds_read_b64_tr_b16 v[52:53], v2 offset:15360
v_mfma_f32_32x32x16_bf16 v[128:143], v[24:27], a[0:3], 0
ds_read_b64_tr_b16 v[54:55], v2 offset:16128
ds_read_b64_tr_b16 v[56:57], v2 offset:15424
v_mfma_f32_32x32x16_bf16 v[144:159], v[24:27], a[4:7], 0
ds_read_b64_tr_b16 v[58:59], v2 offset:16192
ds_read_b64_tr_b16 v[60:61], v2 offset:15488
v_mfma_f32_32x32x16_bf16 v[160:175], v[28:31], a[0:3], 0
ds_read_b64_tr_b16 v[62:63], v2 offset:16256
buffer_load_dwordx4 a[64:67], v11, s[4:7], s61 offen offset:0 sc1
buffer_load_dwordx4 a[68:71], v12, s[4:7], s61 offen offset:0 sc1
v_mfma_f32_32x32x16_bf16 v[176:191], v[28:31], a[4:7], 0
v_mfma_f32_32x32x16_bf16 v[192:207], v[32:35], a[0:3], 0
v_mfma_f32_32x32x16_bf16 v[208:223], v[32:35], a[4:7], 0
v_mfma_f32_32x32x16_bf16 v[224:239], v[36:39], a[0:3], 0
v_mfma_f32_32x32x16_bf16 v[240:255], v[36:39], a[4:7], 0
s_waitcnt lgkmcnt(0)
s_waitcnt vmcnt(14)
v_mfma_f32_32x32x16_bf16 v[64:79], v[40:43], a[8:11], v[64:79]
ds_read_b64_tr_b16 v[16:17], v2 offset:6144
ds_read_b64_tr_b16 v[18:19], v2 offset:6912
v_mfma_f32_32x32x16_bf16 v[80:95], v[40:43], a[12:15], v[80:95]
ds_read_b64_tr_b16 v[20:21], v2 offset:6208
ds_read_b64_tr_b16 v[22:23], v2 offset:6976
v_mfma_f32_32x32x16_bf16 v[96:111], v[44:47], a[8:11], v[96:111]
ds_read_b64_tr_b16 v[24:25], v2 offset:6272
ds_read_b64_tr_b16 v[26:27], v2 offset:7040
v_mfma_f32_32x32x16_bf16 v[112:127], v[44:47], a[12:15], v[112:127]
ds_read_b64_tr_b16 v[28:29], v2 offset:18432
ds_read_b64_tr_b16 v[30:31], v2 offset:19200
v_mfma_f32_32x32x16_bf16 v[128:143], v[48:51], a[8:11], v[128:143]
ds_read_b64_tr_b16 v[32:33], v2 offset:18496
ds_read_b64_tr_b16 v[34:35], v2 offset:19264
v_mfma_f32_32x32x16_bf16 v[144:159], v[48:51], a[12:15], v[144:159]
ds_read_b64_tr_b16 v[36:37], v2 offset:18560
ds_read_b64_tr_b16 v[38:39], v2 offset:19328
v_mfma_f32_32x32x16_bf16 v[160:175], v[52:55], a[8:11], v[160:175]
buffer_load_dwordx4 a[72:75], v11, s[4:7], s61 offen offset:1024 sc1
buffer_load_dwordx4 a[76:79], v12, s[4:7], s61 offen offset:1024 sc1
v_mfma_f32_32x32x16_bf16 v[176:191], v[52:55], a[12:15], v[176:191]
v_mfma_f32_32x32x16_bf16 v[192:207], v[56:59], a[8:11], v[192:207]
v_mfma_f32_32x32x16_bf16 v[208:223], v[56:59], a[12:15], v[208:223]
v_mfma_f32_32x32x16_bf16 v[224:239], v[60:63], a[8:11], v[224:239]
v_mfma_f32_32x32x16_bf16 v[240:255], v[60:63], a[12:15], v[240:255]
s_waitcnt lgkmcnt(0)
s_waitcnt vmcnt(14)
v_mfma_f32_32x32x16_bf16 v[64:79], v[16:19], a[16:19], v[64:79]
ds_read_b64_tr_b16 v[40:41], v2 offset:9216
ds_read_b64_tr_b16 v[42:43], v2 offset:9984
v_mfma_f32_32x32x16_bf16 v[80:95], v[16:19], a[20:23], v[80:95]
ds_read_b64_tr_b16 v[44:45], v2 offset:9280
ds_read_b64_tr_b16 v[46:47], v2 offset:10048
v_mfma_f32_32x32x16_bf16 v[96:111], v[20:23], a[16:19], v[96:111]
ds_read_b64_tr_b16 v[48:49], v2 offset:9344
ds_read_b64_tr_b16 v[50:51], v2 offset:10112
v_mfma_f32_32x32x16_bf16 v[112:127], v[20:23], a[20:23], v[112:127]
ds_read_b64_tr_b16 v[52:53], v2 offset:21504
ds_read_b64_tr_b16 v[54:55], v2 offset:22272
v_mfma_f32_32x32x16_bf16 v[128:143], v[24:27], a[16:19], v[128:143]
ds_read_b64_tr_b16 v[56:57], v2 offset:21568
ds_read_b64_tr_b16 v[58:59], v2 offset:22336
v_mfma_f32_32x32x16_bf16 v[144:159], v[24:27], a[20:23], v[144:159]
ds_read_b64_tr_b16 v[60:61], v2 offset:21632
ds_read_b64_tr_b16 v[62:63], v2 offset:22400
v_mfma_f32_32x32x16_bf16 v[160:175], v[28:31], a[16:19], v[160:175]
buffer_load_dwordx4 a[0:3], v11, s[4:7], s61 offen offset:2048 sc1
buffer_load_dwordx4 a[4:7], v12, s[4:7], s61 offen offset:2048 sc1
v_mfma_f32_32x32x16_bf16 v[176:191], v[28:31], a[20:23], v[176:191]
v_mfma_f32_32x32x16_bf16 v[192:207], v[32:35], a[16:19], v[192:207]
v_mfma_f32_32x32x16_bf16 v[208:223], v[32:35], a[20:23], v[208:223]
v_mfma_f32_32x32x16_bf16 v[224:239], v[36:39], a[16:19], v[224:239]
v_mfma_f32_32x32x16_bf16 v[240:255], v[36:39], a[20:23], v[240:255]
s_waitcnt lgkmcnt(0)
s_barrier
s_waitcnt vmcnt(14)
v_mfma_f32_32x32x16_bf16 v[64:79], v[40:43], a[24:27], v[64:79]
ds_read_b64_tr_b16 v[16:17], v2 offset:24576
ds_read_b64_tr_b16 v[18:19], v2 offset:25344
v_mfma_f32_32x32x16_bf16 v[80:95], v[40:43], a[28:31], v[80:95]
ds_read_b64_tr_b16 v[20:21], v2 offset:24640
ds_read_b64_tr_b16 v[22:23], v2 offset:25408
v_mfma_f32_32x32x16_bf16 v[96:111], v[44:47], a[24:27], v[96:111]
ds_read_b64_tr_b16 v[24:25], v2 offset:24704
ds_read_b64_tr_b16 v[26:27], v2 offset:25472
v_mfma_f32_32x32x16_bf16 v[112:127], v[44:47], a[28:31], v[112:127]
ds_read_b64_tr_b16 v[28:29], v2 offset:36864
ds_read_b64_tr_b16 v[30:31], v2 offset:37632
v_mfma_f32_32x32x16_bf16 v[128:143], v[48:51], a[24:27], v[128:143]
ds_read_b64_tr_b16 v[32:33], v2 offset:36928
ds_read_b64_tr_b16 v[34:35], v2 offset:37696
v_mfma_f32_32x32x16_bf16 v[144:159], v[48:51], a[28:31], v[144:159]
ds_read_b64_tr_b16 v[36:37], v2 offset:36992
ds_read_b64_tr_b16 v[38:39], v2 offset:37760
v_mfma_f32_32x32x16_bf16 v[160:175], v[52:55], a[24:27], v[160:175]
s_add_u32 s43, s56, 589824
s_add_u32 m0, s62, 73728
s_nop 0
buffer_load_dwordx4 v4, s[8:11], s43 offen lds
s_add_u32 m0, s62, 74752
s_nop 0
buffer_load_dwordx4 v5, s[8:11], s43 offen lds
s_add_u32 m0, s62, 75776
s_nop 0
buffer_load_dwordx4 v6, s[8:11], s43 offen lds
s_add_u32 m0, s62, 86016
s_nop 0
buffer_load_dwordx4 v4, s[12:15], s43 offen lds
s_add_u32 m0, s62, 87040
s_nop 0
buffer_load_dwordx4 v5, s[12:15], s43 offen lds
s_add_u32 m0, s62, 88064
s_nop 0
buffer_load_dwordx4 v6, s[12:15], s43 offen lds
buffer_load_dwordx4 a[8:11], v11, s[4:7], s61 offen offset:3072 sc1
buffer_load_dwordx4 a[12:15], v12, s[4:7], s61 offen offset:3072 sc1
v_mfma_f32_32x32x16_bf16 v[176:191], v[52:55], a[28:31], v[176:191]
v_mfma_f32_32x32x16_bf16 v[192:207], v[56:59], a[24:27], v[192:207]
v_mfma_f32_32x32x16_bf16 v[208:223], v[56:59], a[28:31], v[208:223]
v_mfma_f32_32x32x16_bf16 v[224:239], v[60:63], a[24:27], v[224:239]
v_mfma_f32_32x32x16_bf16 v[240:255], v[60:63], a[28:31], v[240:255]
s_waitcnt lgkmcnt(0)
s_waitcnt vmcnt(20)
v_mfma_f32_32x32x16_bf16 v[64:79], v[16:19], a[32:35], v[64:79]
s_add_u32 s59, s57, 12288
ds_read_b64_tr_b16 v[40:41], v2 offset:27648
v_mfma_f32_32x32x16_bf16 v[80:95], v[16:19], a[36:39], v[80:95]
ds_read_b64_tr_b16 v[42:43], v2 offset:28416
ds_read_b64_tr_b16 v[44:45], v2 offset:27712
v_mfma_f32_32x32x16_bf16 v[96:111], v[20:23], a[32:35], v[96:111]
ds_read_b64_tr_b16 v[46:47], v2 offset:28480
ds_read_b64_tr_b16 v[48:49], v2 offset:27776
v_mfma_f32_32x32x16_bf16 v[112:127], v[20:23], a[36:39], v[112:127]
ds_read_b64_tr_b16 v[50:51], v2 offset:28544
ds_read_b64_tr_b16 v[52:53], v2 offset:39936
v_mfma_f32_32x32x16_bf16 v[128:143], v[24:27], a[32:35], v[128:143]
ds_read_b64_tr_b16 v[54:55], v2 offset:40704
ds_read_b64_tr_b16 v[56:57], v2 offset:40000
v_mfma_f32_32x32x16_bf16 v[144:159], v[24:27], a[36:39], v[144:159]
ds_read_b64_tr_b16 v[58:59], v2 offset:40768
ds_read_b64_tr_b16 v[60:61], v2 offset:40064
v_mfma_f32_32x32x16_bf16 v[160:175], v[28:31], a[32:35], v[160:175]
ds_read_b64_tr_b16 v[62:63], v2 offset:40832
buffer_load_dwordx4 a[16:19], v11, s[4:7], s59 offen offset:0 sc1
buffer_load_dwordx4 a[20:23], v12, s[4:7], s59 offen offset:0 sc1
v_mfma_f32_32x32x16_bf16 v[176:191], v[28:31], a[36:39], v[176:191]
v_mfma_f32_32x32x16_bf16 v[192:207], v[32:35], a[32:35], v[192:207]
v_mfma_f32_32x32x16_bf16 v[208:223], v[32:35], a[36:39], v[208:223]
v_mfma_f32_32x32x16_bf16 v[224:239], v[36:39], a[32:35], v[224:239]
v_mfma_f32_32x32x16_bf16 v[240:255], v[36:39], a[36:39], v[240:255]
s_waitcnt lgkmcnt(0)
s_waitcnt vmcnt(20)
v_mfma_f32_32x32x16_bf16 v[64:79], v[40:43], a[40:43], v[64:79]
ds_read_b64_tr_b16 v[16:17], v2 offset:30720
ds_read_b64_tr_b16 v[18:19], v2 offset:31488
v_mfma_f32_32x32x16_bf16 v[80:95], v[40:43], a[44:47], v[80:95]
ds_read_b64_tr_b16 v[20:21], v2 offset:30784
ds_read_b64_tr_b16 v[22:23], v2 offset:31552
v_mfma_f32_32x32x16_bf16 v[96:111], v[44:47], a[40:43], v[96:111]
ds_read_b64_tr_b16 v[24:25], v2 offset:30848
ds_read_b64_tr_b16 v[26:27], v2 offset:31616
v_mfma_f32_32x32x16_bf16 v[112:127], v[44:47], a[44:47], v[112:127]
ds_read_b64_tr_b16 v[28:29], v2 offset:43008
ds_read_b64_tr_b16 v[30:31], v2 offset:43776
v_mfma_f32_32x32x16_bf16 v[128:143], v[48:51], a[40:43], v[128:143]
ds_read_b64_tr_b16 v[32:33], v2 offset:43072
ds_read_b64_tr_b16 v[34:35], v2 offset:43840
v_mfma_f32_32x32x16_bf16 v[144:159], v[48:51], a[44:47], v[144:159]
ds_read_b64_tr_b16 v[36:37], v2 offset:43136
ds_read_b64_tr_b16 v[38:39], v2 offset:43904
v_mfma_f32_32x32x16_bf16 v[160:175], v[52:55], a[40:43], v[160:175]
buffer_load_dwordx4 a[24:27], v11, s[4:7], s59 offen offset:1024 sc1
buffer_load_dwordx4 a[28:31], v12, s[4:7], s59 offen offset:1024 sc1
v_mfma_f32_32x32x16_bf16 v[176:191], v[52:55], a[44:47], v[176:191]
v_mfma_f32_32x32x16_bf16 v[192:207], v[56:59], a[40:43], v[192:207]
v_mfma_f32_32x32x16_bf16 v[208:223], v[56:59], a[44:47], v[208:223]
v_mfma_f32_32x32x16_bf16 v[224:239], v[60:63], a[40:43], v[224:239]
v_mfma_f32_32x32x16_bf16 v[240:255], v[60:63], a[44:47], v[240:255]
s_waitcnt lgkmcnt(0)
s_waitcnt vmcnt(20)
v_mfma_f32_32x32x16_bf16 v[64:79], v[16:19], a[48:51], v[64:79]
ds_read_b64_tr_b16 v[40:41], v2 offset:33792
ds_read_b64_tr_b16 v[42:43], v2 offset:34560
v_mfma_f32_32x32x16_bf16 v[80:95], v[16:19], a[52:55], v[80:95]
ds_read_b64_tr_b16 v[44:45], v2 offset:33856
ds_read_b64_tr_b16 v[46:47], v2 offset:34624
v_mfma_f32_32x32x16_bf16 v[96:111], v[20:23], a[48:51], v[96:111]
ds_read_b64_tr_b16 v[48:49], v2 offset:33920
ds_read_b64_tr_b16 v[50:51], v2 offset:34688
v_mfma_f32_32x32x16_bf16 v[112:127], v[20:23], a[52:55], v[112:127]
ds_read_b64_tr_b16 v[52:53], v2 offset:46080
ds_read_b64_tr_b16 v[54:55], v2 offset:46848
v_mfma_f32_32x32x16_bf16 v[128:143], v[24:27], a[48:51], v[128:143]
ds_read_b64_tr_b16 v[56:57], v2 offset:46144
ds_read_b64_tr_b16 v[58:59], v2 offset:46912
v_mfma_f32_32x32x16_bf16 v[144:159], v[24:27], a[52:55], v[144:159]
ds_read_b64_tr_b16 v[60:61], v2 offset:46208
ds_read_b64_tr_b16 v[62:63], v2 offset:46976
v_mfma_f32_32x32x16_bf16 v[160:175], v[28:31], a[48:51], v[160:175]
buffer_load_dwordx4 a[32:35], v11, s[4:7], s59 offen offset:2048 sc1
buffer_load_dwordx4 a[36:39], v12, s[4:7], s59 offen offset:2048 sc1
v_mfma_f32_32x32x16_bf16 v[176:191], v[28:31], a[52:55], v[176:191]
v_mfma_f32_32x32x16_bf16 v[192:207], v[32:35], a[48:51], v[192:207]
v_mfma_f32_32x32x16_bf16 v[208:223], v[32:35], a[52:55], v[208:223]
v_mfma_f32_32x32x16_bf16 v[224:239], v[36:39], a[48:51], v[224:239]
v_mfma_f32_32x32x16_bf16 v[240:255], v[36:39], a[52:55], v[240:255]
s_waitcnt lgkmcnt(0)
s_barrier
s_waitcnt vmcnt(20)
v_mfma_f32_32x32x16_bf16 v[64:79], v[40:43], a[56:59], v[64:79]
ds_read_b64_tr_b16 v[16:17], v13 offset:0
ds_read_b64_tr_b16 v[18:19], v13 offset:768
v_mfma_f32_32x32x16_bf16 v[80:95], v[40:43], a[60:63], v[80:95]
ds_read_b64_tr_b16 v[20:21], v13 offset:64
ds_read_b64_tr_b16 v[22:23], v13 offset:832
v_mfma_f32_32x32x16_bf16 v[96:111], v[44:47], a[56:59], v[96:111]
ds_read_b64_tr_b16 v[24:25], v13 offset:128
ds_read_b64_tr_b16 v[26:27], v13 offset:896
v_mfma_f32_32x32x16_bf16 v[112:127], v[44:47], a[60:63], v[112:127]
ds_read_b64_tr_b16 v[28:29], v13 offset:12288
ds_read_b64_tr_b16 v[30:31], v13 offset:13056
v_mfma_f32_32x32x16_bf16 v[128:143], v[48:51], a[56:59], v[128:143]
ds_read_b64_tr_b16 v[32:33], v13 offset:12352
ds_read_b64_tr_b16 v[34:35], v13 offset:13120
v_mfma_f32_32x32x16_bf16 v[144:159], v[48:51], a[60:63], v[144:159]
ds_read_b64_tr_b16 v[36:37], v13 offset:12416
ds_read_b64_tr_b16 v[38:39], v13 offset:13184
v_mfma_f32_32x32x16_bf16 v[160:175], v[52:55], a[56:59], v[160:175]
s_add_u32 s43, s56, 786432
s_add_u32 m0, s62, 0
s_nop 0
buffer_load_dwordx4 v4, s[8:11], s43 offen lds
s_add_u32 m0, s62, 1024
s_nop 0
buffer_load_dwordx4 v5, s[8:11], s43 offen lds
s_add_u32 m0, s62, 2048
s_nop 0
buffer_load_dwordx4 v6, s[8:11], s43 offen lds
s_add_u32 m0, s62, 12288
s_nop 0
buffer_load_dwordx4 v4, s[12:15], s43 offen lds
s_add_u32 m0, s62, 13312
s_nop 0
buffer_load_dwordx4 v5, s[12:15], s43 offen lds
s_add_u32 m0, s62, 14336
s_nop 0
buffer_load_dwordx4 v6, s[12:15], s43 offen lds
buffer_load_dwordx4 a[40:43], v11, s[4:7], s59 offen offset:3072 sc1
buffer_load_dwordx4 a[44:47], v12, s[4:7], s59 offen offset:3072 sc1
v_mfma_f32_32x32x16_bf16 v[176:191], v[52:55], a[60:63], v[176:191]
v_mfma_f32_32x32x16_bf16 v[192:207], v[56:59], a[56:59], v[192:207]
v_mfma_f32_32x32x16_bf16 v[208:223], v[56:59], a[60:63], v[208:223]
v_mfma_f32_32x32x16_bf16 v[224:239], v[60:63], a[56:59], v[224:239]
v_mfma_f32_32x32x16_bf16 v[240:255], v[60:63], a[60:63], v[240:255]
s_waitcnt lgkmcnt(0)
s_waitcnt vmcnt(26)
v_mfma_f32_32x32x16_bf16 v[64:79], v[16:19], a[64:67], v[64:79]
s_add_u32 s60, s57, 16384
ds_read_b64_tr_b16 v[40:41], v13 offset:3072
v_mfma_f32_32x32x16_bf16 v[80:95], v[16:19], a[68:71], v[80:95]
ds_read_b64_tr_b16 v[42:43], v13 offset:3840
ds_read_b64_tr_b16 v[44:45], v13 offset:3136
v_mfma_f32_32x32x16_bf16 v[96:111], v[20:23], a[64:67], v[96:111]
ds_read_b64_tr_b16 v[46:47], v13 offset:3904
ds_read_b64_tr_b16 v[48:49], v13 offset:3200
v_mfma_f32_32x32x16_bf16 v[112:127], v[20:23], a[68:71], v[112:127]
ds_read_b64_tr_b16 v[50:51], v13 offset:3968
ds_read_b64_tr_b16 v[52:53], v13 offset:15360
v_mfma_f32_32x32x16_bf16 v[128:143], v[24:27], a[64:67], v[128:143]
ds_read_b64_tr_b16 v[54:55], v13 offset:16128
ds_read_b64_tr_b16 v[56:57], v13 offset:15424
v_mfma_f32_32x32x16_bf16 v[144:159], v[24:27], a[68:71], v[144:159]
ds_read_b64_tr_b16 v[58:59], v13 offset:16192
ds_read_b64_tr_b16 v[60:61], v13 offset:15488
v_mfma_f32_32x32x16_bf16 v[160:175], v[28:31], a[64:67], v[160:175]
ds_read_b64_tr_b16 v[62:63], v13 offset:16256
buffer_load_dwordx4 a[48:51], v11, s[4:7], s60 offen offset:0 sc1
buffer_load_dwordx4 a[52:55], v12, s[4:7], s60 offen offset:0 sc1
v_mfma_f32_32x32x16_bf16 v[176:191], v[28:31], a[68:71], v[176:191]
v_mfma_f32_32x32x16_bf16 v[192:207], v[32:35], a[64:67], v[192:207]
v_mfma_f32_32x32x16_bf16 v[208:223], v[32:35], a[68:71], v[208:223]
v_mfma_f32_32x32x16_bf16 v[224:239], v[36:39], a[64:67], v[224:239]
v_mfma_f32_32x32x16_bf16 v[240:255], v[36:39], a[68:71], v[240:255]
s_waitcnt lgkmcnt(0)
s_waitcnt vmcnt(26)
v_mfma_f32_32x32x16_bf16 v[64:79], v[40:43], a[72:75], v[64:79]
ds_read_b64_tr_b16 v[16:17], v13 offset:6144
ds_read_b64_tr_b16 v[18:19], v13 offset:6912
v_mfma_f32_32x32x16_bf16 v[80:95], v[40:43], a[76:79], v[80:95]
ds_read_b64_tr_b16 v[20:21], v13 offset:6208
ds_read_b64_tr_b16 v[22:23], v13 offset:6976
v_mfma_f32_32x32x16_bf16 v[96:111], v[44:47], a[72:75], v[96:111]
ds_read_b64_tr_b16 v[24:25], v13 offset:6272
ds_read_b64_tr_b16 v[26:27], v13 offset:7040
v_mfma_f32_32x32x16_bf16 v[112:127], v[44:47], a[76:79], v[112:127]
ds_read_b64_tr_b16 v[28:29], v13 offset:18432
ds_read_b64_tr_b16 v[30:31], v13 offset:19200
v_mfma_f32_32x32x16_bf16 v[128:143], v[48:51], a[72:75], v[128:143]
ds_read_b64_tr_b16 v[32:33], v13 offset:18496
ds_read_b64_tr_b16 v[34:35], v13 offset:19264
v_mfma_f32_32x32x16_bf16 v[144:159], v[48:51], a[76:79], v[144:159]
ds_read_b64_tr_b16 v[36:37], v13 offset:18560
ds_read_b64_tr_b16 v[38:39], v13 offset:19328
v_mfma_f32_32x32x16_bf16 v[160:175], v[52:55], a[72:75], v[160:175]
buffer_load_dwordx4 a[56:59], v11, s[4:7], s60 offen offset:1024 sc1
buffer_load_dwordx4 a[60:63], v12, s[4:7], s60 offen offset:1024 sc1
v_mfma_f32_32x32x16_bf16 v[176:191], v[52:55], a[76:79], v[176:191]
v_mfma_f32_32x32x16_bf16 v[192:207], v[56:59], a[72:75], v[192:207]
v_mfma_f32_32x32x16_bf16 v[208:223], v[56:59], a[76:79], v[208:223]
v_mfma_f32_32x32x16_bf16 v[224:239], v[60:63], a[72:75], v[224:239]
v_mfma_f32_32x32x16_bf16 v[240:255], v[60:63], a[76:79], v[240:255]
s_waitcnt lgkmcnt(0)
s_waitcnt vmcnt(26)
v_mfma_f32_32x32x16_bf16 v[64:79], v[16:19], a[0:3], v[64:79]
ds_read_b64_tr_b16 v[40:41], v13 offset:9216
ds_read_b64_tr_b16 v[42:43], v13 offset:9984
v_mfma_f32_32x32x16_bf16 v[80:95], v[16:19], a[4:7], v[80:95]
ds_read_b64_tr_b16 v[44:45], v13 offset:9280
ds_read_b64_tr_b16 v[46:47], v13 offset:10048
v_mfma_f32_32x32x16_bf16 v[96:111], v[20:23], a[0:3], v[96:111]
ds_read_b64_tr_b16 v[48:49], v13 offset:9344
ds_read_b64_tr_b16 v[50:51], v13 offset:10112
v_mfma_f32_32x32x16_bf16 v[112:127], v[20:23], a[4:7], v[112:127]
ds_read_b64_tr_b16 v[52:53], v13 offset:21504
ds_read_b64_tr_b16 v[54:55], v13 offset:22272
v_mfma_f32_32x32x16_bf16 v[128:143], v[24:27], a[0:3], v[128:143]
ds_read_b64_tr_b16 v[56:57], v13 offset:21568
ds_read_b64_tr_b16 v[58:59], v13 offset:22336
v_mfma_f32_32x32x16_bf16 v[144:159], v[24:27], a[4:7], v[144:159]
ds_read_b64_tr_b16 v[60:61], v13 offset:21632
ds_read_b64_tr_b16 v[62:63], v13 offset:22400
v_mfma_f32_32x32x16_bf16 v[160:175], v[28:31], a[0:3], v[160:175]
buffer_load_dwordx4 a[64:67], v11, s[4:7], s60 offen offset:2048 sc1
buffer_load_dwordx4 a[68:71], v12, s[4:7], s60 offen offset:2048 sc1
v_mfma_f32_32x32x16_bf16 v[176:191], v[28:31], a[4:7], v[176:191]
v_mfma_f32_32x32x16_bf16 v[192:207], v[32:35], a[0:3], v[192:207]
v_mfma_f32_32x32x16_bf16 v[208:223], v[32:35], a[4:7], v[208:223]
v_mfma_f32_32x32x16_bf16 v[224:239], v[36:39], a[0:3], v[224:239]
v_mfma_f32_32x32x16_bf16 v[240:255], v[36:39], a[4:7], v[240:255]
s_waitcnt lgkmcnt(0)
s_waitcnt vmcnt(22)
s_barrier
s_waitcnt vmcnt(20)
v_mfma_f32_32x32x16_bf16 v[64:79], v[40:43], a[8:11], v[64:79]
ds_read_b64_tr_b16 v[16:17], v13 offset:24576
ds_read_b64_tr_b16 v[18:19], v13 offset:25344
v_mfma_f32_32x32x16_bf16 v[80:95], v[40:43], a[12:15], v[80:95]
ds_read_b64_tr_b16 v[20:21], v13 offset:24640
ds_read_b64_tr_b16 v[22:23], v13 offset:25408
v_mfma_f32_32x32x16_bf16 v[96:111], v[44:47], a[8:11], v[96:111]
ds_read_b64_tr_b16 v[24:25], v13 offset:24704
ds_read_b64_tr_b16 v[26:27], v13 offset:25472
v_mfma_f32_32x32x16_bf16 v[112:127], v[44:47], a[12:15], v[112:127]
ds_read_b64_tr_b16 v[28:29], v13 offset:36864
ds_read_b64_tr_b16 v[30:31], v13 offset:37632
v_mfma_f32_32x32x16_bf16 v[128:143], v[48:51], a[8:11], v[128:143]
ds_read_b64_tr_b16 v[32:33], v13 offset:36928
ds_read_b64_tr_b16 v[34:35], v13 offset:37696
v_mfma_f32_32x32x16_bf16 v[144:159], v[48:51], a[12:15], v[144:159]
ds_read_b64_tr_b16 v[36:37], v13 offset:36992
ds_read_b64_tr_b16 v[38:39], v13 offset:37760
v_mfma_f32_32x32x16_bf16 v[160:175], v[52:55], a[8:11], v[160:175]
s_add_u32 s43, s56, 983040
s_add_u32 m0, s62, 24576
s_nop 0
buffer_load_dwordx4 v4, s[8:11], s43 offen lds
s_add_u32 m0, s62, 25600
s_nop 0
buffer_load_dwordx4 v5, s[8:11], s43 offen lds
s_add_u32 m0, s62, 26624
s_nop 0
buffer_load_dwordx4 v6, s[8:11], s43 offen lds
s_add_u32 m0, s62, 36864
s_nop 0
buffer_load_dwordx4 v4, s[12:15], s43 offen lds
s_add_u32 m0, s62, 37888
s_nop 0
buffer_load_dwordx4 v5, s[12:15], s43 offen lds
s_add_u32 m0, s62, 38912
s_nop 0
buffer_load_dwordx4 v6, s[12:15], s43 offen lds
buffer_load_dwordx4 a[72:75], v11, s[4:7], s60 offen offset:3072 sc1
buffer_load_dwordx4 a[76:79], v12, s[4:7], s60 offen offset:3072 sc1
v_mfma_f32_32x32x16_bf16 v[176:191], v[52:55], a[12:15], v[176:191]
v_mfma_f32_32x32x16_bf16 v[192:207], v[56:59], a[8:11], v[192:207]
v_mfma_f32_32x32x16_bf16 v[208:223], v[56:59], a[12:15], v[208:223]
v_mfma_f32_32x32x16_bf16 v[224:239], v[60:63], a[8:11], v[224:239]
v_mfma_f32_32x32x16_bf16 v[240:255], v[60:63], a[12:15], v[240:255]
s_waitcnt lgkmcnt(0)
s_waitcnt vmcnt(26)
v_mfma_f32_32x32x16_bf16 v[64:79], v[16:19], a[16:19], v[64:79]
s_add_u32 s61, s57, 20480
ds_read_b64_tr_b16 v[40:41], v13 offset:27648
v_mfma_f32_32x32x16_bf16 v[80:95], v[16:19], a[20:23], v[80:95]
ds_read_b64_tr_b16 v[42:43], v13 offset:28416
ds_read_b64_tr_b16 v[44:45], v13 offset:27712
v_mfma_f32_32x32x16_bf16 v[96:111], v[20:23], a[16:19], v[96:111]
ds_read_b64_tr_b16 v[46:47], v13 offset:28480
ds_read_b64_tr_b16 v[48:49], v13 offset:27776
v_mfma_f32_32x32x16_bf16 v[112:127], v[20:23], a[20:23], v[112:127]
ds_read_b64_tr_b16 v[50:51], v13 offset:28544
ds_read_b64_tr_b16 v[52:53], v13 offset:39936
v_mfma_f32_32x32x16_bf16 v[128:143], v[24:27], a[16:19], v[128:143]
ds_read_b64_tr_b16 v[54:55], v13 offset:40704
ds_read_b64_tr_b16 v[56:57], v13 offset:40000
v_mfma_f32_32x32x16_bf16 v[144:159], v[24:27], a[20:23], v[144:159]
ds_read_b64_tr_b16 v[58:59], v13 offset:40768
ds_read_b64_tr_b16 v[60:61], v13 offset:40064
v_mfma_f32_32x32x16_bf16 v[160:175], v[28:31], a[16:19], v[160:175]
ds_read_b64_tr_b16 v[62:63], v13 offset:40832
buffer_load_dwordx4 a[0:3], v11, s[4:7], s61 offen offset:0 sc1
buffer_load_dwordx4 a[4:7], v12, s[4:7], s61 offen offset:0 sc1
v_mfma_f32_32x32x16_bf16 v[176:191], v[28:31], a[20:23], v[176:191]
v_mfma_f32_32x32x16_bf16 v[192:207], v[32:35], a[16:19], v[192:207]
v_mfma_f32_32x32x16_bf16 v[208:223], v[32:35], a[20:23], v[208:223]
v_mfma_f32_32x32x16_bf16 v[224:239], v[36:39], a[16:19], v[224:239]
v_mfma_f32_32x32x16_bf16 v[240:255], v[36:39], a[20:23], v[240:255]
s_waitcnt lgkmcnt(0)
s_waitcnt vmcnt(26)
v_mfma_f32_32x32x16_bf16 v[64:79], v[40:43], a[24:27], v[64:79]
ds_read_b64_tr_b16 v[16:17], v13 offset:30720
ds_read_b64_tr_b16 v[18:19], v13 offset:31488
v_mfma_f32_32x32x16_bf16 v[80:95], v[40:43], a[28:31], v[80:95]
ds_read_b64_tr_b16 v[20:21], v13 offset:30784
ds_read_b64_tr_b16 v[22:23], v13 offset:31552
v_mfma_f32_32x32x16_bf16 v[96:111], v[44:47], a[24:27], v[96:111]
ds_read_b64_tr_b16 v[24:25], v13 offset:30848
ds_read_b64_tr_b16 v[26:27], v13 offset:31616
v_mfma_f32_32x32x16_bf16 v[112:127], v[44:47], a[28:31], v[112:127]
ds_read_b64_tr_b16 v[28:29], v13 offset:43008
ds_read_b64_tr_b16 v[30:31], v13 offset:43776
v_mfma_f32_32x32x16_bf16 v[128:143], v[48:51], a[24:27], v[128:143]
ds_read_b64_tr_b16 v[32:33], v13 offset:43072
ds_read_b64_tr_b16 v[34:35], v13 offset:43840
v_mfma_f32_32x32x16_bf16 v[144:159], v[48:51], a[28:31], v[144:159]
ds_read_b64_tr_b16 v[36:37], v13 offset:43136
ds_read_b64_tr_b16 v[38:39], v13 offset:43904
v_mfma_f32_32x32x16_bf16 v[160:175], v[52:55], a[24:27], v[160:175]
buffer_load_dwordx4 a[8:11], v11, s[4:7], s61 offen offset:1024 sc1
buffer_load_dwordx4 a[12:15], v12, s[4:7], s61 offen offset:1024 sc1
v_mfma_f32_32x32x16_bf16 v[176:191], v[52:55], a[28:31], v[176:191]
v_mfma_f32_32x32x16_bf16 v[192:207], v[56:59], a[24:27], v[192:207]
v_mfma_f32_32x32x16_bf16 v[208:223], v[56:59], a[28:31], v[208:223]
v_mfma_f32_32x32x16_bf16 v[224:239], v[60:63], a[24:27], v[224:239]
v_mfma_f32_32x32x16_bf16 v[240:255], v[60:63], a[28:31], v[240:255]
s_waitcnt lgkmcnt(0)
s_waitcnt vmcnt(26)
v_mfma_f32_32x32x16_bf16 v[64:79], v[16:19], a[32:35], v[64:79]
ds_read_b64_tr_b16 v[40:41], v13 offset:33792
ds_read_b64_tr_b16 v[42:43], v13 offset:34560
v_mfma_f32_32x32x16_bf16 v[80:95], v[16:19], a[36:39], v[80:95]
ds_read_b64_tr_b16 v[44:45], v13 offset:33856
ds_read_b64_tr_b16 v[46:47], v13 offset:34624
v_mfma_f32_32x32x16_bf16 v[96:111], v[20:23], a[32:35], v[96:111]
ds_read_b64_tr_b16 v[48:49], v13 offset:33920
ds_read_b64_tr_b16 v[50:51], v13 offset:34688
v_mfma_f32_32x32x16_bf16 v[112:127], v[20:23], a[36:39], v[112:127]
ds_read_b64_tr_b16 v[52:53], v13 offset:46080
ds_read_b64_tr_b16 v[54:55], v13 offset:46848
v_mfma_f32_32x32x16_bf16 v[128:143], v[24:27], a[32:35], v[128:143]
ds_read_b64_tr_b16 v[56:57], v13 offset:46144
ds_read_b64_tr_b16 v[58:59], v13 offset:46912
v_mfma_f32_32x32x16_bf16 v[144:159], v[24:27], a[36:39], v[144:159]
ds_read_b64_tr_b16 v[60:61], v13 offset:46208
ds_read_b64_tr_b16 v[62:63], v13 offset:46976
v_mfma_f32_32x32x16_bf16 v[160:175], v[28:31], a[32:35], v[160:175]
buffer_load_dwordx4 a[16:19], v11, s[4:7], s61 offen offset:2048 sc1
buffer_load_dwordx4 a[20:23], v12, s[4:7], s61 offen offset:2048 sc1
v_mfma_f32_32x32x16_bf16 v[176:191], v[28:31], a[36:39], v[176:191]
v_mfma_f32_32x32x16_bf16 v[192:207], v[32:35], a[32:35], v[192:207]
v_mfma_f32_32x32x16_bf16 v[208:223], v[32:35], a[36:39], v[208:223]
v_mfma_f32_32x32x16_bf16 v[224:239], v[36:39], a[32:35], v[224:239]
v_mfma_f32_32x32x16_bf16 v[240:255], v[36:39], a[36:39], v[240:255]
s_waitcnt lgkmcnt(0)
s_waitcnt vmcnt(22)
s_barrier
s_waitcnt vmcnt(20)
v_mfma_f32_32x32x16_bf16 v[64:79], v[40:43], a[40:43], v[64:79]
ds_read_b64_tr_b16 v[16:17], v2 offset:0
ds_read_b64_tr_b16 v[18:19], v2 offset:768
v_mfma_f32_32x32x16_bf16 v[80:95], v[40:43], a[44:47], v[80:95]
ds_read_b64_tr_b16 v[20:21], v2 offset:64
ds_read_b64_tr_b16 v[22:23], v2 offset:832
v_mfma_f32_32x32x16_bf16 v[96:111], v[44:47], a[40:43], v[96:111]
ds_read_b64_tr_b16 v[24:25], v2 offset:128
ds_read_b64_tr_b16 v[26:27], v2 offset:896
v_mfma_f32_32x32x16_bf16 v[112:127], v[44:47], a[44:47], v[112:127]
ds_read_b64_tr_b16 v[28:29], v2 offset:12288
ds_read_b64_tr_b16 v[30:31], v2 offset:13056
v_mfma_f32_32x32x16_bf16 v[128:143], v[48:51], a[40:43], v[128:143]
ds_read_b64_tr_b16 v[32:33], v2 offset:12352
ds_read_b64_tr_b16 v[34:35], v2 offset:13120
v_mfma_f32_32x32x16_bf16 v[144:159], v[48:51], a[44:47], v[144:159]
ds_read_b64_tr_b16 v[36:37], v2 offset:12416
ds_read_b64_tr_b16 v[38:39], v2 offset:13184
v_mfma_f32_32x32x16_bf16 v[160:175], v[52:55], a[40:43], v[160:175]
s_add_u32 s43, s56, 1179648
s_add_u32 m0, s62, 49152
s_nop 0
buffer_load_dwordx4 v4, s[8:11], s43 offen lds
s_add_u32 m0, s62, 50176
s_nop 0
buffer_load_dwordx4 v5, s[8:11], s43 offen lds
s_add_u32 m0, s62, 51200
s_nop 0
buffer_load_dwordx4 v6, s[8:11], s43 offen lds
s_add_u32 m0, s62, 61440
s_nop 0
buffer_load_dwordx4 v4, s[12:15], s43 offen lds
s_add_u32 m0, s62, 62464
s_nop 0
buffer_load_dwordx4 v5, s[12:15], s43 offen lds
s_add_u32 m0, s62, 63488
s_nop 0
buffer_load_dwordx4 v6, s[12:15], s43 offen lds
buffer_load_dwordx4 a[24:27], v11, s[4:7], s61 offen offset:3072 sc1
buffer_load_dwordx4 a[28:31], v12, s[4:7], s61 offen offset:3072 sc1
v_mfma_f32_32x32x16_bf16 v[176:191], v[52:55], a[44:47], v[176:191]
v_mfma_f32_32x32x16_bf16 v[192:207], v[56:59], a[40:43], v[192:207]
v_mfma_f32_32x32x16_bf16 v[208:223], v[56:59], a[44:47], v[208:223]
v_mfma_f32_32x32x16_bf16 v[224:239], v[60:63], a[40:43], v[224:239]
v_mfma_f32_32x32x16_bf16 v[240:255], v[60:63], a[44:47], v[240:255]
s_waitcnt lgkmcnt(0)
s_waitcnt vmcnt(26)
v_mfma_f32_32x32x16_bf16 v[64:79], v[16:19], a[48:51], v[64:79]
s_add_u32 s59, s57, 24576
ds_read_b64_tr_b16 v[40:41], v2 offset:3072
v_mfma_f32_32x32x16_bf16 v[80:95], v[16:19], a[52:55], v[80:95]
ds_read_b64_tr_b16 v[42:43], v2 offset:3840
ds_read_b64_tr_b16 v[44:45], v2 offset:3136
v_mfma_f32_32x32x16_bf16 v[96:111], v[20:23], a[48:51], v[96:111]
ds_read_b64_tr_b16 v[46:47], v2 offset:3904
ds_read_b64_tr_b16 v[48:49], v2 offset:3200
v_mfma_f32_32x32x16_bf16 v[112:127], v[20:23], a[52:55], v[112:127]
ds_read_b64_tr_b16 v[50:51], v2 offset:3968
ds_read_b64_tr_b16 v[52:53], v2 offset:15360
v_mfma_f32_32x32x16_bf16 v[128:143], v[24:27], a[48:51], v[128:143]
ds_read_b64_tr_b16 v[54:55], v2 offset:16128
ds_read_b64_tr_b16 v[56:57], v2 offset:15424
v_mfma_f32_32x32x16_bf16 v[144:159], v[24:27], a[52:55], v[144:159]
ds_read_b64_tr_b16 v[58:59], v2 offset:16192
ds_read_b64_tr_b16 v[60:61], v2 offset:15488
v_mfma_f32_32x32x16_bf16 v[160:175], v[28:31], a[48:51], v[160:175]
ds_read_b64_tr_b16 v[62:63], v2 offset:16256
buffer_load_dwordx4 a[32:35], v11, s[4:7], s59 offen offset:0 sc1
buffer_load_dwordx4 a[36:39], v12, s[4:7], s59 offen offset:0 sc1
v_mfma_f32_32x32x16_bf16 v[176:191], v[28:31], a[52:55], v[176:191]
v_mfma_f32_32x32x16_bf16 v[192:207], v[32:35], a[48:51], v[192:207]
v_mfma_f32_32x32x16_bf16 v[208:223], v[32:35], a[52:55], v[208:223]
v_mfma_f32_32x32x16_bf16 v[224:239], v[36:39], a[48:51], v[224:239]
v_mfma_f32_32x32x16_bf16 v[240:255], v[36:39], a[52:55], v[240:255]
s_waitcnt lgkmcnt(0)
s_waitcnt vmcnt(26)
v_mfma_f32_32x32x16_bf16 v[64:79], v[40:43], a[56:59], v[64:79]
ds_read_b64_tr_b16 v[16:17], v2 offset:6144
ds_read_b64_tr_b16 v[18:19], v2 offset:6912
v_mfma_f32_32x32x16_bf16 v[80:95], v[40:43], a[60:63], v[80:95]
ds_read_b64_tr_b16 v[20:21], v2 offset:6208
ds_read_b64_tr_b16 v[22:23], v2 offset:6976
v_mfma_f32_32x32x16_bf16 v[96:111], v[44:47], a[56:59], v[96:111]
ds_read_b64_tr_b16 v[24:25], v2 offset:6272
ds_read_b64_tr_b16 v[26:27], v2 offset:7040
v_mfma_f32_32x32x16_bf16 v[112:127], v[44:47], a[60:63], v[112:127]
ds_read_b64_tr_b16 v[28:29], v2 offset:18432
ds_read_b64_tr_b16 v[30:31], v2 offset:19200
v_mfma_f32_32x32x16_bf16 v[128:143], v[48:51], a[56:59], v[128:143]
ds_read_b64_tr_b16 v[32:33], v2 offset:18496
ds_read_b64_tr_b16 v[34:35], v2 offset:19264
v_mfma_f32_32x32x16_bf16 v[144:159], v[48:51], a[60:63], v[144:159]
ds_read_b64_tr_b16 v[36:37], v2 offset:18560
ds_read_b64_tr_b16 v[38:39], v2 offset:19328
v_mfma_f32_32x32x16_bf16 v[160:175], v[52:55], a[56:59], v[160:175]
buffer_load_dwordx4 a[40:43], v11, s[4:7], s59 offen offset:1024 sc1
buffer_load_dwordx4 a[44:47], v12, s[4:7], s59 offen offset:1024 sc1
v_mfma_f32_32x32x16_bf16 v[176:191], v[52:55], a[60:63], v[176:191]
v_mfma_f32_32x32x16_bf16 v[192:207], v[56:59], a[56:59], v[192:207]
v_mfma_f32_32x32x16_bf16 v[208:223], v[56:59], a[60:63], v[208:223]
v_mfma_f32_32x32x16_bf16 v[224:239], v[60:63], a[56:59], v[224:239]
v_mfma_f32_32x32x16_bf16 v[240:255], v[60:63], a[60:63], v[240:255]
s_waitcnt lgkmcnt(0)
s_waitcnt vmcnt(26)
v_mfma_f32_32x32x16_bf16 v[64:79], v[16:19], a[64:67], v[64:79]
ds_read_b64_tr_b16 v[40:41], v2 offset:9216
ds_read_b64_tr_b16 v[42:43], v2 offset:9984
v_mfma_f32_32x32x16_bf16 v[80:95], v[16:19], a[68:71], v[80:95]
ds_read_b64_tr_b16 v[44:45], v2 offset:9280
ds_read_b64_tr_b16 v[46:47], v2 offset:10048
v_mfma_f32_32x32x16_bf16 v[96:111], v[20:23], a[64:67], v[96:111]
ds_read_b64_tr_b16 v[48:49], v2 offset:9344
ds_read_b64_tr_b16 v[50:51], v2 offset:10112
v_mfma_f32_32x32x16_bf16 v[112:127], v[20:23], a[68:71], v[112:127]
ds_read_b64_tr_b16 v[52:53], v2 offset:21504
ds_read_b64_tr_b16 v[54:55], v2 offset:22272
v_mfma_f32_32x32x16_bf16 v[128:143], v[24:27], a[64:67], v[128:143]
ds_read_b64_tr_b16 v[56:57], v2 offset:21568
ds_read_b64_tr_b16 v[58:59], v2 offset:22336
v_mfma_f32_32x32x16_bf16 v[144:159], v[24:27], a[68:71], v[144:159]
ds_read_b64_tr_b16 v[60:61], v2 offset:21632
ds_read_b64_tr_b16 v[62:63], v2 offset:22400
v_mfma_f32_32x32x16_bf16 v[160:175], v[28:31], a[64:67], v[160:175]
buffer_load_dwordx4 a[48:51], v11, s[4:7], s59 offen offset:2048 sc1
buffer_load_dwordx4 a[52:55], v12, s[4:7], s59 offen offset:2048 sc1
v_mfma_f32_32x32x16_bf16 v[176:191], v[28:31], a[68:71], v[176:191]
v_mfma_f32_32x32x16_bf16 v[192:207], v[32:35], a[64:67], v[192:207]
v_mfma_f32_32x32x16_bf16 v[208:223], v[32:35], a[68:71], v[208:223]
v_mfma_f32_32x32x16_bf16 v[224:239], v[36:39], a[64:67], v[224:239]
v_mfma_f32_32x32x16_bf16 v[240:255], v[36:39], a[68:71], v[240:255]
s_waitcnt lgkmcnt(0)
s_waitcnt vmcnt(22)
s_barrier
s_waitcnt vmcnt(20)
v_mfma_f32_32x32x16_bf16 v[64:79], v[40:43], a[72:75], v[64:79]
ds_read_b64_tr_b16 v[16:17], v2 offset:24576
ds_read_b64_tr_b16 v[18:19], v2 offset:25344
v_mfma_f32_32x32x16_bf16 v[80:95], v[40:43], a[76:79], v[80:95]
ds_read_b64_tr_b16 v[20:21], v2 offset:24640
ds_read_b64_tr_b16 v[22:23], v2 offset:25408
v_mfma_f32_32x32x16_bf16 v[96:111], v[44:47], a[72:75], v[96:111]
ds_read_b64_tr_b16 v[24:25], v2 offset:24704
ds_read_b64_tr_b16 v[26:27], v2 offset:25472
v_mfma_f32_32x32x16_bf16 v[112:127], v[44:47], a[76:79], v[112:127]
ds_read_b64_tr_b16 v[28:29], v2 offset:36864
ds_read_b64_tr_b16 v[30:31], v2 offset:37632
v_mfma_f32_32x32x16_bf16 v[128:143], v[48:51], a[72:75], v[128:143]
ds_read_b64_tr_b16 v[32:33], v2 offset:36928
ds_read_b64_tr_b16 v[34:35], v2 offset:37696
v_mfma_f32_32x32x16_bf16 v[144:159], v[48:51], a[76:79], v[144:159]
ds_read_b64_tr_b16 v[36:37], v2 offset:36992
ds_read_b64_tr_b16 v[38:39], v2 offset:37760
v_mfma_f32_32x32x16_bf16 v[160:175], v[52:55], a[72:75], v[160:175]
s_add_u32 s43, s56, 1376256
s_add_u32 m0, s62, 73728
s_nop 0
buffer_load_dwordx4 v4, s[8:11], s43 offen lds
s_add_u32 m0, s62, 74752
s_nop 0
buffer_load_dwordx4 v5, s[8:11], s43 offen lds
s_add_u32 m0, s62, 75776
s_nop 0
buffer_load_dwordx4 v6, s[8:11], s43 offen lds
s_add_u32 m0, s62, 86016
s_nop 0
buffer_load_dwordx4 v4, s[12:15], s43 offen lds
s_add_u32 m0, s62, 87040
s_nop 0
buffer_load_dwordx4 v5, s[12:15], s43 offen lds
s_add_u32 m0, s62, 88064
s_nop 0
buffer_load_dwordx4 v6, s[12:15], s43 offen lds
buffer_load_dwordx4 a[56:59], v11, s[4:7], s59 offen offset:3072 sc1
buffer_load_dwordx4 a[60:63], v12, s[4:7], s59 offen offset:3072 sc1
v_mfma_f32_32x32x16_bf16 v[176:191], v[52:55], a[76:79], v[176:191]
v_mfma_f32_32x32x16_bf16 v[192:207], v[56:59], a[72:75], v[192:207]
v_mfma_f32_32x32x16_bf16 v[208:223], v[56:59], a[76:79], v[208:223]
v_mfma_f32_32x32x16_bf16 v[224:239], v[60:63], a[72:75], v[224:239]
v_mfma_f32_32x32x16_bf16 v[240:255], v[60:63], a[76:79], v[240:255]
s_waitcnt lgkmcnt(0)
s_waitcnt vmcnt(26)
v_mfma_f32_32x32x16_bf16 v[64:79], v[16:19], a[0:3], v[64:79]
s_add_u32 s60, s57, 28672
ds_read_b64_tr_b16 v[40:41], v2 offset:27648
v_mfma_f32_32x32x16_bf16 v[80:95], v[16:19], a[4:7], v[80:95]
ds_read_b64_tr_b16 v[42:43], v2 offset:28416
ds_read_b64_tr_b16 v[44:45], v2 offset:27712
v_mfma_f32_32x32x16_bf16 v[96:111], v[20:23], a[0:3], v[96:111]
ds_read_b64_tr_b16 v[46:47], v2 offset:28480
ds_read_b64_tr_b16 v[48:49], v2 offset:27776
v_mfma_f32_32x32x16_bf16 v[112:127], v[20:23], a[4:7], v[112:127]
ds_read_b64_tr_b16 v[50:51], v2 offset:28544
ds_read_b64_tr_b16 v[52:53], v2 offset:39936
v_mfma_f32_32x32x16_bf16 v[128:143], v[24:27], a[0:3], v[128:143]
ds_read_b64_tr_b16 v[54:55], v2 offset:40704
ds_read_b64_tr_b16 v[56:57], v2 offset:40000
v_mfma_f32_32x32x16_bf16 v[144:159], v[24:27], a[4:7], v[144:159]
ds_read_b64_tr_b16 v[58:59], v2 offset:40768
ds_read_b64_tr_b16 v[60:61], v2 offset:40064
v_mfma_f32_32x32x16_bf16 v[160:175], v[28:31], a[0:3], v[160:175]
ds_read_b64_tr_b16 v[62:63], v2 offset:40832
buffer_load_dwordx4 a[64:67], v11, s[4:7], s60 offen offset:0 sc1
buffer_load_dwordx4 a[68:71], v12, s[4:7], s60 offen offset:0 sc1
v_mfma_f32_32x32x16_bf16 v[176:191], v[28:31], a[4:7], v[176:191]
v_mfma_f32_32x32x16_bf16 v[192:207], v[32:35], a[0:3], v[192:207]
v_mfma_f32_32x32x16_bf16 v[208:223], v[32:35], a[4:7], v[208:223]
v_mfma_f32_32x32x16_bf16 v[224:239], v[36:39], a[0:3], v[224:239]
v_mfma_f32_32x32x16_bf16 v[240:255], v[36:39], a[4:7], v[240:255]
s_waitcnt lgkmcnt(0)
s_waitcnt vmcnt(26)
v_mfma_f32_32x32x16_bf16 v[64:79], v[40:43], a[8:11], v[64:79]
ds_read_b64_tr_b16 v[16:17], v2 offset:30720
ds_read_b64_tr_b16 v[18:19], v2 offset:31488
v_mfma_f32_32x32x16_bf16 v[80:95], v[40:43], a[12:15], v[80:95]
ds_read_b64_tr_b16 v[20:21], v2 offset:30784
ds_read_b64_tr_b16 v[22:23], v2 offset:31552
v_mfma_f32_32x32x16_bf16 v[96:111], v[44:47], a[8:11], v[96:111]
ds_read_b64_tr_b16 v[24:25], v2 offset:30848
ds_read_b64_tr_b16 v[26:27], v2 offset:31616
v_mfma_f32_32x32x16_bf16 v[112:127], v[44:47], a[12:15], v[112:127]
ds_read_b64_tr_b16 v[28:29], v2 offset:43008
ds_read_b64_tr_b16 v[30:31], v2 offset:43776
v_mfma_f32_32x32x16_bf16 v[128:143], v[48:51], a[8:11], v[128:143]
ds_read_b64_tr_b16 v[32:33], v2 offset:43072
ds_read_b64_tr_b16 v[34:35], v2 offset:43840
v_mfma_f32_32x32x16_bf16 v[144:159], v[48:51], a[12:15], v[144:159]
ds_read_b64_tr_b16 v[36:37], v2 offset:43136
ds_read_b64_tr_b16 v[38:39], v2 offset:43904
v_mfma_f32_32x32x16_bf16 v[160:175], v[52:55], a[8:11], v[160:175]
buffer_load_dwordx4 a[72:75], v11, s[4:7], s60 offen offset:1024 sc1
buffer_load_dwordx4 a[76:79], v12, s[4:7], s60 offen offset:1024 sc1
v_mfma_f32_32x32x16_bf16 v[176:191], v[52:55], a[12:15], v[176:191]
v_mfma_f32_32x32x16_bf16 v[192:207], v[56:59], a[8:11], v[192:207]
v_mfma_f32_32x32x16_bf16 v[208:223], v[56:59], a[12:15], v[208:223]
v_mfma_f32_32x32x16_bf16 v[224:239], v[60:63], a[8:11], v[224:239]
v_mfma_f32_32x32x16_bf16 v[240:255], v[60:63], a[12:15], v[240:255]
s_waitcnt lgkmcnt(0)
s_waitcnt vmcnt(26)
v_mfma_f32_32x32x16_bf16 v[64:79], v[16:19], a[16:19], v[64:79]
ds_read_b64_tr_b16 v[40:41], v2 offset:33792
ds_read_b64_tr_b16 v[42:43], v2 offset:34560
v_mfma_f32_32x32x16_bf16 v[80:95], v[16:19], a[20:23], v[80:95]
ds_read_b64_tr_b16 v[44:45], v2 offset:33856
ds_read_b64_tr_b16 v[46:47], v2 offset:34624
v_mfma_f32_32x32x16_bf16 v[96:111], v[20:23], a[16:19], v[96:111]
ds_read_b64_tr_b16 v[48:49], v2 offset:33920
ds_read_b64_tr_b16 v[50:51], v2 offset:34688
v_mfma_f32_32x32x16_bf16 v[112:127], v[20:23], a[20:23], v[112:127]
ds_read_b64_tr_b16 v[52:53], v2 offset:46080
ds_read_b64_tr_b16 v[54:55], v2 offset:46848
v_mfma_f32_32x32x16_bf16 v[128:143], v[24:27], a[16:19], v[128:143]
ds_read_b64_tr_b16 v[56:57], v2 offset:46144
ds_read_b64_tr_b16 v[58:59], v2 offset:46912
v_mfma_f32_32x32x16_bf16 v[144:159], v[24:27], a[20:23], v[144:159]
ds_read_b64_tr_b16 v[60:61], v2 offset:46208
ds_read_b64_tr_b16 v[62:63], v2 offset:46976
v_mfma_f32_32x32x16_bf16 v[160:175], v[28:31], a[16:19], v[160:175]
buffer_load_dwordx4 a[0:3], v11, s[4:7], s60 offen offset:2048 sc1
buffer_load_dwordx4 a[4:7], v12, s[4:7], s60 offen offset:2048 sc1
v_mfma_f32_32x32x16_bf16 v[176:191], v[28:31], a[20:23], v[176:191]
v_mfma_f32_32x32x16_bf16 v[192:207], v[32:35], a[16:19], v[192:207]
v_mfma_f32_32x32x16_bf16 v[208:223], v[32:35], a[20:23], v[208:223]
v_mfma_f32_32x32x16_bf16 v[224:239], v[36:39], a[16:19], v[224:239]
v_mfma_f32_32x32x16_bf16 v[240:255], v[36:39], a[20:23], v[240:255]
s_waitcnt lgkmcnt(0)
s_waitcnt vmcnt(22)
s_barrier
s_waitcnt vmcnt(20)
v_mfma_f32_32x32x16_bf16 v[64:79], v[40:43], a[24:27], v[64:79]
ds_read_b64_tr_b16 v[16:17], v13 offset:0
ds_read_b64_tr_b16 v[18:19], v13 offset:768
v_mfma_f32_32x32x16_bf16 v[80:95], v[40:43], a[28:31], v[80:95]
ds_read_b64_tr_b16 v[20:21], v13 offset:64
ds_read_b64_tr_b16 v[22:23], v13 offset:832
v_mfma_f32_32x32x16_bf16 v[96:111], v[44:47], a[24:27], v[96:111]
ds_read_b64_tr_b16 v[24:25], v13 offset:128
ds_read_b64_tr_b16 v[26:27], v13 offset:896
v_mfma_f32_32x32x16_bf16 v[112:127], v[44:47], a[28:31], v[112:127]
ds_read_b64_tr_b16 v[28:29], v13 offset:12288
ds_read_b64_tr_b16 v[30:31], v13 offset:13056
v_mfma_f32_32x32x16_bf16 v[128:143], v[48:51], a[24:27], v[128:143]
ds_read_b64_tr_b16 v[32:33], v13 offset:12352
ds_read_b64_tr_b16 v[34:35], v13 offset:13120
v_mfma_f32_32x32x16_bf16 v[144:159], v[48:51], a[28:31], v[144:159]
ds_read_b64_tr_b16 v[36:37], v13 offset:12416
ds_read_b64_tr_b16 v[38:39], v13 offset:13184
v_mfma_f32_32x32x16_bf16 v[160:175], v[52:55], a[24:27], v[160:175]
s_add_u32 s43, s56, 1572864
s_add_u32 m0, s62, 0
s_nop 0
buffer_load_dwordx4 v4, s[8:11], s43 offen lds
s_add_u32 m0, s62, 1024
s_nop 0
buffer_load_dwordx4 v5, s[8:11], s43 offen lds
s_add_u32 m0, s62, 2048
s_nop 0
buffer_load_dwordx4 v6, s[8:11], s43 offen lds
s_add_u32 m0, s62, 12288
s_nop 0
buffer_load_dwordx4 v4, s[12:15], s43 offen lds
s_add_u32 m0, s62, 13312
s_nop 0
buffer_load_dwordx4 v5, s[12:15], s43 offen lds
s_add_u32 m0, s62, 14336
s_nop 0
buffer_load_dwordx4 v6, s[12:15], s43 offen lds
buffer_load_dwordx4 a[8:11], v11, s[4:7], s60 offen offset:3072 sc1
buffer_load_dwordx4 a[12:15], v12, s[4:7], s60 offen offset:3072 sc1
v_mfma_f32_32x32x16_bf16 v[176:191], v[52:55], a[28:31], v[176:191]
v_mfma_f32_32x32x16_bf16 v[192:207], v[56:59], a[24:27], v[192:207]
v_mfma_f32_32x32x16_bf16 v[208:223], v[56:59], a[28:31], v[208:223]
v_mfma_f32_32x32x16_bf16 v[224:239], v[60:63], a[24:27], v[224:239]
v_mfma_f32_32x32x16_bf16 v[240:255], v[60:63], a[28:31], v[240:255]
s_waitcnt lgkmcnt(0)
s_waitcnt vmcnt(26)
v_mfma_f32_32x32x16_bf16 v[64:79], v[16:19], a[32:35], v[64:79]
s_add_u32 s61, s57, 32768
ds_read_b64_tr_b16 v[40:41], v13 offset:3072
v_mfma_f32_32x32x16_bf16 v[80:95], v[16:19], a[36:39], v[80:95]
ds_read_b64_tr_b16 v[42:43], v13 offset:3840
ds_read_b64_tr_b16 v[44:45], v13 offset:3136
v_mfma_f32_32x32x16_bf16 v[96:111], v[20:23], a[32:35], v[96:111]
ds_read_b64_tr_b16 v[46:47], v13 offset:3904
ds_read_b64_tr_b16 v[48:49], v13 offset:3200
v_mfma_f32_32x32x16_bf16 v[112:127], v[20:23], a[36:39], v[112:127]
ds_read_b64_tr_b16 v[50:51], v13 offset:3968
ds_read_b64_tr_b16 v[52:53], v13 offset:15360
v_mfma_f32_32x32x16_bf16 v[128:143], v[24:27], a[32:35], v[128:143]
ds_read_b64_tr_b16 v[54:55], v13 offset:16128
ds_read_b64_tr_b16 v[56:57], v13 offset:15424
v_mfma_f32_32x32x16_bf16 v[144:159], v[24:27], a[36:39], v[144:159]
ds_read_b64_tr_b16 v[58:59], v13 offset:16192
ds_read_b64_tr_b16 v[60:61], v13 offset:15488
v_mfma_f32_32x32x16_bf16 v[160:175], v[28:31], a[32:35], v[160:175]
ds_read_b64_tr_b16 v[62:63], v13 offset:16256
buffer_load_dwordx4 a[16:19], v11, s[4:7], s61 offen offset:0 sc1
buffer_load_dwordx4 a[20:23], v12, s[4:7], s61 offen offset:0 sc1
v_mfma_f32_32x32x16_bf16 v[176:191], v[28:31], a[36:39], v[176:191]
v_mfma_f32_32x32x16_bf16 v[192:207], v[32:35], a[32:35], v[192:207]
v_mfma_f32_32x32x16_bf16 v[208:223], v[32:35], a[36:39], v[208:223]
v_mfma_f32_32x32x16_bf16 v[224:239], v[36:39], a[32:35], v[224:239]
v_mfma_f32_32x32x16_bf16 v[240:255], v[36:39], a[36:39], v[240:255]
s_waitcnt lgkmcnt(0)
s_waitcnt vmcnt(26)
v_mfma_f32_32x32x16_bf16 v[64:79], v[40:43], a[40:43], v[64:79]
ds_read_b64_tr_b16 v[16:17], v13 offset:6144
ds_read_b64_tr_b16 v[18:19], v13 offset:6912
v_mfma_f32_32x32x16_bf16 v[80:95], v[40:43], a[44:47], v[80:95]
ds_read_b64_tr_b16 v[20:21], v13 offset:6208
ds_read_b64_tr_b16 v[22:23], v13 offset:6976
v_mfma_f32_32x32x16_bf16 v[96:111], v[44:47], a[40:43], v[96:111]
ds_read_b64_tr_b16 v[24:25], v13 offset:6272
ds_read_b64_tr_b16 v[26:27], v13 offset:7040
v_mfma_f32_32x32x16_bf16 v[112:127], v[44:47], a[44:47], v[112:127]
ds_read_b64_tr_b16 v[28:29], v13 offset:18432
ds_read_b64_tr_b16 v[30:31], v13 offset:19200
v_mfma_f32_32x32x16_bf16 v[128:143], v[48:51], a[40:43], v[128:143]
ds_read_b64_tr_b16 v[32:33], v13 offset:18496
ds_read_b64_tr_b16 v[34:35], v13 offset:19264
v_mfma_f32_32x32x16_bf16 v[144:159], v[48:51], a[44:47], v[144:159]
ds_read_b64_tr_b16 v[36:37], v13 offset:18560
ds_read_b64_tr_b16 v[38:39], v13 offset:19328
v_mfma_f32_32x32x16_bf16 v[160:175], v[52:55], a[40:43], v[160:175]
buffer_load_dwordx4 a[24:27], v11, s[4:7], s61 offen offset:1024 sc1
buffer_load_dwordx4 a[28:31], v12, s[4:7], s61 offen offset:1024 sc1
v_mfma_f32_32x32x16_bf16 v[176:191], v[52:55], a[44:47], v[176:191]
v_mfma_f32_32x32x16_bf16 v[192:207], v[56:59], a[40:43], v[192:207]
v_mfma_f32_32x32x16_bf16 v[208:223], v[56:59], a[44:47], v[208:223]
v_mfma_f32_32x32x16_bf16 v[224:239], v[60:63], a[40:43], v[224:239]
v_mfma_f32_32x32x16_bf16 v[240:255], v[60:63], a[44:47], v[240:255]
s_waitcnt lgkmcnt(0)
s_waitcnt vmcnt(26)
v_mfma_f32_32x32x16_bf16 v[64:79], v[16:19], a[48:51], v[64:79]
ds_read_b64_tr_b16 v[40:41], v13 offset:9216
ds_read_b64_tr_b16 v[42:43], v13 offset:9984
v_mfma_f32_32x32x16_bf16 v[80:95], v[16:19], a[52:55], v[80:95]
ds_read_b64_tr_b16 v[44:45], v13 offset:9280
ds_read_b64_tr_b16 v[46:47], v13 offset:10048
v_mfma_f32_32x32x16_bf16 v[96:111], v[20:23], a[48:51], v[96:111]
ds_read_b64_tr_b16 v[48:49], v13 offset:9344
ds_read_b64_tr_b16 v[50:51], v13 offset:10112
v_mfma_f32_32x32x16_bf16 v[112:127], v[20:23], a[52:55], v[112:127]
ds_read_b64_tr_b16 v[52:53], v13 offset:21504
ds_read_b64_tr_b16 v[54:55], v13 offset:22272
v_mfma_f32_32x32x16_bf16 v[128:143], v[24:27], a[48:51], v[128:143]
ds_read_b64_tr_b16 v[56:57], v13 offset:21568
ds_read_b64_tr_b16 v[58:59], v13 offset:22336
v_mfma_f32_32x32x16_bf16 v[144:159], v[24:27], a[52:55], v[144:159]
ds_read_b64_tr_b16 v[60:61], v13 offset:21632
ds_read_b64_tr_b16 v[62:63], v13 offset:22400
v_mfma_f32_32x32x16_bf16 v[160:175], v[28:31], a[48:51], v[160:175]
buffer_load_dwordx4 a[32:35], v11, s[4:7], s61 offen offset:2048 sc1
buffer_load_dwordx4 a[36:39], v12, s[4:7], s61 offen offset:2048 sc1
v_mfma_f32_32x32x16_bf16 v[176:191], v[28:31], a[52:55], v[176:191]
v_mfma_f32_32x32x16_bf16 v[192:207], v[32:35], a[48:51], v[192:207]
v_mfma_f32_32x32x16_bf16 v[208:223], v[32:35], a[52:55], v[208:223]
v_mfma_f32_32x32x16_bf16 v[224:239], v[36:39], a[48:51], v[224:239]
v_mfma_f32_32x32x16_bf16 v[240:255], v[36:39], a[52:55], v[240:255]
s_waitcnt lgkmcnt(0)
s_waitcnt vmcnt(22)
s_barrier
s_waitcnt vmcnt(20)
v_mfma_f32_32x32x16_bf16 v[64:79], v[40:43], a[56:59], v[64:79]
ds_read_b64_tr_b16 v[16:17], v13 offset:24576
ds_read_b64_tr_b16 v[18:19], v13 offset:25344
v_mfma_f32_32x32x16_bf16 v[80:95], v[40:43], a[60:63], v[80:95]
ds_read_b64_tr_b16 v[20:21], v13 offset:24640
ds_read_b64_tr_b16 v[22:23], v13 offset:25408
v_mfma_f32_32x32x16_bf16 v[96:111], v[44:47], a[56:59], v[96:111]
ds_read_b64_tr_b16 v[24:25], v13 offset:24704
ds_read_b64_tr_b16 v[26:27], v13 offset:25472
v_mfma_f32_32x32x16_bf16 v[112:127], v[44:47], a[60:63], v[112:127]
ds_read_b64_tr_b16 v[28:29], v13 offset:36864
ds_read_b64_tr_b16 v[30:31], v13 offset:37632
v_mfma_f32_32x32x16_bf16 v[128:143], v[48:51], a[56:59], v[128:143]
ds_read_b64_tr_b16 v[32:33], v13 offset:36928
ds_read_b64_tr_b16 v[34:35], v13 offset:37696
v_mfma_f32_32x32x16_bf16 v[144:159], v[48:51], a[60:63], v[144:159]
ds_read_b64_tr_b16 v[36:37], v13 offset:36992
ds_read_b64_tr_b16 v[38:39], v13 offset:37760
v_mfma_f32_32x32x16_bf16 v[160:175], v[52:55], a[56:59], v[160:175]
s_add_u32 s43, s56, 1769472
s_add_u32 m0, s62, 24576
s_nop 0
buffer_load_dwordx4 v4, s[8:11], s43 offen lds
s_add_u32 m0, s62, 25600
s_nop 0
buffer_load_dwordx4 v5, s[8:11], s43 offen lds
s_add_u32 m0, s62, 26624
s_nop 0
buffer_load_dwordx4 v6, s[8:11], s43 offen lds
s_add_u32 m0, s62, 36864
s_nop 0
buffer_load_dwordx4 v4, s[12:15], s43 offen lds
s_add_u32 m0, s62, 37888
s_nop 0
buffer_load_dwordx4 v5, s[12:15], s43 offen lds
s_add_u32 m0, s62, 38912
s_nop 0
buffer_load_dwordx4 v6, s[12:15], s43 offen lds
buffer_load_dwordx4 a[40:43], v11, s[4:7], s61 offen offset:3072 sc1
buffer_load_dwordx4 a[44:47], v12, s[4:7], s61 offen offset:3072 sc1
v_mfma_f32_32x32x16_bf16 v[176:191], v[52:55], a[60:63], v[176:191]
v_mfma_f32_32x32x16_bf16 v[192:207], v[56:59], a[56:59], v[192:207]
v_mfma_f32_32x32x16_bf16 v[208:223], v[56:59], a[60:63], v[208:223]
v_mfma_f32_32x32x16_bf16 v[224:239], v[60:63], a[56:59], v[224:239]
v_mfma_f32_32x32x16_bf16 v[240:255], v[60:63], a[60:63], v[240:255]
s_waitcnt lgkmcnt(0)
s_waitcnt vmcnt(26)
v_mfma_f32_32x32x16_bf16 v[64:79], v[16:19], a[64:67], v[64:79]
s_add_u32 s59, s57, 36864
ds_read_b64_tr_b16 v[40:41], v13 offset:27648
v_mfma_f32_32x32x16_bf16 v[80:95], v[16:19], a[68:71], v[80:95]
ds_read_b64_tr_b16 v[42:43], v13 offset:28416
ds_read_b64_tr_b16 v[44:45], v13 offset:27712
v_mfma_f32_32x32x16_bf16 v[96:111], v[20:23], a[64:67], v[96:111]
ds_read_b64_tr_b16 v[46:47], v13 offset:28480
ds_read_b64_tr_b16 v[48:49], v13 offset:27776
v_mfma_f32_32x32x16_bf16 v[112:127], v[20:23], a[68:71], v[112:127]
ds_read_b64_tr_b16 v[50:51], v13 offset:28544
ds_read_b64_tr_b16 v[52:53], v13 offset:39936
v_mfma_f32_32x32x16_bf16 v[128:143], v[24:27], a[64:67], v[128:143]
ds_read_b64_tr_b16 v[54:55], v13 offset:40704
ds_read_b64_tr_b16 v[56:57], v13 offset:40000
v_mfma_f32_32x32x16_bf16 v[144:159], v[24:27], a[68:71], v[144:159]
ds_read_b64_tr_b16 v[58:59], v13 offset:40768
ds_read_b64_tr_b16 v[60:61], v13 offset:40064
v_mfma_f32_32x32x16_bf16 v[160:175], v[28:31], a[64:67], v[160:175]
ds_read_b64_tr_b16 v[62:63], v13 offset:40832
buffer_load_dwordx4 a[48:51], v11, s[4:7], s59 offen offset:0 sc1
buffer_load_dwordx4 a[52:55], v12, s[4:7], s59 offen offset:0 sc1
v_mfma_f32_32x32x16_bf16 v[176:191], v[28:31], a[68:71], v[176:191]
v_mfma_f32_32x32x16_bf16 v[192:207], v[32:35], a[64:67], v[192:207]
v_mfma_f32_32x32x16_bf16 v[208:223], v[32:35], a[68:71], v[208:223]
v_mfma_f32_32x32x16_bf16 v[224:239], v[36:39], a[64:67], v[224:239]
v_mfma_f32_32x32x16_bf16 v[240:255], v[36:39], a[68:71], v[240:255]
s_waitcnt lgkmcnt(0)
s_waitcnt vmcnt(26)
v_mfma_f32_32x32x16_bf16 v[64:79], v[40:43], a[72:75], v[64:79]
ds_read_b64_tr_b16 v[16:17], v13 offset:30720
ds_read_b64_tr_b16 v[18:19], v13 offset:31488
v_mfma_f32_32x32x16_bf16 v[80:95], v[40:43], a[76:79], v[80:95]
ds_read_b64_tr_b16 v[20:21], v13 offset:30784
ds_read_b64_tr_b16 v[22:23], v13 offset:31552
v_mfma_f32_32x32x16_bf16 v[96:111], v[44:47], a[72:75], v[96:111]
ds_read_b64_tr_b16 v[24:25], v13 offset:30848
ds_read_b64_tr_b16 v[26:27], v13 offset:31616
v_mfma_f32_32x32x16_bf16 v[112:127], v[44:47], a[76:79], v[112:127]
ds_read_b64_tr_b16 v[28:29], v13 offset:43008
ds_read_b64_tr_b16 v[30:31], v13 offset:43776
v_mfma_f32_32x32x16_bf16 v[128:143], v[48:51], a[72:75], v[128:143]
ds_read_b64_tr_b16 v[32:33], v13 offset:43072
ds_read_b64_tr_b16 v[34:35], v13 offset:43840
v_mfma_f32_32x32x16_bf16 v[144:159], v[48:51], a[76:79], v[144:159]
ds_read_b64_tr_b16 v[36:37], v13 offset:43136
ds_read_b64_tr_b16 v[38:39], v13 offset:43904
v_mfma_f32_32x32x16_bf16 v[160:175], v[52:55], a[72:75], v[160:175]
buffer_load_dwordx4 a[56:59], v11, s[4:7], s59 offen offset:1024 sc1
buffer_load_dwordx4 a[60:63], v12, s[4:7], s59 offen offset:1024 sc1
v_mfma_f32_32x32x16_bf16 v[176:191], v[52:55], a[76:79], v[176:191]
v_mfma_f32_32x32x16_bf16 v[192:207], v[56:59], a[72:75], v[192:207]
v_mfma_f32_32x32x16_bf16 v[208:223], v[56:59], a[76:79], v[208:223]
v_mfma_f32_32x32x16_bf16 v[224:239], v[60:63], a[72:75], v[224:239]
v_mfma_f32_32x32x16_bf16 v[240:255], v[60:63], a[76:79], v[240:255]
s_waitcnt lgkmcnt(0)
s_waitcnt vmcnt(26)
v_mfma_f32_32x32x16_bf16 v[64:79], v[16:19], a[0:3], v[64:79]
ds_read_b64_tr_b16 v[40:41], v13 offset:33792
ds_read_b64_tr_b16 v[42:43], v13 offset:34560
v_mfma_f32_32x32x16_bf16 v[80:95], v[16:19], a[4:7], v[80:95]
ds_read_b64_tr_b16 v[44:45], v13 offset:33856
ds_read_b64_tr_b16 v[46:47], v13 offset:34624
v_mfma_f32_32x32x16_bf16 v[96:111], v[20:23], a[0:3], v[96:111]
ds_read_b64_tr_b16 v[48:49], v13 offset:33920
ds_read_b64_tr_b16 v[50:51], v13 offset:34688
v_mfma_f32_32x32x16_bf16 v[112:127], v[20:23], a[4:7], v[112:127]
ds_read_b64_tr_b16 v[52:53], v13 offset:46080
ds_read_b64_tr_b16 v[54:55], v13 offset:46848
v_mfma_f32_32x32x16_bf16 v[128:143], v[24:27], a[0:3], v[128:143]
ds_read_b64_tr_b16 v[56:57], v13 offset:46144
ds_read_b64_tr_b16 v[58:59], v13 offset:46912
v_mfma_f32_32x32x16_bf16 v[144:159], v[24:27], a[4:7], v[144:159]
ds_read_b64_tr_b16 v[60:61], v13 offset:46208
ds_read_b64_tr_b16 v[62:63], v13 offset:46976
v_mfma_f32_32x32x16_bf16 v[160:175], v[28:31], a[0:3], v[160:175]
buffer_load_dwordx4 a[64:67], v11, s[4:7], s59 offen offset:2048 sc1
buffer_load_dwordx4 a[68:71], v12, s[4:7], s59 offen offset:2048 sc1
v_mfma_f32_32x32x16_bf16 v[176:191], v[28:31], a[4:7], v[176:191]
v_mfma_f32_32x32x16_bf16 v[192:207], v[32:35], a[0:3], v[192:207]
v_mfma_f32_32x32x16_bf16 v[208:223], v[32:35], a[4:7], v[208:223]
v_mfma_f32_32x32x16_bf16 v[224:239], v[36:39], a[0:3], v[224:239]
v_mfma_f32_32x32x16_bf16 v[240:255], v[36:39], a[4:7], v[240:255]
s_waitcnt lgkmcnt(0)
s_waitcnt vmcnt(22)
s_barrier
s_waitcnt vmcnt(20)
v_mfma_f32_32x32x16_bf16 v[64:79], v[40:43], a[8:11], v[64:79]
ds_read_b64_tr_b16 v[16:17], v2 offset:0
ds_read_b64_tr_b16 v[18:19], v2 offset:768
v_mfma_f32_32x32x16_bf16 v[80:95], v[40:43], a[12:15], v[80:95]
ds_read_b64_tr_b16 v[20:21], v2 offset:64
ds_read_b64_tr_b16 v[22:23], v2 offset:832
v_mfma_f32_32x32x16_bf16 v[96:111], v[44:47], a[8:11], v[96:111]
ds_read_b64_tr_b16 v[24:25], v2 offset:128
ds_read_b64_tr_b16 v[26:27], v2 offset:896
v_mfma_f32_32x32x16_bf16 v[112:127], v[44:47], a[12:15], v[112:127]
ds_read_b64_tr_b16 v[28:29], v2 offset:12288
ds_read_b64_tr_b16 v[30:31], v2 offset:13056
v_mfma_f32_32x32x16_bf16 v[128:143], v[48:51], a[8:11], v[128:143]
ds_read_b64_tr_b16 v[32:33], v2 offset:12352
ds_read_b64_tr_b16 v[34:35], v2 offset:13120
v_mfma_f32_32x32x16_bf16 v[144:159], v[48:51], a[12:15], v[144:159]
ds_read_b64_tr_b16 v[36:37], v2 offset:12416
ds_read_b64_tr_b16 v[38:39], v2 offset:13184
v_mfma_f32_32x32x16_bf16 v[160:175], v[52:55], a[8:11], v[160:175]
buffer_load_dwordx4 a[72:75], v11, s[4:7], s59 offen offset:3072 sc1
buffer_load_dwordx4 a[76:79], v12, s[4:7], s59 offen offset:3072 sc1
v_mfma_f32_32x32x16_bf16 v[176:191], v[52:55], a[12:15], v[176:191]
v_mfma_f32_32x32x16_bf16 v[192:207], v[56:59], a[8:11], v[192:207]
v_mfma_f32_32x32x16_bf16 v[208:223], v[56:59], a[12:15], v[208:223]
v_mfma_f32_32x32x16_bf16 v[224:239], v[60:63], a[8:11], v[224:239]
v_mfma_f32_32x32x16_bf16 v[240:255], v[60:63], a[12:15], v[240:255]
s_waitcnt lgkmcnt(0)
s_waitcnt vmcnt(20)
v_mfma_f32_32x32x16_bf16 v[64:79], v[16:19], a[16:19], v[64:79]
ds_read_b64_tr_b16 v[40:41], v2 offset:3072
v_mfma_f32_32x32x16_bf16 v[80:95], v[16:19], a[20:23], v[80:95]
ds_read_b64_tr_b16 v[42:43], v2 offset:3840
ds_read_b64_tr_b16 v[44:45], v2 offset:3136
v_mfma_f32_32x32x16_bf16 v[96:111], v[20:23], a[16:19], v[96:111]
ds_read_b64_tr_b16 v[46:47], v2 offset:3904
ds_read_b64_tr_b16 v[48:49], v2 offset:3200
v_mfma_f32_32x32x16_bf16 v[112:127], v[20:23], a[20:23], v[112:127]
ds_read_b64_tr_b16 v[50:51], v2 offset:3968
ds_read_b64_tr_b16 v[52:53], v2 offset:15360
v_mfma_f32_32x32x16_bf16 v[128:143], v[24:27], a[16:19], v[128:143]
ds_read_b64_tr_b16 v[54:55], v2 offset:16128
ds_read_b64_tr_b16 v[56:57], v2 offset:15424
v_mfma_f32_32x32x16_bf16 v[144:159], v[24:27], a[20:23], v[144:159]
ds_read_b64_tr_b16 v[58:59], v2 offset:16192
ds_read_b64_tr_b16 v[60:61], v2 offset:15488
v_mfma_f32_32x32x16_bf16 v[160:175], v[28:31], a[16:19], v[160:175]
ds_read_b64_tr_b16 v[62:63], v2 offset:16256
v_mfma_f32_32x32x16_bf16 v[176:191], v[28:31], a[20:23], v[176:191]
v_mfma_f32_32x32x16_bf16 v[192:207], v[32:35], a[16:19], v[192:207]
v_mfma_f32_32x32x16_bf16 v[208:223], v[32:35], a[20:23], v[208:223]
v_mfma_f32_32x32x16_bf16 v[224:239], v[36:39], a[16:19], v[224:239]
v_mfma_f32_32x32x16_bf16 v[240:255], v[36:39], a[20:23], v[240:255]
s_waitcnt lgkmcnt(0)
s_waitcnt vmcnt(18)
v_mfma_f32_32x32x16_bf16 v[64:79], v[40:43], a[24:27], v[64:79]
ds_read_b64_tr_b16 v[16:17], v2 offset:6144
ds_read_b64_tr_b16 v[18:19], v2 offset:6912
v_mfma_f32_32x32x16_bf16 v[80:95], v[40:43], a[28:31], v[80:95]
ds_read_b64_tr_b16 v[20:21], v2 offset:6208
ds_read_b64_tr_b16 v[22:23], v2 offset:6976
v_mfma_f32_32x32x16_bf16 v[96:111], v[44:47], a[24:27], v[96:111]
ds_read_b64_tr_b16 v[24:25], v2 offset:6272
ds_read_b64_tr_b16 v[26:27], v2 offset:7040
v_mfma_f32_32x32x16_bf16 v[112:127], v[44:47], a[28:31], v[112:127]
ds_read_b64_tr_b16 v[28:29], v2 offset:18432
ds_read_b64_tr_b16 v[30:31], v2 offset:19200
v_mfma_f32_32x32x16_bf16 v[128:143], v[48:51], a[24:27], v[128:143]
ds_read_b64_tr_b16 v[32:33], v2 offset:18496
ds_read_b64_tr_b16 v[34:35], v2 offset:19264
v_mfma_f32_32x32x16_bf16 v[144:159], v[48:51], a[28:31], v[144:159]
ds_read_b64_tr_b16 v[36:37], v2 offset:18560
ds_read_b64_tr_b16 v[38:39], v2 offset:19328
v_mfma_f32_32x32x16_bf16 v[160:175], v[52:55], a[24:27], v[160:175]
v_mfma_f32_32x32x16_bf16 v[176:191], v[52:55], a[28:31], v[176:191]
v_mfma_f32_32x32x16_bf16 v[192:207], v[56:59], a[24:27], v[192:207]
v_mfma_f32_32x32x16_bf16 v[208:223], v[56:59], a[28:31], v[208:223]
v_mfma_f32_32x32x16_bf16 v[224:239], v[60:63], a[24:27], v[224:239]
v_mfma_f32_32x32x16_bf16 v[240:255], v[60:63], a[28:31], v[240:255]
s_waitcnt lgkmcnt(0)
s_waitcnt vmcnt(16)
v_mfma_f32_32x32x16_bf16 v[64:79], v[16:19], a[32:35], v[64:79]
ds_read_b64_tr_b16 v[40:41], v2 offset:9216
ds_read_b64_tr_b16 v[42:43], v2 offset:9984
v_mfma_f32_32x32x16_bf16 v[80:95], v[16:19], a[36:39], v[80:95]
ds_read_b64_tr_b16 v[44:45], v2 offset:9280
ds_read_b64_tr_b16 v[46:47], v2 offset:10048
v_mfma_f32_32x32x16_bf16 v[96:111], v[20:23], a[32:35], v[96:111]
ds_read_b64_tr_b16 v[48:49], v2 offset:9344
ds_read_b64_tr_b16 v[50:51], v2 offset:10112
v_mfma_f32_32x32x16_bf16 v[112:127], v[20:23], a[36:39], v[112:127]
ds_read_b64_tr_b16 v[52:53], v2 offset:21504
ds_read_b64_tr_b16 v[54:55], v2 offset:22272
v_mfma_f32_32x32x16_bf16 v[128:143], v[24:27], a[32:35], v[128:143]
ds_read_b64_tr_b16 v[56:57], v2 offset:21568
ds_read_b64_tr_b16 v[58:59], v2 offset:22336
v_mfma_f32_32x32x16_bf16 v[144:159], v[24:27], a[36:39], v[144:159]
ds_read_b64_tr_b16 v[60:61], v2 offset:21632
ds_read_b64_tr_b16 v[62:63], v2 offset:22400
v_mfma_f32_32x32x16_bf16 v[160:175], v[28:31], a[32:35], v[160:175]
v_mfma_f32_32x32x16_bf16 v[176:191], v[28:31], a[36:39], v[176:191]
v_mfma_f32_32x32x16_bf16 v[192:207], v[32:35], a[32:35], v[192:207]
v_mfma_f32_32x32x16_bf16 v[208:223], v[32:35], a[36:39], v[208:223]
v_mfma_f32_32x32x16_bf16 v[224:239], v[36:39], a[32:35], v[224:239]
v_mfma_f32_32x32x16_bf16 v[240:255], v[36:39], a[36:39], v[240:255]
s_waitcnt lgkmcnt(0)
s_waitcnt vmcnt(10)
s_barrier
s_waitcnt vmcnt(8)
v_mfma_f32_32x32x16_bf16 v[64:79], v[40:43], a[40:43], v[64:79]
ds_read_b64_tr_b16 v[16:17], v2 offset:24576
ds_read_b64_tr_b16 v[18:19], v2 offset:25344
v_mfma_f32_32x32x16_bf16 v[80:95], v[40:43], a[44:47], v[80:95]
ds_read_b64_tr_b16 v[20:21], v2 offset:24640
ds_read_b64_tr_b16 v[22:23], v2 offset:25408
v_mfma_f32_32x32x16_bf16 v[96:111], v[44:47], a[40:43], v[96:111]
ds_read_b64_tr_b16 v[24:25], v2 offset:24704
ds_read_b64_tr_b16 v[26:27], v2 offset:25472
v_mfma_f32_32x32x16_bf16 v[112:127], v[44:47], a[44:47], v[112:127]
ds_read_b64_tr_b16 v[28:29], v2 offset:36864
ds_read_b64_tr_b16 v[30:31], v2 offset:37632
v_mfma_f32_32x32x16_bf16 v[128:143], v[48:51], a[40:43], v[128:143]
ds_read_b64_tr_b16 v[32:33], v2 offset:36928
ds_read_b64_tr_b16 v[34:35], v2 offset:37696
v_mfma_f32_32x32x16_bf16 v[144:159], v[48:51], a[44:47], v[144:159]
ds_read_b64_tr_b16 v[36:37], v2 offset:36992
ds_read_b64_tr_b16 v[38:39], v2 offset:37760
v_mfma_f32_32x32x16_bf16 v[160:175], v[52:55], a[40:43], v[160:175]
v_mfma_f32_32x32x16_bf16 v[176:191], v[52:55], a[44:47], v[176:191]
v_mfma_f32_32x32x16_bf16 v[192:207], v[56:59], a[40:43], v[192:207]
v_mfma_f32_32x32x16_bf16 v[208:223], v[56:59], a[44:47], v[208:223]
v_mfma_f32_32x32x16_bf16 v[224:239], v[60:63], a[40:43], v[224:239]
v_mfma_f32_32x32x16_bf16 v[240:255], v[60:63], a[44:47], v[240:255]
s_waitcnt lgkmcnt(0)
s_waitcnt vmcnt(6)
v_mfma_f32_32x32x16_bf16 v[64:79], v[16:19], a[48:51], v[64:79]
ds_read_b64_tr_b16 v[40:41], v2 offset:27648
v_mfma_f32_32x32x16_bf16 v[80:95], v[16:19], a[52:55], v[80:95]
ds_read_b64_tr_b16 v[42:43], v2 offset:28416
ds_read_b64_tr_b16 v[44:45], v2 offset:27712
v_mfma_f32_32x32x16_bf16 v[96:111], v[20:23], a[48:51], v[96:111]
ds_read_b64_tr_b16 v[46:47], v2 offset:28480
ds_read_b64_tr_b16 v[48:49], v2 offset:27776
v_mfma_f32_32x32x16_bf16 v[112:127], v[20:23], a[52:55], v[112:127]
ds_read_b64_tr_b16 v[50:51], v2 offset:28544
ds_read_b64_tr_b16 v[52:53], v2 offset:39936
v_mfma_f32_32x32x16_bf16 v[128:143], v[24:27], a[48:51], v[128:143]
ds_read_b64_tr_b16 v[54:55], v2 offset:40704
ds_read_b64_tr_b16 v[56:57], v2 offset:40000
v_mfma_f32_32x32x16_bf16 v[144:159], v[24:27], a[52:55], v[144:159]
ds_read_b64_tr_b16 v[58:59], v2 offset:40768
ds_read_b64_tr_b16 v[60:61], v2 offset:40064
v_mfma_f32_32x32x16_bf16 v[160:175], v[28:31], a[48:51], v[160:175]
ds_read_b64_tr_b16 v[62:63], v2 offset:40832
v_mfma_f32_32x32x16_bf16 v[176:191], v[28:31], a[52:55], v[176:191]
v_mfma_f32_32x32x16_bf16 v[192:207], v[32:35], a[48:51], v[192:207]
v_mfma_f32_32x32x16_bf16 v[208:223], v[32:35], a[52:55], v[208:223]
v_mfma_f32_32x32x16_bf16 v[224:239], v[36:39], a[48:51], v[224:239]
v_mfma_f32_32x32x16_bf16 v[240:255], v[36:39], a[52:55], v[240:255]
s_waitcnt lgkmcnt(0)
s_waitcnt vmcnt(4)
v_mfma_f32_32x32x16_bf16 v[64:79], v[40:43], a[56:59], v[64:79]
ds_read_b64_tr_b16 v[16:17], v2 offset:30720
ds_read_b64_tr_b16 v[18:19], v2 offset:31488
v_mfma_f32_32x32x16_bf16 v[80:95], v[40:43], a[60:63], v[80:95]
ds_read_b64_tr_b16 v[20:21], v2 offset:30784
ds_read_b64_tr_b16 v[22:23], v2 offset:31552
v_mfma_f32_32x32x16_bf16 v[96:111], v[44:47], a[56:59], v[96:111]
ds_read_b64_tr_b16 v[24:25], v2 offset:30848
ds_read_b64_tr_b16 v[26:27], v2 offset:31616
v_mfma_f32_32x32x16_bf16 v[112:127], v[44:47], a[60:63], v[112:127]
ds_read_b64_tr_b16 v[28:29], v2 offset:43008
ds_read_b64_tr_b16 v[30:31], v2 offset:43776
v_mfma_f32_32x32x16_bf16 v[128:143], v[48:51], a[56:59], v[128:143]
ds_read_b64_tr_b16 v[32:33], v2 offset:43072
ds_read_b64_tr_b16 v[34:35], v2 offset:43840
v_mfma_f32_32x32x16_bf16 v[144:159], v[48:51], a[60:63], v[144:159]
ds_read_b64_tr_b16 v[36:37], v2 offset:43136
ds_read_b64_tr_b16 v[38:39], v2 offset:43904
v_mfma_f32_32x32x16_bf16 v[160:175], v[52:55], a[56:59], v[160:175]
v_mfma_f32_32x32x16_bf16 v[176:191], v[52:55], a[60:63], v[176:191]
v_mfma_f32_32x32x16_bf16 v[192:207], v[56:59], a[56:59], v[192:207]
v_mfma_f32_32x32x16_bf16 v[208:223], v[56:59], a[60:63], v[208:223]
v_mfma_f32_32x32x16_bf16 v[224:239], v[60:63], a[56:59], v[224:239]
v_mfma_f32_32x32x16_bf16 v[240:255], v[60:63], a[60:63], v[240:255]
s_waitcnt lgkmcnt(0)
s_waitcnt vmcnt(2)
v_mfma_f32_32x32x16_bf16 v[64:79], v[16:19], a[64:67], v[64:79]
ds_read_b64_tr_b16 v[40:41], v2 offset:33792
ds_read_b64_tr_b16 v[42:43], v2 offset:34560
v_mfma_f32_32x32x16_bf16 v[80:95], v[16:19], a[68:71], v[80:95]
ds_read_b64_tr_b16 v[44:45], v2 offset:33856
ds_read_b64_tr_b16 v[46:47], v2 offset:34624
v_mfma_f32_32x32x16_bf16 v[96:111], v[20:23], a[64:67], v[96:111]
ds_read_b64_tr_b16 v[48:49], v2 offset:33920
ds_read_b64_tr_b16 v[50:51], v2 offset:34688
v_mfma_f32_32x32x16_bf16 v[112:127], v[20:23], a[68:71], v[112:127]
ds_read_b64_tr_b16 v[52:53], v2 offset:46080
ds_read_b64_tr_b16 v[54:55], v2 offset:46848
v_mfma_f32_32x32x16_bf16 v[128:143], v[24:27], a[64:67], v[128:143]
ds_read_b64_tr_b16 v[56:57], v2 offset:46144
ds_read_b64_tr_b16 v[58:59], v2 offset:46912
v_mfma_f32_32x32x16_bf16 v[144:159], v[24:27], a[68:71], v[144:159]
ds_read_b64_tr_b16 v[60:61], v2 offset:46208
ds_read_b64_tr_b16 v[62:63], v2 offset:46976
v_mfma_f32_32x32x16_bf16 v[160:175], v[28:31], a[64:67], v[160:175]
v_mfma_f32_32x32x16_bf16 v[176:191], v[28:31], a[68:71], v[176:191]
v_mfma_f32_32x32x16_bf16 v[192:207], v[32:35], a[64:67], v[192:207]
v_mfma_f32_32x32x16_bf16 v[208:223], v[32:35], a[68:71], v[208:223]
v_mfma_f32_32x32x16_bf16 v[224:239], v[36:39], a[64:67], v[224:239]
v_mfma_f32_32x32x16_bf16 v[240:255], v[36:39], a[68:71], v[240:255]
s_waitcnt lgkmcnt(0)
s_waitcnt vmcnt(0)
v_mfma_f32_32x32x16_bf16 v[64:79], v[40:43], a[72:75], v[64:79]
v_mfma_f32_32x32x16_bf16 v[80:95], v[40:43], a[76:79], v[80:95]
v_mfma_f32_32x32x16_bf16 v[96:111], v[44:47], a[72:75], v[96:111]
v_mfma_f32_32x32x16_bf16 v[112:127], v[44:47], a[76:79], v[112:127]
v_mfma_f32_32x32x16_bf16 v[128:143], v[48:51], a[72:75], v[128:143]
v_mfma_f32_32x32x16_bf16 v[144:159], v[48:51], a[76:79], v[144:159]
v_mfma_f32_32x32x16_bf16 v[160:175], v[52:55], a[72:75], v[160:175]
v_mfma_f32_32x32x16_bf16 v[176:191], v[52:55], a[76:79], v[176:191]
v_mfma_f32_32x32x16_bf16 v[192:207], v[56:59], a[72:75], v[192:207]
v_mfma_f32_32x32x16_bf16 v[208:223], v[56:59], a[76:79], v[208:223]
v_mfma_f32_32x32x16_bf16 v[224:239], v[60:63], a[72:75], v[224:239]
v_mfma_f32_32x32x16_bf16 v[240:255], v[60:63], a[76:79], v[240:255]
s_cmp_eq_u32 s24, 0
s_cbranch_scc0 tk12458
v_accvgpr_write_b32 a200, 1
s_mov_b64 exec, 1
buffer_atomic_add a200, off, s[28:31], s32 sc0
s_mov_b64 exec, -1
tk12458:
s_lshl_b32 s42, s55, 2
s_add_u32 s42, s42, s24
s_mul_i32 s42, s42, 196608
s_mul_i32 s43, s54, 6144
s_add_u32 s42, s42, s43
s_add_u32 s42, s42, 184549376
s_mov_b32 s65, 0xbfb8aa3b
v_cvt_pk_bf16_f32 v24, v64, v65
v_cvt_pk_bf16_f32 v25, v66, v67
v_cvt_pk_bf16_f32 v26, v68, v69
v_cvt_pk_bf16_f32 v27, v70, v71
v_cvt_pk_bf16_f32 v28, v72, v73
v_cvt_pk_bf16_f32 v29, v74, v75
v_cvt_pk_bf16_f32 v30, v76, v77
v_cvt_pk_bf16_f32 v31, v78, v79
v_lshlrev_b32 v64, 16, v24
v_and_b32 v65, 0xffff0000, v24
v_lshlrev_b32 v66, 16, v25
v_and_b32 v67, 0xffff0000, v25
v_lshlrev_b32 v68, 16, v26
v_and_b32 v69, 0xffff0000, v26
v_lshlrev_b32 v70, 16, v27
v_and_b32 v71, 0xffff0000, v27
v_lshlrev_b32 v72, 16, v28
v_and_b32 v73, 0xffff0000, v28
v_lshlrev_b32 v74, 16, v29
v_and_b32 v75, 0xffff0000, v29
v_lshlrev_b32 v76, 16, v30
v_and_b32 v77, 0xffff0000, v30
v_lshlrev_b32 v78, 16, v31
v_and_b32 v79, 0xffff0000, v31
v_cvt_pk_bf16_f32 v24, v160, v161
v_cvt_pk_bf16_f32 v25, v162, v163
v_cvt_pk_bf16_f32 v26, v164, v165
v_cvt_pk_bf16_f32 v27, v166, v167
v_cvt_pk_bf16_f32 v28, v168, v169
v_cvt_pk_bf16_f32 v29, v170, v171
v_cvt_pk_bf16_f32 v30, v172, v173
v_cvt_pk_bf16_f32 v31, v174, v175
v_lshlrev_b32 v160, 16, v24
v_and_b32 v161, 0xffff0000, v24
v_lshlrev_b32 v162, 16, v25
v_and_b32 v163, 0xffff0000, v25
v_lshlrev_b32 v164, 16, v26
v_and_b32 v165, 0xffff0000, v26
v_lshlrev_b32 v166, 16, v27
v_and_b32 v167, 0xffff0000, v27
v_lshlrev_b32 v168, 16, v28
v_and_b32 v169, 0xffff0000, v28
v_lshlrev_b32 v170, 16, v29
v_and_b32 v171, 0xffff0000, v29
v_lshlrev_b32 v172, 16, v30
v_and_b32 v173, 0xffff0000, v30
v_lshlrev_b32 v174, 16, v31
v_and_b32 v175, 0xffff0000, v31
v_mul_f32 v64, s65, v64
v_mul_f32 v65, s65, v65
v_mul_f32 v66, s65, v66
v_mul_f32 v67, s65, v67
v_mul_f32 v68, s65, v68
v_mul_f32 v69, s65, v69
v_mul_f32 v70, s65, v70
v_mul_f32 v71, s65, v71
v_mul_f32 v72, s65, v72
v_mul_f32 v73, s65, v73
v_mul_f32 v74, s65, v74
v_mul_f32 v75, s65, v75
v_mul_f32 v76, s65, v76
v_mul_f32 v77, s65, v77
v_mul_f32 v78, s65, v78
v_mul_f32 v79, s65, v79
v_exp_f32 v64, v64
v_exp_f32 v65, v65
v_exp_f32 v66, v66
v_exp_f32 v67, v67
v_exp_f32 v68, v68
v_exp_f32 v69, v69
v_exp_f32 v70, v70
v_exp_f32 v71, v71
v_exp_f32 v72, v72
v_exp_f32 v73, v73
v_exp_f32 v74, v74
v_exp_f32 v75, v75
v_exp_f32 v76, v76
v_exp_f32 v77, v77
v_exp_f32 v78, v78
v_exp_f32 v79, v79
v_add_f32 v64, 1.0, v64
v_add_f32 v65, 1.0, v65
v_add_f32 v66, 1.0, v66
v_add_f32 v67, 1.0, v67
v_add_f32 v68, 1.0, v68
v_add_f32 v69, 1.0, v69
v_add_f32 v70, 1.0, v70
v_add_f32 v71, 1.0, v71
v_add_f32 v72, 1.0, v72
v_add_f32 v73, 1.0, v73
v_add_f32 v74, 1.0, v74
v_add_f32 v75, 1.0, v75
v_add_f32 v76, 1.0, v76
v_add_f32 v77, 1.0, v77
v_add_f32 v78, 1.0, v78
v_add_f32 v79, 1.0, v79
v_rcp_f32 v64, v64
v_rcp_f32 v65, v65
v_rcp_f32 v66, v66
v_rcp_f32 v67, v67
v_rcp_f32 v68, v68
v_rcp_f32 v69, v69
v_rcp_f32 v70, v70
v_rcp_f32 v71, v71
v_rcp_f32 v72, v72
v_rcp_f32 v73, v73
v_rcp_f32 v74, v74
v_rcp_f32 v75, v75
v_rcp_f32 v76, v76
v_rcp_f32 v77, v77
v_rcp_f32 v78, v78
v_rcp_f32 v79, v79
v_cvt_pk_bf16_f32 v24, v64, v65
v_cvt_pk_bf16_f32 v25, v66, v67
v_cvt_pk_bf16_f32 v26, v68, v69
v_cvt_pk_bf16_f32 v27, v70, v71
v_cvt_pk_bf16_f32 v28, v72, v73
v_cvt_pk_bf16_f32 v29, v74, v75
v_cvt_pk_bf16_f32 v30, v76, v77
v_cvt_pk_bf16_f32 v31, v78, v79
v_lshlrev_b32 v64, 16, v24
v_and_b32 v65, 0xffff0000, v24
v_lshlrev_b32 v66, 16, v25
v_and_b32 v67, 0xffff0000, v25
v_lshlrev_b32 v68, 16, v26
v_and_b32 v69, 0xffff0000, v26
v_lshlrev_b32 v70, 16, v27
v_and_b32 v71, 0xffff0000, v27
v_lshlrev_b32 v72, 16, v28
v_and_b32 v73, 0xffff0000, v28
v_lshlrev_b32 v74, 16, v29
v_and_b32 v75, 0xffff0000, v29
v_lshlrev_b32 v76, 16, v30
v_and_b32 v77, 0xffff0000, v30
v_lshlrev_b32 v78, 16, v31
v_and_b32 v79, 0xffff0000, v31
v_mul_f32 v64, v64, v160
v_mul_f32 v65, v65, v161
v_mul_f32 v66, v66, v162
v_mul_f32 v67, v67, v163
v_mul_f32 v68, v68, v164
v_mul_f32 v69, v69, v165
v_mul_f32 v70, v70, v166
v_mul_f32 v71, v71, v167
v_mul_f32 v72, v72, v168
v_mul_f32 v73, v73, v169
v_mul_f32 v74, v74, v170
v_mul_f32 v75, v75, v171
v_mul_f32 v76, v76, v172
v_mul_f32 v77, v77, v173
v_mul_f32 v78, v78, v174
v_mul_f32 v79, v79, v175
v_cvt_pk_bf16_f32 v16, v64, v65
v_cvt_pk_bf16_f32 v17, v66, v67
v_cvt_pk_bf16_f32 v18, v68, v69
v_cvt_pk_bf16_f32 v19, v70, v71
s_add_u32 s43, s42, 0
buffer_store_dwordx4 v[16:19], v1, s[4:7], s43 offen sc1
v_cvt_pk_bf16_f32 v20, v72, v73
v_cvt_pk_bf16_f32 v21, v74, v75
v_cvt_pk_bf16_f32 v22, v76, v77
v_cvt_pk_bf16_f32 v23, v78, v79
s_add_u32 s43, s42, 1024
buffer_store_dwordx4 v[20:23], v1, s[4:7], s43 offen sc1
v_cvt_pk_bf16_f32 v24, v96, v97
v_cvt_pk_bf16_f32 v25, v98, v99
v_cvt_pk_bf16_f32 v26, v100, v101
v_cvt_pk_bf16_f32 v27, v102, v103
v_cvt_pk_bf16_f32 v28, v104, v105
v_cvt_pk_bf16_f32 v29, v106, v107
v_cvt_pk_bf16_f32 v30, v108, v109
v_cvt_pk_bf16_f32 v31, v110, v111
v_lshlrev_b32 v96, 16, v24
v_and_b32 v97, 0xffff0000, v24
v_lshlrev_b32 v98, 16, v25
v_and_b32 v99, 0xffff0000, v25
v_lshlrev_b32 v100, 16, v26
v_and_b32 v101, 0xffff0000, v26
v_lshlrev_b32 v102, 16, v27
v_and_b32 v103, 0xffff0000, v27
v_lshlrev_b32 v104, 16, v28
v_and_b32 v105, 0xffff0000, v28
v_lshlrev_b32 v106, 16, v29
v_and_b32 v107, 0xffff0000, v29
v_lshlrev_b32 v108, 16, v30
v_and_b32 v109, 0xffff0000, v30
v_lshlrev_b32 v110, 16, v31
v_and_b32 v111, 0xffff0000, v31
v_cvt_pk_bf16_f32 v24, v192, v193
v_cvt_pk_bf16_f32 v25, v194, v195
v_cvt_pk_bf16_f32 v26, v196, v197
v_cvt_pk_bf16_f32 v27, v198, v199
v_cvt_pk_bf16_f32 v28, v200, v201
v_cvt_pk_bf16_f32 v29, v202, v203
v_cvt_pk_bf16_f32 v30, v204, v205
v_cvt_pk_bf16_f32 v31, v206, v207
v_lshlrev_b32 v192, 16, v24
v_and_b32 v193, 0xffff0000, v24
v_lshlrev_b32 v194, 16, v25
v_and_b32 v195, 0xffff0000, v25
v_lshlrev_b32 v196, 16, v26
v_and_b32 v197, 0xffff0000, v26
v_lshlrev_b32 v198, 16, v27
v_and_b32 v199, 0xffff0000, v27
v_lshlrev_b32 v200, 16, v28
v_and_b32 v201, 0xffff0000, v28
v_lshlrev_b32 v202, 16, v29
v_and_b32 v203, 0xffff0000, v29
v_lshlrev_b32 v204, 16, v30
v_and_b32 v205, 0xffff0000, v30
v_lshlrev_b32 v206, 16, v31
v_and_b32 v207, 0xffff0000, v31
v_mul_f32 v96, s65, v96
v_mul_f32 v97, s65, v97
v_mul_f32 v98, s65, v98
v_mul_f32 v99, s65, v99
v_mul_f32 v100, s65, v100
v_mul_f32 v101, s65, v101
v_mul_f32 v102, s65, v102
v_mul_f32 v103, s65, v103
v_mul_f32 v104, s65, v104
v_mul_f32 v105, s65, v105
v_mul_f32 v106, s65, v106
v_mul_f32 v107, s65, v107
v_mul_f32 v108, s65, v108
v_mul_f32 v109, s65, v109
v_mul_f32 v110, s65, v110
v_mul_f32 v111, s65, v111
v_exp_f32 v96, v96
v_exp_f32 v97, v97
v_exp_f32 v98, v98
v_exp_f32 v99, v99
v_exp_f32 v100, v100
v_exp_f32 v101, v101
v_exp_f32 v102, v102
v_exp_f32 v103, v103
v_exp_f32 v104, v104
v_exp_f32 v105, v105
v_exp_f32 v106, v106
v_exp_f32 v107, v107
v_exp_f32 v108, v108
v_exp_f32 v109, v109
v_exp_f32 v110, v110
v_exp_f32 v111, v111
v_add_f32 v96, 1.0, v96
v_add_f32 v97, 1.0, v97
v_add_f32 v98, 1.0, v98
v_add_f32 v99, 1.0, v99
v_add_f32 v100, 1.0, v100
v_add_f32 v101, 1.0, v101
v_add_f32 v102, 1.0, v102
v_add_f32 v103, 1.0, v103
v_add_f32 v104, 1.0, v104
v_add_f32 v105, 1.0, v105
v_add_f32 v106, 1.0, v106
v_add_f32 v107, 1.0, v107
v_add_f32 v108, 1.0, v108
v_add_f32 v109, 1.0, v109
v_add_f32 v110, 1.0, v110
v_add_f32 v111, 1.0, v111
v_rcp_f32 v96, v96
v_rcp_f32 v97, v97
v_rcp_f32 v98, v98
v_rcp_f32 v99, v99
v_rcp_f32 v100, v100
v_rcp_f32 v101, v101
v_rcp_f32 v102, v102
v_rcp_f32 v103, v103
v_rcp_f32 v104, v104
v_rcp_f32 v105, v105
v_rcp_f32 v106, v106
v_rcp_f32 v107, v107
v_rcp_f32 v108, v108
v_rcp_f32 v109, v109
v_rcp_f32 v110, v110
v_rcp_f32 v111, v111
v_cvt_pk_bf16_f32 v24, v96, v97
v_cvt_pk_bf16_f32 v25, v98, v99
v_cvt_pk_bf16_f32 v26, v100, v101
v_cvt_pk_bf16_f32 v27, v102, v103
v_cvt_pk_bf16_f32 v28, v104, v105
v_cvt_pk_bf16_f32 v29, v106, v107
v_cvt_pk_bf16_f32 v30, v108, v109
v_cvt_pk_bf16_f32 v31, v110, v111
v_lshlrev_b32 v96, 16, v24
v_and_b32 v97, 0xffff0000, v24
v_lshlrev_b32 v98, 16, v25
v_and_b32 v99, 0xffff0000, v25
v_lshlrev_b32 v100, 16, v26
v_and_b32 v101, 0xffff0000, v26
v_lshlrev_b32 v102, 16, v27
v_and_b32 v103, 0xffff0000, v27
v_lshlrev_b32 v104, 16, v28
v_and_b32 v105, 0xffff0000, v28
v_lshlrev_b32 v106, 16, v29
v_and_b32 v107, 0xffff0000, v29
v_lshlrev_b32 v108, 16, v30
v_and_b32 v109, 0xffff0000, v30
v_lshlrev_b32 v110, 16, v31
v_and_b32 v111, 0xffff0000, v31
v_mul_f32 v96, v96, v192
v_mul_f32 v97, v97, v193
v_mul_f32 v98, v98, v194
v_mul_f32 v99, v99, v195
v_mul_f32 v100, v100, v196
v_mul_f32 v101, v101, v197
v_mul_f32 v102, v102, v198
v_mul_f32 v103, v103, v199
v_mul_f32 v104, v104, v200
v_mul_f32 v105, v105, v201
v_mul_f32 v106, v106, v202
v_mul_f32 v107, v107, v203
v_mul_f32 v108, v108, v204
v_mul_f32 v109, v109, v205
v_mul_f32 v110, v110, v206
v_mul_f32 v111, v111, v207
v_cvt_pk_bf16_f32 v16, v96, v97
v_cvt_pk_bf16_f32 v17, v98, v99
v_cvt_pk_bf16_f32 v18, v100, v101
v_cvt_pk_bf16_f32 v19, v102, v103
s_add_u32 s43, s42, 2048
buffer_store_dwordx4 v[16:19], v1, s[4:7], s43 offen sc1
v_cvt_pk_bf16_f32 v20, v104, v105
v_cvt_pk_bf16_f32 v21, v106, v107
v_cvt_pk_bf16_f32 v22, v108, v109
v_cvt_pk_bf16_f32 v23, v110, v111
s_add_u32 s43, s42, 3072
buffer_store_dwordx4 v[20:23], v1, s[4:7], s43 offen sc1
v_cvt_pk_bf16_f32 v24, v128, v129
v_cvt_pk_bf16_f32 v25, v130, v131
v_cvt_pk_bf16_f32 v26, v132, v133
v_cvt_pk_bf16_f32 v27, v134, v135
v_cvt_pk_bf16_f32 v28, v136, v137
v_cvt_pk_bf16_f32 v29, v138, v139
v_cvt_pk_bf16_f32 v30, v140, v141
v_cvt_pk_bf16_f32 v31, v142, v143
v_lshlrev_b32 v128, 16, v24
v_and_b32 v129, 0xffff0000, v24
v_lshlrev_b32 v130, 16, v25
v_and_b32 v131, 0xffff0000, v25
v_lshlrev_b32 v132, 16, v26
v_and_b32 v133, 0xffff0000, v26
v_lshlrev_b32 v134, 16, v27
v_and_b32 v135, 0xffff0000, v27
v_lshlrev_b32 v136, 16, v28
v_and_b32 v137, 0xffff0000, v28
v_lshlrev_b32 v138, 16, v29
v_and_b32 v139, 0xffff0000, v29
v_lshlrev_b32 v140, 16, v30
v_and_b32 v141, 0xffff0000, v30
v_lshlrev_b32 v142, 16, v31
v_and_b32 v143, 0xffff0000, v31
v_cvt_pk_bf16_f32 v24, v224, v225
v_cvt_pk_bf16_f32 v25, v226, v227
v_cvt_pk_bf16_f32 v26, v228, v229
v_cvt_pk_bf16_f32 v27, v230, v231
v_cvt_pk_bf16_f32 v28, v232, v233
v_cvt_pk_bf16_f32 v29, v234, v235
v_cvt_pk_bf16_f32 v30, v236, v237
v_cvt_pk_bf16_f32 v31, v238, v239
v_lshlrev_b32 v224, 16, v24
v_and_b32 v225, 0xffff0000, v24
v_lshlrev_b32 v226, 16, v25
v_and_b32 v227, 0xffff0000, v25
v_lshlrev_b32 v228, 16, v26
v_and_b32 v229, 0xffff0000, v26
v_lshlrev_b32 v230, 16, v27
v_and_b32 v231, 0xffff0000, v27
v_lshlrev_b32 v232, 16, v28
v_and_b32 v233, 0xffff0000, v28
v_lshlrev_b32 v234, 16, v29
v_and_b32 v235, 0xffff0000, v29
v_lshlrev_b32 v236, 16, v30
v_and_b32 v237, 0xffff0000, v30
v_lshlrev_b32 v238, 16, v31
v_and_b32 v239, 0xffff0000, v31
v_mul_f32 v128, s65, v128
v_mul_f32 v129, s65, v129
v_mul_f32 v130, s65, v130
v_mul_f32 v131, s65, v131
v_mul_f32 v132, s65, v132
v_mul_f32 v133, s65, v133
v_mul_f32 v134, s65, v134
v_mul_f32 v135, s65, v135
v_mul_f32 v136, s65, v136
v_mul_f32 v137, s65, v137
v_mul_f32 v138, s65, v138
v_mul_f32 v139, s65, v139
v_mul_f32 v140, s65, v140
v_mul_f32 v141, s65, v141
v_mul_f32 v142, s65, v142
v_mul_f32 v143, s65, v143
v_exp_f32 v128, v128
v_exp_f32 v129, v129
v_exp_f32 v130, v130
v_exp_f32 v131, v131
v_exp_f32 v132, v132
v_exp_f32 v133, v133
v_exp_f32 v134, v134
v_exp_f32 v135, v135
v_exp_f32 v136, v136
v_exp_f32 v137, v137
v_exp_f32 v138, v138
v_exp_f32 v139, v139
v_exp_f32 v140, v140
v_exp_f32 v141, v141
v_exp_f32 v142, v142
v_exp_f32 v143, v143
v_add_f32 v128, 1.0, v128
v_add_f32 v129, 1.0, v129
v_add_f32 v130, 1.0, v130
v_add_f32 v131, 1.0, v131
v_add_f32 v132, 1.0, v132
v_add_f32 v133, 1.0, v133
v_add_f32 v134, 1.0, v134
v_add_f32 v135, 1.0, v135
v_add_f32 v136, 1.0, v136
v_add_f32 v137, 1.0, v137
v_add_f32 v138, 1.0, v138
v_add_f32 v139, 1.0, v139
v_add_f32 v140, 1.0, v140
v_add_f32 v141, 1.0, v141
v_add_f32 v142, 1.0, v142
v_add_f32 v143, 1.0, v143
v_rcp_f32 v128, v128
v_rcp_f32 v129, v129
v_rcp_f32 v130, v130
v_rcp_f32 v131, v131
v_rcp_f32 v132, v132
v_rcp_f32 v133, v133
v_rcp_f32 v134, v134
v_rcp_f32 v135, v135
v_rcp_f32 v136, v136
v_rcp_f32 v137, v137
v_rcp_f32 v138, v138
v_rcp_f32 v139, v139
v_rcp_f32 v140, v140
v_rcp_f32 v141, v141
v_rcp_f32 v142, v142
v_rcp_f32 v143, v143
v_cvt_pk_bf16_f32 v24, v128, v129
v_cvt_pk_bf16_f32 v25, v130, v131
v_cvt_pk_bf16_f32 v26, v132, v133
v_cvt_pk_bf16_f32 v27, v134, v135
v_cvt_pk_bf16_f32 v28, v136, v137
v_cvt_pk_bf16_f32 v29, v138, v139
v_cvt_pk_bf16_f32 v30, v140, v141
v_cvt_pk_bf16_f32 v31, v142, v143
v_lshlrev_b32 v128, 16, v24
v_and_b32 v129, 0xffff0000, v24
v_lshlrev_b32 v130, 16, v25
v_and_b32 v131, 0xffff0000, v25
v_lshlrev_b32 v132, 16, v26
v_and_b32 v133, 0xffff0000, v26
v_lshlrev_b32 v134, 16, v27
v_and_b32 v135, 0xffff0000, v27
v_lshlrev_b32 v136, 16, v28
v_and_b32 v137, 0xffff0000, v28
v_lshlrev_b32 v138, 16, v29
v_and_b32 v139, 0xffff0000, v29
v_lshlrev_b32 v140, 16, v30
v_and_b32 v141, 0xffff0000, v30
v_lshlrev_b32 v142, 16, v31
v_and_b32 v143, 0xffff0000, v31
v_mul_f32 v128, v128, v224
v_mul_f32 v129, v129, v225
v_mul_f32 v130, v130, v226
v_mul_f32 v131, v131, v227
v_mul_f32 v132, v132, v228
v_mul_f32 v133, v133, v229
v_mul_f32 v134, v134, v230
v_mul_f32 v135, v135, v231
v_mul_f32 v136, v136, v232
v_mul_f32 v137, v137, v233
v_mul_f32 v138, v138, v234
v_mul_f32 v139, v139, v235
v_mul_f32 v140, v140, v236
v_mul_f32 v141, v141, v237
v_mul_f32 v142, v142, v238
v_mul_f32 v143, v143, v239
v_cvt_pk_bf16_f32 v16, v128, v129
v_cvt_pk_bf16_f32 v17, v130, v131
v_cvt_pk_bf16_f32 v18, v132, v133
v_cvt_pk_bf16_f32 v19, v134, v135
s_add_u32 s43, s42, 4096
buffer_store_dwordx4 v[16:19], v1, s[4:7], s43 offen sc1
v_cvt_pk_bf16_f32 v20, v136, v137
v_cvt_pk_bf16_f32 v21, v138, v139
v_cvt_pk_bf16_f32 v22, v140, v141
v_cvt_pk_bf16_f32 v23, v142, v143
s_add_u32 s43, s42, 5120
buffer_store_dwordx4 v[20:23], v1, s[4:7], s43 offen sc1
v_cvt_pk_bf16_f32 v24, v80, v81
v_cvt_pk_bf16_f32 v25, v82, v83
v_cvt_pk_bf16_f32 v26, v84, v85
v_cvt_pk_bf16_f32 v27, v86, v87
v_cvt_pk_bf16_f32 v28, v88, v89
v_cvt_pk_bf16_f32 v29, v90, v91
v_cvt_pk_bf16_f32 v30, v92, v93
v_cvt_pk_bf16_f32 v31, v94, v95
v_lshlrev_b32 v80, 16, v24
v_and_b32 v81, 0xffff0000, v24
v_lshlrev_b32 v82, 16, v25
v_and_b32 v83, 0xffff0000, v25
v_lshlrev_b32 v84, 16, v26
v_and_b32 v85, 0xffff0000, v26
v_lshlrev_b32 v86, 16, v27
v_and_b32 v87, 0xffff0000, v27
v_lshlrev_b32 v88, 16, v28
v_and_b32 v89, 0xffff0000, v28
v_lshlrev_b32 v90, 16, v29
v_and_b32 v91, 0xffff0000, v29
v_lshlrev_b32 v92, 16, v30
v_and_b32 v93, 0xffff0000, v30
v_lshlrev_b32 v94, 16, v31
v_and_b32 v95, 0xffff0000, v31
v_cvt_pk_bf16_f32 v24, v176, v177
v_cvt_pk_bf16_f32 v25, v178, v179
v_cvt_pk_bf16_f32 v26, v180, v181
v_cvt_pk_bf16_f32 v27, v182, v183
v_cvt_pk_bf16_f32 v28, v184, v185
v_cvt_pk_bf16_f32 v29, v186, v187
v_cvt_pk_bf16_f32 v30, v188, v189
v_cvt_pk_bf16_f32 v31, v190, v191
v_lshlrev_b32 v176, 16, v24
v_and_b32 v177, 0xffff0000, v24
v_lshlrev_b32 v178, 16, v25
v_and_b32 v179, 0xffff0000, v25
v_lshlrev_b32 v180, 16, v26
v_and_b32 v181, 0xffff0000, v26
v_lshlrev_b32 v182, 16, v27
v_and_b32 v183, 0xffff0000, v27
v_lshlrev_b32 v184, 16, v28
v_and_b32 v185, 0xffff0000, v28
v_lshlrev_b32 v186, 16, v29
v_and_b32 v187, 0xffff0000, v29
v_lshlrev_b32 v188, 16, v30
v_and_b32 v189, 0xffff0000, v30
v_lshlrev_b32 v190, 16, v31
v_and_b32 v191, 0xffff0000, v31
v_mul_f32 v80, s65, v80
v_mul_f32 v81, s65, v81
v_mul_f32 v82, s65, v82
v_mul_f32 v83, s65, v83
v_mul_f32 v84, s65, v84
v_mul_f32 v85, s65, v85
v_mul_f32 v86, s65, v86
v_mul_f32 v87, s65, v87
v_mul_f32 v88, s65, v88
v_mul_f32 v89, s65, v89
v_mul_f32 v90, s65, v90
v_mul_f32 v91, s65, v91
v_mul_f32 v92, s65, v92
v_mul_f32 v93, s65, v93
v_mul_f32 v94, s65, v94
v_mul_f32 v95, s65, v95
v_exp_f32 v80, v80
v_exp_f32 v81, v81
v_exp_f32 v82, v82
v_exp_f32 v83, v83
v_exp_f32 v84, v84
v_exp_f32 v85, v85
v_exp_f32 v86, v86
v_exp_f32 v87, v87
v_exp_f32 v88, v88
v_exp_f32 v89, v89
v_exp_f32 v90, v90
v_exp_f32 v91, v91
v_exp_f32 v92, v92
v_exp_f32 v93, v93
v_exp_f32 v94, v94
v_exp_f32 v95, v95
v_add_f32 v80, 1.0, v80
v_add_f32 v81, 1.0, v81
v_add_f32 v82, 1.0, v82
v_add_f32 v83, 1.0, v83
v_add_f32 v84, 1.0, v84
v_add_f32 v85, 1.0, v85
v_add_f32 v86, 1.0, v86
v_add_f32 v87, 1.0, v87
v_add_f32 v88, 1.0, v88
v_add_f32 v89, 1.0, v89
v_add_f32 v90, 1.0, v90
v_add_f32 v91, 1.0, v91
v_add_f32 v92, 1.0, v92
v_add_f32 v93, 1.0, v93
v_add_f32 v94, 1.0, v94
v_add_f32 v95, 1.0, v95
v_rcp_f32 v80, v80
v_rcp_f32 v81, v81
v_rcp_f32 v82, v82
v_rcp_f32 v83, v83
v_rcp_f32 v84, v84
v_rcp_f32 v85, v85
v_rcp_f32 v86, v86
v_rcp_f32 v87, v87
v_rcp_f32 v88, v88
v_rcp_f32 v89, v89
v_rcp_f32 v90, v90
v_rcp_f32 v91, v91
v_rcp_f32 v92, v92
v_rcp_f32 v93, v93
v_rcp_f32 v94, v94
v_rcp_f32 v95, v95
v_cvt_pk_bf16_f32 v24, v80, v81
v_cvt_pk_bf16_f32 v25, v82, v83
v_cvt_pk_bf16_f32 v26, v84, v85
v_cvt_pk_bf16_f32 v27, v86, v87
v_cvt_pk_bf16_f32 v28, v88, v89
v_cvt_pk_bf16_f32 v29, v90, v91
v_cvt_pk_bf16_f32 v30, v92, v93
v_cvt_pk_bf16_f32 v31, v94, v95
v_lshlrev_b32 v80, 16, v24
v_and_b32 v81, 0xffff0000, v24
v_lshlrev_b32 v82, 16, v25
v_and_b32 v83, 0xffff0000, v25
v_lshlrev_b32 v84, 16, v26
v_and_b32 v85, 0xffff0000, v26
v_lshlrev_b32 v86, 16, v27
v_and_b32 v87, 0xffff0000, v27
v_lshlrev_b32 v88, 16, v28
v_and_b32 v89, 0xffff0000, v28
v_lshlrev_b32 v90, 16, v29
v_and_b32 v91, 0xffff0000, v29
v_lshlrev_b32 v92, 16, v30
v_and_b32 v93, 0xffff0000, v30
v_lshlrev_b32 v94, 16, v31
v_and_b32 v95, 0xffff0000, v31
v_mul_f32 v80, v80, v176
v_mul_f32 v81, v81, v177
v_mul_f32 v82, v82, v178
v_mul_f32 v83, v83, v179
v_mul_f32 v84, v84, v180
v_mul_f32 v85, v85, v181
v_mul_f32 v86, v86, v182
v_mul_f32 v87, v87, v183
v_mul_f32 v88, v88, v184
v_mul_f32 v89, v89, v185
v_mul_f32 v90, v90, v186
v_mul_f32 v91, v91, v187
v_mul_f32 v92, v92, v188
v_mul_f32 v93, v93, v189
v_mul_f32 v94, v94, v190
v_mul_f32 v95, v95, v191
v_cvt_pk_bf16_f32 v16, v80, v81
v_cvt_pk_bf16_f32 v17, v82, v83
v_cvt_pk_bf16_f32 v18, v84, v85
v_cvt_pk_bf16_f32 v19, v86, v87
s_add_u32 s43, s42, 98304
buffer_store_dwordx4 v[16:19], v1, s[4:7], s43 offen sc1
v_cvt_pk_bf16_f32 v20, v88, v89
v_cvt_pk_bf16_f32 v21, v90, v91
v_cvt_pk_bf16_f32 v22, v92, v93
v_cvt_pk_bf16_f32 v23, v94, v95
s_add_u32 s43, s42, 99328
buffer_store_dwordx4 v[20:23], v1, s[4:7], s43 offen sc1
v_cvt_pk_bf16_f32 v24, v112, v113
v_cvt_pk_bf16_f32 v25, v114, v115
v_cvt_pk_bf16_f32 v26, v116, v117
v_cvt_pk_bf16_f32 v27, v118, v119
v_cvt_pk_bf16_f32 v28, v120, v121
v_cvt_pk_bf16_f32 v29, v122, v123
v_cvt_pk_bf16_f32 v30, v124, v125
v_cvt_pk_bf16_f32 v31, v126, v127
v_lshlrev_b32 v112, 16, v24
v_and_b32 v113, 0xffff0000, v24
v_lshlrev_b32 v114, 16, v25
v_and_b32 v115, 0xffff0000, v25
v_lshlrev_b32 v116, 16, v26
v_and_b32 v117, 0xffff0000, v26
v_lshlrev_b32 v118, 16, v27
v_and_b32 v119, 0xffff0000, v27
v_lshlrev_b32 v120, 16, v28
v_and_b32 v121, 0xffff0000, v28
v_lshlrev_b32 v122, 16, v29
v_and_b32 v123, 0xffff0000, v29
v_lshlrev_b32 v124, 16, v30
v_and_b32 v125, 0xffff0000, v30
v_lshlrev_b32 v126, 16, v31
v_and_b32 v127, 0xffff0000, v31
v_cvt_pk_bf16_f32 v24, v208, v209
v_cvt_pk_bf16_f32 v25, v210, v211
v_cvt_pk_bf16_f32 v26, v212, v213
v_cvt_pk_bf16_f32 v27, v214, v215
v_cvt_pk_bf16_f32 v28, v216, v217
v_cvt_pk_bf16_f32 v29, v218, v219
v_cvt_pk_bf16_f32 v30, v220, v221
v_cvt_pk_bf16_f32 v31, v222, v223
v_lshlrev_b32 v208, 16, v24
v_and_b32 v209, 0xffff0000, v24
v_lshlrev_b32 v210, 16, v25
v_and_b32 v211, 0xffff0000, v25
v_lshlrev_b32 v212, 16, v26
v_and_b32 v213, 0xffff0000, v26
v_lshlrev_b32 v214, 16, v27
v_and_b32 v215, 0xffff0000, v27
v_lshlrev_b32 v216, 16, v28
v_and_b32 v217, 0xffff0000, v28
v_lshlrev_b32 v218, 16, v29
v_and_b32 v219, 0xffff0000, v29
v_lshlrev_b32 v220, 16, v30
v_and_b32 v221, 0xffff0000, v30
v_lshlrev_b32 v222, 16, v31
v_and_b32 v223, 0xffff0000, v31
v_mul_f32 v112, s65, v112
v_mul_f32 v113, s65, v113
v_mul_f32 v114, s65, v114
v_mul_f32 v115, s65, v115
v_mul_f32 v116, s65, v116
v_mul_f32 v117, s65, v117
v_mul_f32 v118, s65, v118
v_mul_f32 v119, s65, v119
v_mul_f32 v120, s65, v120
v_mul_f32 v121, s65, v121
v_mul_f32 v122, s65, v122
v_mul_f32 v123, s65, v123
v_mul_f32 v124, s65, v124
v_mul_f32 v125, s65, v125
v_mul_f32 v126, s65, v126
v_mul_f32 v127, s65, v127
v_exp_f32 v112, v112
v_exp_f32 v113, v113
v_exp_f32 v114, v114
v_exp_f32 v115, v115
v_exp_f32 v116, v116
v_exp_f32 v117, v117
v_exp_f32 v118, v118
v_exp_f32 v119, v119
v_exp_f32 v120, v120
v_exp_f32 v121, v121
v_exp_f32 v122, v122
v_exp_f32 v123, v123
v_exp_f32 v124, v124
v_exp_f32 v125, v125
v_exp_f32 v126, v126
v_exp_f32 v127, v127
v_add_f32 v112, 1.0, v112
v_add_f32 v113, 1.0, v113
v_add_f32 v114, 1.0, v114
v_add_f32 v115, 1.0, v115
v_add_f32 v116, 1.0, v116
v_add_f32 v117, 1.0, v117
v_add_f32 v118, 1.0, v118
v_add_f32 v119, 1.0, v119
v_add_f32 v120, 1.0, v120
v_add_f32 v121, 1.0, v121
v_add_f32 v122, 1.0, v122
v_add_f32 v123, 1.0, v123
v_add_f32 v124, 1.0, v124
v_add_f32 v125, 1.0, v125
v_add_f32 v126, 1.0, v126
v_add_f32 v127, 1.0, v127
v_rcp_f32 v112, v112
v_rcp_f32 v113, v113
v_rcp_f32 v114, v114
v_rcp_f32 v115, v115
v_rcp_f32 v116, v116
v_rcp_f32 v117, v117
v_rcp_f32 v118, v118
v_rcp_f32 v119, v119
v_rcp_f32 v120, v120
v_rcp_f32 v121, v121
v_rcp_f32 v122, v122
v_rcp_f32 v123, v123
v_rcp_f32 v124, v124
v_rcp_f32 v125, v125
v_rcp_f32 v126, v126
v_rcp_f32 v127, v127
v_cvt_pk_bf16_f32 v24, v112, v113
v_cvt_pk_bf16_f32 v25, v114, v115
v_cvt_pk_bf16_f32 v26, v116, v117
v_cvt_pk_bf16_f32 v27, v118, v119
v_cvt_pk_bf16_f32 v28, v120, v121
v_cvt_pk_bf16_f32 v29, v122, v123
v_cvt_pk_bf16_f32 v30, v124, v125
v_cvt_pk_bf16_f32 v31, v126, v127
v_lshlrev_b32 v112, 16, v24
v_and_b32 v113, 0xffff0000, v24
v_lshlrev_b32 v114, 16, v25
v_and_b32 v115, 0xffff0000, v25
v_lshlrev_b32 v116, 16, v26
v_and_b32 v117, 0xffff0000, v26
v_lshlrev_b32 v118, 16, v27
v_and_b32 v119, 0xffff0000, v27
v_lshlrev_b32 v120, 16, v28
v_and_b32 v121, 0xffff0000, v28
v_lshlrev_b32 v122, 16, v29
v_and_b32 v123, 0xffff0000, v29
v_lshlrev_b32 v124, 16, v30
v_and_b32 v125, 0xffff0000, v30
v_lshlrev_b32 v126, 16, v31
v_and_b32 v127, 0xffff0000, v31
v_mul_f32 v112, v112, v208
v_mul_f32 v113, v113, v209
v_mul_f32 v114, v114, v210
v_mul_f32 v115, v115, v211
v_mul_f32 v116, v116, v212
v_mul_f32 v117, v117, v213
v_mul_f32 v118, v118, v214
v_mul_f32 v119, v119, v215
v_mul_f32 v120, v120, v216
v_mul_f32 v121, v121, v217
v_mul_f32 v122, v122, v218
v_mul_f32 v123, v123, v219
v_mul_f32 v124, v124, v220
v_mul_f32 v125, v125, v221
v_mul_f32 v126, v126, v222
v_mul_f32 v127, v127, v223
v_cvt_pk_bf16_f32 v16, v112, v113
v_cvt_pk_bf16_f32 v17, v114, v115
v_cvt_pk_bf16_f32 v18, v116, v117
v_cvt_pk_bf16_f32 v19, v118, v119
s_add_u32 s43, s42, 100352
buffer_store_dwordx4 v[16:19], v1, s[4:7], s43 offen sc1
v_cvt_pk_bf16_f32 v20, v120, v121
v_cvt_pk_bf16_f32 v21, v122, v123
v_cvt_pk_bf16_f32 v22, v124, v125
v_cvt_pk_bf16_f32 v23, v126, v127
s_add_u32 s43, s42, 101376
buffer_store_dwordx4 v[20:23], v1, s[4:7], s43 offen sc1
v_cvt_pk_bf16_f32 v24, v144, v145
v_cvt_pk_bf16_f32 v25, v146, v147
v_cvt_pk_bf16_f32 v26, v148, v149
v_cvt_pk_bf16_f32 v27, v150, v151
v_cvt_pk_bf16_f32 v28, v152, v153
v_cvt_pk_bf16_f32 v29, v154, v155
v_cvt_pk_bf16_f32 v30, v156, v157
v_cvt_pk_bf16_f32 v31, v158, v159
v_lshlrev_b32 v144, 16, v24
v_and_b32 v145, 0xffff0000, v24
v_lshlrev_b32 v146, 16, v25
v_and_b32 v147, 0xffff0000, v25
v_lshlrev_b32 v148, 16, v26
v_and_b32 v149, 0xffff0000, v26
v_lshlrev_b32 v150, 16, v27
v_and_b32 v151, 0xffff0000, v27
v_lshlrev_b32 v152, 16, v28
v_and_b32 v153, 0xffff0000, v28
v_lshlrev_b32 v154, 16, v29
v_and_b32 v155, 0xffff0000, v29
v_lshlrev_b32 v156, 16, v30
v_and_b32 v157, 0xffff0000, v30
v_lshlrev_b32 v158, 16, v31
v_and_b32 v159, 0xffff0000, v31
v_cvt_pk_bf16_f32 v24, v240, v241
v_cvt_pk_bf16_f32 v25, v242, v243
v_cvt_pk_bf16_f32 v26, v244, v245
v_cvt_pk_bf16_f32 v27, v246, v247
v_cvt_pk_bf16_f32 v28, v248, v249
v_cvt_pk_bf16_f32 v29, v250, v251
v_cvt_pk_bf16_f32 v30, v252, v253
v_cvt_pk_bf16_f32 v31, v254, v255
v_lshlrev_b32 v240, 16, v24
v_and_b32 v241, 0xffff0000, v24
v_lshlrev_b32 v242, 16, v25
v_and_b32 v243, 0xffff0000, v25
v_lshlrev_b32 v244, 16, v26
v_and_b32 v245, 0xffff0000, v26
v_lshlrev_b32 v246, 16, v27
v_and_b32 v247, 0xffff0000, v27
v_lshlrev_b32 v248, 16, v28
v_and_b32 v249, 0xffff0000, v28
v_lshlrev_b32 v250, 16, v29
v_and_b32 v251, 0xffff0000, v29
v_lshlrev_b32 v252, 16, v30
v_and_b32 v253, 0xffff0000, v30
v_lshlrev_b32 v254, 16, v31
v_and_b32 v255, 0xffff0000, v31
v_mul_f32 v144, s65, v144
v_mul_f32 v145, s65, v145
v_mul_f32 v146, s65, v146
v_mul_f32 v147, s65, v147
v_mul_f32 v148, s65, v148
v_mul_f32 v149, s65, v149
v_mul_f32 v150, s65, v150
v_mul_f32 v151, s65, v151
v_mul_f32 v152, s65, v152
v_mul_f32 v153, s65, v153
v_mul_f32 v154, s65, v154
v_mul_f32 v155, s65, v155
v_mul_f32 v156, s65, v156
v_mul_f32 v157, s65, v157
v_mul_f32 v158, s65, v158
v_mul_f32 v159, s65, v159
v_exp_f32 v144, v144
v_exp_f32 v145, v145
v_exp_f32 v146, v146
v_exp_f32 v147, v147
v_exp_f32 v148, v148
v_exp_f32 v149, v149
v_exp_f32 v150, v150
v_exp_f32 v151, v151
v_exp_f32 v152, v152
v_exp_f32 v153, v153
v_exp_f32 v154, v154
v_exp_f32 v155, v155
v_exp_f32 v156, v156
v_exp_f32 v157, v157
v_exp_f32 v158, v158
v_exp_f32 v159, v159
v_add_f32 v144, 1.0, v144
v_add_f32 v145, 1.0, v145
v_add_f32 v146, 1.0, v146
v_add_f32 v147, 1.0, v147
v_add_f32 v148, 1.0, v148
v_add_f32 v149, 1.0, v149
v_add_f32 v150, 1.0, v150
v_add_f32 v151, 1.0, v151
v_add_f32 v152, 1.0, v152
v_add_f32 v153, 1.0, v153
v_add_f32 v154, 1.0, v154
v_add_f32 v155, 1.0, v155
v_add_f32 v156, 1.0, v156
v_add_f32 v157, 1.0, v157
v_add_f32 v158, 1.0, v158
v_add_f32 v159, 1.0, v159
v_rcp_f32 v144, v144
v_rcp_f32 v145, v145
v_rcp_f32 v146, v146
v_rcp_f32 v147, v147
v_rcp_f32 v148, v148
v_rcp_f32 v149, v149
v_rcp_f32 v150, v150
v_rcp_f32 v151, v151
v_rcp_f32 v152, v152
v_rcp_f32 v153, v153
v_rcp_f32 v154, v154
v_rcp_f32 v155, v155
v_rcp_f32 v156, v156
v_rcp_f32 v157, v157
v_rcp_f32 v158, v158
v_rcp_f32 v159, v159
v_cvt_pk_bf16_f32 v24, v144, v145
v_cvt_pk_bf16_f32 v25, v146, v147
v_cvt_pk_bf16_f32 v26, v148, v149
v_cvt_pk_bf16_f32 v27, v150, v151
v_cvt_pk_bf16_f32 v28, v152, v153
v_cvt_pk_bf16_f32 v29, v154, v155
v_cvt_pk_bf16_f32 v30, v156, v157
v_cvt_pk_bf16_f32 v31, v158, v159
v_lshlrev_b32 v144, 16, v24
v_and_b32 v145, 0xffff0000, v24
v_lshlrev_b32 v146, 16, v25
v_and_b32 v147, 0xffff0000, v25
v_lshlrev_b32 v148, 16, v26
v_and_b32 v149, 0xffff0000, v26
v_lshlrev_b32 v150, 16, v27
v_and_b32 v151, 0xffff0000, v27
v_lshlrev_b32 v152, 16, v28
v_and_b32 v153, 0xffff0000, v28
v_lshlrev_b32 v154, 16, v29
v_and_b32 v155, 0xffff0000, v29
v_lshlrev_b32 v156, 16, v30
v_and_b32 v157, 0xffff0000, v30
v_lshlrev_b32 v158, 16, v31
v_and_b32 v159, 0xffff0000, v31
v_mul_f32 v144, v144, v240
v_mul_f32 v145, v145, v241
v_mul_f32 v146, v146, v242
v_mul_f32 v147, v147, v243
v_mul_f32 v148, v148, v244
v_mul_f32 v149, v149, v245
v_mul_f32 v150, v150, v246
v_mul_f32 v151, v151, v247
v_mul_f32 v152, v152, v248
v_mul_f32 v153, v153, v249
v_mul_f32 v154, v154, v250
v_mul_f32 v155, v155, v251
v_mul_f32 v156, v156, v252
v_mul_f32 v157, v157, v253
v_mul_f32 v158, v158, v254
v_mul_f32 v159, v159, v255
v_cvt_pk_bf16_f32 v16, v144, v145
v_cvt_pk_bf16_f32 v17, v146, v147
v_cvt_pk_bf16_f32 v18, v148, v149
v_cvt_pk_bf16_f32 v19, v150, v151
s_add_u32 s43, s42, 102400
buffer_store_dwordx4 v[16:19], v1, s[4:7], s43 offen sc1
v_cvt_pk_bf16_f32 v20, v152, v153
v_cvt_pk_bf16_f32 v21, v154, v155
v_cvt_pk_bf16_f32 v22, v156, v157
v_cvt_pk_bf16_f32 v23, v158, v159
s_add_u32 s43, s42, 103424
buffer_store_dwordx4 v[20:23], v1, s[4:7], s43 offen sc1
s_mul_i32 s62, s24, 6144
s_waitcnt vmcnt(0)
s_branch z_taskdone
z_taskdone:
s_add_u32 s65, s55, 48
s_mov_b32 s66, 1
s_branch wk_sig
wk_dn:
s_mov_b32 s54, s93
s_lshr_b32 s84, s55, 1
s_lshl_b32 s47, s84, 7
s_add_u32 s47, s47, 201332736
s_mov_b32 s46, 0
v_mov_b32 v17, 0
wdn_wf:
buffer_load_dword v16, off, s[4:7], s47 sc1
s_waitcnt vmcnt(0)
v_readfirstlane_b32 s45, v16
s_cmp_ge_u32 s45, 16
s_cbranch_scc1 wdn_wd
s_sleep 4
s_add_u32 s46, s46, 1
s_cmp_lt_u32 s46, 0x200000
s_cbranch_scc1 wdn_wf
s_branch timeout
wdn_wd:
s_cmp_eq_u32 s64, 4
s_cbranch_scc1 x_dn
x_dn:
s_mov_b32 s8, s80
s_and_b32 s9, s81, 0xffff
s_mov_b32 s10, 1966080
s_mov_b32 s11, 0x20000
v_accvgpr_read_b32 v4, a121
v_accvgpr_read_b32 v5, a122
v_accvgpr_read_b32 v6, a123
v_accvgpr_read_b32 v7, a124
v_accvgpr_read_b32 v8, a125
v_accvgpr_read_b32 v2, a126
v_accvgpr_read_b32 v13, a127
v_accvgpr_read_b32 v14, a128
s_mul_i32 s40, s24, 98304
v_add_u32 v11, s40, v1
s_mul_i32 s57, s55, 393216
s_add_u32 s57, s57, 184549376
s_mul_i32 s56, s54, 320
s_mul_i32 s62, s24, 5120
s_add_u32 s43, s56, 0
s_add_u32 m0, s62, 0
s_nop 0
buffer_load_dwordx4 v4, s[8:11], s43 offen lds
s_add_u32 m0, s62, 1024
s_nop 0
buffer_load_dwordx4 v5, s[8:11], s43 offen lds
s_add_u32 m0, s62, 2048
s_nop 0
buffer_load_dwordx4 v6, s[8:11], s43 offen lds
s_add_u32 m0, s62, 3072
s_nop 0
buffer_load_dwordx4 v7, s[8:11], s43 offen lds
s_add_u32 m0, s62, 4096
s_nop 0
buffer_load_dwordx4 v8, s[8:11], s43 offen lds
s_add_u32 s43, s56, 81920
s_add_u32 m0, s62, 24576
s_nop 0
buffer_load_dwordx4 v4, s[8:11], s43 offen lds
s_add_u32 m0, s62, 25600
s_nop 0
buffer_load_dwordx4 v5, s[8:11], s43 offen lds
s_add_u32 m0, s62, 26624
s_nop 0
buffer_load_dwordx4 v6, s[8:11], s43 offen lds
s_add_u32 m0, s62, 27648
s_nop 0
buffer_load_dwordx4 v7, s[8:11], s43 offen lds
s_add_u32 m0, s62, 28672
s_nop 0
buffer_load_dwordx4 v8, s[8:11], s43 offen lds
s_add_u32 s43, s56, 163840
s_add_u32 m0, s62, 49152
s_nop 0
buffer_load_dwordx4 v4, s[8:11], s43 offen lds
s_add_u32 m0, s62, 50176
s_nop 0
buffer_load_dwordx4 v5, s[8:11], s43 offen lds
s_add_u32 m0, s62, 51200
s_nop 0
buffer_load_dwordx4 v6, s[8:11], s43 offen lds
s_add_u32 m0, s62, 52224
s_nop 0
buffer_load_dwordx4 v7, s[8:11], s43 offen lds
s_add_u32 m0, s62, 53248
s_nop 0
buffer_load_dwordx4 v8, s[8:11], s43 offen lds
s_add_u32 s59, s57, 0
s_add_u32 s60, s57, 4096
s_add_u32 s61, s57, 8192
buffer_load_dwordx4 a[0:3], v11, s[4:7], s59 offen offset:0 sc1
buffer_load_dwordx4 a[8:11], v11, s[4:7], s59 offen offset:1024 sc1
buffer_load_dwordx4 a[16:19], v11, s[4:7], s59 offen offset:2048 sc1
buffer_load_dwordx4 a[24:27], v11, s[4:7], s59 offen offset:3072 sc1
buffer_load_dwordx4 a[32:35], v11, s[4:7], s60 offen offset:0 sc1
buffer_load_dwordx4 a[40:43], v11, s[4:7], s60 offen offset:1024 sc1
buffer_load_dwordx4 a[48:51], v11, s[4:7], s60 offen offset:2048 sc1
buffer_load_dwordx4 a[56:59], v11, s[4:7], s60 offen offset:3072 sc1
s_waitcnt vmcnt(18)
s_barrier
ds_read_b64_tr_b16 v[16:17], v2 offset:0
ds_read_b64_tr_b16 v[18:19], v2 offset:2560
ds_read_b64_tr_b16 v[20:21], v2 offset:64
ds_read_b64_tr_b16 v[22:23], v2 offset:2624
ds_read_b64_tr_b16 v[24:25], v2 offset:128
ds_read_b64_tr_b16 v[26:27], v2 offset:2688
ds_read_b64_tr_b16 v[28:29], v2 offset:192
ds_read_b64_tr_b16 v[30:31], v2 offset:2752
ds_read_b64_tr_b16 v[32:33], v2 offset:256
ds_read_b64_tr_b16 v[34:35], v2 offset:2816
s_waitcnt lgkmcnt(0)
s_waitcnt vmcnt(7)
v_mfma_f32_32x32x16_bf16 v[64:79], v[16:19], a[0:3], 0
s_add_u32 s61, s57, 8192
ds_read_b64_tr_b16 v[40:41], v2 offset:5120
ds_read_b64_tr_b16 v[42:43], v2 offset:7680
v_mfma_f32_32x32x16_bf16 v[80:95], v[20:23], a[0:3], 0
ds_read_b64_tr_b16 v[44:45], v2 offset:5184
ds_read_b64_tr_b16 v[46:47], v2 offset:7744
ds_read_b64_tr_b16 v[48:49], v2 offset:5248
v_mfma_f32_32x32x16_bf16 v[96:111], v[24:27], a[0:3], 0
ds_read_b64_tr_b16 v[50:51], v2 offset:7808
ds_read_b64_tr_b16 v[52:53], v2 offset:5312
ds_read_b64_tr_b16 v[54:55], v2 offset:7872
v_mfma_f32_32x32x16_bf16 v[112:127], v[28:31], a[0:3], 0
ds_read_b64_tr_b16 v[56:57], v2 offset:5376
ds_read_b64_tr_b16 v[58:59], v2 offset:7936
buffer_load_dwordx4 a[64:67], v11, s[4:7], s61 offen offset:0 sc1
v_mfma_f32_32x32x16_bf16 v[128:143], v[32:35], a[0:3], 0
s_waitcnt lgkmcnt(0)
s_waitcnt vmcnt(7)
v_mfma_f32_32x32x16_bf16 v[64:79], v[40:43], a[8:11], v[64:79]
ds_read_b64_tr_b16 v[16:17], v2 offset:10240
ds_read_b64_tr_b16 v[18:19], v2 offset:12800
ds_read_b64_tr_b16 v[20:21], v2 offset:10304
v_mfma_f32_32x32x16_bf16 v[80:95], v[44:47], a[8:11], v[80:95]
ds_read_b64_tr_b16 v[22:23], v2 offset:12864
ds_read_b64_tr_b16 v[24:25], v2 offset:10368
ds_read_b64_tr_b16 v[26:27], v2 offset:12928
v_mfma_f32_32x32x16_bf16 v[96:111], v[48:51], a[8:11], v[96:111]
ds_read_b64_tr_b16 v[28:29], v2 offset:10432
ds_read_b64_tr_b16 v[30:31], v2 offset:12992
ds_read_b64_tr_b16 v[32:33], v2 offset:10496
v_mfma_f32_32x32x16_bf16 v[112:127], v[52:55], a[8:11], v[112:127]
ds_read_b64_tr_b16 v[34:35], v2 offset:13056
buffer_load_dwordx4 a[72:75], v11, s[4:7], s61 offen offset:1024 sc1
v_mfma_f32_32x32x16_bf16 v[128:143], v[56:59], a[8:11], v[128:143]
s_waitcnt lgkmcnt(0)
s_waitcnt vmcnt(7)
v_mfma_f32_32x32x16_bf16 v[64:79], v[16:19], a[16:19], v[64:79]
ds_read_b64_tr_b16 v[40:41], v2 offset:15360
ds_read_b64_tr_b16 v[42:43], v2 offset:17920
ds_read_b64_tr_b16 v[44:45], v2 offset:15424
v_mfma_f32_32x32x16_bf16 v[80:95], v[20:23], a[16:19], v[80:95]
ds_read_b64_tr_b16 v[46:47], v2 offset:17984
ds_read_b64_tr_b16 v[48:49], v2 offset:15488
ds_read_b64_tr_b16 v[50:51], v2 offset:18048
v_mfma_f32_32x32x16_bf16 v[96:111], v[24:27], a[16:19], v[96:111]
ds_read_b64_tr_b16 v[52:53], v2 offset:15552
ds_read_b64_tr_b16 v[54:55], v2 offset:18112
ds_read_b64_tr_b16 v[56:57], v2 offset:15616
v_mfma_f32_32x32x16_bf16 v[112:127], v[28:31], a[16:19], v[112:127]
ds_read_b64_tr_b16 v[58:59], v2 offset:18176
buffer_load_dwordx4 a[0:3], v11, s[4:7], s61 offen offset:2048 sc1
v_mfma_f32_32x32x16_bf16 v[128:143], v[32:35], a[16:19], v[128:143]
s_waitcnt lgkmcnt(0)
s_barrier
s_waitcnt vmcnt(7)
v_mfma_f32_32x32x16_bf16 v[64:79], v[40:43], a[24:27], v[64:79]
ds_read_b64_tr_b16 v[16:17], v2 offset:24576
ds_read_b64_tr_b16 v[18:19], v2 offset:27136
ds_read_b64_tr_b16 v[20:21], v2 offset:24640
v_mfma_f32_32x32x16_bf16 v[80:95], v[44:47], a[24:27], v[80:95]
ds_read_b64_tr_b16 v[22:23], v2 offset:27200
ds_read_b64_tr_b16 v[24:25], v2 offset:24704
ds_read_b64_tr_b16 v[26:27], v2 offset:27264
v_mfma_f32_32x32x16_bf16 v[96:111], v[48:51], a[24:27], v[96:111]
ds_read_b64_tr_b16 v[28:29], v2 offset:24768
ds_read_b64_tr_b16 v[30:31], v2 offset:27328
ds_read_b64_tr_b16 v[32:33], v2 offset:24832
v_mfma_f32_32x32x16_bf16 v[112:127], v[52:55], a[24:27], v[112:127]
ds_read_b64_tr_b16 v[34:35], v2 offset:27392
s_add_u32 s43, s56, 245760
s_add_u32 m0, s62, 73728
s_nop 0
buffer_load_dwordx4 v4, s[8:11], s43 offen lds
s_add_u32 m0, s62, 74752
s_nop 0
buffer_load_dwordx4 v5, s[8:11], s43 offen lds
s_add_u32 m0, s62, 75776
s_nop 0
buffer_load_dwordx4 v6, s[8:11], s43 offen lds
s_add_u32 m0, s62, 76800
s_nop 0
buffer_load_dwordx4 v7, s[8:11], s43 offen lds
s_add_u32 m0, s62, 77824
s_nop 0
buffer_load_dwordx4 v8, s[8:11], s43 offen lds
buffer_load_dwordx4 a[8:11], v11, s[4:7], s61 offen offset:3072 sc1
v_mfma_f32_32x32x16_bf16 v[128:143], v[56:59], a[24:27], v[128:143]
s_waitcnt lgkmcnt(0)
s_waitcnt vmcnt(12)
v_mfma_f32_32x32x16_bf16 v[64:79], v[16:19], a[32:35], v[64:79]
s_add_u32 s59, s57, 12288
ds_read_b64_tr_b16 v[40:41], v2 offset:29696
ds_read_b64_tr_b16 v[42:43], v2 offset:32256
v_mfma_f32_32x32x16_bf16 v[80:95], v[20:23], a[32:35], v[80:95]
ds_read_b64_tr_b16 v[44:45], v2 offset:29760
ds_read_b64_tr_b16 v[46:47], v2 offset:32320
ds_read_b64_tr_b16 v[48:49], v2 offset:29824
v_mfma_f32_32x32x16_bf16 v[96:111], v[24:27], a[32:35], v[96:111]
ds_read_b64_tr_b16 v[50:51], v2 offset:32384
ds_read_b64_tr_b16 v[52:53], v2 offset:29888
ds_read_b64_tr_b16 v[54:55], v2 offset:32448
v_mfma_f32_32x32x16_bf16 v[112:127], v[28:31], a[32:35], v[112:127]
ds_read_b64_tr_b16 v[56:57], v2 offset:29952
ds_read_b64_tr_b16 v[58:59], v2 offset:32512
buffer_load_dwordx4 a[16:19], v11, s[4:7], s59 offen offset:0 sc1
v_mfma_f32_32x32x16_bf16 v[128:143], v[32:35], a[32:35], v[128:143]
s_waitcnt lgkmcnt(0)
s_waitcnt vmcnt(12)
v_mfma_f32_32x32x16_bf16 v[64:79], v[40:43], a[40:43], v[64:79]
ds_read_b64_tr_b16 v[16:17], v2 offset:34816
ds_read_b64_tr_b16 v[18:19], v2 offset:37376
ds_read_b64_tr_b16 v[20:21], v2 offset:34880
v_mfma_f32_32x32x16_bf16 v[80:95], v[44:47], a[40:43], v[80:95]
ds_read_b64_tr_b16 v[22:23], v2 offset:37440
ds_read_b64_tr_b16 v[24:25], v2 offset:34944
ds_read_b64_tr_b16 v[26:27], v2 offset:37504
v_mfma_f32_32x32x16_bf16 v[96:111], v[48:51], a[40:43], v[96:111]
ds_read_b64_tr_b16 v[28:29], v2 offset:35008
ds_read_b64_tr_b16 v[30:31], v2 offset:37568
ds_read_b64_tr_b16 v[32:33], v2 offset:35072
v_mfma_f32_32x32x16_bf16 v[112:127], v[52:55], a[40:43], v[112:127]
ds_read_b64_tr_b16 v[34:35], v2 offset:37632
buffer_load_dwordx4 a[24:27], v11, s[4:7], s59 offen offset:1024 sc1
v_mfma_f32_32x32x16_bf16 v[128:143], v[56:59], a[40:43], v[128:143]
s_waitcnt lgkmcnt(0)
s_waitcnt vmcnt(12)
v_mfma_f32_32x32x16_bf16 v[64:79], v[16:19], a[48:51], v[64:79]
ds_read_b64_tr_b16 v[40:41], v2 offset:39936
ds_read_b64_tr_b16 v[42:43], v2 offset:42496
ds_read_b64_tr_b16 v[44:45], v2 offset:40000
v_mfma_f32_32x32x16_bf16 v[80:95], v[20:23], a[48:51], v[80:95]
ds_read_b64_tr_b16 v[46:47], v2 offset:42560
ds_read_b64_tr_b16 v[48:49], v2 offset:40064
ds_read_b64_tr_b16 v[50:51], v2 offset:42624
v_mfma_f32_32x32x16_bf16 v[96:111], v[24:27], a[48:51], v[96:111]
ds_read_b64_tr_b16 v[52:53], v2 offset:40128
ds_read_b64_tr_b16 v[54:55], v2 offset:42688
ds_read_b64_tr_b16 v[56:57], v2 offset:40192
v_mfma_f32_32x32x16_bf16 v[112:127], v[28:31], a[48:51], v[112:127]
ds_read_b64_tr_b16 v[58:59], v2 offset:42752
buffer_load_dwordx4 a[32:35], v11, s[4:7], s59 offen offset:2048 sc1
v_mfma_f32_32x32x16_bf16 v[128:143], v[32:35], a[48:51], v[128:143]
s_waitcnt lgkmcnt(0)
s_barrier
s_waitcnt vmcnt(12)
v_mfma_f32_32x32x16_bf16 v[64:79], v[40:43], a[56:59], v[64:79]
ds_read_b64_tr_b16 v[16:17], v13 offset:0
ds_read_b64_tr_b16 v[18:19], v13 offset:2560
ds_read_b64_tr_b16 v[20:21], v13 offset:64
v_mfma_f32_32x32x16_bf16 v[80:95], v[44:47], a[56:59], v[80:95]
ds_read_b64_tr_b16 v[22:23], v13 offset:2624
ds_read_b64_tr_b16 v[24:25], v13 offset:128
ds_read_b64_tr_b16 v[26:27], v13 offset:2688
v_mfma_f32_32x32x16_bf16 v[96:111], v[48:51], a[56:59], v[96:111]
ds_read_b64_tr_b16 v[28:29], v13 offset:192
ds_read_b64_tr_b16 v[30:31], v13 offset:2752
ds_read_b64_tr_b16 v[32:33], v13 offset:256
v_mfma_f32_32x32x16_bf16 v[112:127], v[52:55], a[56:59], v[112:127]
ds_read_b64_tr_b16 v[34:35], v13 offset:2816
s_add_u32 s43, s56, 327680
s_add_u32 m0, s62, 0
s_nop 0
buffer_load_dwordx4 v4, s[8:11], s43 offen lds
s_add_u32 m0, s62, 1024
s_nop 0
buffer_load_dwordx4 v5, s[8:11], s43 offen lds
s_add_u32 m0, s62, 2048
s_nop 0
buffer_load_dwordx4 v6, s[8:11], s43 offen lds
s_add_u32 m0, s62, 3072
s_nop 0
buffer_load_dwordx4 v7, s[8:11], s43 offen lds
s_add_u32 m0, s62, 4096
s_nop 0
buffer_load_dwordx4 v8, s[8:11], s43 offen lds
buffer_load_dwordx4 a[40:43], v11, s[4:7], s59 offen offset:3072 sc1
v_mfma_f32_32x32x16_bf16 v[128:143], v[56:59], a[56:59], v[128:143]
s_waitcnt lgkmcnt(0)
s_waitcnt vmcnt(17)
v_mfma_f32_32x32x16_bf16 v[64:79], v[16:19], a[64:67], v[64:79]
s_add_u32 s60, s57, 16384
ds_read_b64_tr_b16 v[40:41], v13 offset:5120
ds_read_b64_tr_b16 v[42:43], v13 offset:7680
v_mfma_f32_32x32x16_bf16 v[80:95], v[20:23], a[64:67], v[80:95]
ds_read_b64_tr_b16 v[44:45], v13 offset:5184
ds_read_b64_tr_b16 v[46:47], v13 offset:7744
ds_read_b64_tr_b16 v[48:49], v13 offset:5248
v_mfma_f32_32x32x16_bf16 v[96:111], v[24:27], a[64:67], v[96:111]
ds_read_b64_tr_b16 v[50:51], v13 offset:7808
ds_read_b64_tr_b16 v[52:53], v13 offset:5312
ds_read_b64_tr_b16 v[54:55], v13 offset:7872
v_mfma_f32_32x32x16_bf16 v[112:127], v[28:31], a[64:67], v[112:127]
ds_read_b64_tr_b16 v[56:57], v13 offset:5376
ds_read_b64_tr_b16 v[58:59], v13 offset:7936
buffer_load_dwordx4 a[48:51], v11, s[4:7], s60 offen offset:0 sc1
v_mfma_f32_32x32x16_bf16 v[128:143], v[32:35], a[64:67], v[128:143]
s_waitcnt lgkmcnt(0)
s_waitcnt vmcnt(17)
v_mfma_f32_32x32x16_bf16 v[64:79], v[40:43], a[72:75], v[64:79]
ds_read_b64_tr_b16 v[16:17], v13 offset:10240
ds_read_b64_tr_b16 v[18:19], v13 offset:12800
ds_read_b64_tr_b16 v[20:21], v13 offset:10304
v_mfma_f32_32x32x16_bf16 v[80:95], v[44:47], a[72:75], v[80:95]
ds_read_b64_tr_b16 v[22:23], v13 offset:12864
ds_read_b64_tr_b16 v[24:25], v13 offset:10368
ds_read_b64_tr_b16 v[26:27], v13 offset:12928
v_mfma_f32_32x32x16_bf16 v[96:111], v[48:51], a[72:75], v[96:111]
ds_read_b64_tr_b16 v[28:29], v13 offset:10432
ds_read_b64_tr_b16 v[30:31], v13 offset:12992
ds_read_b64_tr_b16 v[32:33], v13 offset:10496
v_mfma_f32_32x32x16_bf16 v[112:127], v[52:55], a[72:75], v[112:127]
ds_read_b64_tr_b16 v[34:35], v13 offset:13056
buffer_load_dwordx4 a[56:59], v11, s[4:7], s60 offen offset:1024 sc1
v_mfma_f32_32x32x16_bf16 v[128:143], v[56:59], a[72:75], v[128:143]
s_waitcnt lgkmcnt(0)
s_waitcnt vmcnt(17)
v_mfma_f32_32x32x16_bf16 v[64:79], v[16:19], a[0:3], v[64:79]
ds_read_b64_tr_b16 v[40:41], v13 offset:15360
ds_read_b64_tr_b16 v[42:43], v13 offset:17920
ds_read_b64_tr_b16 v[44:45], v13 offset:15424
v_mfma_f32_32x32x16_bf16 v[80:95], v[20:23], a[0:3], v[80:95]
ds_read_b64_tr_b16 v[46:47], v13 offset:17984
ds_read_b64_tr_b16 v[48:49], v13 offset:15488
ds_read_b64_tr_b16 v[50:51], v13 offset:18048
v_mfma_f32_32x32x16_bf16 v[96:111], v[24:27], a[0:3], v[96:111]
ds_read_b64_tr_b16 v[52:53], v13 offset:15552
ds_read_b64_tr_b16 v[54:55], v13 offset:18112
ds_read_b64_tr_b16 v[56:57], v13 offset:15616
v_mfma_f32_32x32x16_bf16 v[112:127], v[28:31], a[0:3], v[112:127]
ds_read_b64_tr_b16 v[58:59], v13 offset:18176
buffer_load_dwordx4 a[64:67], v11, s[4:7], s60 offen offset:2048 sc1
v_mfma_f32_32x32x16_bf16 v[128:143], v[32:35], a[0:3], v[128:143]
s_waitcnt lgkmcnt(0)
s_waitcnt vmcnt(13)
s_barrier
s_waitcnt vmcnt(12)
v_mfma_f32_32x32x16_bf16 v[64:79], v[40:43], a[8:11], v[64:79]
ds_read_b64_tr_b16 v[16:17], v13 offset:24576
ds_read_b64_tr_b16 v[18:19], v13 offset:27136
ds_read_b64_tr_b16 v[20:21], v13 offset:24640
v_mfma_f32_32x32x16_bf16 v[80:95], v[44:47], a[8:11], v[80:95]
ds_read_b64_tr_b16 v[22:23], v13 offset:27200
ds_read_b64_tr_b16 v[24:25], v13 offset:24704
ds_read_b64_tr_b16 v[26:27], v13 offset:27264
v_mfma_f32_32x32x16_bf16 v[96:111], v[48:51], a[8:11], v[96:111]
ds_read_b64_tr_b16 v[28:29], v13 offset:24768
ds_read_b64_tr_b16 v[30:31], v13 offset:27328
ds_read_b64_tr_b16 v[32:33], v13 offset:24832
v_mfma_f32_32x32x16_bf16 v[112:127], v[52:55], a[8:11], v[112:127]
ds_read_b64_tr_b16 v[34:35], v13 offset:27392
s_add_u32 s43, s56, 409600
s_add_u32 m0, s62, 24576
s_nop 0
buffer_load_dwordx4 v4, s[8:11], s43 offen lds
s_add_u32 m0, s62, 25600
s_nop 0
buffer_load_dwordx4 v5, s[8:11], s43 offen lds
s_add_u32 m0, s62, 26624
s_nop 0
buffer_load_dwordx4 v6, s[8:11], s43 offen lds
s_add_u32 m0, s62, 27648
s_nop 0
buffer_load_dwordx4 v7, s[8:11], s43 offen lds
s_add_u32 m0, s62, 28672
s_nop 0
buffer_load_dwordx4 v8, s[8:11], s43 offen lds
buffer_load_dwordx4 a[72:75], v11, s[4:7], s60 offen offset:3072 sc1
v_mfma_f32_32x32x16_bf16 v[128:143], v[56:59], a[8:11], v[128:143]
s_waitcnt lgkmcnt(0)
s_waitcnt vmcnt(17)
v_mfma_f32_32x32x16_bf16 v[64:79], v[16:19], a[16:19], v[64:79]
s_add_u32 s61, s57, 20480
ds_read_b64_tr_b16 v[40:41], v13 offset:29696
ds_read_b64_tr_b16 v[42:43], v13 offset:32256
v_mfma_f32_32x32x16_bf16 v[80:95], v[20:23], a[16:19], v[80:95]
ds_read_b64_tr_b16 v[44:45], v13 offset:29760
ds_read_b64_tr_b16 v[46:47], v13 offset:32320
ds_read_b64_tr_b16 v[48:49], v13 offset:29824
v_mfma_f32_32x32x16_bf16 v[96:111], v[24:27], a[16:19], v[96:111]
ds_read_b64_tr_b16 v[50:51], v13 offset:32384
ds_read_b64_tr_b16 v[52:53], v13 offset:29888
ds_read_b64_tr_b16 v[54:55], v13 offset:32448
v_mfma_f32_32x32x16_bf16 v[112:127], v[28:31], a[16:19], v[112:127]
ds_read_b64_tr_b16 v[56:57], v13 offset:29952
ds_read_b64_tr_b16 v[58:59], v13 offset:32512
buffer_load_dwordx4 a[0:3], v11, s[4:7], s61 offen offset:0 sc1
v_mfma_f32_32x32x16_bf16 v[128:143], v[32:35], a[16:19], v[128:143]
s_waitcnt lgkmcnt(0)
s_waitcnt vmcnt(17)
v_mfma_f32_32x32x16_bf16 v[64:79], v[40:43], a[24:27], v[64:79]
ds_read_b64_tr_b16 v[16:17], v13 offset:34816
ds_read_b64_tr_b16 v[18:19], v13 offset:37376
ds_read_b64_tr_b16 v[20:21], v13 offset:34880
v_mfma_f32_32x32x16_bf16 v[80:95], v[44:47], a[24:27], v[80:95]
ds_read_b64_tr_b16 v[22:23], v13 offset:37440
ds_read_b64_tr_b16 v[24:25], v13 offset:34944
ds_read_b64_tr_b16 v[26:27], v13 offset:37504
v_mfma_f32_32x32x16_bf16 v[96:111], v[48:51], a[24:27], v[96:111]
ds_read_b64_tr_b16 v[28:29], v13 offset:35008
ds_read_b64_tr_b16 v[30:31], v13 offset:37568
ds_read_b64_tr_b16 v[32:33], v13 offset:35072
v_mfma_f32_32x32x16_bf16 v[112:127], v[52:55], a[24:27], v[112:127]
ds_read_b64_tr_b16 v[34:35], v13 offset:37632
buffer_load_dwordx4 a[8:11], v11, s[4:7], s61 offen offset:1024 sc1
v_mfma_f32_32x32x16_bf16 v[128:143], v[56:59], a[24:27], v[128:143]
s_waitcnt lgkmcnt(0)
s_waitcnt vmcnt(17)
v_mfma_f32_32x32x16_bf16 v[64:79], v[16:19], a[32:35], v[64:79]
ds_read_b64_tr_b16 v[40:41], v13 offset:39936
ds_read_b64_tr_b16 v[42:43], v13 offset:42496
ds_read_b64_tr_b16 v[44:45], v13 offset:40000
v_mfma_f32_32x32x16_bf16 v[80:95], v[20:23], a[32:35], v[80:95]
ds_read_b64_tr_b16 v[46:47], v13 offset:42560
ds_read_b64_tr_b16 v[48:49], v13 offset:40064
ds_read_b64_tr_b16 v[50:51], v13 offset:42624
v_mfma_f32_32x32x16_bf16 v[96:111], v[24:27], a[32:35], v[96:111]
ds_read_b64_tr_b16 v[52:53], v13 offset:40128
ds_read_b64_tr_b16 v[54:55], v13 offset:42688
ds_read_b64_tr_b16 v[56:57], v13 offset:40192
v_mfma_f32_32x32x16_bf16 v[112:127], v[28:31], a[32:35], v[112:127]
ds_read_b64_tr_b16 v[58:59], v13 offset:42752
buffer_load_dwordx4 a[16:19], v11, s[4:7], s61 offen offset:2048 sc1
v_mfma_f32_32x32x16_bf16 v[128:143], v[32:35], a[32:35], v[128:143]
s_waitcnt lgkmcnt(0)
s_waitcnt vmcnt(13)
s_barrier
s_waitcnt vmcnt(12)
v_mfma_f32_32x32x16_bf16 v[64:79], v[40:43], a[40:43], v[64:79]
ds_read_b64_tr_b16 v[16:17], v2 offset:0
ds_read_b64_tr_b16 v[18:19], v2 offset:2560
ds_read_b64_tr_b16 v[20:21], v2 offset:64
v_mfma_f32_32x32x16_bf16 v[80:95], v[44:47], a[40:43], v[80:95]
ds_read_b64_tr_b16 v[22:23], v2 offset:2624
ds_read_b64_tr_b16 v[24:25], v2 offset:128
ds_read_b64_tr_b16 v[26:27], v2 offset:2688
v_mfma_f32_32x32x16_bf16 v[96:111], v[48:51], a[40:43], v[96:111]
ds_read_b64_tr_b16 v[28:29], v2 offset:192
ds_read_b64_tr_b16 v[30:31], v2 offset:2752
ds_read_b64_tr_b16 v[32:33], v2 offset:256
v_mfma_f32_32x32x16_bf16 v[112:127], v[52:55], a[40:43], v[112:127]
ds_read_b64_tr_b16 v[34:35], v2 offset:2816
s_add_u32 s43, s56, 491520
s_add_u32 m0, s62, 49152
s_nop 0
buffer_load_dwordx4 v4, s[8:11], s43 offen lds
s_add_u32 m0, s62, 50176
s_nop 0
buffer_load_dwordx4 v5, s[8:11], s43 offen lds
s_add_u32 m0, s62, 51200
s_nop 0
buffer_load_dwordx4 v6, s[8:11], s43 offen lds
s_add_u32 m0, s62, 52224
s_nop 0
buffer_load_dwordx4 v7, s[8:11], s43 offen lds
s_add_u32 m0, s62, 53248
s_nop 0
buffer_load_dwordx4 v8, s[8:11], s43 offen lds
buffer_load_dwordx4 a[24:27], v11, s[4:7], s61 offen offset:3072 sc1
v_mfma_f32_32x32x16_bf16 v[128:143], v[56:59], a[40:43], v[128:143]
s_waitcnt lgkmcnt(0)
s_waitcnt vmcnt(17)
v_mfma_f32_32x32x16_bf16 v[64:79], v[16:19], a[48:51], v[64:79]
s_add_u32 s59, s57, 24576
ds_read_b64_tr_b16 v[40:41], v2 offset:5120
ds_read_b64_tr_b16 v[42:43], v2 offset:7680
v_mfma_f32_32x32x16_bf16 v[80:95], v[20:23], a[48:51], v[80:95]
ds_read_b64_tr_b16 v[44:45], v2 offset:5184
ds_read_b64_tr_b16 v[46:47], v2 offset:7744
ds_read_b64_tr_b16 v[48:49], v2 offset:5248
v_mfma_f32_32x32x16_bf16 v[96:111], v[24:27], a[48:51], v[96:111]
ds_read_b64_tr_b16 v[50:51], v2 offset:7808
ds_read_b64_tr_b16 v[52:53], v2 offset:5312
ds_read_b64_tr_b16 v[54:55], v2 offset:7872
v_mfma_f32_32x32x16_bf16 v[112:127], v[28:31], a[48:51], v[112:127]
ds_read_b64_tr_b16 v[56:57], v2 offset:5376
ds_read_b64_tr_b16 v[58:59], v2 offset:7936
buffer_load_dwordx4 a[32:35], v11, s[4:7], s59 offen offset:0 sc1
v_mfma_f32_32x32x16_bf16 v[128:143], v[32:35], a[48:51], v[128:143]
s_waitcnt lgkmcnt(0)
s_waitcnt vmcnt(17)
v_mfma_f32_32x32x16_bf16 v[64:79], v[40:43], a[56:59], v[64:79]
ds_read_b64_tr_b16 v[16:17], v2 offset:10240
ds_read_b64_tr_b16 v[18:19], v2 offset:12800
ds_read_b64_tr_b16 v[20:21], v2 offset:10304
v_mfma_f32_32x32x16_bf16 v[80:95], v[44:47], a[56:59], v[80:95]
ds_read_b64_tr_b16 v[22:23], v2 offset:12864
ds_read_b64_tr_b16 v[24:25], v2 offset:10368
ds_read_b64_tr_b16 v[26:27], v2 offset:12928
v_mfma_f32_32x32x16_bf16 v[96:111], v[48:51], a[56:59], v[96:111]
ds_read_b64_tr_b16 v[28:29], v2 offset:10432
ds_read_b64_tr_b16 v[30:31], v2 offset:12992
ds_read_b64_tr_b16 v[32:33], v2 offset:10496
v_mfma_f32_32x32x16_bf16 v[112:127], v[52:55], a[56:59], v[112:127]
ds_read_b64_tr_b16 v[34:35], v2 offset:13056
buffer_load_dwordx4 a[40:43], v11, s[4:7], s59 offen offset:1024 sc1
v_mfma_f32_32x32x16_bf16 v[128:143], v[56:59], a[56:59], v[128:143]
s_waitcnt lgkmcnt(0)
s_waitcnt vmcnt(17)
v_mfma_f32_32x32x16_bf16 v[64:79], v[16:19], a[64:67], v[64:79]
ds_read_b64_tr_b16 v[40:41], v2 offset:15360
ds_read_b64_tr_b16 v[42:43], v2 offset:17920
ds_read_b64_tr_b16 v[44:45], v2 offset:15424
v_mfma_f32_32x32x16_bf16 v[80:95], v[20:23], a[64:67], v[80:95]
ds_read_b64_tr_b16 v[46:47], v2 offset:17984
ds_read_b64_tr_b16 v[48:49], v2 offset:15488
ds_read_b64_tr_b16 v[50:51], v2 offset:18048
v_mfma_f32_32x32x16_bf16 v[96:111], v[24:27], a[64:67], v[96:111]
ds_read_b64_tr_b16 v[52:53], v2 offset:15552
ds_read_b64_tr_b16 v[54:55], v2 offset:18112
ds_read_b64_tr_b16 v[56:57], v2 offset:15616
v_mfma_f32_32x32x16_bf16 v[112:127], v[28:31], a[64:67], v[112:127]
ds_read_b64_tr_b16 v[58:59], v2 offset:18176
buffer_load_dwordx4 a[48:51], v11, s[4:7], s59 offen offset:2048 sc1
v_mfma_f32_32x32x16_bf16 v[128:143], v[32:35], a[64:67], v[128:143]
s_waitcnt lgkmcnt(0)
s_waitcnt vmcnt(13)
s_barrier
s_waitcnt vmcnt(12)
v_mfma_f32_32x32x16_bf16 v[64:79], v[40:43], a[72:75], v[64:79]
ds_read_b64_tr_b16 v[16:17], v2 offset:24576
ds_read_b64_tr_b16 v[18:19], v2 offset:27136
ds_read_b64_tr_b16 v[20:21], v2 offset:24640
v_mfma_f32_32x32x16_bf16 v[80:95], v[44:47], a[72:75], v[80:95]
ds_read_b64_tr_b16 v[22:23], v2 offset:27200
ds_read_b64_tr_b16 v[24:25], v2 offset:24704
ds_read_b64_tr_b16 v[26:27], v2 offset:27264
v_mfma_f32_32x32x16_bf16 v[96:111], v[48:51], a[72:75], v[96:111]
ds_read_b64_tr_b16 v[28:29], v2 offset:24768
ds_read_b64_tr_b16 v[30:31], v2 offset:27328
ds_read_b64_tr_b16 v[32:33], v2 offset:24832
v_mfma_f32_32x32x16_bf16 v[112:127], v[52:55], a[72:75], v[112:127]
ds_read_b64_tr_b16 v[34:35], v2 offset:27392
s_add_u32 s43, s56, 573440
s_add_u32 m0, s62, 73728
s_nop 0
buffer_load_dwordx4 v4, s[8:11], s43 offen lds
s_add_u32 m0, s62, 74752
s_nop 0
buffer_load_dwordx4 v5, s[8:11], s43 offen lds
s_add_u32 m0, s62, 75776
s_nop 0
buffer_load_dwordx4 v6, s[8:11], s43 offen lds
s_add_u32 m0, s62, 76800
s_nop 0
buffer_load_dwordx4 v7, s[8:11], s43 offen lds
s_add_u32 m0, s62, 77824
s_nop 0
buffer_load_dwordx4 v8, s[8:11], s43 offen lds
buffer_load_dwordx4 a[56:59], v11, s[4:7], s59 offen offset:3072 sc1
v_mfma_f32_32x32x16_bf16 v[128:143], v[56:59], a[72:75], v[128:143]
s_waitcnt lgkmcnt(0)
s_waitcnt vmcnt(17)
v_mfma_f32_32x32x16_bf16 v[64:79], v[16:19], a[0:3], v[64:79]
s_add_u32 s60, s57, 28672
ds_read_b64_tr_b16 v[40:41], v2 offset:29696
ds_read_b64_tr_b16 v[42:43], v2 offset:32256
v_mfma_f32_32x32x16_bf16 v[80:95], v[20:23], a[0:3], v[80:95]
ds_read_b64_tr_b16 v[44:45], v2 offset:29760
ds_read_b64_tr_b16 v[46:47], v2 offset:32320
ds_read_b64_tr_b16 v[48:49], v2 offset:29824
v_mfma_f32_32x32x16_bf16 v[96:111], v[24:27], a[0:3], v[96:111]
ds_read_b64_tr_b16 v[50:51], v2 offset:32384
ds_read_b64_tr_b16 v[52:53], v2 offset:29888
ds_read_b64_tr_b16 v[54:55], v2 offset:32448
v_mfma_f32_32x32x16_bf16 v[112:127], v[28:31], a[0:3], v[112:127]
ds_read_b64_tr_b16 v[56:57], v2 offset:29952
ds_read_b64_tr_b16 v[58:59], v2 offset:32512
buffer_load_dwordx4 a[64:67], v11, s[4:7], s60 offen offset:0 sc1
v_mfma_f32_32x32x16_bf16 v[128:143], v[32:35], a[0:3], v[128:143]
s_waitcnt lgkmcnt(0)
s_waitcnt vmcnt(17)
v_mfma_f32_32x32x16_bf16 v[64:79], v[40:43], a[8:11], v[64:79]
ds_read_b64_tr_b16 v[16:17], v2 offset:34816
ds_read_b64_tr_b16 v[18:19], v2 offset:37376
ds_read_b64_tr_b16 v[20:21], v2 offset:34880
v_mfma_f32_32x32x16_bf16 v[80:95], v[44:47], a[8:11], v[80:95]
ds_read_b64_tr_b16 v[22:23], v2 offset:37440
ds_read_b64_tr_b16 v[24:25], v2 offset:34944
ds_read_b64_tr_b16 v[26:27], v2 offset:37504
v_mfma_f32_32x32x16_bf16 v[96:111], v[48:51], a[8:11], v[96:111]
ds_read_b64_tr_b16 v[28:29], v2 offset:35008
ds_read_b64_tr_b16 v[30:31], v2 offset:37568
ds_read_b64_tr_b16 v[32:33], v2 offset:35072
v_mfma_f32_32x32x16_bf16 v[112:127], v[52:55], a[8:11], v[112:127]
ds_read_b64_tr_b16 v[34:35], v2 offset:37632
buffer_load_dwordx4 a[72:75], v11, s[4:7], s60 offen offset:1024 sc1
v_mfma_f32_32x32x16_bf16 v[128:143], v[56:59], a[8:11], v[128:143]
s_waitcnt lgkmcnt(0)
s_waitcnt vmcnt(17)
v_mfma_f32_32x32x16_bf16 v[64:79], v[16:19], a[16:19], v[64:79]
ds_read_b64_tr_b16 v[40:41], v2 offset:39936
ds_read_b64_tr_b16 v[42:43], v2 offset:42496
ds_read_b64_tr_b16 v[44:45], v2 offset:40000
v_mfma_f32_32x32x16_bf16 v[80:95], v[20:23], a[16:19], v[80:95]
ds_read_b64_tr_b16 v[46:47], v2 offset:42560
ds_read_b64_tr_b16 v[48:49], v2 offset:40064
ds_read_b64_tr_b16 v[50:51], v2 offset:42624
v_mfma_f32_32x32x16_bf16 v[96:111], v[24:27], a[16:19], v[96:111]
ds_read_b64_tr_b16 v[52:53], v2 offset:40128
ds_read_b64_tr_b16 v[54:55], v2 offset:42688
ds_read_b64_tr_b16 v[56:57], v2 offset:40192
v_mfma_f32_32x32x16_bf16 v[112:127], v[28:31], a[16:19], v[112:127]
ds_read_b64_tr_b16 v[58:59], v2 offset:42752
buffer_load_dwordx4 a[0:3], v11, s[4:7], s60 offen offset:2048 sc1
v_mfma_f32_32x32x16_bf16 v[128:143], v[32:35], a[16:19], v[128:143]
s_waitcnt lgkmcnt(0)
s_waitcnt vmcnt(13)
s_barrier
s_waitcnt vmcnt(12)
v_mfma_f32_32x32x16_bf16 v[64:79], v[40:43], a[24:27], v[64:79]
ds_read_b64_tr_b16 v[16:17], v13 offset:0
ds_read_b64_tr_b16 v[18:19], v13 offset:2560
ds_read_b64_tr_b16 v[20:21], v13 offset:64
v_mfma_f32_32x32x16_bf16 v[80:95], v[44:47], a[24:27], v[80:95]
ds_read_b64_tr_b16 v[22:23], v13 offset:2624
ds_read_b64_tr_b16 v[24:25], v13 offset:128
ds_read_b64_tr_b16 v[26:27], v13 offset:2688
v_mfma_f32_32x32x16_bf16 v[96:111], v[48:51], a[24:27], v[96:111]
ds_read_b64_tr_b16 v[28:29], v13 offset:192
ds_read_b64_tr_b16 v[30:31], v13 offset:2752
ds_read_b64_tr_b16 v[32:33], v13 offset:256
v_mfma_f32_32x32x16_bf16 v[112:127], v[52:55], a[24:27], v[112:127]
ds_read_b64_tr_b16 v[34:35], v13 offset:2816
s_add_u32 s43, s56, 655360
s_add_u32 m0, s62, 0
s_nop 0
buffer_load_dwordx4 v4, s[8:11], s43 offen lds
s_add_u32 m0, s62, 1024
s_nop 0
buffer_load_dwordx4 v5, s[8:11], s43 offen lds
s_add_u32 m0, s62, 2048
s_nop 0
buffer_load_dwordx4 v6, s[8:11], s43 offen lds
s_add_u32 m0, s62, 3072
s_nop 0
buffer_load_dwordx4 v7, s[8:11], s43 offen lds
s_add_u32 m0, s62, 4096
s_nop 0
buffer_load_dwordx4 v8, s[8:11], s43 offen lds
buffer_load_dwordx4 a[8:11], v11, s[4:7], s60 offen offset:3072 sc1
v_mfma_f32_32x32x16_bf16 v[128:143], v[56:59], a[24:27], v[128:143]
s_waitcnt lgkmcnt(0)
s_waitcnt vmcnt(17)
v_mfma_f32_32x32x16_bf16 v[64:79], v[16:19], a[32:35], v[64:79]
s_add_u32 s61, s57, 32768
ds_read_b64_tr_b16 v[40:41], v13 offset:5120
ds_read_b64_tr_b16 v[42:43], v13 offset:7680
v_mfma_f32_32x32x16_bf16 v[80:95], v[20:23], a[32:35], v[80:95]
ds_read_b64_tr_b16 v[44:45], v13 offset:5184
ds_read_b64_tr_b16 v[46:47], v13 offset:7744
ds_read_b64_tr_b16 v[48:49], v13 offset:5248
v_mfma_f32_32x32x16_bf16 v[96:111], v[24:27], a[32:35], v[96:111]
ds_read_b64_tr_b16 v[50:51], v13 offset:7808
ds_read_b64_tr_b16 v[52:53], v13 offset:5312
ds_read_b64_tr_b16 v[54:55], v13 offset:7872
v_mfma_f32_32x32x16_bf16 v[112:127], v[28:31], a[32:35], v[112:127]
ds_read_b64_tr_b16 v[56:57], v13 offset:5376
ds_read_b64_tr_b16 v[58:59], v13 offset:7936
buffer_load_dwordx4 a[16:19], v11, s[4:7], s61 offen offset:0 sc1
v_mfma_f32_32x32x16_bf16 v[128:143], v[32:35], a[32:35], v[128:143]
s_waitcnt lgkmcnt(0)
s_waitcnt vmcnt(17)
v_mfma_f32_32x32x16_bf16 v[64:79], v[40:43], a[40:43], v[64:79]
ds_read_b64_tr_b16 v[16:17], v13 offset:10240
ds_read_b64_tr_b16 v[18:19], v13 offset:12800
ds_read_b64_tr_b16 v[20:21], v13 offset:10304
v_mfma_f32_32x32x16_bf16 v[80:95], v[44:47], a[40:43], v[80:95]
ds_read_b64_tr_b16 v[22:23], v13 offset:12864
ds_read_b64_tr_b16 v[24:25], v13 offset:10368
ds_read_b64_tr_b16 v[26:27], v13 offset:12928
v_mfma_f32_32x32x16_bf16 v[96:111], v[48:51], a[40:43], v[96:111]
ds_read_b64_tr_b16 v[28:29], v13 offset:10432
ds_read_b64_tr_b16 v[30:31], v13 offset:12992
ds_read_b64_tr_b16 v[32:33], v13 offset:10496
v_mfma_f32_32x32x16_bf16 v[112:127], v[52:55], a[40:43], v[112:127]
ds_read_b64_tr_b16 v[34:35], v13 offset:13056
buffer_load_dwordx4 a[24:27], v11, s[4:7], s61 offen offset:1024 sc1
v_mfma_f32_32x32x16_bf16 v[128:143], v[56:59], a[40:43], v[128:143]
s_waitcnt lgkmcnt(0)
s_waitcnt vmcnt(17)
v_mfma_f32_32x32x16_bf16 v[64:79], v[16:19], a[48:51], v[64:79]
ds_read_b64_tr_b16 v[40:41], v13 offset:15360
ds_read_b64_tr_b16 v[42:43], v13 offset:17920
ds_read_b64_tr_b16 v[44:45], v13 offset:15424
v_mfma_f32_32x32x16_bf16 v[80:95], v[20:23], a[48:51], v[80:95]
ds_read_b64_tr_b16 v[46:47], v13 offset:17984
ds_read_b64_tr_b16 v[48:49], v13 offset:15488
ds_read_b64_tr_b16 v[50:51], v13 offset:18048
v_mfma_f32_32x32x16_bf16 v[96:111], v[24:27], a[48:51], v[96:111]
ds_read_b64_tr_b16 v[52:53], v13 offset:15552
ds_read_b64_tr_b16 v[54:55], v13 offset:18112
ds_read_b64_tr_b16 v[56:57], v13 offset:15616
v_mfma_f32_32x32x16_bf16 v[112:127], v[28:31], a[48:51], v[112:127]
ds_read_b64_tr_b16 v[58:59], v13 offset:18176
buffer_load_dwordx4 a[32:35], v11, s[4:7], s61 offen offset:2048 sc1
v_mfma_f32_32x32x16_bf16 v[128:143], v[32:35], a[48:51], v[128:143]
s_waitcnt lgkmcnt(0)
s_waitcnt vmcnt(13)
s_barrier
s_waitcnt vmcnt(12)
v_mfma_f32_32x32x16_bf16 v[64:79], v[40:43], a[56:59], v[64:79]
ds_read_b64_tr_b16 v[16:17], v13 offset:24576
ds_read_b64_tr_b16 v[18:19], v13 offset:27136
ds_read_b64_tr_b16 v[20:21], v13 offset:24640
v_mfma_f32_32x32x16_bf16 v[80:95], v[44:47], a[56:59], v[80:95]
ds_read_b64_tr_b16 v[22:23], v13 offset:27200
ds_read_b64_tr_b16 v[24:25], v13 offset:24704
ds_read_b64_tr_b16 v[26:27], v13 offset:27264
v_mfma_f32_32x32x16_bf16 v[96:111], v[48:51], a[56:59], v[96:111]
ds_read_b64_tr_b16 v[28:29], v13 offset:24768
ds_read_b64_tr_b16 v[30:31], v13 offset:27328
ds_read_b64_tr_b16 v[32:33], v13 offset:24832
v_mfma_f32_32x32x16_bf16 v[112:127], v[52:55], a[56:59], v[112:127]
ds_read_b64_tr_b16 v[34:35], v13 offset:27392
s_add_u32 s43, s56, 737280
s_add_u32 m0, s62, 24576
s_nop 0
buffer_load_dwordx4 v4, s[8:11], s43 offen lds
s_add_u32 m0, s62, 25600
s_nop 0
buffer_load_dwordx4 v5, s[8:11], s43 offen lds
s_add_u32 m0, s62, 26624
s_nop 0
buffer_load_dwordx4 v6, s[8:11], s43 offen lds
s_add_u32 m0, s62, 27648
s_nop 0
buffer_load_dwordx4 v7, s[8:11], s43 offen lds
s_add_u32 m0, s62, 28672
s_nop 0
buffer_load_dwordx4 v8, s[8:11], s43 offen lds
buffer_load_dwordx4 a[40:43], v11, s[4:7], s61 offen offset:3072 sc1
v_mfma_f32_32x32x16_bf16 v[128:143], v[56:59], a[56:59], v[128:143]
s_waitcnt lgkmcnt(0)
s_waitcnt vmcnt(17)
v_mfma_f32_32x32x16_bf16 v[64:79], v[16:19], a[64:67], v[64:79]
s_add_u32 s59, s57, 36864
ds_read_b64_tr_b16 v[40:41], v13 offset:29696
ds_read_b64_tr_b16 v[42:43], v13 offset:32256
v_mfma_f32_32x32x16_bf16 v[80:95], v[20:23], a[64:67], v[80:95]
ds_read_b64_tr_b16 v[44:45], v13 offset:29760
ds_read_b64_tr_b16 v[46:47], v13 offset:32320
ds_read_b64_tr_b16 v[48:49], v13 offset:29824
v_mfma_f32_32x32x16_bf16 v[96:111], v[24:27], a[64:67], v[96:111]
ds_read_b64_tr_b16 v[50:51], v13 offset:32384
ds_read_b64_tr_b16 v[52:53], v13 offset:29888
ds_read_b64_tr_b16 v[54:55], v13 offset:32448
v_mfma_f32_32x32x16_bf16 v[112:127], v[28:31], a[64:67], v[112:127]
ds_read_b64_tr_b16 v[56:57], v13 offset:29952
ds_read_b64_tr_b16 v[58:59], v13 offset:32512
buffer_load_dwordx4 a[48:51], v11, s[4:7], s59 offen offset:0 sc1
v_mfma_f32_32x32x16_bf16 v[128:143], v[32:35], a[64:67], v[128:143]
s_waitcnt lgkmcnt(0)
s_waitcnt vmcnt(17)
v_mfma_f32_32x32x16_bf16 v[64:79], v[40:43], a[72:75], v[64:79]
ds_read_b64_tr_b16 v[16:17], v13 offset:34816
ds_read_b64_tr_b16 v[18:19], v13 offset:37376
ds_read_b64_tr_b16 v[20:21], v13 offset:34880
v_mfma_f32_32x32x16_bf16 v[80:95], v[44:47], a[72:75], v[80:95]
ds_read_b64_tr_b16 v[22:23], v13 offset:37440
ds_read_b64_tr_b16 v[24:25], v13 offset:34944
ds_read_b64_tr_b16 v[26:27], v13 offset:37504
v_mfma_f32_32x32x16_bf16 v[96:111], v[48:51], a[72:75], v[96:111]
ds_read_b64_tr_b16 v[28:29], v13 offset:35008
ds_read_b64_tr_b16 v[30:31], v13 offset:37568
ds_read_b64_tr_b16 v[32:33], v13 offset:35072
v_mfma_f32_32x32x16_bf16 v[112:127], v[52:55], a[72:75], v[112:127]
ds_read_b64_tr_b16 v[34:35], v13 offset:37632
buffer_load_dwordx4 a[56:59], v11, s[4:7], s59 offen offset:1024 sc1
v_mfma_f32_32x32x16_bf16 v[128:143], v[56:59], a[72:75], v[128:143]
s_waitcnt lgkmcnt(0)
s_waitcnt vmcnt(17)
v_mfma_f32_32x32x16_bf16 v[64:79], v[16:19], a[0:3], v[64:79]
ds_read_b64_tr_b16 v[40:41], v13 offset:39936
ds_read_b64_tr_b16 v[42:43], v13 offset:42496
ds_read_b64_tr_b16 v[44:45], v13 offset:40000
v_mfma_f32_32x32x16_bf16 v[80:95], v[20:23], a[0:3], v[80:95]
ds_read_b64_tr_b16 v[46:47], v13 offset:42560
ds_read_b64_tr_b16 v[48:49], v13 offset:40064
ds_read_b64_tr_b16 v[50:51], v13 offset:42624
v_mfma_f32_32x32x16_bf16 v[96:111], v[24:27], a[0:3], v[96:111]
ds_read_b64_tr_b16 v[52:53], v13 offset:40128
ds_read_b64_tr_b16 v[54:55], v13 offset:42688
ds_read_b64_tr_b16 v[56:57], v13 offset:40192
v_mfma_f32_32x32x16_bf16 v[112:127], v[28:31], a[0:3], v[112:127]
ds_read_b64_tr_b16 v[58:59], v13 offset:42752
buffer_load_dwordx4 a[64:67], v11, s[4:7], s59 offen offset:2048 sc1
v_mfma_f32_32x32x16_bf16 v[128:143], v[32:35], a[0:3], v[128:143]
s_waitcnt lgkmcnt(0)
s_waitcnt vmcnt(13)
s_barrier
s_waitcnt vmcnt(12)
v_mfma_f32_32x32x16_bf16 v[64:79], v[40:43], a[8:11], v[64:79]
ds_read_b64_tr_b16 v[16:17], v2 offset:0
ds_read_b64_tr_b16 v[18:19], v2 offset:2560
ds_read_b64_tr_b16 v[20:21], v2 offset:64
v_mfma_f32_32x32x16_bf16 v[80:95], v[44:47], a[8:11], v[80:95]
ds_read_b64_tr_b16 v[22:23], v2 offset:2624
ds_read_b64_tr_b16 v[24:25], v2 offset:128
ds_read_b64_tr_b16 v[26:27], v2 offset:2688
v_mfma_f32_32x32x16_bf16 v[96:111], v[48:51], a[8:11], v[96:111]
ds_read_b64_tr_b16 v[28:29], v2 offset:192
ds_read_b64_tr_b16 v[30:31], v2 offset:2752
ds_read_b64_tr_b16 v[32:33], v2 offset:256
v_mfma_f32_32x32x16_bf16 v[112:127], v[52:55], a[8:11], v[112:127]
ds_read_b64_tr_b16 v[34:35], v2 offset:2816
s_add_u32 s43, s56, 819200
s_add_u32 m0, s62, 49152
s_nop 0
buffer_load_dwordx4 v4, s[8:11], s43 offen lds
s_add_u32 m0, s62, 50176
s_nop 0
buffer_load_dwordx4 v5, s[8:11], s43 offen lds
s_add_u32 m0, s62, 51200
s_nop 0
buffer_load_dwordx4 v6, s[8:11], s43 offen lds
s_add_u32 m0, s62, 52224
s_nop 0
buffer_load_dwordx4 v7, s[8:11], s43 offen lds
s_add_u32 m0, s62, 53248
s_nop 0
buffer_load_dwordx4 v8, s[8:11], s43 offen lds
buffer_load_dwordx4 a[72:75], v11, s[4:7], s59 offen offset:3072 sc1
v_mfma_f32_32x32x16_bf16 v[128:143], v[56:59], a[8:11], v[128:143]
s_waitcnt lgkmcnt(0)
s_waitcnt vmcnt(17)
v_mfma_f32_32x32x16_bf16 v[64:79], v[16:19], a[16:19], v[64:79]
s_add_u32 s60, s57, 40960
ds_read_b64_tr_b16 v[40:41], v2 offset:5120
ds_read_b64_tr_b16 v[42:43], v2 offset:7680
v_mfma_f32_32x32x16_bf16 v[80:95], v[20:23], a[16:19], v[80:95]
ds_read_b64_tr_b16 v[44:45], v2 offset:5184
ds_read_b64_tr_b16 v[46:47], v2 offset:7744
ds_read_b64_tr_b16 v[48:49], v2 offset:5248
v_mfma_f32_32x32x16_bf16 v[96:111], v[24:27], a[16:19], v[96:111]
ds_read_b64_tr_b16 v[50:51], v2 offset:7808
ds_read_b64_tr_b16 v[52:53], v2 offset:5312
ds_read_b64_tr_b16 v[54:55], v2 offset:7872
v_mfma_f32_32x32x16_bf16 v[112:127], v[28:31], a[16:19], v[112:127]
ds_read_b64_tr_b16 v[56:57], v2 offset:5376
ds_read_b64_tr_b16 v[58:59], v2 offset:7936
buffer_load_dwordx4 a[0:3], v11, s[4:7], s60 offen offset:0 sc1
v_mfma_f32_32x32x16_bf16 v[128:143], v[32:35], a[16:19], v[128:143]
s_waitcnt lgkmcnt(0)
s_waitcnt vmcnt(17)
v_mfma_f32_32x32x16_bf16 v[64:79], v[40:43], a[24:27], v[64:79]
ds_read_b64_tr_b16 v[16:17], v2 offset:10240
ds_read_b64_tr_b16 v[18:19], v2 offset:12800
ds_read_b64_tr_b16 v[20:21], v2 offset:10304
v_mfma_f32_32x32x16_bf16 v[80:95], v[44:47], a[24:27], v[80:95]
ds_read_b64_tr_b16 v[22:23], v2 offset:12864
ds_read_b64_tr_b16 v[24:25], v2 offset:10368
ds_read_b64_tr_b16 v[26:27], v2 offset:12928
v_mfma_f32_32x32x16_bf16 v[96:111], v[48:51], a[24:27], v[96:111]
ds_read_b64_tr_b16 v[28:29], v2 offset:10432
ds_read_b64_tr_b16 v[30:31], v2 offset:12992
ds_read_b64_tr_b16 v[32:33], v2 offset:10496
v_mfma_f32_32x32x16_bf16 v[112:127], v[52:55], a[24:27], v[112:127]
ds_read_b64_tr_b16 v[34:35], v2 offset:13056
buffer_load_dwordx4 a[8:11], v11, s[4:7], s60 offen offset:1024 sc1
v_mfma_f32_32x32x16_bf16 v[128:143], v[56:59], a[24:27], v[128:143]
s_waitcnt lgkmcnt(0)
s_waitcnt vmcnt(17)
v_mfma_f32_32x32x16_bf16 v[64:79], v[16:19], a[32:35], v[64:79]
ds_read_b64_tr_b16 v[40:41], v2 offset:15360
ds_read_b64_tr_b16 v[42:43], v2 offset:17920
ds_read_b64_tr_b16 v[44:45], v2 offset:15424
v_mfma_f32_32x32x16_bf16 v[80:95], v[20:23], a[32:35], v[80:95]
ds_read_b64_tr_b16 v[46:47], v2 offset:17984
ds_read_b64_tr_b16 v[48:49], v2 offset:15488
ds_read_b64_tr_b16 v[50:51], v2 offset:18048
v_mfma_f32_32x32x16_bf16 v[96:111], v[24:27], a[32:35], v[96:111]
ds_read_b64_tr_b16 v[52:53], v2 offset:15552
ds_read_b64_tr_b16 v[54:55], v2 offset:18112
ds_read_b64_tr_b16 v[56:57], v2 offset:15616
v_mfma_f32_32x32x16_bf16 v[112:127], v[28:31], a[32:35], v[112:127]
ds_read_b64_tr_b16 v[58:59], v2 offset:18176
buffer_load_dwordx4 a[16:19], v11, s[4:7], s60 offen offset:2048 sc1
v_mfma_f32_32x32x16_bf16 v[128:143], v[32:35], a[32:35], v[128:143]
s_waitcnt lgkmcnt(0)
s_waitcnt vmcnt(13)
s_barrier
s_waitcnt vmcnt(12)
v_mfma_f32_32x32x16_bf16 v[64:79], v[40:43], a[40:43], v[64:79]
ds_read_b64_tr_b16 v[16:17], v2 offset:24576
ds_read_b64_tr_b16 v[18:19], v2 offset:27136
ds_read_b64_tr_b16 v[20:21], v2 offset:24640
v_mfma_f32_32x32x16_bf16 v[80:95], v[44:47], a[40:43], v[80:95]
ds_read_b64_tr_b16 v[22:23], v2 offset:27200
ds_read_b64_tr_b16 v[24:25], v2 offset:24704
ds_read_b64_tr_b16 v[26:27], v2 offset:27264
v_mfma_f32_32x32x16_bf16 v[96:111], v[48:51], a[40:43], v[96:111]
ds_read_b64_tr_b16 v[28:29], v2 offset:24768
ds_read_b64_tr_b16 v[30:31], v2 offset:27328
ds_read_b64_tr_b16 v[32:33], v2 offset:24832
v_mfma_f32_32x32x16_bf16 v[112:127], v[52:55], a[40:43], v[112:127]
ds_read_b64_tr_b16 v[34:35], v2 offset:27392
s_add_u32 s43, s56, 901120
s_add_u32 m0, s62, 73728
s_nop 0
buffer_load_dwordx4 v4, s[8:11], s43 offen lds
s_add_u32 m0, s62, 74752
s_nop 0
buffer_load_dwordx4 v5, s[8:11], s43 offen lds
s_add_u32 m0, s62, 75776
s_nop 0
buffer_load_dwordx4 v6, s[8:11], s43 offen lds
s_add_u32 m0, s62, 76800
s_nop 0
buffer_load_dwordx4 v7, s[8:11], s43 offen lds
s_add_u32 m0, s62, 77824
s_nop 0
buffer_load_dwordx4 v8, s[8:11], s43 offen lds
buffer_load_dwordx4 a[24:27], v11, s[4:7], s60 offen offset:3072 sc1
v_mfma_f32_32x32x16_bf16 v[128:143], v[56:59], a[40:43], v[128:143]
s_waitcnt lgkmcnt(0)
s_waitcnt vmcnt(17)
v_mfma_f32_32x32x16_bf16 v[64:79], v[16:19], a[48:51], v[64:79]
s_add_u32 s61, s57, 45056
ds_read_b64_tr_b16 v[40:41], v2 offset:29696
ds_read_b64_tr_b16 v[42:43], v2 offset:32256
v_mfma_f32_32x32x16_bf16 v[80:95], v[20:23], a[48:51], v[80:95]
ds_read_b64_tr_b16 v[44:45], v2 offset:29760
ds_read_b64_tr_b16 v[46:47], v2 offset:32320
ds_read_b64_tr_b16 v[48:49], v2 offset:29824
v_mfma_f32_32x32x16_bf16 v[96:111], v[24:27], a[48:51], v[96:111]
ds_read_b64_tr_b16 v[50:51], v2 offset:32384
ds_read_b64_tr_b16 v[52:53], v2 offset:29888
ds_read_b64_tr_b16 v[54:55], v2 offset:32448
v_mfma_f32_32x32x16_bf16 v[112:127], v[28:31], a[48:51], v[112:127]
ds_read_b64_tr_b16 v[56:57], v2 offset:29952
ds_read_b64_tr_b16 v[58:59], v2 offset:32512
buffer_load_dwordx4 a[32:35], v11, s[4:7], s61 offen offset:0 sc1
v_mfma_f32_32x32x16_bf16 v[128:143], v[32:35], a[48:51], v[128:143]
s_waitcnt lgkmcnt(0)
s_waitcnt vmcnt(17)
v_mfma_f32_32x32x16_bf16 v[64:79], v[40:43], a[56:59], v[64:79]
ds_read_b64_tr_b16 v[16:17], v2 offset:34816
ds_read_b64_tr_b16 v[18:19], v2 offset:37376
ds_read_b64_tr_b16 v[20:21], v2 offset:34880
v_mfma_f32_32x32x16_bf16 v[80:95], v[44:47], a[56:59], v[80:95]
ds_read_b64_tr_b16 v[22:23], v2 offset:37440
ds_read_b64_tr_b16 v[24:25], v2 offset:34944
ds_read_b64_tr_b16 v[26:27], v2 offset:37504
v_mfma_f32_32x32x16_bf16 v[96:111], v[48:51], a[56:59], v[96:111]
ds_read_b64_tr_b16 v[28:29], v2 offset:35008
ds_read_b64_tr_b16 v[30:31], v2 offset:37568
ds_read_b64_tr_b16 v[32:33], v2 offset:35072
v_mfma_f32_32x32x16_bf16 v[112:127], v[52:55], a[56:59], v[112:127]
ds_read_b64_tr_b16 v[34:35], v2 offset:37632
buffer_load_dwordx4 a[40:43], v11, s[4:7], s61 offen offset:1024 sc1
v_mfma_f32_32x32x16_bf16 v[128:143], v[56:59], a[56:59], v[128:143]
s_waitcnt lgkmcnt(0)
s_waitcnt vmcnt(17)
v_mfma_f32_32x32x16_bf16 v[64:79], v[16:19], a[64:67], v[64:79]
ds_read_b64_tr_b16 v[40:41], v2 offset:39936
ds_read_b64_tr_b16 v[42:43], v2 offset:42496
ds_read_b64_tr_b16 v[44:45], v2 offset:40000
v_mfma_f32_32x32x16_bf16 v[80:95], v[20:23], a[64:67], v[80:95]
ds_read_b64_tr_b16 v[46:47], v2 offset:42560
ds_read_b64_tr_b16 v[48:49], v2 offset:40064
ds_read_b64_tr_b16 v[50:51], v2 offset:42624
v_mfma_f32_32x32x16_bf16 v[96:111], v[24:27], a[64:67], v[96:111]
ds_read_b64_tr_b16 v[52:53], v2 offset:40128
ds_read_b64_tr_b16 v[54:55], v2 offset:42688
ds_read_b64_tr_b16 v[56:57], v2 offset:40192
v_mfma_f32_32x32x16_bf16 v[112:127], v[28:31], a[64:67], v[112:127]
ds_read_b64_tr_b16 v[58:59], v2 offset:42752
buffer_load_dwordx4 a[48:51], v11, s[4:7], s61 offen offset:2048 sc1
v_mfma_f32_32x32x16_bf16 v[128:143], v[32:35], a[64:67], v[128:143]
s_waitcnt lgkmcnt(0)
s_waitcnt vmcnt(13)
s_barrier
s_waitcnt vmcnt(12)
v_mfma_f32_32x32x16_bf16 v[64:79], v[40:43], a[72:75], v[64:79]
ds_read_b64_tr_b16 v[16:17], v13 offset:0
ds_read_b64_tr_b16 v[18:19], v13 offset:2560
ds_read_b64_tr_b16 v[20:21], v13 offset:64
v_mfma_f32_32x32x16_bf16 v[80:95], v[44:47], a[72:75], v[80:95]
ds_read_b64_tr_b16 v[22:23], v13 offset:2624
ds_read_b64_tr_b16 v[24:25], v13 offset:128
ds_read_b64_tr_b16 v[26:27], v13 offset:2688
v_mfma_f32_32x32x16_bf16 v[96:111], v[48:51], a[72:75], v[96:111]
ds_read_b64_tr_b16 v[28:29], v13 offset:192
ds_read_b64_tr_b16 v[30:31], v13 offset:2752
ds_read_b64_tr_b16 v[32:33], v13 offset:256
v_mfma_f32_32x32x16_bf16 v[112:127], v[52:55], a[72:75], v[112:127]
ds_read_b64_tr_b16 v[34:35], v13 offset:2816
s_add_u32 s43, s56, 983040
s_add_u32 m0, s62, 0
s_nop 0
buffer_load_dwordx4 v4, s[8:11], s43 offen lds
s_add_u32 m0, s62, 1024
s_nop 0
buffer_load_dwordx4 v5, s[8:11], s43 offen lds
s_add_u32 m0, s62, 2048
s_nop 0
buffer_load_dwordx4 v6, s[8:11], s43 offen lds
s_add_u32 m0, s62, 3072
s_nop 0
buffer_load_dwordx4 v7, s[8:11], s43 offen lds
s_add_u32 m0, s62, 4096
s_nop 0
buffer_load_dwordx4 v8, s[8:11], s43 offen lds
buffer_load_dwordx4 a[56:59], v11, s[4:7], s61 offen offset:3072 sc1
v_mfma_f32_32x32x16_bf16 v[128:143], v[56:59], a[72:75], v[128:143]
s_waitcnt lgkmcnt(0)
s_waitcnt vmcnt(17)
v_mfma_f32_32x32x16_bf16 v[64:79], v[16:19], a[0:3], v[64:79]
s_add_u32 s59, s57, 49152
ds_read_b64_tr_b16 v[40:41], v13 offset:5120
ds_read_b64_tr_b16 v[42:43], v13 offset:7680
v_mfma_f32_32x32x16_bf16 v[80:95], v[20:23], a[0:3], v[80:95]
ds_read_b64_tr_b16 v[44:45], v13 offset:5184
ds_read_b64_tr_b16 v[46:47], v13 offset:7744
ds_read_b64_tr_b16 v[48:49], v13 offset:5248
v_mfma_f32_32x32x16_bf16 v[96:111], v[24:27], a[0:3], v[96:111]
ds_read_b64_tr_b16 v[50:51], v13 offset:7808
ds_read_b64_tr_b16 v[52:53], v13 offset:5312
ds_read_b64_tr_b16 v[54:55], v13 offset:7872
v_mfma_f32_32x32x16_bf16 v[112:127], v[28:31], a[0:3], v[112:127]
ds_read_b64_tr_b16 v[56:57], v13 offset:5376
ds_read_b64_tr_b16 v[58:59], v13 offset:7936
buffer_load_dwordx4 a[64:67], v11, s[4:7], s59 offen offset:0 sc1
v_mfma_f32_32x32x16_bf16 v[128:143], v[32:35], a[0:3], v[128:143]
s_waitcnt lgkmcnt(0)
s_waitcnt vmcnt(17)
v_mfma_f32_32x32x16_bf16 v[64:79], v[40:43], a[8:11], v[64:79]
ds_read_b64_tr_b16 v[16:17], v13 offset:10240
ds_read_b64_tr_b16 v[18:19], v13 offset:12800
ds_read_b64_tr_b16 v[20:21], v13 offset:10304
v_mfma_f32_32x32x16_bf16 v[80:95], v[44:47], a[8:11], v[80:95]
ds_read_b64_tr_b16 v[22:23], v13 offset:12864
ds_read_b64_tr_b16 v[24:25], v13 offset:10368
ds_read_b64_tr_b16 v[26:27], v13 offset:12928
v_mfma_f32_32x32x16_bf16 v[96:111], v[48:51], a[8:11], v[96:111]
ds_read_b64_tr_b16 v[28:29], v13 offset:10432
ds_read_b64_tr_b16 v[30:31], v13 offset:12992
ds_read_b64_tr_b16 v[32:33], v13 offset:10496
v_mfma_f32_32x32x16_bf16 v[112:127], v[52:55], a[8:11], v[112:127]
ds_read_b64_tr_b16 v[34:35], v13 offset:13056
buffer_load_dwordx4 a[72:75], v11, s[4:7], s59 offen offset:1024 sc1
v_mfma_f32_32x32x16_bf16 v[128:143], v[56:59], a[8:11], v[128:143]
s_waitcnt lgkmcnt(0)
s_waitcnt vmcnt(17)
v_mfma_f32_32x32x16_bf16 v[64:79], v[16:19], a[16:19], v[64:79]
ds_read_b64_tr_b16 v[40:41], v13 offset:15360
ds_read_b64_tr_b16 v[42:43], v13 offset:17920
ds_read_b64_tr_b16 v[44:45], v13 offset:15424
v_mfma_f32_32x32x16_bf16 v[80:95], v[20:23], a[16:19], v[80:95]
ds_read_b64_tr_b16 v[46:47], v13 offset:17984
ds_read_b64_tr_b16 v[48:49], v13 offset:15488
ds_read_b64_tr_b16 v[50:51], v13 offset:18048
v_mfma_f32_32x32x16_bf16 v[96:111], v[24:27], a[16:19], v[96:111]
ds_read_b64_tr_b16 v[52:53], v13 offset:15552
ds_read_b64_tr_b16 v[54:55], v13 offset:18112
ds_read_b64_tr_b16 v[56:57], v13 offset:15616
v_mfma_f32_32x32x16_bf16 v[112:127], v[28:31], a[16:19], v[112:127]
ds_read_b64_tr_b16 v[58:59], v13 offset:18176
buffer_load_dwordx4 a[0:3], v11, s[4:7], s59 offen offset:2048 sc1
v_mfma_f32_32x32x16_bf16 v[128:143], v[32:35], a[16:19], v[128:143]
s_waitcnt lgkmcnt(0)
s_waitcnt vmcnt(13)
s_barrier
s_waitcnt vmcnt(12)
v_mfma_f32_32x32x16_bf16 v[64:79], v[40:43], a[24:27], v[64:79]
ds_read_b64_tr_b16 v[16:17], v13 offset:24576
ds_read_b64_tr_b16 v[18:19], v13 offset:27136
ds_read_b64_tr_b16 v[20:21], v13 offset:24640
v_mfma_f32_32x32x16_bf16 v[80:95], v[44:47], a[24:27], v[80:95]
ds_read_b64_tr_b16 v[22:23], v13 offset:27200
ds_read_b64_tr_b16 v[24:25], v13 offset:24704
ds_read_b64_tr_b16 v[26:27], v13 offset:27264
v_mfma_f32_32x32x16_bf16 v[96:111], v[48:51], a[24:27], v[96:111]
ds_read_b64_tr_b16 v[28:29], v13 offset:24768
ds_read_b64_tr_b16 v[30:31], v13 offset:27328
ds_read_b64_tr_b16 v[32:33], v13 offset:24832
v_mfma_f32_32x32x16_bf16 v[112:127], v[52:55], a[24:27], v[112:127]
ds_read_b64_tr_b16 v[34:35], v13 offset:27392
s_add_u32 s43, s56, 1064960
s_add_u32 m0, s62, 24576
s_nop 0
buffer_load_dwordx4 v4, s[8:11], s43 offen lds
s_add_u32 m0, s62, 25600
s_nop 0
buffer_load_dwordx4 v5, s[8:11], s43 offen lds
s_add_u32 m0, s62, 26624
s_nop 0
buffer_load_dwordx4 v6, s[8:11], s43 offen lds
s_add_u32 m0, s62, 27648
s_nop 0
buffer_load_dwordx4 v7, s[8:11], s43 offen lds
s_add_u32 m0, s62, 28672
s_nop 0
buffer_load_dwordx4 v8, s[8:11], s43 offen lds
buffer_load_dwordx4 a[8:11], v11, s[4:7], s59 offen offset:3072 sc1
v_mfma_f32_32x32x16_bf16 v[128:143], v[56:59], a[24:27], v[128:143]
s_waitcnt lgkmcnt(0)
s_waitcnt vmcnt(17)
v_mfma_f32_32x32x16_bf16 v[64:79], v[16:19], a[32:35], v[64:79]
s_add_u32 s60, s57, 53248
ds_read_b64_tr_b16 v[40:41], v13 offset:29696
ds_read_b64_tr_b16 v[42:43], v13 offset:32256
v_mfma_f32_32x32x16_bf16 v[80:95], v[20:23], a[32:35], v[80:95]
ds_read_b64_tr_b16 v[44:45], v13 offset:29760
ds_read_b64_tr_b16 v[46:47], v13 offset:32320
ds_read_b64_tr_b16 v[48:49], v13 offset:29824
v_mfma_f32_32x32x16_bf16 v[96:111], v[24:27], a[32:35], v[96:111]
ds_read_b64_tr_b16 v[50:51], v13 offset:32384
ds_read_b64_tr_b16 v[52:53], v13 offset:29888
ds_read_b64_tr_b16 v[54:55], v13 offset:32448
v_mfma_f32_32x32x16_bf16 v[112:127], v[28:31], a[32:35], v[112:127]
ds_read_b64_tr_b16 v[56:57], v13 offset:29952
ds_read_b64_tr_b16 v[58:59], v13 offset:32512
buffer_load_dwordx4 a[16:19], v11, s[4:7], s60 offen offset:0 sc1
v_mfma_f32_32x32x16_bf16 v[128:143], v[32:35], a[32:35], v[128:143]
s_waitcnt lgkmcnt(0)
s_waitcnt vmcnt(17)
v_mfma_f32_32x32x16_bf16 v[64:79], v[40:43], a[40:43], v[64:79]
ds_read_b64_tr_b16 v[16:17], v13 offset:34816
ds_read_b64_tr_b16 v[18:19], v13 offset:37376
ds_read_b64_tr_b16 v[20:21], v13 offset:34880
v_mfma_f32_32x32x16_bf16 v[80:95], v[44:47], a[40:43], v[80:95]
ds_read_b64_tr_b16 v[22:23], v13 offset:37440
ds_read_b64_tr_b16 v[24:25], v13 offset:34944
ds_read_b64_tr_b16 v[26:27], v13 offset:37504
v_mfma_f32_32x32x16_bf16 v[96:111], v[48:51], a[40:43], v[96:111]
ds_read_b64_tr_b16 v[28:29], v13 offset:35008
ds_read_b64_tr_b16 v[30:31], v13 offset:37568
ds_read_b64_tr_b16 v[32:33], v13 offset:35072
v_mfma_f32_32x32x16_bf16 v[112:127], v[52:55], a[40:43], v[112:127]
ds_read_b64_tr_b16 v[34:35], v13 offset:37632
buffer_load_dwordx4 a[24:27], v11, s[4:7], s60 offen offset:1024 sc1
v_mfma_f32_32x32x16_bf16 v[128:143], v[56:59], a[40:43], v[128:143]
s_waitcnt lgkmcnt(0)
s_waitcnt vmcnt(17)
v_mfma_f32_32x32x16_bf16 v[64:79], v[16:19], a[48:51], v[64:79]
ds_read_b64_tr_b16 v[40:41], v13 offset:39936
ds_read_b64_tr_b16 v[42:43], v13 offset:42496
ds_read_b64_tr_b16 v[44:45], v13 offset:40000
v_mfma_f32_32x32x16_bf16 v[80:95], v[20:23], a[48:51], v[80:95]
ds_read_b64_tr_b16 v[46:47], v13 offset:42560
ds_read_b64_tr_b16 v[48:49], v13 offset:40064
ds_read_b64_tr_b16 v[50:51], v13 offset:42624
v_mfma_f32_32x32x16_bf16 v[96:111], v[24:27], a[48:51], v[96:111]
ds_read_b64_tr_b16 v[52:53], v13 offset:40128
ds_read_b64_tr_b16 v[54:55], v13 offset:42688
ds_read_b64_tr_b16 v[56:57], v13 offset:40192
v_mfma_f32_32x32x16_bf16 v[112:127], v[28:31], a[48:51], v[112:127]
ds_read_b64_tr_b16 v[58:59], v13 offset:42752
buffer_load_dwordx4 a[32:35], v11, s[4:7], s60 offen offset:2048 sc1
v_mfma_f32_32x32x16_bf16 v[128:143], v[32:35], a[48:51], v[128:143]
s_waitcnt lgkmcnt(0)
s_waitcnt vmcnt(13)
s_barrier
s_waitcnt vmcnt(12)
v_mfma_f32_32x32x16_bf16 v[64:79], v[40:43], a[56:59], v[64:79]
ds_read_b64_tr_b16 v[16:17], v2 offset:0
ds_read_b64_tr_b16 v[18:19], v2 offset:2560
ds_read_b64_tr_b16 v[20:21], v2 offset:64
v_mfma_f32_32x32x16_bf16 v[80:95], v[44:47], a[56:59], v[80:95]
ds_read_b64_tr_b16 v[22:23], v2 offset:2624
ds_read_b64_tr_b16 v[24:25], v2 offset:128
ds_read_b64_tr_b16 v[26:27], v2 offset:2688
v_mfma_f32_32x32x16_bf16 v[96:111], v[48:51], a[56:59], v[96:111]
ds_read_b64_tr_b16 v[28:29], v2 offset:192
ds_read_b64_tr_b16 v[30:31], v2 offset:2752
ds_read_b64_tr_b16 v[32:33], v2 offset:256
v_mfma_f32_32x32x16_bf16 v[112:127], v[52:55], a[56:59], v[112:127]
ds_read_b64_tr_b16 v[34:35], v2 offset:2816
s_add_u32 s43, s56, 1146880
s_add_u32 m0, s62, 49152
s_nop 0
buffer_load_dwordx4 v4, s[8:11], s43 offen lds
s_add_u32 m0, s62, 50176
s_nop 0
buffer_load_dwordx4 v5, s[8:11], s43 offen lds
s_add_u32 m0, s62, 51200
s_nop 0
buffer_load_dwordx4 v6, s[8:11], s43 offen lds
s_add_u32 m0, s62, 52224
s_nop 0
buffer_load_dwordx4 v7, s[8:11], s43 offen lds
s_add_u32 m0, s62, 53248
s_nop 0
buffer_load_dwordx4 v8, s[8:11], s43 offen lds
buffer_load_dwordx4 a[40:43], v11, s[4:7], s60 offen offset:3072 sc1
v_mfma_f32_32x32x16_bf16 v[128:143], v[56:59], a[56:59], v[128:143]
s_waitcnt lgkmcnt(0)
s_waitcnt vmcnt(17)
v_mfma_f32_32x32x16_bf16 v[64:79], v[16:19], a[64:67], v[64:79]
s_add_u32 s61, s57, 57344
ds_read_b64_tr_b16 v[40:41], v2 offset:5120
ds_read_b64_tr_b16 v[42:43], v2 offset:7680
v_mfma_f32_32x32x16_bf16 v[80:95], v[20:23], a[64:67], v[80:95]
ds_read_b64_tr_b16 v[44:45], v2 offset:5184
ds_read_b64_tr_b16 v[46:47], v2 offset:7744
ds_read_b64_tr_b16 v[48:49], v2 offset:5248
v_mfma_f32_32x32x16_bf16 v[96:111], v[24:27], a[64:67], v[96:111]
ds_read_b64_tr_b16 v[50:51], v2 offset:7808
ds_read_b64_tr_b16 v[52:53], v2 offset:5312
ds_read_b64_tr_b16 v[54:55], v2 offset:7872
v_mfma_f32_32x32x16_bf16 v[112:127], v[28:31], a[64:67], v[112:127]
ds_read_b64_tr_b16 v[56:57], v2 offset:5376
ds_read_b64_tr_b16 v[58:59], v2 offset:7936
buffer_load_dwordx4 a[48:51], v11, s[4:7], s61 offen offset:0 sc1
v_mfma_f32_32x32x16_bf16 v[128:143], v[32:35], a[64:67], v[128:143]
s_waitcnt lgkmcnt(0)
s_waitcnt vmcnt(17)
v_mfma_f32_32x32x16_bf16 v[64:79], v[40:43], a[72:75], v[64:79]
ds_read_b64_tr_b16 v[16:17], v2 offset:10240
ds_read_b64_tr_b16 v[18:19], v2 offset:12800
ds_read_b64_tr_b16 v[20:21], v2 offset:10304
v_mfma_f32_32x32x16_bf16 v[80:95], v[44:47], a[72:75], v[80:95]
ds_read_b64_tr_b16 v[22:23], v2 offset:12864
ds_read_b64_tr_b16 v[24:25], v2 offset:10368
ds_read_b64_tr_b16 v[26:27], v2 offset:12928
v_mfma_f32_32x32x16_bf16 v[96:111], v[48:51], a[72:75], v[96:111]
ds_read_b64_tr_b16 v[28:29], v2 offset:10432
ds_read_b64_tr_b16 v[30:31], v2 offset:12992
ds_read_b64_tr_b16 v[32:33], v2 offset:10496
v_mfma_f32_32x32x16_bf16 v[112:127], v[52:55], a[72:75], v[112:127]
ds_read_b64_tr_b16 v[34:35], v2 offset:13056
buffer_load_dwordx4 a[56:59], v11, s[4:7], s61 offen offset:1024 sc1
v_mfma_f32_32x32x16_bf16 v[128:143], v[56:59], a[72:75], v[128:143]
s_waitcnt lgkmcnt(0)
s_waitcnt vmcnt(17)
v_mfma_f32_32x32x16_bf16 v[64:79], v[16:19], a[0:3], v[64:79]
ds_read_b64_tr_b16 v[40:41], v2 offset:15360
ds_read_b64_tr_b16 v[42:43], v2 offset:17920
ds_read_b64_tr_b16 v[44:45], v2 offset:15424
v_mfma_f32_32x32x16_bf16 v[80:95], v[20:23], a[0:3], v[80:95]
ds_read_b64_tr_b16 v[46:47], v2 offset:17984
ds_read_b64_tr_b16 v[48:49], v2 offset:15488
ds_read_b64_tr_b16 v[50:51], v2 offset:18048
v_mfma_f32_32x32x16_bf16 v[96:111], v[24:27], a[0:3], v[96:111]
ds_read_b64_tr_b16 v[52:53], v2 offset:15552
ds_read_b64_tr_b16 v[54:55], v2 offset:18112
ds_read_b64_tr_b16 v[56:57], v2 offset:15616
v_mfma_f32_32x32x16_bf16 v[112:127], v[28:31], a[0:3], v[112:127]
ds_read_b64_tr_b16 v[58:59], v2 offset:18176
buffer_load_dwordx4 a[64:67], v11, s[4:7], s61 offen offset:2048 sc1
v_mfma_f32_32x32x16_bf16 v[128:143], v[32:35], a[0:3], v[128:143]
s_waitcnt lgkmcnt(0)
s_waitcnt vmcnt(13)
s_barrier
s_waitcnt vmcnt(12)
v_mfma_f32_32x32x16_bf16 v[64:79], v[40:43], a[8:11], v[64:79]
ds_read_b64_tr_b16 v[16:17], v2 offset:24576
ds_read_b64_tr_b16 v[18:19], v2 offset:27136
ds_read_b64_tr_b16 v[20:21], v2 offset:24640
v_mfma_f32_32x32x16_bf16 v[80:95], v[44:47], a[8:11], v[80:95]
ds_read_b64_tr_b16 v[22:23], v2 offset:27200
ds_read_b64_tr_b16 v[24:25], v2 offset:24704
ds_read_b64_tr_b16 v[26:27], v2 offset:27264
v_mfma_f32_32x32x16_bf16 v[96:111], v[48:51], a[8:11], v[96:111]
ds_read_b64_tr_b16 v[28:29], v2 offset:24768
ds_read_b64_tr_b16 v[30:31], v2 offset:27328
ds_read_b64_tr_b16 v[32:33], v2 offset:24832
v_mfma_f32_32x32x16_bf16 v[112:127], v[52:55], a[8:11], v[112:127]
ds_read_b64_tr_b16 v[34:35], v2 offset:27392
s_add_u32 s43, s56, 1228800
s_add_u32 m0, s62, 73728
s_nop 0
buffer_load_dwordx4 v4, s[8:11], s43 offen lds
s_add_u32 m0, s62, 74752
s_nop 0
buffer_load_dwordx4 v5, s[8:11], s43 offen lds
s_add_u32 m0, s62, 75776
s_nop 0
buffer_load_dwordx4 v6, s[8:11], s43 offen lds
s_add_u32 m0, s62, 76800
s_nop 0
buffer_load_dwordx4 v7, s[8:11], s43 offen lds
s_add_u32 m0, s62, 77824
s_nop 0
buffer_load_dwordx4 v8, s[8:11], s43 offen lds
buffer_load_dwordx4 a[72:75], v11, s[4:7], s61 offen offset:3072 sc1
v_mfma_f32_32x32x16_bf16 v[128:143], v[56:59], a[8:11], v[128:143]
s_waitcnt lgkmcnt(0)
s_waitcnt vmcnt(17)
v_mfma_f32_32x32x16_bf16 v[64:79], v[16:19], a[16:19], v[64:79]
s_add_u32 s59, s57, 61440
ds_read_b64_tr_b16 v[40:41], v2 offset:29696
ds_read_b64_tr_b16 v[42:43], v2 offset:32256
v_mfma_f32_32x32x16_bf16 v[80:95], v[20:23], a[16:19], v[80:95]
ds_read_b64_tr_b16 v[44:45], v2 offset:29760
ds_read_b64_tr_b16 v[46:47], v2 offset:32320
ds_read_b64_tr_b16 v[48:49], v2 offset:29824
v_mfma_f32_32x32x16_bf16 v[96:111], v[24:27], a[16:19], v[96:111]
ds_read_b64_tr_b16 v[50:51], v2 offset:32384
ds_read_b64_tr_b16 v[52:53], v2 offset:29888
ds_read_b64_tr_b16 v[54:55], v2 offset:32448
v_mfma_f32_32x32x16_bf16 v[112:127], v[28:31], a[16:19], v[112:127]
ds_read_b64_tr_b16 v[56:57], v2 offset:29952
ds_read_b64_tr_b16 v[58:59], v2 offset:32512
buffer_load_dwordx4 a[0:3], v11, s[4:7], s59 offen offset:0 sc1
v_mfma_f32_32x32x16_bf16 v[128:143], v[32:35], a[16:19], v[128:143]
s_waitcnt lgkmcnt(0)
s_waitcnt vmcnt(17)
v_mfma_f32_32x32x16_bf16 v[64:79], v[40:43], a[24:27], v[64:79]
ds_read_b64_tr_b16 v[16:17], v2 offset:34816
ds_read_b64_tr_b16 v[18:19], v2 offset:37376
ds_read_b64_tr_b16 v[20:21], v2 offset:34880
v_mfma_f32_32x32x16_bf16 v[80:95], v[44:47], a[24:27], v[80:95]
ds_read_b64_tr_b16 v[22:23], v2 offset:37440
ds_read_b64_tr_b16 v[24:25], v2 offset:34944
ds_read_b64_tr_b16 v[26:27], v2 offset:37504
v_mfma_f32_32x32x16_bf16 v[96:111], v[48:51], a[24:27], v[96:111]
ds_read_b64_tr_b16 v[28:29], v2 offset:35008
ds_read_b64_tr_b16 v[30:31], v2 offset:37568
ds_read_b64_tr_b16 v[32:33], v2 offset:35072
v_mfma_f32_32x32x16_bf16 v[112:127], v[52:55], a[24:27], v[112:127]
ds_read_b64_tr_b16 v[34:35], v2 offset:37632
buffer_load_dwordx4 a[8:11], v11, s[4:7], s59 offen offset:1024 sc1
v_mfma_f32_32x32x16_bf16 v[128:143], v[56:59], a[24:27], v[128:143]
s_waitcnt lgkmcnt(0)
s_waitcnt vmcnt(17)
v_mfma_f32_32x32x16_bf16 v[64:79], v[16:19], a[32:35], v[64:79]
ds_read_b64_tr_b16 v[40:41], v2 offset:39936
ds_read_b64_tr_b16 v[42:43], v2 offset:42496
ds_read_b64_tr_b16 v[44:45], v2 offset:40000
v_mfma_f32_32x32x16_bf16 v[80:95], v[20:23], a[32:35], v[80:95]
ds_read_b64_tr_b16 v[46:47], v2 offset:42560
ds_read_b64_tr_b16 v[48:49], v2 offset:40064
ds_read_b64_tr_b16 v[50:51], v2 offset:42624
v_mfma_f32_32x32x16_bf16 v[96:111], v[24:27], a[32:35], v[96:111]
ds_read_b64_tr_b16 v[52:53], v2 offset:40128
ds_read_b64_tr_b16 v[54:55], v2 offset:42688
ds_read_b64_tr_b16 v[56:57], v2 offset:40192
v_mfma_f32_32x32x16_bf16 v[112:127], v[28:31], a[32:35], v[112:127]
ds_read_b64_tr_b16 v[58:59], v2 offset:42752
buffer_load_dwordx4 a[16:19], v11, s[4:7], s59 offen offset:2048 sc1
v_mfma_f32_32x32x16_bf16 v[128:143], v[32:35], a[32:35], v[128:143]
s_waitcnt lgkmcnt(0)
s_waitcnt vmcnt(13)
s_barrier
s_waitcnt vmcnt(12)
v_mfma_f32_32x32x16_bf16 v[64:79], v[40:43], a[40:43], v[64:79]
ds_read_b64_tr_b16 v[16:17], v13 offset:0
ds_read_b64_tr_b16 v[18:19], v13 offset:2560
ds_read_b64_tr_b16 v[20:21], v13 offset:64
v_mfma_f32_32x32x16_bf16 v[80:95], v[44:47], a[40:43], v[80:95]
ds_read_b64_tr_b16 v[22:23], v13 offset:2624
ds_read_b64_tr_b16 v[24:25], v13 offset:128
ds_read_b64_tr_b16 v[26:27], v13 offset:2688
v_mfma_f32_32x32x16_bf16 v[96:111], v[48:51], a[40:43], v[96:111]
ds_read_b64_tr_b16 v[28:29], v13 offset:192
ds_read_b64_tr_b16 v[30:31], v13 offset:2752
ds_read_b64_tr_b16 v[32:33], v13 offset:256
v_mfma_f32_32x32x16_bf16 v[112:127], v[52:55], a[40:43], v[112:127]
ds_read_b64_tr_b16 v[34:35], v13 offset:2816
s_add_u32 s43, s56, 1310720
s_add_u32 m0, s62, 0
s_nop 0
buffer_load_dwordx4 v4, s[8:11], s43 offen lds
s_add_u32 m0, s62, 1024
s_nop 0
buffer_load_dwordx4 v5, s[8:11], s43 offen lds
s_add_u32 m0, s62, 2048
s_nop 0
buffer_load_dwordx4 v6, s[8:11], s43 offen lds
s_add_u32 m0, s62, 3072
s_nop 0
buffer_load_dwordx4 v7, s[8:11], s43 offen lds
s_add_u32 m0, s62, 4096
s_nop 0
buffer_load_dwordx4 v8, s[8:11], s43 offen lds
buffer_load_dwordx4 a[24:27], v11, s[4:7], s59 offen offset:3072 sc1
v_mfma_f32_32x32x16_bf16 v[128:143], v[56:59], a[40:43], v[128:143]
s_waitcnt lgkmcnt(0)
s_waitcnt vmcnt(17)
v_mfma_f32_32x32x16_bf16 v[64:79], v[16:19], a[48:51], v[64:79]
s_add_u32 s60, s57, 65536
ds_read_b64_tr_b16 v[40:41], v13 offset:5120
ds_read_b64_tr_b16 v[42:43], v13 offset:7680
v_mfma_f32_32x32x16_bf16 v[80:95], v[20:23], a[48:51], v[80:95]
ds_read_b64_tr_b16 v[44:45], v13 offset:5184
ds_read_b64_tr_b16 v[46:47], v13 offset:7744
ds_read_b64_tr_b16 v[48:49], v13 offset:5248
v_mfma_f32_32x32x16_bf16 v[96:111], v[24:27], a[48:51], v[96:111]
ds_read_b64_tr_b16 v[50:51], v13 offset:7808
ds_read_b64_tr_b16 v[52:53], v13 offset:5312
ds_read_b64_tr_b16 v[54:55], v13 offset:7872
v_mfma_f32_32x32x16_bf16 v[112:127], v[28:31], a[48:51], v[112:127]
ds_read_b64_tr_b16 v[56:57], v13 offset:5376
ds_read_b64_tr_b16 v[58:59], v13 offset:7936
buffer_load_dwordx4 a[32:35], v11, s[4:7], s60 offen offset:0 sc1
v_mfma_f32_32x32x16_bf16 v[128:143], v[32:35], a[48:51], v[128:143]
s_waitcnt lgkmcnt(0)
s_waitcnt vmcnt(17)
v_mfma_f32_32x32x16_bf16 v[64:79], v[40:43], a[56:59], v[64:79]
ds_read_b64_tr_b16 v[16:17], v13 offset:10240
ds_read_b64_tr_b16 v[18:19], v13 offset:12800
ds_read_b64_tr_b16 v[20:21], v13 offset:10304
v_mfma_f32_32x32x16_bf16 v[80:95], v[44:47], a[56:59], v[80:95]
ds_read_b64_tr_b16 v[22:23], v13 offset:12864
ds_read_b64_tr_b16 v[24:25], v13 offset:10368
ds_read_b64_tr_b16 v[26:27], v13 offset:12928
v_mfma_f32_32x32x16_bf16 v[96:111], v[48:51], a[56:59], v[96:111]
ds_read_b64_tr_b16 v[28:29], v13 offset:10432
ds_read_b64_tr_b16 v[30:31], v13 offset:12992
ds_read_b64_tr_b16 v[32:33], v13 offset:10496
v_mfma_f32_32x32x16_bf16 v[112:127], v[52:55], a[56:59], v[112:127]
ds_read_b64_tr_b16 v[34:35], v13 offset:13056
buffer_load_dwordx4 a[40:43], v11, s[4:7], s60 offen offset:1024 sc1
v_mfma_f32_32x32x16_bf16 v[128:143], v[56:59], a[56:59], v[128:143]
s_waitcnt lgkmcnt(0)
s_waitcnt vmcnt(17)
v_mfma_f32_32x32x16_bf16 v[64:79], v[16:19], a[64:67], v[64:79]
ds_read_b64_tr_b16 v[40:41], v13 offset:15360
ds_read_b64_tr_b16 v[42:43], v13 offset:17920
ds_read_b64_tr_b16 v[44:45], v13 offset:15424
v_mfma_f32_32x32x16_bf16 v[80:95], v[20:23], a[64:67], v[80:95]
ds_read_b64_tr_b16 v[46:47], v13 offset:17984
ds_read_b64_tr_b16 v[48:49], v13 offset:15488
ds_read_b64_tr_b16 v[50:51], v13 offset:18048
v_mfma_f32_32x32x16_bf16 v[96:111], v[24:27], a[64:67], v[96:111]
ds_read_b64_tr_b16 v[52:53], v13 offset:15552
ds_read_b64_tr_b16 v[54:55], v13 offset:18112
ds_read_b64_tr_b16 v[56:57], v13 offset:15616
v_mfma_f32_32x32x16_bf16 v[112:127], v[28:31], a[64:67], v[112:127]
ds_read_b64_tr_b16 v[58:59], v13 offset:18176
buffer_load_dwordx4 a[48:51], v11, s[4:7], s60 offen offset:2048 sc1
v_mfma_f32_32x32x16_bf16 v[128:143], v[32:35], a[64:67], v[128:143]
s_waitcnt lgkmcnt(0)
s_waitcnt vmcnt(13)
s_barrier
s_waitcnt vmcnt(12)
v_mfma_f32_32x32x16_bf16 v[64:79], v[40:43], a[72:75], v[64:79]
ds_read_b64_tr_b16 v[16:17], v13 offset:24576
ds_read_b64_tr_b16 v[18:19], v13 offset:27136
ds_read_b64_tr_b16 v[20:21], v13 offset:24640
v_mfma_f32_32x32x16_bf16 v[80:95], v[44:47], a[72:75], v[80:95]
ds_read_b64_tr_b16 v[22:23], v13 offset:27200
ds_read_b64_tr_b16 v[24:25], v13 offset:24704
ds_read_b64_tr_b16 v[26:27], v13 offset:27264
v_mfma_f32_32x32x16_bf16 v[96:111], v[48:51], a[72:75], v[96:111]
ds_read_b64_tr_b16 v[28:29], v13 offset:24768
ds_read_b64_tr_b16 v[30:31], v13 offset:27328
ds_read_b64_tr_b16 v[32:33], v13 offset:24832
v_mfma_f32_32x32x16_bf16 v[112:127], v[52:55], a[72:75], v[112:127]
ds_read_b64_tr_b16 v[34:35], v13 offset:27392
s_add_u32 s43, s56, 1392640
s_add_u32 m0, s62, 24576
s_nop 0
buffer_load_dwordx4 v4, s[8:11], s43 offen lds
s_add_u32 m0, s62, 25600
s_nop 0
buffer_load_dwordx4 v5, s[8:11], s43 offen lds
s_add_u32 m0, s62, 26624
s_nop 0
buffer_load_dwordx4 v6, s[8:11], s43 offen lds
s_add_u32 m0, s62, 27648
s_nop 0
buffer_load_dwordx4 v7, s[8:11], s43 offen lds
s_add_u32 m0, s62, 28672
s_nop 0
buffer_load_dwordx4 v8, s[8:11], s43 offen lds
buffer_load_dwordx4 a[56:59], v11, s[4:7], s60 offen offset:3072 sc1
v_mfma_f32_32x32x16_bf16 v[128:143], v[56:59], a[72:75], v[128:143]
s_waitcnt lgkmcnt(0)
s_waitcnt vmcnt(17)
v_mfma_f32_32x32x16_bf16 v[64:79], v[16:19], a[0:3], v[64:79]
s_add_u32 s61, s57, 69632
ds_read_b64_tr_b16 v[40:41], v13 offset:29696
ds_read_b64_tr_b16 v[42:43], v13 offset:32256
v_mfma_f32_32x32x16_bf16 v[80:95], v[20:23], a[0:3], v[80:95]
ds_read_b64_tr_b16 v[44:45], v13 offset:29760
ds_read_b64_tr_b16 v[46:47], v13 offset:32320
ds_read_b64_tr_b16 v[48:49], v13 offset:29824
v_mfma_f32_32x32x16_bf16 v[96:111], v[24:27], a[0:3], v[96:111]
ds_read_b64_tr_b16 v[50:51], v13 offset:32384
ds_read_b64_tr_b16 v[52:53], v13 offset:29888
ds_read_b64_tr_b16 v[54:55], v13 offset:32448
v_mfma_f32_32x32x16_bf16 v[112:127], v[28:31], a[0:3], v[112:127]
ds_read_b64_tr_b16 v[56:57], v13 offset:29952
ds_read_b64_tr_b16 v[58:59], v13 offset:32512
buffer_load_dwordx4 a[64:67], v11, s[4:7], s61 offen offset:0 sc1
v_mfma_f32_32x32x16_bf16 v[128:143], v[32:35], a[0:3], v[128:143]
s_waitcnt lgkmcnt(0)
s_waitcnt vmcnt(17)
v_mfma_f32_32x32x16_bf16 v[64:79], v[40:43], a[8:11], v[64:79]
ds_read_b64_tr_b16 v[16:17], v13 offset:34816
ds_read_b64_tr_b16 v[18:19], v13 offset:37376
ds_read_b64_tr_b16 v[20:21], v13 offset:34880
v_mfma_f32_32x32x16_bf16 v[80:95], v[44:47], a[8:11], v[80:95]
ds_read_b64_tr_b16 v[22:23], v13 offset:37440
ds_read_b64_tr_b16 v[24:25], v13 offset:34944
ds_read_b64_tr_b16 v[26:27], v13 offset:37504
v_mfma_f32_32x32x16_bf16 v[96:111], v[48:51], a[8:11], v[96:111]
ds_read_b64_tr_b16 v[28:29], v13 offset:35008
ds_read_b64_tr_b16 v[30:31], v13 offset:37568
ds_read_b64_tr_b16 v[32:33], v13 offset:35072
v_mfma_f32_32x32x16_bf16 v[112:127], v[52:55], a[8:11], v[112:127]
ds_read_b64_tr_b16 v[34:35], v13 offset:37632
buffer_load_dwordx4 a[72:75], v11, s[4:7], s61 offen offset:1024 sc1
v_mfma_f32_32x32x16_bf16 v[128:143], v[56:59], a[8:11], v[128:143]
s_waitcnt lgkmcnt(0)
s_waitcnt vmcnt(17)
v_mfma_f32_32x32x16_bf16 v[64:79], v[16:19], a[16:19], v[64:79]
ds_read_b64_tr_b16 v[40:41], v13 offset:39936
ds_read_b64_tr_b16 v[42:43], v13 offset:42496
ds_read_b64_tr_b16 v[44:45], v13 offset:40000
v_mfma_f32_32x32x16_bf16 v[80:95], v[20:23], a[16:19], v[80:95]
ds_read_b64_tr_b16 v[46:47], v13 offset:42560
ds_read_b64_tr_b16 v[48:49], v13 offset:40064
ds_read_b64_tr_b16 v[50:51], v13 offset:42624
v_mfma_f32_32x32x16_bf16 v[96:111], v[24:27], a[16:19], v[96:111]
ds_read_b64_tr_b16 v[52:53], v13 offset:40128
ds_read_b64_tr_b16 v[54:55], v13 offset:42688
ds_read_b64_tr_b16 v[56:57], v13 offset:40192
v_mfma_f32_32x32x16_bf16 v[112:127], v[28:31], a[16:19], v[112:127]
ds_read_b64_tr_b16 v[58:59], v13 offset:42752
buffer_load_dwordx4 a[0:3], v11, s[4:7], s61 offen offset:2048 sc1
v_mfma_f32_32x32x16_bf16 v[128:143], v[32:35], a[16:19], v[128:143]
s_waitcnt lgkmcnt(0)
s_waitcnt vmcnt(13)
s_barrier
s_waitcnt vmcnt(12)
v_mfma_f32_32x32x16_bf16 v[64:79], v[40:43], a[24:27], v[64:79]
ds_read_b64_tr_b16 v[16:17], v2 offset:0
ds_read_b64_tr_b16 v[18:19], v2 offset:2560
ds_read_b64_tr_b16 v[20:21], v2 offset:64
v_mfma_f32_32x32x16_bf16 v[80:95], v[44:47], a[24:27], v[80:95]
ds_read_b64_tr_b16 v[22:23], v2 offset:2624
ds_read_b64_tr_b16 v[24:25], v2 offset:128
ds_read_b64_tr_b16 v[26:27], v2 offset:2688
v_mfma_f32_32x32x16_bf16 v[96:111], v[48:51], a[24:27], v[96:111]
ds_read_b64_tr_b16 v[28:29], v2 offset:192
ds_read_b64_tr_b16 v[30:31], v2 offset:2752
ds_read_b64_tr_b16 v[32:33], v2 offset:256
v_mfma_f32_32x32x16_bf16 v[112:127], v[52:55], a[24:27], v[112:127]
ds_read_b64_tr_b16 v[34:35], v2 offset:2816
s_add_u32 s43, s56, 1474560
s_add_u32 m0, s62, 49152
s_nop 0
buffer_load_dwordx4 v4, s[8:11], s43 offen lds
s_add_u32 m0, s62, 50176
s_nop 0
buffer_load_dwordx4 v5, s[8:11], s43 offen lds
s_add_u32 m0, s62, 51200
s_nop 0
buffer_load_dwordx4 v6, s[8:11], s43 offen lds
s_add_u32 m0, s62, 52224
s_nop 0
buffer_load_dwordx4 v7, s[8:11], s43 offen lds
s_add_u32 m0, s62, 53248
s_nop 0
buffer_load_dwordx4 v8, s[8:11], s43 offen lds
buffer_load_dwordx4 a[8:11], v11, s[4:7], s61 offen offset:3072 sc1
v_mfma_f32_32x32x16_bf16 v[128:143], v[56:59], a[24:27], v[128:143]
s_waitcnt lgkmcnt(0)
s_waitcnt vmcnt(17)
v_mfma_f32_32x32x16_bf16 v[64:79], v[16:19], a[32:35], v[64:79]
s_add_u32 s59, s57, 73728
ds_read_b64_tr_b16 v[40:41], v2 offset:5120
ds_read_b64_tr_b16 v[42:43], v2 offset:7680
v_mfma_f32_32x32x16_bf16 v[80:95], v[20:23], a[32:35], v[80:95]
ds_read_b64_tr_b16 v[44:45], v2 offset:5184
ds_read_b64_tr_b16 v[46:47], v2 offset:7744
ds_read_b64_tr_b16 v[48:49], v2 offset:5248
v_mfma_f32_32x32x16_bf16 v[96:111], v[24:27], a[32:35], v[96:111]
ds_read_b64_tr_b16 v[50:51], v2 offset:7808
ds_read_b64_tr_b16 v[52:53], v2 offset:5312
ds_read_b64_tr_b16 v[54:55], v2 offset:7872
v_mfma_f32_32x32x16_bf16 v[112:127], v[28:31], a[32:35], v[112:127]
ds_read_b64_tr_b16 v[56:57], v2 offset:5376
ds_read_b64_tr_b16 v[58:59], v2 offset:7936
buffer_load_dwordx4 a[16:19], v11, s[4:7], s59 offen offset:0 sc1
v_mfma_f32_32x32x16_bf16 v[128:143], v[32:35], a[32:35], v[128:143]
s_waitcnt lgkmcnt(0)
s_waitcnt vmcnt(17)
v_mfma_f32_32x32x16_bf16 v[64:79], v[40:43], a[40:43], v[64:79]
ds_read_b64_tr_b16 v[16:17], v2 offset:10240
ds_read_b64_tr_b16 v[18:19], v2 offset:12800
ds_read_b64_tr_b16 v[20:21], v2 offset:10304
v_mfma_f32_32x32x16_bf16 v[80:95], v[44:47], a[40:43], v[80:95]
ds_read_b64_tr_b16 v[22:23], v2 offset:12864
ds_read_b64_tr_b16 v[24:25], v2 offset:10368
ds_read_b64_tr_b16 v[26:27], v2 offset:12928
v_mfma_f32_32x32x16_bf16 v[96:111], v[48:51], a[40:43], v[96:111]
ds_read_b64_tr_b16 v[28:29], v2 offset:10432
ds_read_b64_tr_b16 v[30:31], v2 offset:12992
ds_read_b64_tr_b16 v[32:33], v2 offset:10496
v_mfma_f32_32x32x16_bf16 v[112:127], v[52:55], a[40:43], v[112:127]
ds_read_b64_tr_b16 v[34:35], v2 offset:13056
buffer_load_dwordx4 a[24:27], v11, s[4:7], s59 offen offset:1024 sc1
v_mfma_f32_32x32x16_bf16 v[128:143], v[56:59], a[40:43], v[128:143]
s_waitcnt lgkmcnt(0)
s_waitcnt vmcnt(17)
v_mfma_f32_32x32x16_bf16 v[64:79], v[16:19], a[48:51], v[64:79]
ds_read_b64_tr_b16 v[40:41], v2 offset:15360
ds_read_b64_tr_b16 v[42:43], v2 offset:17920
ds_read_b64_tr_b16 v[44:45], v2 offset:15424
v_mfma_f32_32x32x16_bf16 v[80:95], v[20:23], a[48:51], v[80:95]
ds_read_b64_tr_b16 v[46:47], v2 offset:17984
ds_read_b64_tr_b16 v[48:49], v2 offset:15488
ds_read_b64_tr_b16 v[50:51], v2 offset:18048
v_mfma_f32_32x32x16_bf16 v[96:111], v[24:27], a[48:51], v[96:111]
ds_read_b64_tr_b16 v[52:53], v2 offset:15552
ds_read_b64_tr_b16 v[54:55], v2 offset:18112
ds_read_b64_tr_b16 v[56:57], v2 offset:15616
v_mfma_f32_32x32x16_bf16 v[112:127], v[28:31], a[48:51], v[112:127]
ds_read_b64_tr_b16 v[58:59], v2 offset:18176
buffer_load_dwordx4 a[32:35], v11, s[4:7], s59 offen offset:2048 sc1
v_mfma_f32_32x32x16_bf16 v[128:143], v[32:35], a[48:51], v[128:143]
s_waitcnt lgkmcnt(0)
s_waitcnt vmcnt(13)
s_barrier
s_waitcnt vmcnt(12)
v_mfma_f32_32x32x16_bf16 v[64:79], v[40:43], a[56:59], v[64:79]
ds_read_b64_tr_b16 v[16:17], v2 offset:24576
ds_read_b64_tr_b16 v[18:19], v2 offset:27136
ds_read_b64_tr_b16 v[20:21], v2 offset:24640
v_mfma_f32_32x32x16_bf16 v[80:95], v[44:47], a[56:59], v[80:95]
ds_read_b64_tr_b16 v[22:23], v2 offset:27200
ds_read_b64_tr_b16 v[24:25], v2 offset:24704
ds_read_b64_tr_b16 v[26:27], v2 offset:27264
v_mfma_f32_32x32x16_bf16 v[96:111], v[48:51], a[56:59], v[96:111]
ds_read_b64_tr_b16 v[28:29], v2 offset:24768
ds_read_b64_tr_b16 v[30:31], v2 offset:27328
ds_read_b64_tr_b16 v[32:33], v2 offset:24832
v_mfma_f32_32x32x16_bf16 v[112:127], v[52:55], a[56:59], v[112:127]
ds_read_b64_tr_b16 v[34:35], v2 offset:27392
s_add_u32 s43, s56, 1556480
s_add_u32 m0, s62, 73728
s_nop 0
buffer_load_dwordx4 v4, s[8:11], s43 offen lds
s_add_u32 m0, s62, 74752
s_nop 0
buffer_load_dwordx4 v5, s[8:11], s43 offen lds
s_add_u32 m0, s62, 75776
s_nop 0
buffer_load_dwordx4 v6, s[8:11], s43 offen lds
s_add_u32 m0, s62, 76800
s_nop 0
buffer_load_dwordx4 v7, s[8:11], s43 offen lds
s_add_u32 m0, s62, 77824
s_nop 0
buffer_load_dwordx4 v8, s[8:11], s43 offen lds
buffer_load_dwordx4 a[40:43], v11, s[4:7], s59 offen offset:3072 sc1
v_mfma_f32_32x32x16_bf16 v[128:143], v[56:59], a[56:59], v[128:143]
s_waitcnt lgkmcnt(0)
s_waitcnt vmcnt(17)
v_mfma_f32_32x32x16_bf16 v[64:79], v[16:19], a[64:67], v[64:79]
s_add_u32 s60, s57, 77824
ds_read_b64_tr_b16 v[40:41], v2 offset:29696
ds_read_b64_tr_b16 v[42:43], v2 offset:32256
v_mfma_f32_32x32x16_bf16 v[80:95], v[20:23], a[64:67], v[80:95]
ds_read_b64_tr_b16 v[44:45], v2 offset:29760
ds_read_b64_tr_b16 v[46:47], v2 offset:32320
ds_read_b64_tr_b16 v[48:49], v2 offset:29824
v_mfma_f32_32x32x16_bf16 v[96:111], v[24:27], a[64:67], v[96:111]
ds_read_b64_tr_b16 v[50:51], v2 offset:32384
ds_read_b64_tr_b16 v[52:53], v2 offset:29888
ds_read_b64_tr_b16 v[54:55], v2 offset:32448
v_mfma_f32_32x32x16_bf16 v[112:127], v[28:31], a[64:67], v[112:127]
ds_read_b64_tr_b16 v[56:57], v2 offset:29952
ds_read_b64_tr_b16 v[58:59], v2 offset:32512
buffer_load_dwordx4 a[48:51], v11, s[4:7], s60 offen offset:0 sc1
v_mfma_f32_32x32x16_bf16 v[128:143], v[32:35], a[64:67], v[128:143]
s_waitcnt lgkmcnt(0)
s_waitcnt vmcnt(17)
v_mfma_f32_32x32x16_bf16 v[64:79], v[40:43], a[72:75], v[64:79]
ds_read_b64_tr_b16 v[16:17], v2 offset:34816
ds_read_b64_tr_b16 v[18:19], v2 offset:37376
ds_read_b64_tr_b16 v[20:21], v2 offset:34880
v_mfma_f32_32x32x16_bf16 v[80:95], v[44:47], a[72:75], v[80:95]
ds_read_b64_tr_b16 v[22:23], v2 offset:37440
ds_read_b64_tr_b16 v[24:25], v2 offset:34944
ds_read_b64_tr_b16 v[26:27], v2 offset:37504
v_mfma_f32_32x32x16_bf16 v[96:111], v[48:51], a[72:75], v[96:111]
ds_read_b64_tr_b16 v[28:29], v2 offset:35008
ds_read_b64_tr_b16 v[30:31], v2 offset:37568
ds_read_b64_tr_b16 v[32:33], v2 offset:35072
v_mfma_f32_32x32x16_bf16 v[112:127], v[52:55], a[72:75], v[112:127]
ds_read_b64_tr_b16 v[34:35], v2 offset:37632
buffer_load_dwordx4 a[56:59], v11, s[4:7], s60 offen offset:1024 sc1
v_mfma_f32_32x32x16_bf16 v[128:143], v[56:59], a[72:75], v[128:143]
s_waitcnt lgkmcnt(0)
s_waitcnt vmcnt(17)
v_mfma_f32_32x32x16_bf16 v[64:79], v[16:19], a[0:3], v[64:79]
ds_read_b64_tr_b16 v[40:41], v2 offset:39936
ds_read_b64_tr_b16 v[42:43], v2 offset:42496
ds_read_b64_tr_b16 v[44:45], v2 offset:40000
v_mfma_f32_32x32x16_bf16 v[80:95], v[20:23], a[0:3], v[80:95]
ds_read_b64_tr_b16 v[46:47], v2 offset:42560
ds_read_b64_tr_b16 v[48:49], v2 offset:40064
ds_read_b64_tr_b16 v[50:51], v2 offset:42624
v_mfma_f32_32x32x16_bf16 v[96:111], v[24:27], a[0:3], v[96:111]
ds_read_b64_tr_b16 v[52:53], v2 offset:40128
ds_read_b64_tr_b16 v[54:55], v2 offset:42688
ds_read_b64_tr_b16 v[56:57], v2 offset:40192
v_mfma_f32_32x32x16_bf16 v[112:127], v[28:31], a[0:3], v[112:127]
ds_read_b64_tr_b16 v[58:59], v2 offset:42752
buffer_load_dwordx4 a[64:67], v11, s[4:7], s60 offen offset:2048 sc1
v_mfma_f32_32x32x16_bf16 v[128:143], v[32:35], a[0:3], v[128:143]
s_waitcnt lgkmcnt(0)
s_waitcnt vmcnt(13)
s_barrier
s_waitcnt vmcnt(12)
v_mfma_f32_32x32x16_bf16 v[64:79], v[40:43], a[8:11], v[64:79]
ds_read_b64_tr_b16 v[16:17], v13 offset:0
ds_read_b64_tr_b16 v[18:19], v13 offset:2560
ds_read_b64_tr_b16 v[20:21], v13 offset:64
v_mfma_f32_32x32x16_bf16 v[80:95], v[44:47], a[8:11], v[80:95]
ds_read_b64_tr_b16 v[22:23], v13 offset:2624
ds_read_b64_tr_b16 v[24:25], v13 offset:128
ds_read_b64_tr_b16 v[26:27], v13 offset:2688
v_mfma_f32_32x32x16_bf16 v[96:111], v[48:51], a[8:11], v[96:111]
ds_read_b64_tr_b16 v[28:29], v13 offset:192
ds_read_b64_tr_b16 v[30:31], v13 offset:2752
ds_read_b64_tr_b16 v[32:33], v13 offset:256
v_mfma_f32_32x32x16_bf16 v[112:127], v[52:55], a[8:11], v[112:127]
ds_read_b64_tr_b16 v[34:35], v13 offset:2816
s_add_u32 s43, s56, 1638400
s_add_u32 m0, s62, 0
s_nop 0
buffer_load_dwordx4 v4, s[8:11], s43 offen lds
s_add_u32 m0, s62, 1024
s_nop 0
buffer_load_dwordx4 v5, s[8:11], s43 offen lds
s_add_u32 m0, s62, 2048
s_nop 0
buffer_load_dwordx4 v6, s[8:11], s43 offen lds
s_add_u32 m0, s62, 3072
s_nop 0
buffer_load_dwordx4 v7, s[8:11], s43 offen lds
s_add_u32 m0, s62, 4096
s_nop 0
buffer_load_dwordx4 v8, s[8:11], s43 offen lds
buffer_load_dwordx4 a[72:75], v11, s[4:7], s60 offen offset:3072 sc1
v_mfma_f32_32x32x16_bf16 v[128:143], v[56:59], a[8:11], v[128:143]
s_waitcnt lgkmcnt(0)
s_waitcnt vmcnt(17)
v_mfma_f32_32x32x16_bf16 v[64:79], v[16:19], a[16:19], v[64:79]
s_add_u32 s61, s57, 81920
ds_read_b64_tr_b16 v[40:41], v13 offset:5120
ds_read_b64_tr_b16 v[42:43], v13 offset:7680
v_mfma_f32_32x32x16_bf16 v[80:95], v[20:23], a[16:19], v[80:95]
ds_read_b64_tr_b16 v[44:45], v13 offset:5184
ds_read_b64_tr_b16 v[46:47], v13 offset:7744
ds_read_b64_tr_b16 v[48:49], v13 offset:5248
v_mfma_f32_32x32x16_bf16 v[96:111], v[24:27], a[16:19], v[96:111]
ds_read_b64_tr_b16 v[50:51], v13 offset:7808
ds_read_b64_tr_b16 v[52:53], v13 offset:5312
ds_read_b64_tr_b16 v[54:55], v13 offset:7872
v_mfma_f32_32x32x16_bf16 v[112:127], v[28:31], a[16:19], v[112:127]
ds_read_b64_tr_b16 v[56:57], v13 offset:5376
ds_read_b64_tr_b16 v[58:59], v13 offset:7936
buffer_load_dwordx4 a[0:3], v11, s[4:7], s61 offen offset:0 sc1
v_mfma_f32_32x32x16_bf16 v[128:143], v[32:35], a[16:19], v[128:143]
s_waitcnt lgkmcnt(0)
s_waitcnt vmcnt(17)
v_mfma_f32_32x32x16_bf16 v[64:79], v[40:43], a[24:27], v[64:79]
ds_read_b64_tr_b16 v[16:17], v13 offset:10240
ds_read_b64_tr_b16 v[18:19], v13 offset:12800
ds_read_b64_tr_b16 v[20:21], v13 offset:10304
v_mfma_f32_32x32x16_bf16 v[80:95], v[44:47], a[24:27], v[80:95]
ds_read_b64_tr_b16 v[22:23], v13 offset:12864
ds_read_b64_tr_b16 v[24:25], v13 offset:10368
ds_read_b64_tr_b16 v[26:27], v13 offset:12928
v_mfma_f32_32x32x16_bf16 v[96:111], v[48:51], a[24:27], v[96:111]
ds_read_b64_tr_b16 v[28:29], v13 offset:10432
ds_read_b64_tr_b16 v[30:31], v13 offset:12992
ds_read_b64_tr_b16 v[32:33], v13 offset:10496
v_mfma_f32_32x32x16_bf16 v[112:127], v[52:55], a[24:27], v[112:127]
ds_read_b64_tr_b16 v[34:35], v13 offset:13056
buffer_load_dwordx4 a[8:11], v11, s[4:7], s61 offen offset:1024 sc1
v_mfma_f32_32x32x16_bf16 v[128:143], v[56:59], a[24:27], v[128:143]
s_waitcnt lgkmcnt(0)
s_waitcnt vmcnt(17)
v_mfma_f32_32x32x16_bf16 v[64:79], v[16:19], a[32:35], v[64:79]
ds_read_b64_tr_b16 v[40:41], v13 offset:15360
ds_read_b64_tr_b16 v[42:43], v13 offset:17920
ds_read_b64_tr_b16 v[44:45], v13 offset:15424
v_mfma_f32_32x32x16_bf16 v[80:95], v[20:23], a[32:35], v[80:95]
ds_read_b64_tr_b16 v[46:47], v13 offset:17984
ds_read_b64_tr_b16 v[48:49], v13 offset:15488
ds_read_b64_tr_b16 v[50:51], v13 offset:18048
v_mfma_f32_32x32x16_bf16 v[96:111], v[24:27], a[32:35], v[96:111]
ds_read_b64_tr_b16 v[52:53], v13 offset:15552
ds_read_b64_tr_b16 v[54:55], v13 offset:18112
ds_read_b64_tr_b16 v[56:57], v13 offset:15616
v_mfma_f32_32x32x16_bf16 v[112:127], v[28:31], a[32:35], v[112:127]
ds_read_b64_tr_b16 v[58:59], v13 offset:18176
buffer_load_dwordx4 a[16:19], v11, s[4:7], s61 offen offset:2048 sc1
v_mfma_f32_32x32x16_bf16 v[128:143], v[32:35], a[32:35], v[128:143]
s_waitcnt lgkmcnt(0)
s_waitcnt vmcnt(13)
s_barrier
s_waitcnt vmcnt(12)
v_mfma_f32_32x32x16_bf16 v[64:79], v[40:43], a[40:43], v[64:79]
ds_read_b64_tr_b16 v[16:17], v13 offset:24576
ds_read_b64_tr_b16 v[18:19], v13 offset:27136
ds_read_b64_tr_b16 v[20:21], v13 offset:24640
v_mfma_f32_32x32x16_bf16 v[80:95], v[44:47], a[40:43], v[80:95]
ds_read_b64_tr_b16 v[22:23], v13 offset:27200
ds_read_b64_tr_b16 v[24:25], v13 offset:24704
ds_read_b64_tr_b16 v[26:27], v13 offset:27264
v_mfma_f32_32x32x16_bf16 v[96:111], v[48:51], a[40:43], v[96:111]
ds_read_b64_tr_b16 v[28:29], v13 offset:24768
ds_read_b64_tr_b16 v[30:31], v13 offset:27328
ds_read_b64_tr_b16 v[32:33], v13 offset:24832
v_mfma_f32_32x32x16_bf16 v[112:127], v[52:55], a[40:43], v[112:127]
ds_read_b64_tr_b16 v[34:35], v13 offset:27392
s_add_u32 s43, s56, 1720320
s_add_u32 m0, s62, 24576
s_nop 0
buffer_load_dwordx4 v4, s[8:11], s43 offen lds
s_add_u32 m0, s62, 25600
s_nop 0
buffer_load_dwordx4 v5, s[8:11], s43 offen lds
s_add_u32 m0, s62, 26624
s_nop 0
buffer_load_dwordx4 v6, s[8:11], s43 offen lds
s_add_u32 m0, s62, 27648
s_nop 0
buffer_load_dwordx4 v7, s[8:11], s43 offen lds
s_add_u32 m0, s62, 28672
s_nop 0
buffer_load_dwordx4 v8, s[8:11], s43 offen lds
buffer_load_dwordx4 a[24:27], v11, s[4:7], s61 offen offset:3072 sc1
v_mfma_f32_32x32x16_bf16 v[128:143], v[56:59], a[40:43], v[128:143]
s_waitcnt lgkmcnt(0)
s_waitcnt vmcnt(17)
v_mfma_f32_32x32x16_bf16 v[64:79], v[16:19], a[48:51], v[64:79]
s_add_u32 s59, s57, 86016
ds_read_b64_tr_b16 v[40:41], v13 offset:29696
ds_read_b64_tr_b16 v[42:43], v13 offset:32256
v_mfma_f32_32x32x16_bf16 v[80:95], v[20:23], a[48:51], v[80:95]
ds_read_b64_tr_b16 v[44:45], v13 offset:29760
ds_read_b64_tr_b16 v[46:47], v13 offset:32320
ds_read_b64_tr_b16 v[48:49], v13 offset:29824
v_mfma_f32_32x32x16_bf16 v[96:111], v[24:27], a[48:51], v[96:111]
ds_read_b64_tr_b16 v[50:51], v13 offset:32384
ds_read_b64_tr_b16 v[52:53], v13 offset:29888
ds_read_b64_tr_b16 v[54:55], v13 offset:32448
v_mfma_f32_32x32x16_bf16 v[112:127], v[28:31], a[48:51], v[112:127]
ds_read_b64_tr_b16 v[56:57], v13 offset:29952
ds_read_b64_tr_b16 v[58:59], v13 offset:32512
buffer_load_dwordx4 a[32:35], v11, s[4:7], s59 offen offset:0 sc1
v_mfma_f32_32x32x16_bf16 v[128:143], v[32:35], a[48:51], v[128:143]
s_waitcnt lgkmcnt(0)
s_waitcnt vmcnt(17)
v_mfma_f32_32x32x16_bf16 v[64:79], v[40:43], a[56:59], v[64:79]
ds_read_b64_tr_b16 v[16:17], v13 offset:34816
ds_read_b64_tr_b16 v[18:19], v13 offset:37376
ds_read_b64_tr_b16 v[20:21], v13 offset:34880
v_mfma_f32_32x32x16_bf16 v[80:95], v[44:47], a[56:59], v[80:95]
ds_read_b64_tr_b16 v[22:23], v13 offset:37440
ds_read_b64_tr_b16 v[24:25], v13 offset:34944
ds_read_b64_tr_b16 v[26:27], v13 offset:37504
v_mfma_f32_32x32x16_bf16 v[96:111], v[48:51], a[56:59], v[96:111]
ds_read_b64_tr_b16 v[28:29], v13 offset:35008
ds_read_b64_tr_b16 v[30:31], v13 offset:37568
ds_read_b64_tr_b16 v[32:33], v13 offset:35072
v_mfma_f32_32x32x16_bf16 v[112:127], v[52:55], a[56:59], v[112:127]
ds_read_b64_tr_b16 v[34:35], v13 offset:37632
buffer_load_dwordx4 a[40:43], v11, s[4:7], s59 offen offset:1024 sc1
v_mfma_f32_32x32x16_bf16 v[128:143], v[56:59], a[56:59], v[128:143]
s_waitcnt lgkmcnt(0)
s_waitcnt vmcnt(17)
v_mfma_f32_32x32x16_bf16 v[64:79], v[16:19], a[64:67], v[64:79]
ds_read_b64_tr_b16 v[40:41], v13 offset:39936
ds_read_b64_tr_b16 v[42:43], v13 offset:42496
ds_read_b64_tr_b16 v[44:45], v13 offset:40000
v_mfma_f32_32x32x16_bf16 v[80:95], v[20:23], a[64:67], v[80:95]
ds_read_b64_tr_b16 v[46:47], v13 offset:42560
ds_read_b64_tr_b16 v[48:49], v13 offset:40064
ds_read_b64_tr_b16 v[50:51], v13 offset:42624
v_mfma_f32_32x32x16_bf16 v[96:111], v[24:27], a[64:67], v[96:111]
ds_read_b64_tr_b16 v[52:53], v13 offset:40128
ds_read_b64_tr_b16 v[54:55], v13 offset:42688
ds_read_b64_tr_b16 v[56:57], v13 offset:40192
v_mfma_f32_32x32x16_bf16 v[112:127], v[28:31], a[64:67], v[112:127]
ds_read_b64_tr_b16 v[58:59], v13 offset:42752
buffer_load_dwordx4 a[48:51], v11, s[4:7], s59 offen offset:2048 sc1
v_mfma_f32_32x32x16_bf16 v[128:143], v[32:35], a[64:67], v[128:143]
s_waitcnt lgkmcnt(0)
s_waitcnt vmcnt(13)
s_barrier
s_waitcnt vmcnt(12)
v_mfma_f32_32x32x16_bf16 v[64:79], v[40:43], a[72:75], v[64:79]
ds_read_b64_tr_b16 v[16:17], v2 offset:0
ds_read_b64_tr_b16 v[18:19], v2 offset:2560
ds_read_b64_tr_b16 v[20:21], v2 offset:64
v_mfma_f32_32x32x16_bf16 v[80:95], v[44:47], a[72:75], v[80:95]
ds_read_b64_tr_b16 v[22:23], v2 offset:2624
ds_read_b64_tr_b16 v[24:25], v2 offset:128
ds_read_b64_tr_b16 v[26:27], v2 offset:2688
v_mfma_f32_32x32x16_bf16 v[96:111], v[48:51], a[72:75], v[96:111]
ds_read_b64_tr_b16 v[28:29], v2 offset:192
ds_read_b64_tr_b16 v[30:31], v2 offset:2752
ds_read_b64_tr_b16 v[32:33], v2 offset:256
v_mfma_f32_32x32x16_bf16 v[112:127], v[52:55], a[72:75], v[112:127]
ds_read_b64_tr_b16 v[34:35], v2 offset:2816
s_add_u32 s43, s56, 1802240
s_add_u32 m0, s62, 49152
s_nop 0
buffer_load_dwordx4 v4, s[8:11], s43 offen lds
s_add_u32 m0, s62, 50176
s_nop 0
buffer_load_dwordx4 v5, s[8:11], s43 offen lds
s_add_u32 m0, s62, 51200
s_nop 0
buffer_load_dwordx4 v6, s[8:11], s43 offen lds
s_add_u32 m0, s62, 52224
s_nop 0
buffer_load_dwordx4 v7, s[8:11], s43 offen lds
s_add_u32 m0, s62, 53248
s_nop 0
buffer_load_dwordx4 v8, s[8:11], s43 offen lds
buffer_load_dwordx4 a[56:59], v11, s[4:7], s59 offen offset:3072 sc1
v_mfma_f32_32x32x16_bf16 v[128:143], v[56:59], a[72:75], v[128:143]
s_waitcnt lgkmcnt(0)
s_waitcnt vmcnt(17)
v_mfma_f32_32x32x16_bf16 v[64:79], v[16:19], a[0:3], v[64:79]
s_add_u32 s60, s57, 90112
ds_read_b64_tr_b16 v[40:41], v2 offset:5120
ds_read_b64_tr_b16 v[42:43], v2 offset:7680
v_mfma_f32_32x32x16_bf16 v[80:95], v[20:23], a[0:3], v[80:95]
ds_read_b64_tr_b16 v[44:45], v2 offset:5184
ds_read_b64_tr_b16 v[46:47], v2 offset:7744
ds_read_b64_tr_b16 v[48:49], v2 offset:5248
v_mfma_f32_32x32x16_bf16 v[96:111], v[24:27], a[0:3], v[96:111]
ds_read_b64_tr_b16 v[50:51], v2 offset:7808
ds_read_b64_tr_b16 v[52:53], v2 offset:5312
ds_read_b64_tr_b16 v[54:55], v2 offset:7872
v_mfma_f32_32x32x16_bf16 v[112:127], v[28:31], a[0:3], v[112:127]
ds_read_b64_tr_b16 v[56:57], v2 offset:5376
ds_read_b64_tr_b16 v[58:59], v2 offset:7936
buffer_load_dwordx4 a[64:67], v11, s[4:7], s60 offen offset:0 sc1
v_mfma_f32_32x32x16_bf16 v[128:143], v[32:35], a[0:3], v[128:143]
s_waitcnt lgkmcnt(0)
s_waitcnt vmcnt(17)
v_mfma_f32_32x32x16_bf16 v[64:79], v[40:43], a[8:11], v[64:79]
ds_read_b64_tr_b16 v[16:17], v2 offset:10240
ds_read_b64_tr_b16 v[18:19], v2 offset:12800
ds_read_b64_tr_b16 v[20:21], v2 offset:10304
v_mfma_f32_32x32x16_bf16 v[80:95], v[44:47], a[8:11], v[80:95]
ds_read_b64_tr_b16 v[22:23], v2 offset:12864
ds_read_b64_tr_b16 v[24:25], v2 offset:10368
ds_read_b64_tr_b16 v[26:27], v2 offset:12928
v_mfma_f32_32x32x16_bf16 v[96:111], v[48:51], a[8:11], v[96:111]
ds_read_b64_tr_b16 v[28:29], v2 offset:10432
ds_read_b64_tr_b16 v[30:31], v2 offset:12992
ds_read_b64_tr_b16 v[32:33], v2 offset:10496
v_mfma_f32_32x32x16_bf16 v[112:127], v[52:55], a[8:11], v[112:127]
ds_read_b64_tr_b16 v[34:35], v2 offset:13056
buffer_load_dwordx4 a[72:75], v11, s[4:7], s60 offen offset:1024 sc1
v_mfma_f32_32x32x16_bf16 v[128:143], v[56:59], a[8:11], v[128:143]
s_waitcnt lgkmcnt(0)
s_waitcnt vmcnt(17)
v_mfma_f32_32x32x16_bf16 v[64:79], v[16:19], a[16:19], v[64:79]
ds_read_b64_tr_b16 v[40:41], v2 offset:15360
ds_read_b64_tr_b16 v[42:43], v2 offset:17920
ds_read_b64_tr_b16 v[44:45], v2 offset:15424
v_mfma_f32_32x32x16_bf16 v[80:95], v[20:23], a[16:19], v[80:95]
ds_read_b64_tr_b16 v[46:47], v2 offset:17984
ds_read_b64_tr_b16 v[48:49], v2 offset:15488
ds_read_b64_tr_b16 v[50:51], v2 offset:18048
v_mfma_f32_32x32x16_bf16 v[96:111], v[24:27], a[16:19], v[96:111]
ds_read_b64_tr_b16 v[52:53], v2 offset:15552
ds_read_b64_tr_b16 v[54:55], v2 offset:18112
ds_read_b64_tr_b16 v[56:57], v2 offset:15616
v_mfma_f32_32x32x16_bf16 v[112:127], v[28:31], a[16:19], v[112:127]
ds_read_b64_tr_b16 v[58:59], v2 offset:18176
buffer_load_dwordx4 a[0:3], v11, s[4:7], s60 offen offset:2048 sc1
v_mfma_f32_32x32x16_bf16 v[128:143], v[32:35], a[16:19], v[128:143]
s_waitcnt lgkmcnt(0)
s_waitcnt vmcnt(13)
s_barrier
s_waitcnt vmcnt(12)
v_mfma_f32_32x32x16_bf16 v[64:79], v[40:43], a[24:27], v[64:79]
ds_read_b64_tr_b16 v[16:17], v2 offset:24576
ds_read_b64_tr_b16 v[18:19], v2 offset:27136
ds_read_b64_tr_b16 v[20:21], v2 offset:24640
v_mfma_f32_32x32x16_bf16 v[80:95], v[44:47], a[24:27], v[80:95]
ds_read_b64_tr_b16 v[22:23], v2 offset:27200
ds_read_b64_tr_b16 v[24:25], v2 offset:24704
ds_read_b64_tr_b16 v[26:27], v2 offset:27264
v_mfma_f32_32x32x16_bf16 v[96:111], v[48:51], a[24:27], v[96:111]
ds_read_b64_tr_b16 v[28:29], v2 offset:24768
ds_read_b64_tr_b16 v[30:31], v2 offset:27328
ds_read_b64_tr_b16 v[32:33], v2 offset:24832
v_mfma_f32_32x32x16_bf16 v[112:127], v[52:55], a[24:27], v[112:127]
ds_read_b64_tr_b16 v[34:35], v2 offset:27392
s_add_u32 s43, s56, 1884160
s_add_u32 m0, s62, 73728
s_nop 0
buffer_load_dwordx4 v4, s[8:11], s43 offen lds
s_add_u32 m0, s62, 74752
s_nop 0
buffer_load_dwordx4 v5, s[8:11], s43 offen lds
s_add_u32 m0, s62, 75776
s_nop 0
buffer_load_dwordx4 v6, s[8:11], s43 offen lds
s_add_u32 m0, s62, 76800
s_nop 0
buffer_load_dwordx4 v7, s[8:11], s43 offen lds
s_add_u32 m0, s62, 77824
s_nop 0
buffer_load_dwordx4 v8, s[8:11], s43 offen lds
buffer_load_dwordx4 a[8:11], v11, s[4:7], s60 offen offset:3072 sc1
v_mfma_f32_32x32x16_bf16 v[128:143], v[56:59], a[24:27], v[128:143]
s_waitcnt lgkmcnt(0)
s_waitcnt vmcnt(17)
v_mfma_f32_32x32x16_bf16 v[64:79], v[16:19], a[32:35], v[64:79]
s_add_u32 s61, s57, 94208
ds_read_b64_tr_b16 v[40:41], v2 offset:29696
ds_read_b64_tr_b16 v[42:43], v2 offset:32256
v_mfma_f32_32x32x16_bf16 v[80:95], v[20:23], a[32:35], v[80:95]
ds_read_b64_tr_b16 v[44:45], v2 offset:29760
ds_read_b64_tr_b16 v[46:47], v2 offset:32320
ds_read_b64_tr_b16 v[48:49], v2 offset:29824
v_mfma_f32_32x32x16_bf16 v[96:111], v[24:27], a[32:35], v[96:111]
ds_read_b64_tr_b16 v[50:51], v2 offset:32384
ds_read_b64_tr_b16 v[52:53], v2 offset:29888
ds_read_b64_tr_b16 v[54:55], v2 offset:32448
v_mfma_f32_32x32x16_bf16 v[112:127], v[28:31], a[32:35], v[112:127]
ds_read_b64_tr_b16 v[56:57], v2 offset:29952
ds_read_b64_tr_b16 v[58:59], v2 offset:32512
buffer_load_dwordx4 a[16:19], v11, s[4:7], s61 offen offset:0 sc1
v_mfma_f32_32x32x16_bf16 v[128:143], v[32:35], a[32:35], v[128:143]
s_waitcnt lgkmcnt(0)
s_waitcnt vmcnt(17)
v_mfma_f32_32x32x16_bf16 v[64:79], v[40:43], a[40:43], v[64:79]
ds_read_b64_tr_b16 v[16:17], v2 offset:34816
ds_read_b64_tr_b16 v[18:19], v2 offset:37376
ds_read_b64_tr_b16 v[20:21], v2 offset:34880
v_mfma_f32_32x32x16_bf16 v[80:95], v[44:47], a[40:43], v[80:95]
ds_read_b64_tr_b16 v[22:23], v2 offset:37440
ds_read_b64_tr_b16 v[24:25], v2 offset:34944
ds_read_b64_tr_b16 v[26:27], v2 offset:37504
v_mfma_f32_32x32x16_bf16 v[96:111], v[48:51], a[40:43], v[96:111]
ds_read_b64_tr_b16 v[28:29], v2 offset:35008
ds_read_b64_tr_b16 v[30:31], v2 offset:37568
ds_read_b64_tr_b16 v[32:33], v2 offset:35072
v_mfma_f32_32x32x16_bf16 v[112:127], v[52:55], a[40:43], v[112:127]
ds_read_b64_tr_b16 v[34:35], v2 offset:37632
buffer_load_dwordx4 a[24:27], v11, s[4:7], s61 offen offset:1024 sc1
v_mfma_f32_32x32x16_bf16 v[128:143], v[56:59], a[40:43], v[128:143]
s_waitcnt lgkmcnt(0)
s_waitcnt vmcnt(17)
v_mfma_f32_32x32x16_bf16 v[64:79], v[16:19], a[48:51], v[64:79]
ds_read_b64_tr_b16 v[40:41], v2 offset:39936
ds_read_b64_tr_b16 v[42:43], v2 offset:42496
ds_read_b64_tr_b16 v[44:45], v2 offset:40000
v_mfma_f32_32x32x16_bf16 v[80:95], v[20:23], a[48:51], v[80:95]
ds_read_b64_tr_b16 v[46:47], v2 offset:42560
ds_read_b64_tr_b16 v[48:49], v2 offset:40064
ds_read_b64_tr_b16 v[50:51], v2 offset:42624
v_mfma_f32_32x32x16_bf16 v[96:111], v[24:27], a[48:51], v[96:111]
ds_read_b64_tr_b16 v[52:53], v2 offset:40128
ds_read_b64_tr_b16 v[54:55], v2 offset:42688
ds_read_b64_tr_b16 v[56:57], v2 offset:40192
v_mfma_f32_32x32x16_bf16 v[112:127], v[28:31], a[48:51], v[112:127]
ds_read_b64_tr_b16 v[58:59], v2 offset:42752
buffer_load_dwordx4 a[32:35], v11, s[4:7], s61 offen offset:2048 sc1
v_mfma_f32_32x32x16_bf16 v[128:143], v[32:35], a[48:51], v[128:143]
s_waitcnt lgkmcnt(0)
s_waitcnt vmcnt(13)
s_barrier
s_waitcnt vmcnt(12)
v_mfma_f32_32x32x16_bf16 v[64:79], v[40:43], a[56:59], v[64:79]
ds_read_b64_tr_b16 v[16:17], v13 offset:0
ds_read_b64_tr_b16 v[18:19], v13 offset:2560
ds_read_b64_tr_b16 v[20:21], v13 offset:64
v_mfma_f32_32x32x16_bf16 v[80:95], v[44:47], a[56:59], v[80:95]
ds_read_b64_tr_b16 v[22:23], v13 offset:2624
ds_read_b64_tr_b16 v[24:25], v13 offset:128
ds_read_b64_tr_b16 v[26:27], v13 offset:2688
v_mfma_f32_32x32x16_bf16 v[96:111], v[48:51], a[56:59], v[96:111]
ds_read_b64_tr_b16 v[28:29], v13 offset:192
ds_read_b64_tr_b16 v[30:31], v13 offset:2752
ds_read_b64_tr_b16 v[32:33], v13 offset:256
v_mfma_f32_32x32x16_bf16 v[112:127], v[52:55], a[56:59], v[112:127]
ds_read_b64_tr_b16 v[34:35], v13 offset:2816
buffer_load_dwordx4 a[40:43], v11, s[4:7], s61 offen offset:3072 sc1
v_mfma_f32_32x32x16_bf16 v[128:143], v[56:59], a[56:59], v[128:143]
s_waitcnt lgkmcnt(0)
s_waitcnt vmcnt(12)
v_mfma_f32_32x32x16_bf16 v[64:79], v[16:19], a[64:67], v[64:79]
ds_read_b64_tr_b16 v[40:41], v13 offset:5120
ds_read_b64_tr_b16 v[42:43], v13 offset:7680
v_mfma_f32_32x32x16_bf16 v[80:95], v[20:23], a[64:67], v[80:95]
ds_read_b64_tr_b16 v[44:45], v13 offset:5184
ds_read_b64_tr_b16 v[46:47], v13 offset:7744
ds_read_b64_tr_b16 v[48:49], v13 offset:5248
v_mfma_f32_32x32x16_bf16 v[96:111], v[24:27], a[64:67], v[96:111]
ds_read_b64_tr_b16 v[50:51], v13 offset:7808
ds_read_b64_tr_b16 v[52:53], v13 offset:5312
ds_read_b64_tr_b16 v[54:55], v13 offset:7872
v_mfma_f32_32x32x16_bf16 v[112:127], v[28:31], a[64:67], v[112:127]
ds_read_b64_tr_b16 v[56:57], v13 offset:5376
ds_read_b64_tr_b16 v[58:59], v13 offset:7936
v_mfma_f32_32x32x16_bf16 v[128:143], v[32:35], a[64:67], v[128:143]
s_waitcnt lgkmcnt(0)
s_waitcnt vmcnt(11)
v_mfma_f32_32x32x16_bf16 v[64:79], v[40:43], a[72:75], v[64:79]
ds_read_b64_tr_b16 v[16:17], v13 offset:10240
ds_read_b64_tr_b16 v[18:19], v13 offset:12800
ds_read_b64_tr_b16 v[20:21], v13 offset:10304
v_mfma_f32_32x32x16_bf16 v[80:95], v[44:47], a[72:75], v[80:95]
ds_read_b64_tr_b16 v[22:23], v13 offset:12864
ds_read_b64_tr_b16 v[24:25], v13 offset:10368
ds_read_b64_tr_b16 v[26:27], v13 offset:12928
v_mfma_f32_32x32x16_bf16 v[96:111], v[48:51], a[72:75], v[96:111]
ds_read_b64_tr_b16 v[28:29], v13 offset:10432
ds_read_b64_tr_b16 v[30:31], v13 offset:12992
ds_read_b64_tr_b16 v[32:33], v13 offset:10496
v_mfma_f32_32x32x16_bf16 v[112:127], v[52:55], a[72:75], v[112:127]
ds_read_b64_tr_b16 v[34:35], v13 offset:13056
v_mfma_f32_32x32x16_bf16 v[128:143], v[56:59], a[72:75], v[128:143]
s_waitcnt lgkmcnt(0)
s_waitcnt vmcnt(10)
v_mfma_f32_32x32x16_bf16 v[64:79], v[16:19], a[0:3], v[64:79]
ds_read_b64_tr_b16 v[40:41], v13 offset:15360
ds_read_b64_tr_b16 v[42:43], v13 offset:17920
ds_read_b64_tr_b16 v[44:45], v13 offset:15424
v_mfma_f32_32x32x16_bf16 v[80:95], v[20:23], a[0:3], v[80:95]
ds_read_b64_tr_b16 v[46:47], v13 offset:17984
ds_read_b64_tr_b16 v[48:49], v13 offset:15488
ds_read_b64_tr_b16 v[50:51], v13 offset:18048
v_mfma_f32_32x32x16_bf16 v[96:111], v[24:27], a[0:3], v[96:111]
ds_read_b64_tr_b16 v[52:53], v13 offset:15552
ds_read_b64_tr_b16 v[54:55], v13 offset:18112
ds_read_b64_tr_b16 v[56:57], v13 offset:15616
v_mfma_f32_32x32x16_bf16 v[112:127], v[28:31], a[0:3], v[112:127]
ds_read_b64_tr_b16 v[58:59], v13 offset:18176
v_mfma_f32_32x32x16_bf16 v[128:143], v[32:35], a[0:3], v[128:143]
s_waitcnt lgkmcnt(0)
s_waitcnt vmcnt(5)
s_barrier
s_waitcnt vmcnt(4)
v_mfma_f32_32x32x16_bf16 v[64:79], v[40:43], a[8:11], v[64:79]
ds_read_b64_tr_b16 v[16:17], v13 offset:24576
ds_read_b64_tr_b16 v[18:19], v13 offset:27136
ds_read_b64_tr_b16 v[20:21], v13 offset:24640
v_mfma_f32_32x32x16_bf16 v[80:95], v[44:47], a[8:11], v[80:95]
ds_read_b64_tr_b16 v[22:23], v13 offset:27200
ds_read_b64_tr_b16 v[24:25], v13 offset:24704
ds_read_b64_tr_b16 v[26:27], v13 offset:27264
v_mfma_f32_32x32x16_bf16 v[96:111], v[48:51], a[8:11], v[96:111]
ds_read_b64_tr_b16 v[28:29], v13 offset:24768
ds_read_b64_tr_b16 v[30:31], v13 offset:27328
ds_read_b64_tr_b16 v[32:33], v13 offset:24832
v_mfma_f32_32x32x16_bf16 v[112:127], v[52:55], a[8:11], v[112:127]
ds_read_b64_tr_b16 v[34:35], v13 offset:27392
v_mfma_f32_32x32x16_bf16 v[128:143], v[56:59], a[8:11], v[128:143]
s_waitcnt lgkmcnt(0)
s_waitcnt vmcnt(3)
v_mfma_f32_32x32x16_bf16 v[64:79], v[16:19], a[16:19], v[64:79]
ds_read_b64_tr_b16 v[40:41], v13 offset:29696
ds_read_b64_tr_b16 v[42:43], v13 offset:32256
v_mfma_f32_32x32x16_bf16 v[80:95], v[20:23], a[16:19], v[80:95]
ds_read_b64_tr_b16 v[44:45], v13 offset:29760
ds_read_b64_tr_b16 v[46:47], v13 offset:32320
ds_read_b64_tr_b16 v[48:49], v13 offset:29824
v_mfma_f32_32x32x16_bf16 v[96:111], v[24:27], a[16:19], v[96:111]
ds_read_b64_tr_b16 v[50:51], v13 offset:32384
ds_read_b64_tr_b16 v[52:53], v13 offset:29888
ds_read_b64_tr_b16 v[54:55], v13 offset:32448
v_mfma_f32_32x32x16_bf16 v[112:127], v[28:31], a[16:19], v[112:127]
ds_read_b64_tr_b16 v[56:57], v13 offset:29952
ds_read_b64_tr_b16 v[58:59], v13 offset:32512
v_mfma_f32_32x32x16_bf16 v[128:143], v[32:35], a[16:19], v[128:143]
s_waitcnt lgkmcnt(0)
s_waitcnt vmcnt(2)
v_mfma_f32_32x32x16_bf16 v[64:79], v[40:43], a[24:27], v[64:79]
ds_read_b64_tr_b16 v[16:17], v13 offset:34816
ds_read_b64_tr_b16 v[18:19], v13 offset:37376
ds_read_b64_tr_b16 v[20:21], v13 offset:34880
v_mfma_f32_32x32x16_bf16 v[80:95], v[44:47], a[24:27], v[80:95]
ds_read_b64_tr_b16 v[22:23], v13 offset:37440
ds_read_b64_tr_b16 v[24:25], v13 offset:34944
ds_read_b64_tr_b16 v[26:27], v13 offset:37504
v_mfma_f32_32x32x16_bf16 v[96:111], v[48:51], a[24:27], v[96:111]
ds_read_b64_tr_b16 v[28:29], v13 offset:35008
ds_read_b64_tr_b16 v[30:31], v13 offset:37568
ds_read_b64_tr_b16 v[32:33], v13 offset:35072
v_mfma_f32_32x32x16_bf16 v[112:127], v[52:55], a[24:27], v[112:127]
ds_read_b64_tr_b16 v[34:35], v13 offset:37632
v_mfma_f32_32x32x16_bf16 v[128:143], v[56:59], a[24:27], v[128:143]
s_waitcnt lgkmcnt(0)
s_waitcnt vmcnt(1)
v_mfma_f32_32x32x16_bf16 v[64:79], v[16:19], a[32:35], v[64:79]
ds_read_b64_tr_b16 v[40:41], v13 offset:39936
ds_read_b64_tr_b16 v[42:43], v13 offset:42496
ds_read_b64_tr_b16 v[44:45], v13 offset:40000
v_mfma_f32_32x32x16_bf16 v[80:95], v[20:23], a[32:35], v[80:95]
ds_read_b64_tr_b16 v[46:47], v13 offset:42560
ds_read_b64_tr_b16 v[48:49], v13 offset:40064
ds_read_b64_tr_b16 v[50:51], v13 offset:42624
v_mfma_f32_32x32x16_bf16 v[96:111], v[24:27], a[32:35], v[96:111]
ds_read_b64_tr_b16 v[52:53], v13 offset:40128
ds_read_b64_tr_b16 v[54:55], v13 offset:42688
ds_read_b64_tr_b16 v[56:57], v13 offset:40192
v_mfma_f32_32x32x16_bf16 v[112:127], v[28:31], a[32:35], v[112:127]
ds_read_b64_tr_b16 v[58:59], v13 offset:42752
v_mfma_f32_32x32x16_bf16 v[128:143], v[32:35], a[32:35], v[128:143]
s_waitcnt lgkmcnt(0)
s_waitcnt vmcnt(0)
v_mfma_f32_32x32x16_bf16 v[64:79], v[40:43], a[40:43], v[64:79]
v_mfma_f32_32x32x16_bf16 v[80:95], v[44:47], a[40:43], v[80:95]
v_mfma_f32_32x32x16_bf16 v[96:111], v[48:51], a[40:43], v[96:111]
v_mfma_f32_32x32x16_bf16 v[112:127], v[52:55], a[40:43], v[112:127]
v_mfma_f32_32x32x16_bf16 v[128:143], v[56:59], a[40:43], v[128:143]
s_cmp_eq_u32 s24, 0
s_cbranch_scc0 tk15566
v_accvgpr_write_b32 a200, 1
s_mov_b64 exec, 1
buffer_atomic_add a200, off, s[28:31], s32 sc0
s_mov_b64 exec, -1
tk15566:
s_lshl_b32 s42, s55, 2
s_add_u32 s42, s42, s24
s_mul_i32 s42, s42, 40960
s_mul_i32 s43, s54, 320
s_add_u32 s42, s42, s43
s_add_u32 s42, s42, 176160768
s_mov_b32 s65, 0xbfb8aa3b
v_cvt_pk_bf16_f32 v16, v64, v65
v_cvt_pk_bf16_f32 v17, v66, v67
v_cvt_pk_bf16_f32 v18, v68, v69
v_cvt_pk_bf16_f32 v19, v70, v71
v_cvt_pk_bf16_f32 v20, v72, v73
v_cvt_pk_bf16_f32 v21, v74, v75
v_cvt_pk_bf16_f32 v22, v76, v77
v_cvt_pk_bf16_f32 v23, v78, v79
v_lshlrev_b32 v64, 16, v16
v_and_b32 v65, 0xffff0000, v16
v_lshlrev_b32 v66, 16, v17
v_and_b32 v67, 0xffff0000, v17
v_lshlrev_b32 v68, 16, v18
v_and_b32 v69, 0xffff0000, v18
v_lshlrev_b32 v70, 16, v19
v_and_b32 v71, 0xffff0000, v19
v_lshlrev_b32 v72, 16, v20
v_and_b32 v73, 0xffff0000, v20
v_lshlrev_b32 v74, 16, v21
v_and_b32 v75, 0xffff0000, v21
v_lshlrev_b32 v76, 16, v22
v_and_b32 v77, 0xffff0000, v22
v_lshlrev_b32 v78, 16, v23
v_and_b32 v79, 0xffff0000, v23
v_mul_f32 v24, s65, v64
v_mul_f32 v25, s65, v65
v_mul_f32 v26, s65, v66
v_mul_f32 v27, s65, v67
v_mul_f32 v28, s65, v68
v_mul_f32 v29, s65, v69
v_mul_f32 v30, s65, v70
v_mul_f32 v31, s65, v71
v_mul_f32 v32, s65, v72
v_mul_f32 v33, s65, v73
v_mul_f32 v34, s65, v74
v_mul_f32 v35, s65, v75
v_mul_f32 v36, s65, v76
v_mul_f32 v37, s65, v77
v_mul_f32 v38, s65, v78
v_mul_f32 v39, s65, v79
v_exp_f32 v24, v24
v_exp_f32 v25, v25
v_exp_f32 v26, v26
v_exp_f32 v27, v27
v_exp_f32 v28, v28
v_exp_f32 v29, v29
v_exp_f32 v30, v30
v_exp_f32 v31, v31
v_exp_f32 v32, v32
v_exp_f32 v33, v33
v_exp_f32 v34, v34
v_exp_f32 v35, v35
v_exp_f32 v36, v36
v_exp_f32 v37, v37
v_exp_f32 v38, v38
v_exp_f32 v39, v39
v_add_f32 v24, 1.0, v24
v_add_f32 v25, 1.0, v25
v_add_f32 v26, 1.0, v26
v_add_f32 v27, 1.0, v27
v_add_f32 v28, 1.0, v28
v_add_f32 v29, 1.0, v29
v_add_f32 v30, 1.0, v30
v_add_f32 v31, 1.0, v31
v_add_f32 v32, 1.0, v32
v_add_f32 v33, 1.0, v33
v_add_f32 v34, 1.0, v34
v_add_f32 v35, 1.0, v35
v_add_f32 v36, 1.0, v36
v_add_f32 v37, 1.0, v37
v_add_f32 v38, 1.0, v38
v_add_f32 v39, 1.0, v39
v_rcp_f32 v24, v24
v_rcp_f32 v25, v25
v_rcp_f32 v26, v26
v_rcp_f32 v27, v27
v_rcp_f32 v28, v28
v_rcp_f32 v29, v29
v_rcp_f32 v30, v30
v_rcp_f32 v31, v31
v_rcp_f32 v32, v32
v_rcp_f32 v33, v33
v_rcp_f32 v34, v34
v_rcp_f32 v35, v35
v_rcp_f32 v36, v36
v_rcp_f32 v37, v37
v_rcp_f32 v38, v38
v_rcp_f32 v39, v39
v_mul_f32 v24, v24, v64
v_mul_f32 v25, v25, v65
v_mul_f32 v26, v26, v66
v_mul_f32 v27, v27, v67
v_mul_f32 v28, v28, v68
v_mul_f32 v29, v29, v69
v_mul_f32 v30, v30, v70
v_mul_f32 v31, v31, v71
v_mul_f32 v32, v32, v72
v_mul_f32 v33, v33, v73
v_mul_f32 v34, v34, v74
v_mul_f32 v35, v35, v75
v_mul_f32 v36, v36, v76
v_mul_f32 v37, v37, v77
v_mul_f32 v38, v38, v78
v_mul_f32 v39, v39, v79
v_cvt_pk_bf16_f32 v40, v24, v25
v_cvt_pk_bf16_f32 v41, v26, v27
s_add_u32 s43, s42, 0
buffer_store_dwordx2 v[40:41], v14, s[4:7], s43 offen offset:0 sc1
v_cvt_pk_bf16_f32 v42, v28, v29
v_cvt_pk_bf16_f32 v43, v30, v31
s_add_u32 s43, s42, 0
buffer_store_dwordx2 v[42:43], v14, s[4:7], s43 offen offset:16 sc1
v_cvt_pk_bf16_f32 v44, v32, v33
v_cvt_pk_bf16_f32 v45, v34, v35
s_add_u32 s43, s42, 0
buffer_store_dwordx2 v[44:45], v14, s[4:7], s43 offen offset:32 sc1
v_cvt_pk_bf16_f32 v46, v36, v37
v_cvt_pk_bf16_f32 v47, v38, v39
s_add_u32 s43, s42, 0
buffer_store_dwordx2 v[46:47], v14, s[4:7], s43 offen offset:48 sc1
v_cvt_pk_bf16_f32 v16, v80, v81
v_cvt_pk_bf16_f32 v17, v82, v83
v_cvt_pk_bf16_f32 v18, v84, v85
v_cvt_pk_bf16_f32 v19, v86, v87
v_cvt_pk_bf16_f32 v20, v88, v89
v_cvt_pk_bf16_f32 v21, v90, v91
v_cvt_pk_bf16_f32 v22, v92, v93
v_cvt_pk_bf16_f32 v23, v94, v95
v_lshlrev_b32 v80, 16, v16
v_and_b32 v81, 0xffff0000, v16
v_lshlrev_b32 v82, 16, v17
v_and_b32 v83, 0xffff0000, v17
v_lshlrev_b32 v84, 16, v18
v_and_b32 v85, 0xffff0000, v18
v_lshlrev_b32 v86, 16, v19
v_and_b32 v87, 0xffff0000, v19
v_lshlrev_b32 v88, 16, v20
v_and_b32 v89, 0xffff0000, v20
v_lshlrev_b32 v90, 16, v21
v_and_b32 v91, 0xffff0000, v21
v_lshlrev_b32 v92, 16, v22
v_and_b32 v93, 0xffff0000, v22
v_lshlrev_b32 v94, 16, v23
v_and_b32 v95, 0xffff0000, v23
v_mul_f32 v24, s65, v80
v_mul_f32 v25, s65, v81
v_mul_f32 v26, s65, v82
v_mul_f32 v27, s65, v83
v_mul_f32 v28, s65, v84
v_mul_f32 v29, s65, v85
v_mul_f32 v30, s65, v86
v_mul_f32 v31, s65, v87
v_mul_f32 v32, s65, v88
v_mul_f32 v33, s65, v89
v_mul_f32 v34, s65, v90
v_mul_f32 v35, s65, v91
v_mul_f32 v36, s65, v92
v_mul_f32 v37, s65, v93
v_mul_f32 v38, s65, v94
v_mul_f32 v39, s65, v95
v_exp_f32 v24, v24
v_exp_f32 v25, v25
v_exp_f32 v26, v26
v_exp_f32 v27, v27
v_exp_f32 v28, v28
v_exp_f32 v29, v29
v_exp_f32 v30, v30
v_exp_f32 v31, v31
v_exp_f32 v32, v32
v_exp_f32 v33, v33
v_exp_f32 v34, v34
v_exp_f32 v35, v35
v_exp_f32 v36, v36
v_exp_f32 v37, v37
v_exp_f32 v38, v38
v_exp_f32 v39, v39
v_add_f32 v24, 1.0, v24
v_add_f32 v25, 1.0, v25
v_add_f32 v26, 1.0, v26
v_add_f32 v27, 1.0, v27
v_add_f32 v28, 1.0, v28
v_add_f32 v29, 1.0, v29
v_add_f32 v30, 1.0, v30
v_add_f32 v31, 1.0, v31
v_add_f32 v32, 1.0, v32
v_add_f32 v33, 1.0, v33
v_add_f32 v34, 1.0, v34
v_add_f32 v35, 1.0, v35
v_add_f32 v36, 1.0, v36
v_add_f32 v37, 1.0, v37
v_add_f32 v38, 1.0, v38
v_add_f32 v39, 1.0, v39
v_rcp_f32 v24, v24
v_rcp_f32 v25, v25
v_rcp_f32 v26, v26
v_rcp_f32 v27, v27
v_rcp_f32 v28, v28
v_rcp_f32 v29, v29
v_rcp_f32 v30, v30
v_rcp_f32 v31, v31
v_rcp_f32 v32, v32
v_rcp_f32 v33, v33
v_rcp_f32 v34, v34
v_rcp_f32 v35, v35
v_rcp_f32 v36, v36
v_rcp_f32 v37, v37
v_rcp_f32 v38, v38
v_rcp_f32 v39, v39
v_mul_f32 v24, v24, v80
v_mul_f32 v25, v25, v81
v_mul_f32 v26, v26, v82
v_mul_f32 v27, v27, v83
v_mul_f32 v28, v28, v84
v_mul_f32 v29, v29, v85
v_mul_f32 v30, v30, v86
v_mul_f32 v31, v31, v87
v_mul_f32 v32, v32, v88
v_mul_f32 v33, v33, v89
v_mul_f32 v34, v34, v90
v_mul_f32 v35, v35, v91
v_mul_f32 v36, v36, v92
v_mul_f32 v37, v37, v93
v_mul_f32 v38, v38, v94
v_mul_f32 v39, v39, v95
v_cvt_pk_bf16_f32 v40, v24, v25
v_cvt_pk_bf16_f32 v41, v26, v27
s_add_u32 s43, s42, 64
buffer_store_dwordx2 v[40:41], v14, s[4:7], s43 offen offset:0 sc1
v_cvt_pk_bf16_f32 v42, v28, v29
v_cvt_pk_bf16_f32 v43, v30, v31
s_add_u32 s43, s42, 64
buffer_store_dwordx2 v[42:43], v14, s[4:7], s43 offen offset:16 sc1
v_cvt_pk_bf16_f32 v44, v32, v33
v_cvt_pk_bf16_f32 v45, v34, v35
s_add_u32 s43, s42, 64
buffer_store_dwordx2 v[44:45], v14, s[4:7], s43 offen offset:32 sc1
v_cvt_pk_bf16_f32 v46, v36, v37
v_cvt_pk_bf16_f32 v47, v38, v39
s_add_u32 s43, s42, 64
buffer_store_dwordx2 v[46:47], v14, s[4:7], s43 offen offset:48 sc1
v_cvt_pk_bf16_f32 v16, v96, v97
v_cvt_pk_bf16_f32 v17, v98, v99
v_cvt_pk_bf16_f32 v18, v100, v101
v_cvt_pk_bf16_f32 v19, v102, v103
v_cvt_pk_bf16_f32 v20, v104, v105
v_cvt_pk_bf16_f32 v21, v106, v107
v_cvt_pk_bf16_f32 v22, v108, v109
v_cvt_pk_bf16_f32 v23, v110, v111
v_lshlrev_b32 v96, 16, v16
v_and_b32 v97, 0xffff0000, v16
v_lshlrev_b32 v98, 16, v17
v_and_b32 v99, 0xffff0000, v17
v_lshlrev_b32 v100, 16, v18
v_and_b32 v101, 0xffff0000, v18
v_lshlrev_b32 v102, 16, v19
v_and_b32 v103, 0xffff0000, v19
v_lshlrev_b32 v104, 16, v20
v_and_b32 v105, 0xffff0000, v20
v_lshlrev_b32 v106, 16, v21
v_and_b32 v107, 0xffff0000, v21
v_lshlrev_b32 v108, 16, v22
v_and_b32 v109, 0xffff0000, v22
v_lshlrev_b32 v110, 16, v23
v_and_b32 v111, 0xffff0000, v23
v_mul_f32 v24, s65, v96
v_mul_f32 v25, s65, v97
v_mul_f32 v26, s65, v98
v_mul_f32 v27, s65, v99
v_mul_f32 v28, s65, v100
v_mul_f32 v29, s65, v101
v_mul_f32 v30, s65, v102
v_mul_f32 v31, s65, v103
v_mul_f32 v32, s65, v104
v_mul_f32 v33, s65, v105
v_mul_f32 v34, s65, v106
v_mul_f32 v35, s65, v107
v_mul_f32 v36, s65, v108
v_mul_f32 v37, s65, v109
v_mul_f32 v38, s65, v110
v_mul_f32 v39, s65, v111
v_exp_f32 v24, v24
v_exp_f32 v25, v25
v_exp_f32 v26, v26
v_exp_f32 v27, v27
v_exp_f32 v28, v28
v_exp_f32 v29, v29
v_exp_f32 v30, v30
v_exp_f32 v31, v31
v_exp_f32 v32, v32
v_exp_f32 v33, v33
v_exp_f32 v34, v34
v_exp_f32 v35, v35
v_exp_f32 v36, v36
v_exp_f32 v37, v37
v_exp_f32 v38, v38
v_exp_f32 v39, v39
v_add_f32 v24, 1.0, v24
v_add_f32 v25, 1.0, v25
v_add_f32 v26, 1.0, v26
v_add_f32 v27, 1.0, v27
v_add_f32 v28, 1.0, v28
v_add_f32 v29, 1.0, v29
v_add_f32 v30, 1.0, v30
v_add_f32 v31, 1.0, v31
v_add_f32 v32, 1.0, v32
v_add_f32 v33, 1.0, v33
v_add_f32 v34, 1.0, v34
v_add_f32 v35, 1.0, v35
v_add_f32 v36, 1.0, v36
v_add_f32 v37, 1.0, v37
v_add_f32 v38, 1.0, v38
v_add_f32 v39, 1.0, v39
v_rcp_f32 v24, v24
v_rcp_f32 v25, v25
v_rcp_f32 v26, v26
v_rcp_f32 v27, v27
v_rcp_f32 v28, v28
v_rcp_f32 v29, v29
v_rcp_f32 v30, v30
v_rcp_f32 v31, v31
v_rcp_f32 v32, v32
v_rcp_f32 v33, v33
v_rcp_f32 v34, v34
v_rcp_f32 v35, v35
v_rcp_f32 v36, v36
v_rcp_f32 v37, v37
v_rcp_f32 v38, v38
v_rcp_f32 v39, v39
v_mul_f32 v24, v24, v96
v_mul_f32 v25, v25, v97
v_mul_f32 v26, v26, v98
v_mul_f32 v27, v27, v99
v_mul_f32 v28, v28, v100
v_mul_f32 v29, v29, v101
v_mul_f32 v30, v30, v102
v_mul_f32 v31, v31, v103
v_mul_f32 v32, v32, v104
v_mul_f32 v33, v33, v105
v_mul_f32 v34, v34, v106
v_mul_f32 v35, v35, v107
v_mul_f32 v36, v36, v108
v_mul_f32 v37, v37, v109
v_mul_f32 v38, v38, v110
v_mul_f32 v39, v39, v111
v_cvt_pk_bf16_f32 v40, v24, v25
v_cvt_pk_bf16_f32 v41, v26, v27
s_add_u32 s43, s42, 128
buffer_store_dwordx2 v[40:41], v14, s[4:7], s43 offen offset:0 sc1
v_cvt_pk_bf16_f32 v42, v28, v29
v_cvt_pk_bf16_f32 v43, v30, v31
s_add_u32 s43, s42, 128
buffer_store_dwordx2 v[42:43], v14, s[4:7], s43 offen offset:16 sc1
v_cvt_pk_bf16_f32 v44, v32, v33
v_cvt_pk_bf16_f32 v45, v34, v35
s_add_u32 s43, s42, 128
buffer_store_dwordx2 v[44:45], v14, s[4:7], s43 offen offset:32 sc1
v_cvt_pk_bf16_f32 v46, v36, v37
v_cvt_pk_bf16_f32 v47, v38, v39
s_add_u32 s43, s42, 128
buffer_store_dwordx2 v[46:47], v14, s[4:7], s43 offen offset:48 sc1
v_cvt_pk_bf16_f32 v16, v112, v113
v_cvt_pk_bf16_f32 v17, v114, v115
v_cvt_pk_bf16_f32 v18, v116, v117
v_cvt_pk_bf16_f32 v19, v118, v119
v_cvt_pk_bf16_f32 v20, v120, v121
v_cvt_pk_bf16_f32 v21, v122, v123
v_cvt_pk_bf16_f32 v22, v124, v125
v_cvt_pk_bf16_f32 v23, v126, v127
v_lshlrev_b32 v112, 16, v16
v_and_b32 v113, 0xffff0000, v16
v_lshlrev_b32 v114, 16, v17
v_and_b32 v115, 0xffff0000, v17
v_lshlrev_b32 v116, 16, v18
v_and_b32 v117, 0xffff0000, v18
v_lshlrev_b32 v118, 16, v19
v_and_b32 v119, 0xffff0000, v19
v_lshlrev_b32 v120, 16, v20
v_and_b32 v121, 0xffff0000, v20
v_lshlrev_b32 v122, 16, v21
v_and_b32 v123, 0xffff0000, v21
v_lshlrev_b32 v124, 16, v22
v_and_b32 v125, 0xffff0000, v22
v_lshlrev_b32 v126, 16, v23
v_and_b32 v127, 0xffff0000, v23
v_mul_f32 v24, s65, v112
v_mul_f32 v25, s65, v113
v_mul_f32 v26, s65, v114
v_mul_f32 v27, s65, v115
v_mul_f32 v28, s65, v116
v_mul_f32 v29, s65, v117
v_mul_f32 v30, s65, v118
v_mul_f32 v31, s65, v119
v_mul_f32 v32, s65, v120
v_mul_f32 v33, s65, v121
v_mul_f32 v34, s65, v122
v_mul_f32 v35, s65, v123
v_mul_f32 v36, s65, v124
v_mul_f32 v37, s65, v125
v_mul_f32 v38, s65, v126
v_mul_f32 v39, s65, v127
v_exp_f32 v24, v24
v_exp_f32 v25, v25
v_exp_f32 v26, v26
v_exp_f32 v27, v27
v_exp_f32 v28, v28
v_exp_f32 v29, v29
v_exp_f32 v30, v30
v_exp_f32 v31, v31
v_exp_f32 v32, v32
v_exp_f32 v33, v33
v_exp_f32 v34, v34
v_exp_f32 v35, v35
v_exp_f32 v36, v36
v_exp_f32 v37, v37
v_exp_f32 v38, v38
v_exp_f32 v39, v39
v_add_f32 v24, 1.0, v24
v_add_f32 v25, 1.0, v25
v_add_f32 v26, 1.0, v26
v_add_f32 v27, 1.0, v27
v_add_f32 v28, 1.0, v28
v_add_f32 v29, 1.0, v29
v_add_f32 v30, 1.0, v30
v_add_f32 v31, 1.0, v31
v_add_f32 v32, 1.0, v32
v_add_f32 v33, 1.0, v33
v_add_f32 v34, 1.0, v34
v_add_f32 v35, 1.0, v35
v_add_f32 v36, 1.0, v36
v_add_f32 v37, 1.0, v37
v_add_f32 v38, 1.0, v38
v_add_f32 v39, 1.0, v39
v_rcp_f32 v24, v24
v_rcp_f32 v25, v25
v_rcp_f32 v26, v26
v_rcp_f32 v27, v27
v_rcp_f32 v28, v28
v_rcp_f32 v29, v29
v_rcp_f32 v30, v30
v_rcp_f32 v31, v31
v_rcp_f32 v32, v32
v_rcp_f32 v33, v33
v_rcp_f32 v34, v34
v_rcp_f32 v35, v35
v_rcp_f32 v36, v36
v_rcp_f32 v37, v37
v_rcp_f32 v38, v38
v_rcp_f32 v39, v39
v_mul_f32 v24, v24, v112
v_mul_f32 v25, v25, v113
v_mul_f32 v26, v26, v114
v_mul_f32 v27, v27, v115
v_mul_f32 v28, v28, v116
v_mul_f32 v29, v29, v117
v_mul_f32 v30, v30, v118
v_mul_f32 v31, v31, v119
v_mul_f32 v32, v32, v120
v_mul_f32 v33, v33, v121
v_mul_f32 v34, v34, v122
v_mul_f32 v35, v35, v123
v_mul_f32 v36, v36, v124
v_mul_f32 v37, v37, v125
v_mul_f32 v38, v38, v126
v_mul_f32 v39, v39, v127
v_cvt_pk_bf16_f32 v40, v24, v25
v_cvt_pk_bf16_f32 v41, v26, v27
s_add_u32 s43, s42, 192
buffer_store_dwordx2 v[40:41], v14, s[4:7], s43 offen offset:0 sc1
v_cvt_pk_bf16_f32 v42, v28, v29
v_cvt_pk_bf16_f32 v43, v30, v31
s_add_u32 s43, s42, 192
buffer_store_dwordx2 v[42:43], v14, s[4:7], s43 offen offset:16 sc1
v_cvt_pk_bf16_f32 v44, v32, v33
v_cvt_pk_bf16_f32 v45, v34, v35
s_add_u32 s43, s42, 192
buffer_store_dwordx2 v[44:45], v14, s[4:7], s43 offen offset:32 sc1
v_cvt_pk_bf16_f32 v46, v36, v37
v_cvt_pk_bf16_f32 v47, v38, v39
s_add_u32 s43, s42, 192
buffer_store_dwordx2 v[46:47], v14, s[4:7], s43 offen offset:48 sc1
v_cvt_pk_bf16_f32 v16, v128, v129
v_cvt_pk_bf16_f32 v17, v130, v131
v_cvt_pk_bf16_f32 v18, v132, v133
v_cvt_pk_bf16_f32 v19, v134, v135
v_cvt_pk_bf16_f32 v20, v136, v137
v_cvt_pk_bf16_f32 v21, v138, v139
v_cvt_pk_bf16_f32 v22, v140, v141
v_cvt_pk_bf16_f32 v23, v142, v143
v_lshlrev_b32 v128, 16, v16
v_and_b32 v129, 0xffff0000, v16
v_lshlrev_b32 v130, 16, v17
v_and_b32 v131, 0xffff0000, v17
v_lshlrev_b32 v132, 16, v18
v_and_b32 v133, 0xffff0000, v18
v_lshlrev_b32 v134, 16, v19
v_and_b32 v135, 0xffff0000, v19
v_lshlrev_b32 v136, 16, v20
v_and_b32 v137, 0xffff0000, v20
v_lshlrev_b32 v138, 16, v21
v_and_b32 v139, 0xffff0000, v21
v_lshlrev_b32 v140, 16, v22
v_and_b32 v141, 0xffff0000, v22
v_lshlrev_b32 v142, 16, v23
v_and_b32 v143, 0xffff0000, v23
v_mul_f32 v24, s65, v128
v_mul_f32 v25, s65, v129
v_mul_f32 v26, s65, v130
v_mul_f32 v27, s65, v131
v_mul_f32 v28, s65, v132
v_mul_f32 v29, s65, v133
v_mul_f32 v30, s65, v134
v_mul_f32 v31, s65, v135
v_mul_f32 v32, s65, v136
v_mul_f32 v33, s65, v137
v_mul_f32 v34, s65, v138
v_mul_f32 v35, s65, v139
v_mul_f32 v36, s65, v140
v_mul_f32 v37, s65, v141
v_mul_f32 v38, s65, v142
v_mul_f32 v39, s65, v143
v_exp_f32 v24, v24
v_exp_f32 v25, v25
v_exp_f32 v26, v26
v_exp_f32 v27, v27
v_exp_f32 v28, v28
v_exp_f32 v29, v29
v_exp_f32 v30, v30
v_exp_f32 v31, v31
v_exp_f32 v32, v32
v_exp_f32 v33, v33
v_exp_f32 v34, v34
v_exp_f32 v35, v35
v_exp_f32 v36, v36
v_exp_f32 v37, v37
v_exp_f32 v38, v38
v_exp_f32 v39, v39
v_add_f32 v24, 1.0, v24
v_add_f32 v25, 1.0, v25
v_add_f32 v26, 1.0, v26
v_add_f32 v27, 1.0, v27
v_add_f32 v28, 1.0, v28
v_add_f32 v29, 1.0, v29
v_add_f32 v30, 1.0, v30
v_add_f32 v31, 1.0, v31
v_add_f32 v32, 1.0, v32
v_add_f32 v33, 1.0, v33
v_add_f32 v34, 1.0, v34
v_add_f32 v35, 1.0, v35
v_add_f32 v36, 1.0, v36
v_add_f32 v37, 1.0, v37
v_add_f32 v38, 1.0, v38
v_add_f32 v39, 1.0, v39
v_rcp_f32 v24, v24
v_rcp_f32 v25, v25
v_rcp_f32 v26, v26
v_rcp_f32 v27, v27
v_rcp_f32 v28, v28
v_rcp_f32 v29, v29
v_rcp_f32 v30, v30
v_rcp_f32 v31, v31
v_rcp_f32 v32, v32
v_rcp_f32 v33, v33
v_rcp_f32 v34, v34
v_rcp_f32 v35, v35
v_rcp_f32 v36, v36
v_rcp_f32 v37, v37
v_rcp_f32 v38, v38
v_rcp_f32 v39, v39
v_mul_f32 v24, v24, v128
v_mul_f32 v25, v25, v129
v_mul_f32 v26, v26, v130
v_mul_f32 v27, v27, v131
v_mul_f32 v28, v28, v132
v_mul_f32 v29, v29, v133
v_mul_f32 v30, v30, v134
v_mul_f32 v31, v31, v135
v_mul_f32 v32, v32, v136
v_mul_f32 v33, v33, v137
v_mul_f32 v34, v34, v138
v_mul_f32 v35, v35, v139
v_mul_f32 v36, v36, v140
v_mul_f32 v37, v37, v141
v_mul_f32 v38, v38, v142
v_mul_f32 v39, v39, v143
v_cvt_pk_bf16_f32 v40, v24, v25
v_cvt_pk_bf16_f32 v41, v26, v27
s_add_u32 s43, s42, 256
buffer_store_dwordx2 v[40:41], v14, s[4:7], s43 offen offset:0 sc1
v_cvt_pk_bf16_f32 v42, v28, v29
v_cvt_pk_bf16_f32 v43, v30, v31
s_add_u32 s43, s42, 256
buffer_store_dwordx2 v[42:43], v14, s[4:7], s43 offen offset:16 sc1
v_cvt_pk_bf16_f32 v44, v32, v33
v_cvt_pk_bf16_f32 v45, v34, v35
s_add_u32 s43, s42, 256
buffer_store_dwordx2 v[44:45], v14, s[4:7], s43 offen offset:32 sc1
v_cvt_pk_bf16_f32 v46, v36, v37
v_cvt_pk_bf16_f32 v47, v38, v39
s_add_u32 s43, s42, 256
buffer_store_dwordx2 v[46:47], v14, s[4:7], s43 offen offset:48 sc1
s_mul_i32 s62, s24, 6144
s_waitcnt vmcnt(0)
x_taskdone:
s_add_u32 s65, s55, 56
s_mov_b32 s66, 1
s_branch wk_sig
wk_f0:
s_barrier
s_lshl_b32 s54, s65, 2
s_add_u32 s54, s54, s93
wk_f:
s_lshl_b32 s47, s54, 7
s_add_u32 s47, s47, 201335808
s_mov_b32 s46, 0
v_mov_b32 v17, 0
wf1_wf:
buffer_load_dword v16, off, s[4:7], s47 sc1
s_waitcnt vmcnt(0)
v_readfirstlane_b32 s45, v16
s_cmp_ge_u32 s45, 40
s_cbranch_scc1 wf1_wd
s_sleep 8
s_add_u32 s46, s46, 1
s_cmp_lt_u32 s46, 0x200000
s_cbranch_scc1 wf1_wf
s_branch timeout
wf1_wd:
s_lshr_b32 s84, s54, 2
s_lshl_b32 s47, s84, 7
s_add_u32 s47, s47, 201333760
s_mov_b32 s46, 0
v_mov_b32 v17, 0
wf2_wf:
buffer_load_dword v16, off, s[4:7], s47 sc1
s_waitcnt vmcnt(0)
v_readfirstlane_b32 s45, v16
s_cmp_ge_u32 s45, 4
s_cbranch_scc1 wf2_wd
s_sleep 8
s_add_u32 s46, s46, 1
s_cmp_lt_u32 s46, 0x200000
s_cbranch_scc1 wf2_wf
s_branch timeout
wf2_wd:
s_cmp_eq_u32 s24, 0
s_cbranch_scc0 tk16224
v_accvgpr_write_b32 a200, 1
s_mov_b64 exec, 1
buffer_atomic_add a200, off, s[28:31], s32 sc0
s_mov_b64 exec, -1
tk16224:
v_lshlrev_b32 v2, 4, v0
s_mul_i32 s65, s54, 40960
s_add_u32 s66, s65, 192937984
s_add_u32 s67, s65, 176160768
s_add_u32 s40, s65, 0
s_add_u32 s41, s66, 0
s_add_u32 s42, s67, 0
buffer_load_dwordx4 v[16:19], v2, s[16:19], s40 offen
buffer_load_dwordx4 v[20:23], v2, s[4:7], s41 offen sc1
buffer_load_dwordx4 v[24:27], v2, s[4:7], s42 offen sc1
s_add_u32 s40, s65, 4096
s_add_u32 s41, s66, 4096
s_add_u32 s42, s67, 4096
buffer_load_dwordx4 v[28:31], v2, s[16:19], s40 offen
buffer_load_dwordx4 v[32:35], v2, s[4:7], s41 offen sc1
buffer_load_dwordx4 v[36:39], v2, s[4:7], s42 offen sc1
s_add_u32 s40, s65, 8192
s_add_u32 s41, s66, 8192
s_add_u32 s42, s67, 8192
buffer_load_dwordx4 v[40:43], v2, s[16:19], s40 offen
buffer_load_dwordx4 v[44:47], v2, s[4:7], s41 offen sc1
buffer_load_dwordx4 v[48:51], v2, s[4:7], s42 offen sc1
s_add_u32 s40, s65, 12288
s_add_u32 s41, s66, 12288
s_add_u32 s42, s67, 12288
buffer_load_dwordx4 v[52:55], v2, s[16:19], s40 offen
buffer_load_dwordx4 v[56:59], v2, s[4:7], s41 offen sc1
buffer_load_dwordx4 v[60:63], v2, s[4:7], s42 offen sc1
s_add_u32 s40, s65, 16384
s_add_u32 s41, s66, 16384
s_add_u32 s42, s67, 16384
buffer_load_dwordx4 v[64:67], v2, s[16:19], s40 offen
buffer_load_dwordx4 v[68:71], v2, s[4:7], s41 offen sc1
buffer_load_dwordx4 v[72:75], v2, s[4:7], s42 offen sc1
s_waitcnt vmcnt(0)
v_lshlrev_b32 v80, 16, v20
v_and_b32 v81, 0xffff0000, v20
v_lshlrev_b32 v82, 16, v24
v_and_b32 v83, 0xffff0000, v24
v_mul_f32 v80, v80, v82
v_mul_f32 v81, v81, v83
v_cvt_pk_bf16_f32 v80, v80, v81
v_lshlrev_b32 v82, 16, v80
v_and_b32 v83, 0xffff0000, v80
v_lshlrev_b32 v80, 16, v16
v_and_b32 v81, 0xffff0000, v16
v_add_f32 v80, v80, v82
v_add_f32 v81, v81, v83
v_cvt_pk_bf16_f32 v16, v80, v81
v_lshlrev_b32 v80, 16, v21
v_and_b32 v81, 0xffff0000, v21
v_lshlrev_b32 v82, 16, v25
v_and_b32 v83, 0xffff0000, v25
v_mul_f32 v80, v80, v82
v_mul_f32 v81, v81, v83
v_cvt_pk_bf16_f32 v80, v80, v81
v_lshlrev_b32 v82, 16, v80
v_and_b32 v83, 0xffff0000, v80
v_lshlrev_b32 v80, 16, v17
v_and_b32 v81, 0xffff0000, v17
v_add_f32 v80, v80, v82
v_add_f32 v81, v81, v83
v_cvt_pk_bf16_f32 v17, v80, v81
v_lshlrev_b32 v80, 16, v22
v_and_b32 v81, 0xffff0000, v22
v_lshlrev_b32 v82, 16, v26
v_and_b32 v83, 0xffff0000, v26
v_mul_f32 v80, v80, v82
v_mul_f32 v81, v81, v83
v_cvt_pk_bf16_f32 v80, v80, v81
v_lshlrev_b32 v82, 16, v80
v_and_b32 v83, 0xffff0000, v80
v_lshlrev_b32 v80, 16, v18
v_and_b32 v81, 0xffff0000, v18
v_add_f32 v80, v80, v82
v_add_f32 v81, v81, v83
v_cvt_pk_bf16_f32 v18, v80, v81
v_lshlrev_b32 v80, 16, v23
v_and_b32 v81, 0xffff0000, v23
v_lshlrev_b32 v82, 16, v27
v_and_b32 v83, 0xffff0000, v27
v_mul_f32 v80, v80, v82
v_mul_f32 v81, v81, v83
v_cvt_pk_bf16_f32 v80, v80, v81
v_lshlrev_b32 v82, 16, v80
v_and_b32 v83, 0xffff0000, v80
v_lshlrev_b32 v80, 16, v19
v_and_b32 v81, 0xffff0000, v19
v_add_f32 v80, v80, v82
v_add_f32 v81, v81, v83
v_cvt_pk_bf16_f32 v19, v80, v81
s_add_u32 s40, s65, 0
buffer_store_dwordx4 v[16:19], v2, s[20:23], s40 offen
v_lshlrev_b32 v80, 16, v32
v_and_b32 v81, 0xffff0000, v32
v_lshlrev_b32 v82, 16, v36
v_and_b32 v83, 0xffff0000, v36
v_mul_f32 v80, v80, v82
v_mul_f32 v81, v81, v83
v_cvt_pk_bf16_f32 v80, v80, v81
v_lshlrev_b32 v82, 16, v80
v_and_b32 v83, 0xffff0000, v80
v_lshlrev_b32 v80, 16, v28
v_and_b32 v81, 0xffff0000, v28
v_add_f32 v80, v80, v82
v_add_f32 v81, v81, v83
v_cvt_pk_bf16_f32 v28, v80, v81
v_lshlrev_b32 v80, 16, v33
v_and_b32 v81, 0xffff0000, v33
v_lshlrev_b32 v82, 16, v37
v_and_b32 v83, 0xffff0000, v37
v_mul_f32 v80, v80, v82
v_mul_f32 v81, v81, v83
v_cvt_pk_bf16_f32 v80, v80, v81
v_lshlrev_b32 v82, 16, v80
v_and_b32 v83, 0xffff0000, v80
v_lshlrev_b32 v80, 16, v29
v_and_b32 v81, 0xffff0000, v29
v_add_f32 v80, v80, v82
v_add_f32 v81, v81, v83
v_cvt_pk_bf16_f32 v29, v80, v81
v_lshlrev_b32 v80, 16, v34
v_and_b32 v81, 0xffff0000, v34
v_lshlrev_b32 v82, 16, v38
v_and_b32 v83, 0xffff0000, v38
v_mul_f32 v80, v80, v82
v_mul_f32 v81, v81, v83
v_cvt_pk_bf16_f32 v80, v80, v81
v_lshlrev_b32 v82, 16, v80
v_and_b32 v83, 0xffff0000, v80
v_lshlrev_b32 v80, 16, v30
v_and_b32 v81, 0xffff0000, v30
v_add_f32 v80, v80, v82
v_add_f32 v81, v81, v83
v_cvt_pk_bf16_f32 v30, v80, v81
v_lshlrev_b32 v80, 16, v35
v_and_b32 v81, 0xffff0000, v35
v_lshlrev_b32 v82, 16, v39
v_and_b32 v83, 0xffff0000, v39
v_mul_f32 v80, v80, v82
v_mul_f32 v81, v81, v83
v_cvt_pk_bf16_f32 v80, v80, v81
v_lshlrev_b32 v82, 16, v80
v_and_b32 v83, 0xffff0000, v80
v_lshlrev_b32 v80, 16, v31
v_and_b32 v81, 0xffff0000, v31
v_add_f32 v80, v80, v82
v_add_f32 v81, v81, v83
v_cvt_pk_bf16_f32 v31, v80, v81
s_add_u32 s40, s65, 4096
buffer_store_dwordx4 v[28:31], v2, s[20:23], s40 offen
v_lshlrev_b32 v80, 16, v44
v_and_b32 v81, 0xffff0000, v44
v_lshlrev_b32 v82, 16, v48
v_and_b32 v83, 0xffff0000, v48
v_mul_f32 v80, v80, v82
v_mul_f32 v81, v81, v83
v_cvt_pk_bf16_f32 v80, v80, v81
v_lshlrev_b32 v82, 16, v80
v_and_b32 v83, 0xffff0000, v80
v_lshlrev_b32 v80, 16, v40
v_and_b32 v81, 0xffff0000, v40
v_add_f32 v80, v80, v82
v_add_f32 v81, v81, v83
v_cvt_pk_bf16_f32 v40, v80, v81
v_lshlrev_b32 v80, 16, v45
v_and_b32 v81, 0xffff0000, v45
v_lshlrev_b32 v82, 16, v49
v_and_b32 v83, 0xffff0000, v49
v_mul_f32 v80, v80, v82
v_mul_f32 v81, v81, v83
v_cvt_pk_bf16_f32 v80, v80, v81
v_lshlrev_b32 v82, 16, v80
v_and_b32 v83, 0xffff0000, v80
v_lshlrev_b32 v80, 16, v41
v_and_b32 v81, 0xffff0000, v41
v_add_f32 v80, v80, v82
v_add_f32 v81, v81, v83
v_cvt_pk_bf16_f32 v41, v80, v81
v_lshlrev_b32 v80, 16, v46
v_and_b32 v81, 0xffff0000, v46
v_lshlrev_b32 v82, 16, v50
v_and_b32 v83, 0xffff0000, v50
v_mul_f32 v80, v80, v82
v_mul_f32 v81, v81, v83
v_cvt_pk_bf16_f32 v80, v80, v81
v_lshlrev_b32 v82, 16, v80
v_and_b32 v83, 0xffff0000, v80
v_lshlrev_b32 v80, 16, v42
v_and_b32 v81, 0xffff0000, v42
v_add_f32 v80, v80, v82
v_add_f32 v81, v81, v83
v_cvt_pk_bf16_f32 v42, v80, v81
v_lshlrev_b32 v80, 16, v47
v_and_b32 v81, 0xffff0000, v47
v_lshlrev_b32 v82, 16, v51
v_and_b32 v83, 0xffff0000, v51
v_mul_f32 v80, v80, v82
v_mul_f32 v81, v81, v83
v_cvt_pk_bf16_f32 v80, v80, v81
v_lshlrev_b32 v82, 16, v80
v_and_b32 v83, 0xffff0000, v80
v_lshlrev_b32 v80, 16, v43
v_and_b32 v81, 0xffff0000, v43
v_add_f32 v80, v80, v82
v_add_f32 v81, v81, v83
v_cvt_pk_bf16_f32 v43, v80, v81
s_add_u32 s40, s65, 8192
buffer_store_dwordx4 v[40:43], v2, s[20:23], s40 offen
v_lshlrev_b32 v80, 16, v56
v_and_b32 v81, 0xffff0000, v56
v_lshlrev_b32 v82, 16, v60
v_and_b32 v83, 0xffff0000, v60
v_mul_f32 v80, v80, v82
v_mul_f32 v81, v81, v83
v_cvt_pk_bf16_f32 v80, v80, v81
v_lshlrev_b32 v82, 16, v80
v_and_b32 v83, 0xffff0000, v80
v_lshlrev_b32 v80, 16, v52
v_and_b32 v81, 0xffff0000, v52
v_add_f32 v80, v80, v82
v_add_f32 v81, v81, v83
v_cvt_pk_bf16_f32 v52, v80, v81
v_lshlrev_b32 v80, 16, v57
v_and_b32 v81, 0xffff0000, v57
v_lshlrev_b32 v82, 16, v61
v_and_b32 v83, 0xffff0000, v61
v_mul_f32 v80, v80, v82
v_mul_f32 v81, v81, v83
v_cvt_pk_bf16_f32 v80, v80, v81
v_lshlrev_b32 v82, 16, v80
v_and_b32 v83, 0xffff0000, v80
v_lshlrev_b32 v80, 16, v53
v_and_b32 v81, 0xffff0000, v53
v_add_f32 v80, v80, v82
v_add_f32 v81, v81, v83
v_cvt_pk_bf16_f32 v53, v80, v81
v_lshlrev_b32 v80, 16, v58
v_and_b32 v81, 0xffff0000, v58
v_lshlrev_b32 v82, 16, v62
v_and_b32 v83, 0xffff0000, v62
v_mul_f32 v80, v80, v82
v_mul_f32 v81, v81, v83
v_cvt_pk_bf16_f32 v80, v80, v81
v_lshlrev_b32 v82, 16, v80
v_and_b32 v83, 0xffff0000, v80
v_lshlrev_b32 v80, 16, v54
v_and_b32 v81, 0xffff0000, v54
v_add_f32 v80, v80, v82
v_add_f32 v81, v81, v83
v_cvt_pk_bf16_f32 v54, v80, v81
v_lshlrev_b32 v80, 16, v59
v_and_b32 v81, 0xffff0000, v59
v_lshlrev_b32 v82, 16, v63
v_and_b32 v83, 0xffff0000, v63
v_mul_f32 v80, v80, v82
v_mul_f32 v81, v81, v83
v_cvt_pk_bf16_f32 v80, v80, v81
v_lshlrev_b32 v82, 16, v80
v_and_b32 v83, 0xffff0000, v80
v_lshlrev_b32 v80, 16, v55
v_and_b32 v81, 0xffff0000, v55
v_add_f32 v80, v80, v82
v_add_f32 v81, v81, v83
v_cvt_pk_bf16_f32 v55, v80, v81
s_add_u32 s40, s65, 12288
buffer_store_dwordx4 v[52:55], v2, s[20:23], s40 offen
v_lshlrev_b32 v80, 16, v68
v_and_b32 v81, 0xffff0000, v68
v_lshlrev_b32 v82, 16, v72
v_and_b32 v83, 0xffff0000, v72
v_mul_f32 v80, v80, v82
v_mul_f32 v81, v81, v83
v_cvt_pk_bf16_f32 v80, v80, v81
v_lshlrev_b32 v82, 16, v80
v_and_b32 v83, 0xffff0000, v80
v_lshlrev_b32 v80, 16, v64
v_and_b32 v81, 0xffff0000, v64
v_add_f32 v80, v80, v82
v_add_f32 v81, v81, v83
v_cvt_pk_bf16_f32 v64, v80, v81
v_lshlrev_b32 v80, 16, v69
v_and_b32 v81, 0xffff0000, v69
v_lshlrev_b32 v82, 16, v73
v_and_b32 v83, 0xffff0000, v73
v_mul_f32 v80, v80, v82
v_mul_f32 v81, v81, v83
v_cvt_pk_bf16_f32 v80, v80, v81
v_lshlrev_b32 v82, 16, v80
v_and_b32 v83, 0xffff0000, v80
v_lshlrev_b32 v80, 16, v65
v_and_b32 v81, 0xffff0000, v65
v_add_f32 v80, v80, v82
v_add_f32 v81, v81, v83
v_cvt_pk_bf16_f32 v65, v80, v81
v_lshlrev_b32 v80, 16, v70
v_and_b32 v81, 0xffff0000, v70
v_lshlrev_b32 v82, 16, v74
v_and_b32 v83, 0xffff0000, v74
v_mul_f32 v80, v80, v82
v_mul_f32 v81, v81, v83
v_cvt_pk_bf16_f32 v80, v80, v81
v_lshlrev_b32 v82, 16, v80
v_and_b32 v83, 0xffff0000, v80
v_lshlrev_b32 v80, 16, v66
v_and_b32 v81, 0xffff0000, v66
v_add_f32 v80, v80, v82
v_add_f32 v81, v81, v83
v_cvt_pk_bf16_f32 v66, v80, v81
v_lshlrev_b32 v80, 16, v71
v_and_b32 v81, 0xffff0000, v71
v_lshlrev_b32 v82, 16, v75
v_and_b32 v83, 0xffff0000, v75
v_mul_f32 v80, v80, v82
v_mul_f32 v81, v81, v83
v_cvt_pk_bf16_f32 v80, v80, v81
v_lshlrev_b32 v82, 16, v80
v_and_b32 v83, 0xffff0000, v80
v_lshlrev_b32 v80, 16, v67
v_and_b32 v81, 0xffff0000, v67
v_add_f32 v80, v80, v82
v_add_f32 v81, v81, v83
v_cvt_pk_bf16_f32 v67, v80, v81
s_add_u32 s40, s65, 16384
buffer_store_dwordx4 v[64:67], v2, s[20:23], s40 offen
s_add_u32 s40, s65, 20480
s_add_u32 s41, s66, 20480
s_add_u32 s42, s67, 20480
buffer_load_dwordx4 v[16:19], v2, s[16:19], s40 offen
buffer_load_dwordx4 v[20:23], v2, s[4:7], s41 offen sc1
buffer_load_dwordx4 v[24:27], v2, s[4:7], s42 offen sc1
s_add_u32 s40, s65, 24576
s_add_u32 s41, s66, 24576
s_add_u32 s42, s67, 24576
buffer_load_dwordx4 v[28:31], v2, s[16:19], s40 offen
buffer_load_dwordx4 v[32:35], v2, s[4:7], s41 offen sc1
buffer_load_dwordx4 v[36:39], v2, s[4:7], s42 offen sc1
s_add_u32 s40, s65, 28672
s_add_u32 s41, s66, 28672
s_add_u32 s42, s67, 28672
buffer_load_dwordx4 v[40:43], v2, s[16:19], s40 offen
buffer_load_dwordx4 v[44:47], v2, s[4:7], s41 offen sc1
buffer_load_dwordx4 v[48:51], v2, s[4:7], s42 offen sc1
s_add_u32 s40, s65, 32768
s_add_u32 s41, s66, 32768
s_add_u32 s42, s67, 32768
buffer_load_dwordx4 v[52:55], v2, s[16:19], s40 offen
buffer_load_dwordx4 v[56:59], v2, s[4:7], s41 offen sc1
buffer_load_dwordx4 v[60:63], v2, s[4:7], s42 offen sc1
s_add_u32 s40, s65, 36864
s_add_u32 s41, s66, 36864
s_add_u32 s42, s67, 36864
buffer_load_dwordx4 v[64:67], v2, s[16:19], s40 offen
buffer_load_dwordx4 v[68:71], v2, s[4:7], s41 offen sc1
buffer_load_dwordx4 v[72:75], v2, s[4:7], s42 offen sc1
s_waitcnt vmcnt(0)
v_lshlrev_b32 v80, 16, v20
v_and_b32 v81, 0xffff0000, v20
v_lshlrev_b32 v82, 16, v24
v_and_b32 v83, 0xffff0000, v24
v_mul_f32 v80, v80, v82
v_mul_f32 v81, v81, v83
v_cvt_pk_bf16_f32 v80, v80, v81
v_lshlrev_b32 v82, 16, v80
v_and_b32 v83, 0xffff0000, v80
v_lshlrev_b32 v80, 16, v16
v_and_b32 v81, 0xffff0000, v16
v_add_f32 v80, v80, v82
v_add_f32 v81, v81, v83
v_cvt_pk_bf16_f32 v16, v80, v81
v_lshlrev_b32 v80, 16, v21
v_and_b32 v81, 0xffff0000, v21
v_lshlrev_b32 v82, 16, v25
v_and_b32 v83, 0xffff0000, v25
v_mul_f32 v80, v80, v82
v_mul_f32 v81, v81, v83
v_cvt_pk_bf16_f32 v80, v80, v81
v_lshlrev_b32 v82, 16, v80
v_and_b32 v83, 0xffff0000, v80
v_lshlrev_b32 v80, 16, v17
v_and_b32 v81, 0xffff0000, v17
v_add_f32 v80, v80, v82
v_add_f32 v81, v81, v83
v_cvt_pk_bf16_f32 v17, v80, v81
v_lshlrev_b32 v80, 16, v22
v_and_b32 v81, 0xffff0000, v22
v_lshlrev_b32 v82, 16, v26
v_and_b32 v83, 0xffff0000, v26
v_mul_f32 v80, v80, v82
v_mul_f32 v81, v81, v83
v_cvt_pk_bf16_f32 v80, v80, v81
v_lshlrev_b32 v82, 16, v80
v_and_b32 v83, 0xffff0000, v80
v_lshlrev_b32 v80, 16, v18
v_and_b32 v81, 0xffff0000, v18
v_add_f32 v80, v80, v82
v_add_f32 v81, v81, v83
v_cvt_pk_bf16_f32 v18, v80, v81
v_lshlrev_b32 v80, 16, v23
v_and_b32 v81, 0xffff0000, v23
v_lshlrev_b32 v82, 16, v27
v_and_b32 v83, 0xffff0000, v27
v_mul_f32 v80, v80, v82
v_mul_f32 v81, v81, v83
v_cvt_pk_bf16_f32 v80, v80, v81
v_lshlrev_b32 v82, 16, v80
v_and_b32 v83, 0xffff0000, v80
v_lshlrev_b32 v80, 16, v19
v_and_b32 v81, 0xffff0000, v19
v_add_f32 v80, v80, v82
v_add_f32 v81, v81, v83
v_cvt_pk_bf16_f32 v19, v80, v81
s_add_u32 s40, s65, 20480
buffer_store_dwordx4 v[16:19], v2, s[20:23], s40 offen
v_lshlrev_b32 v80, 16, v32
v_and_b32 v81, 0xffff0000, v32
v_lshlrev_b32 v82, 16, v36
v_and_b32 v83, 0xffff0000, v36
v_mul_f32 v80, v80, v82
v_mul_f32 v81, v81, v83
v_cvt_pk_bf16_f32 v80, v80, v81
v_lshlrev_b32 v82, 16, v80
v_and_b32 v83, 0xffff0000, v80
v_lshlrev_b32 v80, 16, v28
v_and_b32 v81, 0xffff0000, v28
v_add_f32 v80, v80, v82
v_add_f32 v81, v81, v83
v_cvt_pk_bf16_f32 v28, v80, v81
v_lshlrev_b32 v80, 16, v33
v_and_b32 v81, 0xffff0000, v33
v_lshlrev_b32 v82, 16, v37
v_and_b32 v83, 0xffff0000, v37
v_mul_f32 v80, v80, v82
v_mul_f32 v81, v81, v83
v_cvt_pk_bf16_f32 v80, v80, v81
v_lshlrev_b32 v82, 16, v80
v_and_b32 v83, 0xffff0000, v80
v_lshlrev_b32 v80, 16, v29
v_and_b32 v81, 0xffff0000, v29
v_add_f32 v80, v80, v82
v_add_f32 v81, v81, v83
v_cvt_pk_bf16_f32 v29, v80, v81
v_lshlrev_b32 v80, 16, v34
v_and_b32 v81, 0xffff0000, v34
v_lshlrev_b32 v82, 16, v38
v_and_b32 v83, 0xffff0000, v38
v_mul_f32 v80, v80, v82
v_mul_f32 v81, v81, v83
v_cvt_pk_bf16_f32 v80, v80, v81
v_lshlrev_b32 v82, 16, v80
v_and_b32 v83, 0xffff0000, v80
v_lshlrev_b32 v80, 16, v30
v_and_b32 v81, 0xffff0000, v30
v_add_f32 v80, v80, v82
v_add_f32 v81, v81, v83
v_cvt_pk_bf16_f32 v30, v80, v81
v_lshlrev_b32 v80, 16, v35
v_and_b32 v81, 0xffff0000, v35
v_lshlrev_b32 v82, 16, v39
v_and_b32 v83, 0xffff0000, v39
v_mul_f32 v80, v80, v82
v_mul_f32 v81, v81, v83
v_cvt_pk_bf16_f32 v80, v80, v81
v_lshlrev_b32 v82, 16, v80
v_and_b32 v83, 0xffff0000, v80
v_lshlrev_b32 v80, 16, v31
v_and_b32 v81, 0xffff0000, v31
v_add_f32 v80, v80, v82
v_add_f32 v81, v81, v83
v_cvt_pk_bf16_f32 v31, v80, v81
s_add_u32 s40, s65, 24576
buffer_store_dwordx4 v[28:31], v2, s[20:23], s40 offen
v_lshlrev_b32 v80, 16, v44
v_and_b32 v81, 0xffff0000, v44
v_lshlrev_b32 v82, 16, v48
v_and_b32 v83, 0xffff0000, v48
v_mul_f32 v80, v80, v82
v_mul_f32 v81, v81, v83
v_cvt_pk_bf16_f32 v80, v80, v81
v_lshlrev_b32 v82, 16, v80
v_and_b32 v83, 0xffff0000, v80
v_lshlrev_b32 v80, 16, v40
v_and_b32 v81, 0xffff0000, v40
v_add_f32 v80, v80, v82
v_add_f32 v81, v81, v83
v_cvt_pk_bf16_f32 v40, v80, v81
v_lshlrev_b32 v80, 16, v45
v_and_b32 v81, 0xffff0000, v45
v_lshlrev_b32 v82, 16, v49
v_and_b32 v83, 0xffff0000, v49
v_mul_f32 v80, v80, v82
v_mul_f32 v81, v81, v83
v_cvt_pk_bf16_f32 v80, v80, v81
v_lshlrev_b32 v82, 16, v80
v_and_b32 v83, 0xffff0000, v80
v_lshlrev_b32 v80, 16, v41
v_and_b32 v81, 0xffff0000, v41
v_add_f32 v80, v80, v82
v_add_f32 v81, v81, v83
v_cvt_pk_bf16_f32 v41, v80, v81
v_lshlrev_b32 v80, 16, v46
v_and_b32 v81, 0xffff0000, v46
v_lshlrev_b32 v82, 16, v50
v_and_b32 v83, 0xffff0000, v50
v_mul_f32 v80, v80, v82
v_mul_f32 v81, v81, v83
v_cvt_pk_bf16_f32 v80, v80, v81
v_lshlrev_b32 v82, 16, v80
v_and_b32 v83, 0xffff0000, v80
v_lshlrev_b32 v80, 16, v42
v_and_b32 v81, 0xffff0000, v42
v_add_f32 v80, v80, v82
v_add_f32 v81, v81, v83
v_cvt_pk_bf16_f32 v42, v80, v81
v_lshlrev_b32 v80, 16, v47
v_and_b32 v81, 0xffff0000, v47
v_lshlrev_b32 v82, 16, v51
v_and_b32 v83, 0xffff0000, v51
v_mul_f32 v80, v80, v82
v_mul_f32 v81, v81, v83
v_cvt_pk_bf16_f32 v80, v80, v81
v_lshlrev_b32 v82, 16, v80
v_and_b32 v83, 0xffff0000, v80
v_lshlrev_b32 v80, 16, v43
v_and_b32 v81, 0xffff0000, v43
v_add_f32 v80, v80, v82
v_add_f32 v81, v81, v83
v_cvt_pk_bf16_f32 v43, v80, v81
s_add_u32 s40, s65, 28672
buffer_store_dwordx4 v[40:43], v2, s[20:23], s40 offen
v_lshlrev_b32 v80, 16, v56
v_and_b32 v81, 0xffff0000, v56
v_lshlrev_b32 v82, 16, v60
v_and_b32 v83, 0xffff0000, v60
v_mul_f32 v80, v80, v82
v_mul_f32 v81, v81, v83
v_cvt_pk_bf16_f32 v80, v80, v81
v_lshlrev_b32 v82, 16, v80
v_and_b32 v83, 0xffff0000, v80
v_lshlrev_b32 v80, 16, v52
v_and_b32 v81, 0xffff0000, v52
v_add_f32 v80, v80, v82
v_add_f32 v81, v81, v83
v_cvt_pk_bf16_f32 v52, v80, v81
v_lshlrev_b32 v80, 16, v57
v_and_b32 v81, 0xffff0000, v57
v_lshlrev_b32 v82, 16, v61
v_and_b32 v83, 0xffff0000, v61
v_mul_f32 v80, v80, v82
v_mul_f32 v81, v81, v83
v_cvt_pk_bf16_f32 v80, v80, v81
v_lshlrev_b32 v82, 16, v80
v_and_b32 v83, 0xffff0000, v80
v_lshlrev_b32 v80, 16, v53
v_and_b32 v81, 0xffff0000, v53
v_add_f32 v80, v80, v82
v_add_f32 v81, v81, v83
v_cvt_pk_bf16_f32 v53, v80, v81
v_lshlrev_b32 v80, 16, v58
v_and_b32 v81, 0xffff0000, v58
v_lshlrev_b32 v82, 16, v62
v_and_b32 v83, 0xffff0000, v62
v_mul_f32 v80, v80, v82
v_mul_f32 v81, v81, v83
v_cvt_pk_bf16_f32 v80, v80, v81
v_lshlrev_b32 v82, 16, v80
v_and_b32 v83, 0xffff0000, v80
v_lshlrev_b32 v80, 16, v54
v_and_b32 v81, 0xffff0000, v54
v_add_f32 v80, v80, v82
v_add_f32 v81, v81, v83
v_cvt_pk_bf16_f32 v54, v80, v81
v_lshlrev_b32 v80, 16, v59
v_and_b32 v81, 0xffff0000, v59
v_lshlrev_b32 v82, 16, v63
v_and_b32 v83, 0xffff0000, v63
v_mul_f32 v80, v80, v82
v_mul_f32 v81, v81, v83
v_cvt_pk_bf16_f32 v80, v80, v81
v_lshlrev_b32 v82, 16, v80
v_and_b32 v83, 0xffff0000, v80
v_lshlrev_b32 v80, 16, v55
v_and_b32 v81, 0xffff0000, v55
v_add_f32 v80, v80, v82
v_add_f32 v81, v81, v83
v_cvt_pk_bf16_f32 v55, v80, v81
s_add_u32 s40, s65, 32768
buffer_store_dwordx4 v[52:55], v2, s[20:23], s40 offen
v_lshlrev_b32 v80, 16, v68
v_and_b32 v81, 0xffff0000, v68
v_lshlrev_b32 v82, 16, v72
v_and_b32 v83, 0xffff0000, v72
v_mul_f32 v80, v80, v82
v_mul_f32 v81, v81, v83
v_cvt_pk_bf16_f32 v80, v80, v81
v_lshlrev_b32 v82, 16, v80
v_and_b32 v83, 0xffff0000, v80
v_lshlrev_b32 v80, 16, v64
v_and_b32 v81, 0xffff0000, v64
v_add_f32 v80, v80, v82
v_add_f32 v81, v81, v83
v_cvt_pk_bf16_f32 v64, v80, v81
v_lshlrev_b32 v80, 16, v69
v_and_b32 v81, 0xffff0000, v69
v_lshlrev_b32 v82, 16, v73
v_and_b32 v83, 0xffff0000, v73
v_mul_f32 v80, v80, v82
v_mul_f32 v81, v81, v83
v_cvt_pk_bf16_f32 v80, v80, v81
v_lshlrev_b32 v82, 16, v80
v_and_b32 v83, 0xffff0000, v80
v_lshlrev_b32 v80, 16, v65
v_and_b32 v81, 0xffff0000, v65
v_add_f32 v80, v80, v82
v_add_f32 v81, v81, v83
v_cvt_pk_bf16_f32 v65, v80, v81
v_lshlrev_b32 v80, 16, v70
v_and_b32 v81, 0xffff0000, v70
v_lshlrev_b32 v82, 16, v74
v_and_b32 v83, 0xffff0000, v74
v_mul_f32 v80, v80, v82
v_mul_f32 v81, v81, v83
v_cvt_pk_bf16_f32 v80, v80, v81
v_lshlrev_b32 v82, 16, v80
v_and_b32 v83, 0xffff0000, v80
v_lshlrev_b32 v80, 16, v66
v_and_b32 v81, 0xffff0000, v66
v_add_f32 v80, v80, v82
v_add_f32 v81, v81, v83
v_cvt_pk_bf16_f32 v66, v80, v81
v_lshlrev_b32 v80, 16, v71
v_and_b32 v81, 0xffff0000, v71
v_lshlrev_b32 v82, 16, v75
v_and_b32 v83, 0xffff0000, v75
v_mul_f32 v80, v80, v82
v_mul_f32 v81, v81, v83
v_cvt_pk_bf16_f32 v80, v80, v81
v_lshlrev_b32 v82, 16, v80
v_and_b32 v83, 0xffff0000, v80
v_lshlrev_b32 v80, 16, v67
v_and_b32 v81, 0xffff0000, v67
v_add_f32 v80, v80, v82
v_add_f32 v81, v81, v83
v_cvt_pk_bf16_f32 v67, v80, v81
s_add_u32 s40, s65, 36864
buffer_store_dwordx4 v[64:67], v2, s[20:23], s40 offen
s_waitcnt vmcnt(0)
s_mov_b32 s66, 0
s_branch wk_sig
timeout:
v_mov_b32 v2, 252
v_mov_b32 v3, 0xdead
s_mov_b64 exec, 1
global_store_dword v2, v3, s[86:87]
done:
s_endpgm
.section .rodata,"a"
.p2align 6
.amdhsa_kernel recurrent_scan__memory_aug_recurrent_mem_tr__glu_gated_glu__prompt_kernel
  .amdhsa_next_free_vgpr 512
  .amdhsa_next_free_sgpr 102
  .amdhsa_accum_offset 256
  .amdhsa_group_segment_fixed_size 0
  .amdhsa_kernarg_size 112
  .amdhsa_user_sgpr_count 2
  .amdhsa_user_sgpr_kernarg_segment_ptr 1
  .amdhsa_system_sgpr_workgroup_id_x 1
.end_amdhsa_kernel
```
